```python
import torch

def _softmax(x, axis=-1):
    return torch.softmax(x, dim=axis)
def _gelu(x):
    return torch.nn.functional.gelu(x, approximate="tanh")
def _silu(x):
    return torch.nn.functional.silu(x)
def _sigmoid(x):
    return torch.sigmoid(x)
def _layernorm(x, axis=-1, eps=1e-5):
    m = x.mean(dim=axis, keepdim=True)
    v = x.var(dim=axis, keepdim=True, unbiased=False)
    return (x - m) / torch.sqrt(v + eps)
def _scatter_add(tgt, idx, src, axis=0):
    return tgt.clone().index_add_(axis, idx, src)
def _segment_sum(src, seg, n):
    out = torch.zeros((n,) + src.shape[1:], dtype=src.dtype)
    return out.index_add_(0, seg, src)
def _pad(x, pw):
    flat = tuple(v for pair in reversed(pw) for v in pair)
    return torch.nn.functional.pad(x, flat)

kernel_name = 'gated_mix__linear_kernel_hedgehog__compressed_kv_cla__prompt'

def setup_inputs():

    _w = (lambda a: (lambda t: t.to(torch.bfloat16) if t.is_floating_point() else t)(torch.as_tensor(a)))
    def _A_setup():
        B, S, D, H = 1, 2048, 1024, 32
        Dh = D // H
        return {
            "x": _w((lambda *s: torch.randn(*s, dtype=torch.bfloat16) * 0.05)(B, S, D)),
            "wqkv": _w((lambda *s: torch.randn(*s, dtype=torch.bfloat16) * 1.6)(D, 3 * D)),
            "w_phi": _w((lambda *s: torch.randn(*s, dtype=torch.bfloat16) * 1.6)(H, Dh, Dh) * (Dh ** -0.5)),
            "wo": _w((lambda *s: torch.randn(*s, dtype=torch.bfloat16) * 0.05)(D, D)),
        }
    _A_in = _A_setup()

    def _B_setup():
        B, H, Sq, Sk, D, M = 1, 32, 2048, 2048, 128, 1024
        Dc = 4 * D
        return {
            "x": _w((lambda *s: torch.randn(*s, dtype=torch.bfloat16) * 0.05)(B, Sq, M)),
            "c_kv": _w((lambda *s: torch.randn(*s, dtype=torch.bfloat16) * 0.8)(B, Sk, Dc)),
            "w_q": _w((lambda *s: torch.randn(*s, dtype=torch.bfloat16) * 6.4)(M, H, D) * (M ** -0.5)),
            "w_uk": _w((lambda *s: torch.randn(*s, dtype=torch.bfloat16) * 6.4)(Dc, H, D) * (Dc ** -0.5)),
            "w_uv": _w((lambda *s: torch.randn(*s, dtype=torch.bfloat16) * 0.8)(Dc, H, D) * (Dc ** -0.5)),
            "w_o": _w((lambda *s: torch.randn(*s, dtype=torch.bfloat16) * 0.8)(H, D, M) * ((H * D) ** -0.5)),
        }
    _B_in = _B_setup()

    return {
        "A_x": _A_in["x"],
        "A_wqkv": _A_in["wqkv"],
        "A_w_phi": _A_in["w_phi"],
        "A_wo": _A_in["wo"],
        "B_x": _B_in["x"],
        "B_c_kv": _B_in["c_kv"],
        "B_w_q": _B_in["w_q"],
        "B_w_uk": _B_in["w_uk"],
        "B_w_uv": _B_in["w_uv"],
        "B_w_o": _B_in["w_o"],
        "gate_w": _w((lambda *s: torch.randn(*s, dtype=torch.bfloat16) * 0.05)(1024) * 16.0),
    }

def reference(A_x, A_wqkv, A_w_phi, A_wo, B_x, B_c_kv, B_w_q, B_w_uk, B_w_uv, B_w_o, gate_w):
    def _A_ref(x, wqkv, w_phi, wo):
        B, S, D = x.shape
        H = 32; Dh = D // H
        qkv = (lambda x, *d: x.permute(*d))((x @ wqkv).reshape(B, S, 3, H, Dh), 2, 0, 3, 1, 4)
        q, k, v = qkv[0], qkv[1], qkv[2]
        pq = torch.einsum("bhsd,hdf->bhsf", q, w_phi)
        pk = torch.einsum("bhsd,hdf->bhsf", k, w_phi)
        phi_q = torch.concatenate([_softmax(pq, axis=-1), _softmax(-pq, axis=-1)], axis=-1)
        phi_k = torch.concatenate([_softmax(pk, axis=-1), _softmax(-pk, axis=-1)], axis=-1)
        kv = torch.einsum("bhsf,bhsd->bhfd", phi_k, v)
        z  = torch.einsum("bhsf->bhf", phi_k)
        num = torch.einsum("bhqf,bhfd->bhqd", phi_q, kv)
        den = torch.einsum("bhqf,bhf->bhq", phi_q, z)[..., None] + 1e-6
        o = num / den
        return (lambda x, *d: x.permute(*d))(o, 0, 2, 1, 3).reshape(B, S, D) @ wo

    def _B_ref(x, c_kv, w_q, w_uk, w_uv, w_o):
        B, Sq, M = x.shape[0], x.shape[1], x.shape[2]
        Sk = c_kv.shape[1]
        H, D = w_q.shape[1], w_q.shape[2]
        q = torch.einsum("bqm,mhd->bhqd", x, w_q)
        k = torch.einsum("bkc,chd->bhkd", c_kv, w_uk)
        v = torch.einsum("bkc,chd->bhkd", c_kv, w_uv)
        scores = torch.einsum("bhqd,bhkd->bhqk", q, k) * (D ** -0.5)
        off = Sk - Sq
        qi = torch.arange(Sq)[:, None]
        kj = torch.arange(Sk)[None, :]
        cmask = kj <= (qi + off)
        scores = torch.where(cmask[None, None], scores, -1e9)
        p = _softmax(scores, axis=-1)
        ctx = torch.einsum("bhqk,bhkd->bhqd", p, v)
        return torch.einsum("bhqd,hdm->bqm", ctx, w_o)

    x = A_x
    g = _sigmoid((x * gate_w).sum(-1, keepdims=True))
    a = _A_ref(x, A_wqkv, A_w_phi, A_wo)
    b = _B_ref(x, B_c_kv, B_w_q, B_w_uk, B_w_uv, B_w_o)
    return g * a + (1 - g) * b
```

```asm
; @launch grid=(256,1,1) block=(256,1,1) lds=163840
.amdgcn_target "amdgcn-amd-amdhsa--gfx950"
.text
.globl gated_mix__linear_kernel_hedgehog__compressed_kv_cla__prompt_kernel
.p2align 8
.type gated_mix__linear_kernel_hedgehog__compressed_kv_cla__prompt_kernel,@function
gated_mix__linear_kernel_hedgehog__compressed_kv_cla__prompt_kernel:
s_cmp_ge_u32 s2, 256
s_cbranch_scc1 L_end
s_load_dwordx8 s[52:59], s[0:1], 40
s_load_dwordx4 s[48:51], s[0:1], 0
s_load_dwordx4 s[64:67], s[0:1], 16
s_load_dwordx8 s[80:87], s[0:1], 72
s_load_dwordx2 s[62:63], s[0:1], 104
v_lshrrev_b32 v2, 6, v0
v_and_b32 v1, 63, v0
v_readfirstlane_b32 s3, v2
s_and_b32 s4, s2, 7
s_lshl_b32 s4, s4, 2
s_lshr_b32 s68, s2, 6
s_add_u32 s4, s4, s68
s_bfe_u32 s5, s2, 0x30003
v_lshrrev_b32 v2, 4, v1
v_and_b32 v3, 15, v1
s_lshl_b32 s68, s5, 7
s_lshl_b32 s69, s3, 5
s_add_u32 s68, s68, s69
s_lshl_b32 s69, s5, 8
s_sub_u32 s69, 1920, s69
v_and_b32 v7, 7, v1
v_xor_b32 v6, v7, v2
v_lshlrev_b32 v6, 4, v6
v_lshrrev_b32 v7, 3, v1
v_add_u32 v7, s68, v7
v_lshl_add_u32 v20, v7, 10, v6
v_xor_b32 v6, 64, v20
v_add_u32 v21, 7168, v6
s_lshl_b32 s73, s4, 8
v_lshlrev_b32 v6, 1, v2
v_xor_b32 v6, v3, v6
v_lshlrev_b32 v6, 4, v6
v_lshlrev_b32_e64 v7, 13, v2
v_add3_u32 v24, v6, v7, s73
v_add_u32 v25, 31744, v24
v_xor_b32 v6, 128, v24
v_add_u32 v26, 63488, v6
v_add_u32 v27, 95232, v6
s_lshl_b32 s32, s69, 10
s_add_u32 s33, s32, 14336
s_mov_b32 s34, 0
s_mov_b32 s35, 14336
s_and_b32 s36, s3, 1
s_lshl_b32 s36, s36, 18
s_add_u32 s37, s36, 131072
s_lshl_b32 s43, s3, 13
s_add_u32 s44, s43, 4096
s_lshl_b32 s45, s3, 12
s_mul_i32 s46, s3, 3072
s_add_u32 s46, s46, 16384
s_mov_b32 s39, 65536
s_mov_b32 s40, s43
s_waitcnt lgkmcnt(0)
s_mov_b32 s8, s52
s_and_b32 s9, s53, 0xffff
s_mov_b32 s10, 2097152
s_mov_b32 s11, 0x20000
s_cmp_lt_u32 s3, 2
s_cselect_b32 s76, s56, s58
s_cselect_b32 s77, s57, s59
s_mov_b32 s16, s76
s_and_b32 s17, s77, 0xffff
s_mov_b32 s18, 4194304
s_mov_b32 s19, 0x20000
s_add_u32 m0, s39, s43
s_nop 0
buffer_load_dwordx4 v24, s[16:19], s36 offen offset:0 lds
buffer_load_dwordx4 v25, s[16:19], s36 offen offset:1024 lds
buffer_load_dwordx4 v26, s[16:19], s36 offen offset:2048 lds
buffer_load_dwordx4 v27, s[16:19], s36 offen offset:3072 lds
s_add_u32 m0, s39, s44
s_nop 0
buffer_load_dwordx4 v24, s[16:19], s37 offen offset:0 lds
buffer_load_dwordx4 v25, s[16:19], s37 offen offset:1024 lds
buffer_load_dwordx4 v26, s[16:19], s37 offen offset:2048 lds
buffer_load_dwordx4 v27, s[16:19], s37 offen offset:3072 lds
s_add_u32 s36, s36, 524288
s_add_u32 s37, s37, 524288
s_add_u32 s39, s39, 0x8000
s_cmp_eq_u32 s39, 163840
s_cselect_b32 s39, 65536, s39
s_mov_b32 m0, s40
s_nop 0
buffer_load_dwordx4 v20, s[8:11], s32 offen offset:0 lds
buffer_load_dwordx4 v21, s[8:11], s32 offen offset:1024 lds
buffer_load_dwordx4 v20, s[8:11], s33 offen offset:2048 lds
buffer_load_dwordx4 v21, s[8:11], s33 offen offset:3072 lds
s_add_u32 m0, s40, 4096
s_nop 0
buffer_load_dwordx4 v20, s[8:11], s34 offen offset:0 lds
buffer_load_dwordx4 v21, s[8:11], s34 offen offset:1024 lds
buffer_load_dwordx4 v20, s[8:11], s35 offen offset:2048 lds
buffer_load_dwordx4 v21, s[8:11], s35 offen offset:3072 lds
s_add_u32 s32, s32, 128
s_add_u32 s33, s33, 128
s_add_u32 s34, s34, 128
s_add_u32 s35, s35, 128
s_xor_b32 s40, s40, 0x8000
s_getpc_b64 s[74:75]
L_pf6:
s_sub_u32 s74, s74, L_pf6-gated_mix__linear_kernel_hedgehog__compressed_kv_cla__prompt_kernel
s_subb_u32 s75, s75, 0
v_lshlrev_b32 v58, 7, v1
v_lshl_add_u32 v58, s3, 13, v58
v_min_u32 v58, L_end-gated_mix__linear_kernel_hedgehog__compressed_kv_cla__prompt_kernel, v58
global_load_dword v0, v58, s[74:75]
s_mov_b32 s12, s48
s_and_b32 s13, s49, 0xffff
s_mov_b32 s14, 4194304
s_mov_b32 s15, 0x20000
s_mov_b32 s24, s50
s_and_b32 s25, s51, 0xffff
s_mov_b32 s26, 6291456
s_mov_b32 s27, 0x20000
s_mov_b32 s20, s54
s_and_b32 s21, s55, 0xffff
s_mov_b32 s22, 8388608
s_mov_b32 s23, 0x20000
s_mov_b32 s28, s62
s_and_b32 s29, s63, 0xffff
s_mov_b32 s30, 268435456
s_mov_b32 s31, 0x20000
s_mov_b64 s[6:7], s[86:87]
s_mov_b64 s[88:89], s[66:67]
s_mov_b64 s[86:87], s[84:85]
s_mov_b64 s[84:85], s[80:81]
s_mov_b64 s[66:67], s[82:83]
s_mov_b64 s[90:91], s[48:49]
s_mov_b64 s[92:93], s[54:55]
s_mov_b64 s[94:95], s[50:51]
s_add_u32 s96, s54, 4194304
s_addc_u32 s97, s55, 0
s_add_u32 s98, s50, 2097152
s_addc_u32 s99, s51, 0
v_lshrrev_b32 v6, 2, v3
v_lshl_add_u32 v7, v2, 3, v6
v_and_b32 v56, 1, v2
v_lshl_add_u32 v57, v56, 2, v6
v_and_b32 v58, 3, v3
v_lshlrev_b32 v58, 3, v58
v_lshlrev_b32 v59, 8, v7
v_lshlrev_b32 v57, 5, v57
v_add3_u32 v59, v59, v57, v58
v_add_u32 v59, 65536, v59
v_xor_b32 v8, 0, v59
v_xor_b32 v9, 32, v59
v_xor_b32 v10, 64, v59
v_xor_b32 v11, 96, v59
v_xor_b32 v12, 128, v59
v_xor_b32 v13, 160, v59
v_xor_b32 v14, 192, v59
v_xor_b32 v15, 224, v59
v_mul_u32_u24 v59, 0xc0, v7
v_lshlrev_b32 v56, 5, v56
v_add_u32 v59, 81920, v59
v_add_u32 v59, v59, v58
v_add_u32 v16, v59, v56
v_xor_b32 v56, 32, v56
v_add_u32 v17, v59, v56
v_lshrrev_b32 v6, 1, v3
v_lshlrev_b32 v7, 7, v3
v_add_u32 v7, s43, v7
v_add_u32 v56, 0, v2
v_xor_b32 v56, v56, v6
v_lshl_add_u32 v18, v56, 4, v7
v_add_u32 v56, 4, v2
v_xor_b32 v56, v56, v6
v_lshl_add_u32 v19, v56, 4, v7
s_mov_b32 s48, 0xffff0000
s_mov_b32 s49, 0x8000
s_lshl_b32 s74, s2, 2
s_add_u32 s74, s74, s3
s_lshl_b32 s74, s74, 12
v_and_b32 v5, 31, v1
v_lshlrev_b32 v5, 7, v5
v_add_u32 v5, s74, v5
s_waitcnt vmcnt(1)
s_barrier
ds_read_b128 a[32:35], v18 offset:0
ds_read_b128 a[48:51], v19 offset:0
ds_read_b64_tr_b16 a[0:1], v8 offset:0
ds_read_b64_tr_b16 a[2:3], v8 offset:1024
ds_read_b64_tr_b16 a[4:5], v8 offset:8192
ds_read_b64_tr_b16 a[6:7], v8 offset:9216
ds_read_b64_tr_b16 a[8:9], v9 offset:0
ds_read_b64_tr_b16 a[10:11], v9 offset:1024
ds_read_b64_tr_b16 a[12:13], v9 offset:8192
ds_read_b64_tr_b16 a[14:15], v9 offset:9216
ds_read_b128 a[36:39], v18 offset:2048
ds_read_b128 a[52:55], v19 offset:2048
ds_read_b128 a[40:43], v18 offset:4096
ds_read_b128 a[56:59], v19 offset:4096
s_mov_b32 s41, s49
s_waitcnt lgkmcnt(10)
v_mfma_f32_16x16x32_bf16 v[64:67], a[0:3], a[32:35], 0
ds_read_b128 a[44:47], v18 offset:6144
ds_read_b128 a[60:63], v19 offset:6144
s_waitcnt lgkmcnt(10)
v_mfma_f32_16x16x32_bf16 v[64:67], a[4:7], a[48:51], v[64:67]
ds_read_b64_tr_b16 a[16:17], v10 offset:0
ds_read_b64_tr_b16 a[18:19], v10 offset:1024
s_waitcnt lgkmcnt(10)
v_mfma_f32_16x16x32_bf16 v[80:83], a[8:11], a[32:35], 0
s_mov_b32 m0, s40
s_nop 0
buffer_load_dwordx4 v20, s[8:11], s32 offen offset:0 lds
s_waitcnt lgkmcnt(8)
v_mfma_f32_16x16x32_bf16 v[80:83], a[12:15], a[48:51], v[80:83]
buffer_load_dwordx4 v21, s[8:11], s32 offen offset:1024 lds
s_waitcnt lgkmcnt(7)
v_mfma_f32_16x16x32_bf16 v[68:71], a[0:3], a[36:39], 0
v_xor_b32 v18, 0x8000, v18
v_xor_b32 v19, 0x8000, v19
s_waitcnt lgkmcnt(6)
v_mfma_f32_16x16x32_bf16 v[68:71], a[4:7], a[52:55], v[68:71]
ds_read_b64_tr_b16 a[20:21], v10 offset:8192
v_mfma_f32_16x16x32_bf16 v[84:87], a[8:11], a[36:39], 0
ds_read_b64_tr_b16 a[22:23], v10 offset:9216
buffer_load_dwordx4 v20, s[8:11], s33 offen offset:2048 lds
v_mfma_f32_16x16x32_bf16 v[84:87], a[12:15], a[52:55], v[84:87]
buffer_load_dwordx4 v21, s[8:11], s33 offen offset:3072 lds
s_waitcnt lgkmcnt(7)
v_mfma_f32_16x16x32_bf16 v[72:75], a[0:3], a[40:43], 0
ds_read_b64_tr_b16 a[24:25], v11 offset:0
ds_read_b64_tr_b16 a[26:27], v11 offset:1024
s_waitcnt lgkmcnt(8)
v_mfma_f32_16x16x32_bf16 v[72:75], a[4:7], a[56:59], v[72:75]
s_add_u32 m0, s40, 4096
v_mfma_f32_16x16x32_bf16 v[88:91], a[8:11], a[40:43], 0
buffer_load_dwordx4 v20, s[8:11], s34 offen offset:0 lds
v_mfma_f32_16x16x32_bf16 v[88:91], a[12:15], a[56:59], v[88:91]
buffer_load_dwordx4 v21, s[8:11], s34 offen offset:1024 lds
s_waitcnt lgkmcnt(7)
v_mfma_f32_16x16x32_bf16 v[76:79], a[0:3], a[44:47], 0
ds_read_b64_tr_b16 a[28:29], v11 offset:8192
s_waitcnt lgkmcnt(7)
v_mfma_f32_16x16x32_bf16 v[76:79], a[4:7], a[60:63], v[76:79]
ds_read_b64_tr_b16 a[30:31], v11 offset:9216
v_mfma_f32_16x16x32_bf16 v[92:95], a[8:11], a[44:47], 0
buffer_load_dwordx4 v20, s[8:11], s35 offen offset:2048 lds
v_mfma_f32_16x16x32_bf16 v[92:95], a[12:15], a[60:63], v[92:95]
buffer_load_dwordx4 v21, s[8:11], s35 offen offset:3072 lds
s_waitcnt lgkmcnt(4)
v_mfma_f32_16x16x32_bf16 v[96:99], a[16:19], a[32:35], 0
ds_read_b64_tr_b16 a[0:1], v12 offset:0
ds_read_b64_tr_b16 a[2:3], v12 offset:1024
s_add_u32 s32, s32, 128
v_mfma_f32_16x16x32_bf16 v[96:99], a[20:23], a[48:51], v[96:99]
s_add_u32 s33, s33, 128
s_add_u32 s34, s34, 128
v_mfma_f32_16x16x32_bf16 v[100:103], a[16:19], a[36:39], 0
s_add_u32 s35, s35, 128
s_xor_b32 s40, s40, 0x8000
s_add_u32 m0, s39, s43
v_mfma_f32_16x16x32_bf16 v[100:103], a[20:23], a[52:55], v[100:103]
buffer_load_dwordx4 v24, s[16:19], s36 offen offset:0 lds
buffer_load_dwordx4 v25, s[16:19], s36 offen offset:1024 lds
v_mfma_f32_16x16x32_bf16 v[104:107], a[16:19], a[40:43], 0
ds_read_b64_tr_b16 a[4:5], v12 offset:8192
v_mfma_f32_16x16x32_bf16 v[104:107], a[20:23], a[56:59], v[104:107]
ds_read_b64_tr_b16 a[6:7], v12 offset:9216
v_mfma_f32_16x16x32_bf16 v[108:111], a[16:19], a[44:47], 0
buffer_load_dwordx4 v26, s[16:19], s36 offen offset:2048 lds
v_mfma_f32_16x16x32_bf16 v[108:111], a[20:23], a[60:63], v[108:111]
buffer_load_dwordx4 v27, s[16:19], s36 offen offset:3072 lds
s_waitcnt lgkmcnt(4)
v_mfma_f32_16x16x32_bf16 v[112:115], a[24:27], a[32:35], 0
ds_read_b64_tr_b16 a[8:9], v13 offset:0
ds_read_b64_tr_b16 a[10:11], v13 offset:1024
v_mfma_f32_16x16x32_bf16 v[112:115], a[28:31], a[48:51], v[112:115]
s_add_u32 m0, s39, s44
v_mfma_f32_16x16x32_bf16 v[116:119], a[24:27], a[36:39], 0
buffer_load_dwordx4 v24, s[16:19], s37 offen offset:0 lds
v_mfma_f32_16x16x32_bf16 v[116:119], a[28:31], a[52:55], v[116:119]
buffer_load_dwordx4 v25, s[16:19], s37 offen offset:1024 lds
v_mfma_f32_16x16x32_bf16 v[120:123], a[24:27], a[40:43], 0
ds_read_b64_tr_b16 a[12:13], v13 offset:8192
ds_read_b64_tr_b16 a[14:15], v13 offset:9216
buffer_load_dwordx4 v26, s[16:19], s37 offen offset:2048 lds
v_mfma_f32_16x16x32_bf16 v[120:123], a[28:31], a[56:59], v[120:123]
buffer_load_dwordx4 v27, s[16:19], s37 offen offset:3072 lds
s_add_u32 s36, s36, 524288
v_mfma_f32_16x16x32_bf16 v[124:127], a[24:27], a[44:47], 0
s_add_u32 s37, s37, 524288
s_add_u32 s39, s39, 0x8000
v_mfma_f32_16x16x32_bf16 v[124:127], a[28:31], a[60:63], v[124:127]
s_cmp_eq_u32 s39, 163840
s_cselect_b32 s39, 65536, s39
s_waitcnt lgkmcnt(4)
v_mfma_f32_16x16x32_bf16 v[128:131], a[0:3], a[32:35], 0
ds_read_b64_tr_b16 a[16:17], v14 offset:0
ds_read_b64_tr_b16 a[18:19], v14 offset:1024
s_mov_b32 m0, s40
v_mfma_f32_16x16x32_bf16 v[128:131], a[4:7], a[48:51], v[128:131]
buffer_load_dwordx4 v20, s[8:11], s32 offen offset:0 lds
v_and_b32 v7, 7, v1
v_mfma_f32_16x16x32_bf16 v[132:135], a[0:3], a[36:39], 0
v_xor_b32 v6, v7, v2
v_lshlrev_b32 v6, 4, v6
v_mfma_f32_16x16x32_bf16 v[132:135], a[4:7], a[52:55], v[132:135]
v_lshrrev_b32 v7, 3, v1
v_add_u32 v7, s68, v7
v_mfma_f32_16x16x32_bf16 v[136:139], a[0:3], a[40:43], 0
ds_read_b64_tr_b16 a[20:21], v14 offset:8192
ds_read_b64_tr_b16 a[22:23], v14 offset:9216
v_mfma_f32_16x16x32_bf16 v[136:139], a[4:7], a[56:59], v[136:139]
buffer_load_dwordx4 v21, s[8:11], s32 offen offset:1024 lds
v_lshl_add_u32 v22, v7, 11, v6
v_mfma_f32_16x16x32_bf16 v[140:143], a[0:3], a[44:47], 0
v_xor_b32 v6, 64, v22
v_add_u32 v23, 15360, v6
v_mfma_f32_16x16x32_bf16 v[140:143], a[4:7], a[60:63], v[140:143]
s_lshl_b32 s73, s4, 6
s_waitcnt lgkmcnt(4)
v_mfma_f32_16x16x32_bf16 v[144:147], a[8:11], a[32:35], 0
ds_read_b64_tr_b16 a[24:25], v15 offset:0
ds_read_b64_tr_b16 a[26:27], v15 offset:1024
v_mfma_f32_16x16x32_bf16 v[144:147], a[12:15], a[48:51], v[144:147]
buffer_load_dwordx4 v20, s[8:11], s33 offen offset:2048 lds
s_mov_b32 s75, 0x5556
v_mfma_f32_16x16x32_bf16 v[148:151], a[8:11], a[36:39], 0
v_add_u32 v6, 0, v1
v_mul_u32_u24 v7, s75, v6
v_mfma_f32_16x16x32_bf16 v[148:151], a[12:15], a[52:55], v[148:151]
v_lshrrev_b32 v7, 18, v7
v_mfma_f32_16x16x32_bf16 v[152:155], a[8:11], a[40:43], 0
ds_read_b64_tr_b16 a[28:29], v15 offset:8192
ds_read_b64_tr_b16 a[30:31], v15 offset:9216
v_mfma_f32_16x16x32_bf16 v[152:155], a[12:15], a[56:59], v[152:155]
v_mul_u32_u24 v56, 12, v7
v_mfma_f32_16x16x32_bf16 v[156:159], a[8:11], a[44:47], 0
v_sub_u32 v6, v6, v56
v_lshrrev_b32 v56, 2, v6
v_mfma_f32_16x16x32_bf16 v[156:159], a[12:15], a[60:63], v[156:159]
v_and_b32 v6, 3, v6
s_waitcnt lgkmcnt(4)
v_mfma_f32_16x16x32_bf16 v[160:163], a[16:19], a[32:35], 0
ds_read_b64_tr_b16 a[0:1], v8 offset:16384
ds_read_b64_tr_b16 a[2:3], v8 offset:17408
v_mfma_f32_16x16x32_bf16 v[160:163], a[20:23], a[48:51], v[160:163]
buffer_load_dwordx4 v21, s[8:11], s33 offen offset:3072 lds
v_lshrrev_b32 v57, 3, v7
v_mfma_f32_16x16x32_bf16 v[164:167], a[16:19], a[36:39], 0
v_lshlrev_b32 v57, 1, v57
v_xor_b32 v6, v6, v57
v_mfma_f32_16x16x32_bf16 v[164:167], a[20:23], a[52:55], v[164:167]
v_lshlrev_b32 v6, 4, v6
v_mfma_f32_16x16x32_bf16 v[168:171], a[16:19], a[40:43], 0
ds_read_b64_tr_b16 a[4:5], v8 offset:24576
ds_read_b64_tr_b16 a[6:7], v8 offset:25600
v_add_u32 v8, s41, v8
v_mfma_f32_16x16x32_bf16 v[168:171], a[20:23], a[56:59], v[168:171]
s_add_u32 m0, s40, 4096
s_nop 0
buffer_load_dwordx4 v20, s[8:11], s34 offen offset:0 lds
v_mfma_f32_16x16x32_bf16 v[172:175], a[16:19], a[44:47], 0
v_lshlrev_b32 v56, 11, v56
v_mul_u32_u24 v7, 0x1800, v7
v_add3_u32 v6, v6, v56, v7
v_mfma_f32_16x16x32_bf16 v[172:175], a[20:23], a[60:63], v[172:175]
v_add_u32 v28, s73, v6
v_add_u32 v6, 64, v1
s_waitcnt lgkmcnt(4)
v_mfma_f32_16x16x32_bf16 v[176:179], a[24:27], a[32:35], 0
ds_read_b64_tr_b16 a[8:9], v9 offset:16384
ds_read_b64_tr_b16 a[10:11], v9 offset:17408
v_mfma_f32_16x16x32_bf16 v[176:179], a[28:31], a[48:51], v[176:179]
v_mul_u32_u24 v7, s75, v6
v_mfma_f32_16x16x32_bf16 v[180:183], a[24:27], a[36:39], 0
v_lshrrev_b32 v7, 18, v7
v_mul_u32_u24 v56, 12, v7
v_mfma_f32_16x16x32_bf16 v[180:183], a[28:31], a[52:55], v[180:183]
v_sub_u32 v6, v6, v56
v_mfma_f32_16x16x32_bf16 v[184:187], a[24:27], a[40:43], 0
ds_read_b64_tr_b16 a[12:13], v9 offset:24576
ds_read_b64_tr_b16 a[14:15], v9 offset:25600
v_mfma_f32_16x16x32_bf16 v[184:187], a[28:31], a[56:59], v[184:187]
v_add_u32 v9, s41, v9
buffer_load_dwordx4 v21, s[8:11], s34 offen offset:1024 lds
v_mfma_f32_16x16x32_bf16 v[188:191], a[24:27], a[44:47], 0
v_lshrrev_b32 v56, 2, v6
v_and_b32 v6, 3, v6
v_mfma_f32_16x16x32_bf16 v[188:191], a[28:31], a[60:63], v[188:191]
v_lshrrev_b32 v57, 3, v7
v_lshlrev_b32 v57, 1, v57
s_waitcnt lgkmcnt(4)
v_mfma_f32_16x16x32_bf16 v[192:195], a[32:35], a[0:3], 0
ds_read_b64_tr_b16 a[16:17], v10 offset:16384
ds_read_b64_tr_b16 a[18:19], v10 offset:17408
v_mfma_f32_16x16x32_bf16 v[192:195], a[48:51], a[4:7], v[192:195]
buffer_load_dwordx4 v20, s[8:11], s35 offen offset:2048 lds
v_xor_b32 v6, v6, v57
v_mfma_f32_16x16x32_bf16 v[196:199], a[36:39], a[0:3], 0
v_lshlrev_b32 v6, 4, v6
v_lshlrev_b32 v56, 11, v56
v_mfma_f32_16x16x32_bf16 v[196:199], a[52:55], a[4:7], v[196:199]
v_mul_u32_u24 v7, 0x1800, v7
v_mfma_f32_16x16x32_bf16 v[200:203], a[40:43], a[0:3], 0
ds_read_b64_tr_b16 a[20:21], v10 offset:24576
ds_read_b64_tr_b16 a[22:23], v10 offset:25600
v_mfma_f32_16x16x32_bf16 v[200:203], a[56:59], a[4:7], v[200:203]
v_add_u32 v10, s41, v10
v_add3_u32 v6, v6, v56, v7
v_mfma_f32_16x16x32_bf16 v[204:207], a[44:47], a[0:3], 0
v_add_u32 v29, s73, v6
v_subrev_u32 v29, 1024, v29
v_mfma_f32_16x16x32_bf16 v[204:207], a[60:63], a[4:7], v[204:207]
v_add_u32 v6, 128, v1
s_waitcnt lgkmcnt(4)
v_mfma_f32_16x16x32_bf16 v[208:211], a[32:35], a[8:11], 0
ds_read_b64_tr_b16 a[24:25], v11 offset:16384
ds_read_b64_tr_b16 a[26:27], v11 offset:17408
buffer_load_dwordx4 v21, s[8:11], s35 offen offset:3072 lds
v_mfma_f32_16x16x32_bf16 v[208:211], a[48:51], a[12:15], v[208:211]
s_add_u32 s32, s32, 128
s_add_u32 s33, s33, 128
s_add_u32 s34, s34, 128
v_mfma_f32_16x16x32_bf16 v[212:215], a[36:39], a[8:11], 0
s_add_u32 s35, s35, 128
s_xor_b32 s40, s40, 0x8000
v_mul_u32_u24 v7, s75, v6
v_mfma_f32_16x16x32_bf16 v[212:215], a[52:55], a[12:15], v[212:215]
v_lshrrev_b32 v7, 18, v7
v_mul_u32_u24 v56, 12, v7
v_sub_u32 v6, v6, v56
v_mfma_f32_16x16x32_bf16 v[216:219], a[40:43], a[8:11], 0
ds_read_b64_tr_b16 a[28:29], v11 offset:24576
ds_read_b64_tr_b16 a[30:31], v11 offset:25600
v_add_u32 v11, s41, v11
v_mfma_f32_16x16x32_bf16 v[216:219], a[56:59], a[12:15], v[216:219]
s_add_u32 m0, s39, s43
s_nop 0
buffer_load_dwordx4 v24, s[16:19], s36 offen offset:0 lds
v_mfma_f32_16x16x32_bf16 v[220:223], a[44:47], a[8:11], 0
v_lshrrev_b32 v56, 2, v6
v_and_b32 v6, 3, v6
v_lshrrev_b32 v57, 3, v7
v_mfma_f32_16x16x32_bf16 v[220:223], a[60:63], a[12:15], v[220:223]
v_lshlrev_b32 v57, 1, v57
v_xor_b32 v6, v6, v57
s_waitcnt lgkmcnt(4)
v_mfma_f32_16x16x32_bf16 v[224:227], a[32:35], a[16:19], 0
ds_read_b64_tr_b16 a[0:1], v12 offset:16384
ds_read_b64_tr_b16 a[2:3], v12 offset:17408
v_mfma_f32_16x16x32_bf16 v[224:227], a[48:51], a[20:23], v[224:227]
buffer_load_dwordx4 v25, s[16:19], s36 offen offset:1024 lds
v_lshlrev_b32 v6, 4, v6
v_mfma_f32_16x16x32_bf16 v[228:231], a[36:39], a[16:19], 0
v_lshlrev_b32 v56, 11, v56
v_mul_u32_u24 v7, 0x1800, v7
v_mfma_f32_16x16x32_bf16 v[228:231], a[52:55], a[20:23], v[228:231]
v_add3_u32 v6, v6, v56, v7
v_mfma_f32_16x16x32_bf16 v[232:235], a[40:43], a[16:19], 0
ds_read_b64_tr_b16 a[4:5], v12 offset:24576
ds_read_b64_tr_b16 a[6:7], v12 offset:25600
v_mfma_f32_16x16x32_bf16 v[232:235], a[56:59], a[20:23], v[232:235]
v_add_u32 v12, s41, v12
v_add_u32 v30, s73, v6
v_mfma_f32_16x16x32_bf16 v[236:239], a[44:47], a[16:19], 0
v_subrev_u32 v30, 2048, v30
s_lshl_b32 s74, s2, 2
v_mfma_f32_16x16x32_bf16 v[236:239], a[60:63], a[20:23], v[236:239]
s_add_u32 s74, s74, s3
s_waitcnt lgkmcnt(4)
v_mfma_f32_16x16x32_bf16 v[240:243], a[32:35], a[24:27], 0
ds_read_b64_tr_b16 a[8:9], v13 offset:16384
ds_read_b64_tr_b16 a[10:11], v13 offset:17408
v_mfma_f32_16x16x32_bf16 v[240:243], a[48:51], a[28:31], v[240:243]
buffer_load_dwordx4 v26, s[16:19], s36 offen offset:2048 lds
s_lshl_b32 s78, s74, 1
v_mfma_f32_16x16x32_bf16 v[244:247], a[36:39], a[24:27], 0
v_and_b32 v6, 1, v1
v_add_u32 v6, s78, v6
v_mfma_f32_16x16x32_bf16 v[244:247], a[52:55], a[28:31], v[244:247]
v_lshlrev_b32 v6, 11, v6
v_mfma_f32_16x16x32_bf16 v[248:251], a[40:43], a[24:27], 0
ds_read_b64_tr_b16 a[12:13], v13 offset:24576
ds_read_b64_tr_b16 a[14:15], v13 offset:25600
v_mfma_f32_16x16x32_bf16 v[248:251], a[56:59], a[28:31], v[248:251]
v_add_u32 v13, s41, v13
buffer_load_dwordx4 v27, s[16:19], s36 offen offset:3072 lds
v_mfma_f32_16x16x32_bf16 v[252:255], a[44:47], a[24:27], 0
v_mov_b32 v7, 0
v_lshl_add_u64 v[60:61], v[6:7], 0, s[12:13]
v_mfma_f32_16x16x32_bf16 v[252:255], a[60:63], a[28:31], v[252:255]
v_mov_b32 v62, 128
v_mov_b32 v63, 0
s_waitcnt lgkmcnt(4)
v_mfma_f32_16x16x32_bf16 a[64:67], a[32:35], a[0:3], 0
ds_read_b64_tr_b16 a[16:17], v14 offset:16384
ds_read_b64_tr_b16 a[18:19], v14 offset:17408
ds_read_b64_tr_b16 a[20:21], v14 offset:24576
v_mfma_f32_16x16x32_bf16 a[64:67], a[48:51], a[4:7], a[64:67]
ds_read_b64_tr_b16 a[22:23], v14 offset:25600
v_add_u32 v14, s41, v14
v_mfma_f32_16x16x32_bf16 a[68:71], a[36:39], a[0:3], 0
s_lshl_b32 s78, s74, 2
v_and_b32 v6, 3, v1
v_add_u32 v6, s78, v6
v_mfma_f32_16x16x32_bf16 a[68:71], a[52:55], a[4:7], a[68:71]
v_lshlrev_b32 v6, 7, v6
v_lshl_add_u64 v[56:57], v[6:7], 0, s[20:21]
v_mfma_f32_16x16x32_bf16 a[72:75], a[40:43], a[0:3], 0
ds_read_b64_tr_b16 a[24:25], v15 offset:16384
ds_read_b64_tr_b16 a[26:27], v15 offset:17408
ds_read_b64_tr_b16 a[28:29], v15 offset:24576
v_mfma_f32_16x16x32_bf16 a[72:75], a[56:59], a[4:7], a[72:75]
ds_read_b64_tr_b16 a[30:31], v15 offset:25600
v_add_u32 v15, s41, v15
s_add_u32 m0, s39, s44
v_mfma_f32_16x16x32_bf16 a[76:79], a[44:47], a[0:3], 0
buffer_load_dwordx4 v24, s[16:19], s37 offen offset:0 lds
v_mov_b32 v58, 524288
v_cmp_le_u32 vcc, 2, v1
v_mfma_f32_16x16x32_bf16 a[76:79], a[60:63], a[4:7], a[76:79]
v_cmp_gt_u32_e64 s[82:83], 6, v1
s_and_b64 vcc, vcc, s[82:83]
s_waitcnt lgkmcnt(8)
v_mfma_f32_16x16x32_bf16 a[80:83], a[32:35], a[8:11], 0
buffer_load_dwordx4 v25, s[16:19], s37 offen offset:1024 lds
v_cndmask_b32 v60, v60, v56, vcc
v_mfma_f32_16x16x32_bf16 a[80:83], a[48:51], a[12:15], a[80:83]
v_cndmask_b32 v61, v61, v57, vcc
v_mfma_f32_16x16x32_bf16 a[84:87], a[36:39], a[8:11], 0
v_cndmask_b32 v62, v62, v58, vcc
v_mfma_f32_16x16x32_bf16 a[84:87], a[52:55], a[12:15], a[84:87]
s_mul_i32 s78, s74, 3
v_mfma_f32_16x16x32_bf16 a[88:91], a[40:43], a[8:11], 0
v_subrev_u32 v6, 6, v1
v_mfma_f32_16x16x32_bf16 a[88:91], a[56:59], a[12:15], a[88:91]
v_min_u32 v6, 2, v6
v_mfma_f32_16x16x32_bf16 a[92:95], a[44:47], a[8:11], 0
v_add_u32 v6, s78, v6
v_mfma_f32_16x16x32_bf16 a[92:95], a[60:63], a[12:15], a[92:95]
v_lshlrev_b32 v6, 7, v6
s_waitcnt vmcnt(14)
s_waitcnt lgkmcnt(0)
s_barrier
v_mfma_f32_16x16x32_bf16 a[96:99], a[32:35], a[16:19], 0
ds_read_b64_tr_b16 a[0:1], v8 offset:0
ds_read_b64_tr_b16 a[2:3], v8 offset:1024
ds_read_b64_tr_b16 a[4:5], v8 offset:8192
v_mfma_f32_16x16x32_bf16 a[96:99], a[48:51], a[20:23], a[96:99]
ds_read_b64_tr_b16 a[6:7], v8 offset:9216
buffer_load_dwordx4 v26, s[16:19], s37 offen offset:2048 lds
v_mfma_f32_16x16x32_bf16 a[112:115], a[32:35], a[24:27], 0
v_lshl_add_u64 v[56:57], v[6:7], 0, s[24:25]
v_mov_b32 v58, 393216
v_mfma_f32_16x16x32_bf16 a[112:115], a[48:51], a[28:31], a[112:115]
v_cmp_le_u32 vcc, 6, v1
v_cmp_gt_u32_e64 s[82:83], 9, v1
v_mfma_f32_16x16x32_bf16 a[100:103], a[36:39], a[16:19], 0
ds_read_b128 a[32:35], v18 offset:0
ds_read_b128 a[48:51], v19 offset:0
ds_read_b64_tr_b16 a[8:9], v9 offset:0
ds_read_b64_tr_b16 a[10:11], v9 offset:1024
v_mfma_f32_16x16x32_bf16 a[100:103], a[52:55], a[20:23], a[100:103]
ds_read_b64_tr_b16 a[12:13], v9 offset:8192
ds_read_b64_tr_b16 a[14:15], v9 offset:9216
buffer_load_dwordx4 v27, s[16:19], s37 offen offset:3072 lds
s_add_u32 s36, s36, 524288
v_mfma_f32_16x16x32_bf16 a[116:119], a[36:39], a[24:27], 0
s_add_u32 s37, s37, 524288
s_add_u32 s39, s39, 0x8000
s_cmp_eq_u32 s39, 163840
s_cselect_b32 s39, 65536, s39
v_mfma_f32_16x16x32_bf16 a[116:119], a[52:55], a[28:31], a[116:119]
s_and_b64 vcc, vcc, s[82:83]
v_cndmask_b32 v60, v60, v56, vcc
v_cndmask_b32 v61, v61, v57, vcc
v_cndmask_b32 v62, v62, v58, vcc
v_mfma_f32_16x16x32_bf16 a[104:107], a[40:43], a[16:19], 0
ds_read_b128 a[36:39], v18 offset:2048
v_mfma_f32_16x16x32_bf16 a[104:107], a[56:59], a[20:23], a[104:107]
v_mfma_f32_16x16x32_bf16 a[120:123], a[40:43], a[24:27], 0
ds_read_b128 a[52:55], v19 offset:2048
v_mfma_f32_16x16x32_bf16 a[120:123], a[56:59], a[28:31], a[120:123]
v_mfma_f32_16x16x32_bf16 a[108:111], a[44:47], a[16:19], 0
ds_read_b128 a[40:43], v18 offset:4096
v_mfma_f32_16x16x32_bf16 a[108:111], a[60:63], a[20:23], a[108:111]
ds_read_b128 a[56:59], v19 offset:4096
v_mfma_f32_16x16x32_bf16 a[124:127], a[44:47], a[24:27], 0
global_load_dword v0, v[60:61], off
v_mfma_f32_16x16x32_bf16 a[124:127], a[60:63], a[28:31], a[124:127]
v_lshl_add_u64 v[60:61], v[60:61], 0, v[62:63]
s_mov_b32 s42, 5
L_p1a:
s_cmp_eq_u32 s39, 98304
s_cselect_b32 s41, s48, s49
s_waitcnt lgkmcnt(9)
v_mfma_f32_16x16x32_bf16 v[64:67], a[0:3], a[32:35], v[64:67]
ds_read_b128 a[44:47], v18 offset:6144
ds_read_b128 a[60:63], v19 offset:6144
s_waitcnt lgkmcnt(10)
v_mfma_f32_16x16x32_bf16 v[64:67], a[4:7], a[48:51], v[64:67]
ds_read_b64_tr_b16 a[16:17], v10 offset:0
s_waitcnt lgkmcnt(9)
v_mfma_f32_16x16x32_bf16 v[80:83], a[8:11], a[32:35], v[80:83]
ds_read_b64_tr_b16 a[18:19], v10 offset:1024
s_add_u32 m0, s39, s43
s_waitcnt lgkmcnt(8)
v_mfma_f32_16x16x32_bf16 v[80:83], a[12:15], a[48:51], v[80:83]
buffer_load_dwordx4 v24, s[16:19], s36 offen offset:0 lds
s_waitcnt lgkmcnt(7)
v_mfma_f32_16x16x32_bf16 v[68:71], a[0:3], a[36:39], v[68:71]
v_xor_b32 v18, 0x8000, v18
v_xor_b32 v19, 0x8000, v19
s_waitcnt lgkmcnt(6)
v_mfma_f32_16x16x32_bf16 v[68:71], a[4:7], a[52:55], v[68:71]
ds_read_b64_tr_b16 a[20:21], v10 offset:8192
v_mfma_f32_16x16x32_bf16 v[84:87], a[8:11], a[36:39], v[84:87]
ds_read_b64_tr_b16 a[22:23], v10 offset:9216
v_mfma_f32_16x16x32_bf16 v[84:87], a[12:15], a[52:55], v[84:87]
buffer_load_dwordx4 v25, s[16:19], s36 offen offset:1024 lds
s_waitcnt lgkmcnt(7)
v_mfma_f32_16x16x32_bf16 v[72:75], a[0:3], a[40:43], v[72:75]
ds_read_b64_tr_b16 a[24:25], v11 offset:0
s_waitcnt lgkmcnt(7)
v_mfma_f32_16x16x32_bf16 v[72:75], a[4:7], a[56:59], v[72:75]
v_mfma_f32_16x16x32_bf16 v[88:91], a[8:11], a[40:43], v[88:91]
ds_read_b64_tr_b16 a[26:27], v11 offset:1024
v_mfma_f32_16x16x32_bf16 v[88:91], a[12:15], a[56:59], v[88:91]
s_waitcnt lgkmcnt(7)
v_mfma_f32_16x16x32_bf16 v[76:79], a[0:3], a[44:47], v[76:79]
ds_read_b64_tr_b16 a[28:29], v11 offset:8192
s_waitcnt lgkmcnt(7)
v_mfma_f32_16x16x32_bf16 v[76:79], a[4:7], a[60:63], v[76:79]
ds_read_b64_tr_b16 a[30:31], v11 offset:9216
v_mfma_f32_16x16x32_bf16 v[92:95], a[8:11], a[44:47], v[92:95]
buffer_load_dwordx4 v26, s[16:19], s36 offen offset:2048 lds
v_mfma_f32_16x16x32_bf16 v[92:95], a[12:15], a[60:63], v[92:95]
s_waitcnt lgkmcnt(4)
v_mfma_f32_16x16x32_bf16 v[96:99], a[16:19], a[32:35], v[96:99]
ds_read_b64_tr_b16 a[0:1], v12 offset:0
v_mfma_f32_16x16x32_bf16 v[96:99], a[20:23], a[48:51], v[96:99]
v_mfma_f32_16x16x32_bf16 v[100:103], a[16:19], a[36:39], v[100:103]
ds_read_b64_tr_b16 a[2:3], v12 offset:1024
v_mfma_f32_16x16x32_bf16 v[100:103], a[20:23], a[52:55], v[100:103]
v_mfma_f32_16x16x32_bf16 v[104:107], a[16:19], a[40:43], v[104:107]
ds_read_b64_tr_b16 a[4:5], v12 offset:8192
v_mfma_f32_16x16x32_bf16 v[104:107], a[20:23], a[56:59], v[104:107]
ds_read_b64_tr_b16 a[6:7], v12 offset:9216
v_mfma_f32_16x16x32_bf16 v[108:111], a[16:19], a[44:47], v[108:111]
buffer_load_dwordx4 v27, s[16:19], s36 offen offset:3072 lds
v_mfma_f32_16x16x32_bf16 v[108:111], a[20:23], a[60:63], v[108:111]
s_waitcnt lgkmcnt(4)
v_mfma_f32_16x16x32_bf16 v[112:115], a[24:27], a[32:35], v[112:115]
ds_read_b64_tr_b16 a[8:9], v13 offset:0
v_mfma_f32_16x16x32_bf16 v[112:115], a[28:31], a[48:51], v[112:115]
v_mfma_f32_16x16x32_bf16 v[116:119], a[24:27], a[36:39], v[116:119]
ds_read_b64_tr_b16 a[10:11], v13 offset:1024
v_mfma_f32_16x16x32_bf16 v[116:119], a[28:31], a[52:55], v[116:119]
v_mfma_f32_16x16x32_bf16 v[120:123], a[24:27], a[40:43], v[120:123]
ds_read_b64_tr_b16 a[12:13], v13 offset:8192
v_mfma_f32_16x16x32_bf16 v[120:123], a[28:31], a[56:59], v[120:123]
ds_read_b64_tr_b16 a[14:15], v13 offset:9216
v_mfma_f32_16x16x32_bf16 v[124:127], a[24:27], a[44:47], v[124:127]
s_mov_b32 m0, s40
v_mfma_f32_16x16x32_bf16 v[124:127], a[28:31], a[60:63], v[124:127]
buffer_load_dwordx4 v20, s[8:11], s32 offen offset:0 lds
s_waitcnt lgkmcnt(4)
v_mfma_f32_16x16x32_bf16 v[128:131], a[0:3], a[32:35], v[128:131]
ds_read_b64_tr_b16 a[16:17], v14 offset:0
v_mfma_f32_16x16x32_bf16 v[128:131], a[4:7], a[48:51], v[128:131]
v_mfma_f32_16x16x32_bf16 v[132:135], a[0:3], a[36:39], v[132:135]
ds_read_b64_tr_b16 a[18:19], v14 offset:1024
v_mfma_f32_16x16x32_bf16 v[132:135], a[4:7], a[52:55], v[132:135]
v_mfma_f32_16x16x32_bf16 v[136:139], a[0:3], a[40:43], v[136:139]
ds_read_b64_tr_b16 a[20:21], v14 offset:8192
v_mfma_f32_16x16x32_bf16 v[136:139], a[4:7], a[56:59], v[136:139]
ds_read_b64_tr_b16 a[22:23], v14 offset:9216
v_mfma_f32_16x16x32_bf16 v[140:143], a[0:3], a[44:47], v[140:143]
buffer_load_dwordx4 v21, s[8:11], s32 offen offset:1024 lds
v_mfma_f32_16x16x32_bf16 v[140:143], a[4:7], a[60:63], v[140:143]
s_waitcnt lgkmcnt(4)
v_mfma_f32_16x16x32_bf16 v[144:147], a[8:11], a[32:35], v[144:147]
ds_read_b64_tr_b16 a[24:25], v15 offset:0
v_mfma_f32_16x16x32_bf16 v[144:147], a[12:15], a[48:51], v[144:147]
v_mfma_f32_16x16x32_bf16 v[148:151], a[8:11], a[36:39], v[148:151]
ds_read_b64_tr_b16 a[26:27], v15 offset:1024
v_mfma_f32_16x16x32_bf16 v[148:151], a[12:15], a[52:55], v[148:151]
s_cmp_lg_u32 s42, 4
s_cbranch_scc1 L_lsm
s_lshl_b32 s74, s2, 3
s_lshl_b32 s75, s3, 1
s_add_u32 s74, s74, s75
s_lshl_b32 s75, s74, 11
v_lshlrev_b32 v6, 5, v1
buffer_load_dwordx4 v[32:35], v6, s[12:15], s75 offen offset:0
buffer_load_dwordx4 v[36:39], v6, s[12:15], s75 offen offset:16
buffer_load_dwordx4 v[40:43], v6, s[12:15], s75 offen offset:2048
buffer_load_dwordx4 v[44:47], v6, s[12:15], s75 offen offset:2064
global_load_dwordx4 v[48:51], v6, s[66:67]
global_load_dwordx4 v[52:55], v6, s[66:67] offset:16
v_mov_b32 v56, 0
v_mov_b32 v57, 0
v_mov_b32 v58, 0
v_mov_b32 v59, 0
s_lshl_b32 s74, s2, 7
s_add_u32 s74, s74, 63963136
v_lshlrev_b32 v6, 15, v2
v_and_b32 v7, 3, v3
v_lshl_add_u32 v6, v7, 4, v6
buffer_store_dwordx4 v[56:59], v6, s[28:31], s74 offen sc1
L_lsm:
v_mfma_f32_16x16x32_bf16 v[152:155], a[8:11], a[40:43], v[152:155]
ds_read_b64_tr_b16 a[28:29], v15 offset:8192
v_mfma_f32_16x16x32_bf16 v[152:155], a[12:15], a[56:59], v[152:155]
ds_read_b64_tr_b16 a[30:31], v15 offset:9216
v_mfma_f32_16x16x32_bf16 v[156:159], a[8:11], a[44:47], v[156:159]
buffer_load_dwordx4 v20, s[8:11], s33 offen offset:2048 lds
v_mfma_f32_16x16x32_bf16 v[156:159], a[12:15], a[60:63], v[156:159]
s_waitcnt lgkmcnt(4)
v_mfma_f32_16x16x32_bf16 v[160:163], a[16:19], a[32:35], v[160:163]
ds_read_b64_tr_b16 a[0:1], v8 offset:16384
v_mfma_f32_16x16x32_bf16 v[160:163], a[20:23], a[48:51], v[160:163]
v_mfma_f32_16x16x32_bf16 v[164:167], a[16:19], a[36:39], v[164:167]
ds_read_b64_tr_b16 a[2:3], v8 offset:17408
v_mfma_f32_16x16x32_bf16 v[164:167], a[20:23], a[52:55], v[164:167]
v_mfma_f32_16x16x32_bf16 v[168:171], a[16:19], a[40:43], v[168:171]
ds_read_b64_tr_b16 a[4:5], v8 offset:24576
v_mfma_f32_16x16x32_bf16 v[168:171], a[20:23], a[56:59], v[168:171]
ds_read_b64_tr_b16 a[6:7], v8 offset:25600
v_mfma_f32_16x16x32_bf16 v[172:175], a[16:19], a[44:47], v[172:175]
v_add_u32 v8, s41, v8
v_mfma_f32_16x16x32_bf16 v[172:175], a[20:23], a[60:63], v[172:175]
buffer_load_dwordx4 v21, s[8:11], s33 offen offset:3072 lds
s_waitcnt lgkmcnt(4)
v_mfma_f32_16x16x32_bf16 v[176:179], a[24:27], a[32:35], v[176:179]
ds_read_b64_tr_b16 a[8:9], v9 offset:16384
v_mfma_f32_16x16x32_bf16 v[176:179], a[28:31], a[48:51], v[176:179]
v_mfma_f32_16x16x32_bf16 v[180:183], a[24:27], a[36:39], v[180:183]
ds_read_b64_tr_b16 a[10:11], v9 offset:17408
v_mfma_f32_16x16x32_bf16 v[180:183], a[28:31], a[52:55], v[180:183]
v_mfma_f32_16x16x32_bf16 v[184:187], a[24:27], a[40:43], v[184:187]
ds_read_b64_tr_b16 a[12:13], v9 offset:24576
ds_read_b64_tr_b16 a[14:15], v9 offset:25600
v_mfma_f32_16x16x32_bf16 v[184:187], a[28:31], a[56:59], v[184:187]
v_add_u32 v9, s41, v9
v_mfma_f32_16x16x32_bf16 v[188:191], a[24:27], a[44:47], v[188:191]
s_add_u32 m0, s40, 4096
v_mfma_f32_16x16x32_bf16 v[188:191], a[28:31], a[60:63], v[188:191]
buffer_load_dwordx4 v20, s[8:11], s34 offen offset:0 lds
s_waitcnt lgkmcnt(4)
v_mfma_f32_16x16x32_bf16 v[192:195], a[32:35], a[0:3], v[192:195]
ds_read_b64_tr_b16 a[16:17], v10 offset:16384
v_mfma_f32_16x16x32_bf16 v[192:195], a[48:51], a[4:7], v[192:195]
v_mfma_f32_16x16x32_bf16 v[196:199], a[36:39], a[0:3], v[196:199]
ds_read_b64_tr_b16 a[18:19], v10 offset:17408
v_mfma_f32_16x16x32_bf16 v[196:199], a[52:55], a[4:7], v[196:199]
v_mfma_f32_16x16x32_bf16 v[200:203], a[40:43], a[0:3], v[200:203]
ds_read_b64_tr_b16 a[20:21], v10 offset:24576
v_mfma_f32_16x16x32_bf16 v[200:203], a[56:59], a[4:7], v[200:203]
ds_read_b64_tr_b16 a[22:23], v10 offset:25600
v_mfma_f32_16x16x32_bf16 v[204:207], a[44:47], a[0:3], v[204:207]
v_add_u32 v10, s41, v10
v_mfma_f32_16x16x32_bf16 v[204:207], a[60:63], a[4:7], v[204:207]
buffer_load_dwordx4 v21, s[8:11], s34 offen offset:1024 lds
s_waitcnt lgkmcnt(4)
v_mfma_f32_16x16x32_bf16 v[208:211], a[32:35], a[8:11], v[208:211]
ds_read_b64_tr_b16 a[24:25], v11 offset:16384
v_mfma_f32_16x16x32_bf16 v[208:211], a[48:51], a[12:15], v[208:211]
v_mfma_f32_16x16x32_bf16 v[212:215], a[36:39], a[8:11], v[212:215]
ds_read_b64_tr_b16 a[26:27], v11 offset:17408
v_mfma_f32_16x16x32_bf16 v[212:215], a[52:55], a[12:15], v[212:215]
v_mfma_f32_16x16x32_bf16 v[216:219], a[40:43], a[8:11], v[216:219]
ds_read_b64_tr_b16 a[28:29], v11 offset:24576
v_mfma_f32_16x16x32_bf16 v[216:219], a[56:59], a[12:15], v[216:219]
ds_read_b64_tr_b16 a[30:31], v11 offset:25600
v_mfma_f32_16x16x32_bf16 v[220:223], a[44:47], a[8:11], v[220:223]
v_add_u32 v11, s41, v11
v_mfma_f32_16x16x32_bf16 v[220:223], a[60:63], a[12:15], v[220:223]
buffer_load_dwordx4 v20, s[8:11], s35 offen offset:2048 lds
s_waitcnt lgkmcnt(4)
v_mfma_f32_16x16x32_bf16 v[224:227], a[32:35], a[16:19], v[224:227]
ds_read_b64_tr_b16 a[0:1], v12 offset:16384
v_mfma_f32_16x16x32_bf16 v[224:227], a[48:51], a[20:23], v[224:227]
v_mfma_f32_16x16x32_bf16 v[228:231], a[36:39], a[16:19], v[228:231]
ds_read_b64_tr_b16 a[2:3], v12 offset:17408
v_mfma_f32_16x16x32_bf16 v[228:231], a[52:55], a[20:23], v[228:231]
v_mfma_f32_16x16x32_bf16 v[232:235], a[40:43], a[16:19], v[232:235]
ds_read_b64_tr_b16 a[4:5], v12 offset:24576
ds_read_b64_tr_b16 a[6:7], v12 offset:25600
v_add_u32 v12, s41, v12
v_mfma_f32_16x16x32_bf16 v[232:235], a[56:59], a[20:23], v[232:235]
buffer_load_dwordx4 v21, s[8:11], s35 offen offset:3072 lds
s_add_u32 s32, s32, 128
v_mfma_f32_16x16x32_bf16 v[236:239], a[44:47], a[16:19], v[236:239]
s_add_u32 s33, s33, 128
s_add_u32 s34, s34, 128
v_mfma_f32_16x16x32_bf16 v[236:239], a[60:63], a[20:23], v[236:239]
s_add_u32 s35, s35, 128
s_xor_b32 s40, s40, 0x8000
s_waitcnt lgkmcnt(4)
v_mfma_f32_16x16x32_bf16 v[240:243], a[32:35], a[24:27], v[240:243]
ds_read_b64_tr_b16 a[8:9], v13 offset:16384
v_mfma_f32_16x16x32_bf16 v[240:243], a[48:51], a[28:31], v[240:243]
v_mfma_f32_16x16x32_bf16 v[244:247], a[36:39], a[24:27], v[244:247]
ds_read_b64_tr_b16 a[10:11], v13 offset:17408
v_mfma_f32_16x16x32_bf16 v[244:247], a[52:55], a[28:31], v[244:247]
v_mfma_f32_16x16x32_bf16 v[248:251], a[40:43], a[24:27], v[248:251]
ds_read_b64_tr_b16 a[12:13], v13 offset:24576
ds_read_b64_tr_b16 a[14:15], v13 offset:25600
v_mfma_f32_16x16x32_bf16 v[248:251], a[56:59], a[28:31], v[248:251]
v_add_u32 v13, s41, v13
v_mfma_f32_16x16x32_bf16 v[252:255], a[44:47], a[24:27], v[252:255]
s_add_u32 m0, s39, s44
v_mfma_f32_16x16x32_bf16 v[252:255], a[60:63], a[28:31], v[252:255]
buffer_load_dwordx4 v24, s[16:19], s37 offen offset:0 lds
s_waitcnt lgkmcnt(4)
v_mfma_f32_16x16x32_bf16 a[64:67], a[32:35], a[0:3], a[64:67]
ds_read_b64_tr_b16 a[16:17], v14 offset:16384
ds_read_b64_tr_b16 a[18:19], v14 offset:17408
v_mfma_f32_16x16x32_bf16 a[64:67], a[48:51], a[4:7], a[64:67]
ds_read_b64_tr_b16 a[20:21], v14 offset:24576
v_mfma_f32_16x16x32_bf16 a[68:71], a[36:39], a[0:3], a[68:71]
ds_read_b64_tr_b16 a[22:23], v14 offset:25600
v_mfma_f32_16x16x32_bf16 a[68:71], a[52:55], a[4:7], a[68:71]
v_add_u32 v14, s41, v14
v_mfma_f32_16x16x32_bf16 a[72:75], a[40:43], a[0:3], a[72:75]
ds_read_b64_tr_b16 a[24:25], v15 offset:16384
ds_read_b64_tr_b16 a[26:27], v15 offset:17408
v_mfma_f32_16x16x32_bf16 a[72:75], a[56:59], a[4:7], a[72:75]
ds_read_b64_tr_b16 a[28:29], v15 offset:24576
v_mfma_f32_16x16x32_bf16 a[76:79], a[44:47], a[0:3], a[76:79]
ds_read_b64_tr_b16 a[30:31], v15 offset:25600
v_add_u32 v15, s41, v15
v_mfma_f32_16x16x32_bf16 a[76:79], a[60:63], a[4:7], a[76:79]
buffer_load_dwordx4 v25, s[16:19], s37 offen offset:1024 lds
s_waitcnt lgkmcnt(8)
v_mfma_f32_16x16x32_bf16 a[80:83], a[32:35], a[8:11], a[80:83]
v_mfma_f32_16x16x32_bf16 a[80:83], a[48:51], a[12:15], a[80:83]
v_mfma_f32_16x16x32_bf16 a[84:87], a[36:39], a[8:11], a[84:87]
v_mfma_f32_16x16x32_bf16 a[84:87], a[52:55], a[12:15], a[84:87]
v_mfma_f32_16x16x32_bf16 a[88:91], a[40:43], a[8:11], a[88:91]
buffer_load_dwordx4 v26, s[16:19], s37 offen offset:2048 lds
v_mfma_f32_16x16x32_bf16 a[88:91], a[56:59], a[12:15], a[88:91]
v_mfma_f32_16x16x32_bf16 a[92:95], a[44:47], a[8:11], a[92:95]
v_mfma_f32_16x16x32_bf16 a[92:95], a[60:63], a[12:15], a[92:95]
s_waitcnt vmcnt(16)
s_waitcnt lgkmcnt(0)
s_barrier
v_mfma_f32_16x16x32_bf16 a[96:99], a[32:35], a[16:19], a[96:99]
ds_read_b64_tr_b16 a[0:1], v8 offset:0
v_mfma_f32_16x16x32_bf16 a[96:99], a[48:51], a[20:23], a[96:99]
ds_read_b64_tr_b16 a[2:3], v8 offset:1024
v_mfma_f32_16x16x32_bf16 a[112:115], a[32:35], a[24:27], a[112:115]
ds_read_b64_tr_b16 a[4:5], v8 offset:8192
v_mfma_f32_16x16x32_bf16 a[112:115], a[48:51], a[28:31], a[112:115]
ds_read_b64_tr_b16 a[6:7], v8 offset:9216
v_mfma_f32_16x16x32_bf16 a[100:103], a[36:39], a[16:19], a[100:103]
ds_read_b128 a[32:35], v18 offset:0
ds_read_b128 a[48:51], v19 offset:0
ds_read_b64_tr_b16 a[8:9], v9 offset:0
v_mfma_f32_16x16x32_bf16 a[100:103], a[52:55], a[20:23], a[100:103]
ds_read_b64_tr_b16 a[10:11], v9 offset:1024
ds_read_b64_tr_b16 a[12:13], v9 offset:8192
ds_read_b64_tr_b16 a[14:15], v9 offset:9216
v_mfma_f32_16x16x32_bf16 a[116:119], a[36:39], a[24:27], a[116:119]
buffer_load_dwordx4 v27, s[16:19], s37 offen offset:3072 lds
s_add_u32 s36, s36, 524288
s_add_u32 s37, s37, 524288
v_mfma_f32_16x16x32_bf16 a[116:119], a[52:55], a[28:31], a[116:119]
s_add_u32 s39, s39, 0x8000
s_cmp_eq_u32 s39, 163840
s_cselect_b32 s39, 65536, s39
v_mfma_f32_16x16x32_bf16 a[104:107], a[40:43], a[16:19], a[104:107]
ds_read_b128 a[36:39], v18 offset:2048
v_mfma_f32_16x16x32_bf16 a[104:107], a[56:59], a[20:23], a[104:107]
v_mfma_f32_16x16x32_bf16 a[120:123], a[40:43], a[24:27], a[120:123]
ds_read_b128 a[52:55], v19 offset:2048
v_mfma_f32_16x16x32_bf16 a[120:123], a[56:59], a[28:31], a[120:123]
v_mfma_f32_16x16x32_bf16 a[108:111], a[44:47], a[16:19], a[108:111]
ds_read_b128 a[40:43], v18 offset:4096
v_mfma_f32_16x16x32_bf16 a[108:111], a[60:63], a[20:23], a[108:111]
ds_read_b128 a[56:59], v19 offset:4096
v_mfma_f32_16x16x32_bf16 a[124:127], a[44:47], a[24:27], a[124:127]
global_load_dword v0, v[60:61], off
v_mfma_f32_16x16x32_bf16 a[124:127], a[60:63], a[28:31], a[124:127]
v_lshl_add_u64 v[60:61], v[60:61], 0, v[62:63]
s_sub_u32 s42, s42, 1
s_cmp_lg_u32 s42, 0
s_cbranch_scc1 L_p1a
s_lshl_b32 s73, s2, 5
s_lshl_b32 s75, s3, 3
s_add_u32 s73, s73, s75
s_add_u32 s73, s73, 62914560
s_lshl_b32 s32, s69, 11
s_add_u32 s33, s32, 30720
s_mov_b32 s34, 0
s_mov_b32 s35, 30720
s_lshl_b32 s36, s3, 17
s_mul_i32 s38, s3, 98304
s_cmp_eq_u32 s39, 98304
s_cselect_b32 s41, s48, s49
s_waitcnt lgkmcnt(9)
v_mfma_f32_16x16x32_bf16 v[64:67], a[0:3], a[32:35], v[64:67]
ds_read_b128 a[44:47], v18 offset:6144
ds_read_b128 a[60:63], v19 offset:6144
s_waitcnt lgkmcnt(10)
v_mfma_f32_16x16x32_bf16 v[64:67], a[4:7], a[48:51], v[64:67]
ds_read_b64_tr_b16 a[16:17], v10 offset:0
ds_read_b64_tr_b16 a[18:19], v10 offset:1024
s_waitcnt lgkmcnt(10)
v_mfma_f32_16x16x32_bf16 v[80:83], a[8:11], a[32:35], v[80:83]
s_add_u32 m0, s39, s45
s_nop 0
buffer_load_dwordx4 v24, s[20:23], s36 offen offset:0 lds
s_waitcnt lgkmcnt(8)
v_mfma_f32_16x16x32_bf16 v[80:83], a[12:15], a[48:51], v[80:83]
v_mov_b32 v56, 0
v_mov_b32 v57, 0
s_waitcnt lgkmcnt(7)
v_mfma_f32_16x16x32_bf16 v[68:71], a[0:3], a[36:39], v[68:71]
v_xor_b32 v18, 0x8000, v18
v_xor_b32 v19, 0x8000, v19
s_waitcnt lgkmcnt(6)
v_mfma_f32_16x16x32_bf16 v[68:71], a[4:7], a[52:55], v[68:71]
ds_read_b64_tr_b16 a[20:21], v10 offset:8192
v_mfma_f32_16x16x32_bf16 v[84:87], a[8:11], a[36:39], v[84:87]
ds_read_b64_tr_b16 a[22:23], v10 offset:9216
v_mfma_f32_16x16x32_bf16 v[84:87], a[12:15], a[52:55], v[84:87]
v_dot2c_f32_bf16 v56, v32, v48
s_waitcnt lgkmcnt(7)
v_mfma_f32_16x16x32_bf16 v[72:75], a[0:3], a[40:43], v[72:75]
ds_read_b64_tr_b16 a[24:25], v11 offset:0
s_waitcnt lgkmcnt(7)
v_mfma_f32_16x16x32_bf16 v[72:75], a[4:7], a[56:59], v[72:75]
ds_read_b64_tr_b16 a[26:27], v11 offset:1024
v_mfma_f32_16x16x32_bf16 v[88:91], a[8:11], a[40:43], v[88:91]
buffer_load_dwordx4 v25, s[20:23], s36 offen offset:1024 lds
v_mfma_f32_16x16x32_bf16 v[88:91], a[12:15], a[56:59], v[88:91]
v_dot2c_f32_bf16 v57, v40, v48
s_waitcnt lgkmcnt(7)
v_mfma_f32_16x16x32_bf16 v[76:79], a[0:3], a[44:47], v[76:79]
ds_read_b64_tr_b16 a[28:29], v11 offset:8192
s_waitcnt lgkmcnt(7)
v_mfma_f32_16x16x32_bf16 v[76:79], a[4:7], a[60:63], v[76:79]
ds_read_b64_tr_b16 a[30:31], v11 offset:9216
v_mfma_f32_16x16x32_bf16 v[92:95], a[8:11], a[44:47], v[92:95]
v_dot2c_f32_bf16 v56, v33, v49
v_mfma_f32_16x16x32_bf16 v[92:95], a[12:15], a[60:63], v[92:95]
s_waitcnt lgkmcnt(4)
v_mfma_f32_16x16x32_bf16 v[96:99], a[16:19], a[32:35], v[96:99]
ds_read_b64_tr_b16 a[0:1], v12 offset:0
v_mfma_f32_16x16x32_bf16 v[96:99], a[20:23], a[48:51], v[96:99]
ds_read_b64_tr_b16 a[2:3], v12 offset:1024
v_mfma_f32_16x16x32_bf16 v[100:103], a[16:19], a[36:39], v[100:103]
buffer_load_dwordx4 v26, s[20:23], s36 offen offset:2048 lds
v_mfma_f32_16x16x32_bf16 v[100:103], a[20:23], a[52:55], v[100:103]
v_dot2c_f32_bf16 v57, v41, v49
v_mfma_f32_16x16x32_bf16 v[104:107], a[16:19], a[40:43], v[104:107]
ds_read_b64_tr_b16 a[4:5], v12 offset:8192
v_mfma_f32_16x16x32_bf16 v[104:107], a[20:23], a[56:59], v[104:107]
ds_read_b64_tr_b16 a[6:7], v12 offset:9216
v_mfma_f32_16x16x32_bf16 v[108:111], a[16:19], a[44:47], v[108:111]
v_dot2c_f32_bf16 v56, v34, v50
v_mfma_f32_16x16x32_bf16 v[108:111], a[20:23], a[60:63], v[108:111]
s_waitcnt lgkmcnt(4)
v_mfma_f32_16x16x32_bf16 v[112:115], a[24:27], a[32:35], v[112:115]
ds_read_b64_tr_b16 a[8:9], v13 offset:0
v_mfma_f32_16x16x32_bf16 v[112:115], a[28:31], a[48:51], v[112:115]
ds_read_b64_tr_b16 a[10:11], v13 offset:1024
v_mfma_f32_16x16x32_bf16 v[116:119], a[24:27], a[36:39], v[116:119]
buffer_load_dwordx4 v27, s[20:23], s36 offen offset:3072 lds
v_mfma_f32_16x16x32_bf16 v[116:119], a[28:31], a[52:55], v[116:119]
v_dot2c_f32_bf16 v57, v42, v50
v_mfma_f32_16x16x32_bf16 v[120:123], a[24:27], a[40:43], v[120:123]
ds_read_b64_tr_b16 a[12:13], v13 offset:8192
ds_read_b64_tr_b16 a[14:15], v13 offset:9216
v_mfma_f32_16x16x32_bf16 v[120:123], a[28:31], a[56:59], v[120:123]
global_load_dword v0, v[60:61], off
v_mfma_f32_16x16x32_bf16 v[124:127], a[24:27], a[44:47], v[124:127]
v_lshl_add_u64 v[60:61], v[60:61], 0, v[62:63]
v_dot2c_f32_bf16 v56, v35, v51
v_mfma_f32_16x16x32_bf16 v[124:127], a[28:31], a[60:63], v[124:127]
v_dot2c_f32_bf16 v57, v43, v51
s_waitcnt lgkmcnt(4)
v_mfma_f32_16x16x32_bf16 v[128:131], a[0:3], a[32:35], v[128:131]
ds_read_b64_tr_b16 a[16:17], v14 offset:0
ds_read_b64_tr_b16 a[18:19], v14 offset:1024
v_mfma_f32_16x16x32_bf16 v[128:131], a[4:7], a[48:51], v[128:131]
s_mov_b32 m0, s40
v_mfma_f32_16x16x32_bf16 v[132:135], a[0:3], a[36:39], v[132:135]
buffer_load_dwordx4 v22, s[12:15], s32 offen offset:0 lds
v_mfma_f32_16x16x32_bf16 v[132:135], a[4:7], a[52:55], v[132:135]
v_dot2c_f32_bf16 v56, v36, v52
v_mfma_f32_16x16x32_bf16 v[136:139], a[0:3], a[40:43], v[136:139]
ds_read_b64_tr_b16 a[20:21], v14 offset:8192
v_mfma_f32_16x16x32_bf16 v[136:139], a[4:7], a[56:59], v[136:139]
ds_read_b64_tr_b16 a[22:23], v14 offset:9216
v_mfma_f32_16x16x32_bf16 v[140:143], a[0:3], a[44:47], v[140:143]
v_dot2c_f32_bf16 v57, v44, v52
v_mfma_f32_16x16x32_bf16 v[140:143], a[4:7], a[60:63], v[140:143]
s_waitcnt lgkmcnt(4)
v_mfma_f32_16x16x32_bf16 v[144:147], a[8:11], a[32:35], v[144:147]
ds_read_b64_tr_b16 a[24:25], v15 offset:0
v_mfma_f32_16x16x32_bf16 v[144:147], a[12:15], a[48:51], v[144:147]
ds_read_b64_tr_b16 a[26:27], v15 offset:1024
v_mfma_f32_16x16x32_bf16 v[148:151], a[8:11], a[36:39], v[148:151]
buffer_load_dwordx4 v23, s[12:15], s32 offen offset:1024 lds
v_mfma_f32_16x16x32_bf16 v[148:151], a[12:15], a[52:55], v[148:151]
v_dot2c_f32_bf16 v56, v37, v53
v_mfma_f32_16x16x32_bf16 v[152:155], a[8:11], a[40:43], v[152:155]
ds_read_b64_tr_b16 a[28:29], v15 offset:8192
v_mfma_f32_16x16x32_bf16 v[152:155], a[12:15], a[56:59], v[152:155]
ds_read_b64_tr_b16 a[30:31], v15 offset:9216
v_mfma_f32_16x16x32_bf16 v[156:159], a[8:11], a[44:47], v[156:159]
v_dot2c_f32_bf16 v57, v45, v53
v_mfma_f32_16x16x32_bf16 v[156:159], a[12:15], a[60:63], v[156:159]
s_waitcnt lgkmcnt(4)
v_mfma_f32_16x16x32_bf16 v[160:163], a[16:19], a[32:35], v[160:163]
ds_read_b64_tr_b16 a[0:1], v8 offset:16384
v_mfma_f32_16x16x32_bf16 v[160:163], a[20:23], a[48:51], v[160:163]
ds_read_b64_tr_b16 a[2:3], v8 offset:17408
v_mfma_f32_16x16x32_bf16 v[164:167], a[16:19], a[36:39], v[164:167]
buffer_load_dwordx4 v22, s[12:15], s33 offen offset:2048 lds
v_mfma_f32_16x16x32_bf16 v[164:167], a[20:23], a[52:55], v[164:167]
v_dot2c_f32_bf16 v56, v38, v54
v_mfma_f32_16x16x32_bf16 v[168:171], a[16:19], a[40:43], v[168:171]
ds_read_b64_tr_b16 a[4:5], v8 offset:24576
ds_read_b64_tr_b16 a[6:7], v8 offset:25600
v_mfma_f32_16x16x32_bf16 v[168:171], a[20:23], a[56:59], v[168:171]
v_add_u32 v8, s41, v8
v_mfma_f32_16x16x32_bf16 v[172:175], a[16:19], a[44:47], v[172:175]
global_load_dword v0, v[60:61], off
v_lshl_add_u64 v[60:61], v[60:61], 0, v[62:63]
v_mfma_f32_16x16x32_bf16 v[172:175], a[20:23], a[60:63], v[172:175]
v_dot2c_f32_bf16 v57, v46, v54
s_waitcnt lgkmcnt(4)
v_mfma_f32_16x16x32_bf16 v[176:179], a[24:27], a[32:35], v[176:179]
ds_read_b64_tr_b16 a[8:9], v9 offset:16384
v_mfma_f32_16x16x32_bf16 v[176:179], a[28:31], a[48:51], v[176:179]
ds_read_b64_tr_b16 a[10:11], v9 offset:17408
v_mfma_f32_16x16x32_bf16 v[180:183], a[24:27], a[36:39], v[180:183]
buffer_load_dwordx4 v23, s[12:15], s33 offen offset:3072 lds
v_mfma_f32_16x16x32_bf16 v[180:183], a[28:31], a[52:55], v[180:183]
v_dot2c_f32_bf16 v56, v39, v55
v_mfma_f32_16x16x32_bf16 v[184:187], a[24:27], a[40:43], v[184:187]
ds_read_b64_tr_b16 a[12:13], v9 offset:24576
ds_read_b64_tr_b16 a[14:15], v9 offset:25600
v_mfma_f32_16x16x32_bf16 v[184:187], a[28:31], a[56:59], v[184:187]
v_add_u32 v9, s41, v9
v_mfma_f32_16x16x32_bf16 v[188:191], a[24:27], a[44:47], v[188:191]
v_dot2c_f32_bf16 v57, v47, v55
v_mfma_f32_16x16x32_bf16 v[188:191], a[28:31], a[60:63], v[188:191]
s_nop 1
v_permlane32_swap_b32 v56, v57
s_waitcnt lgkmcnt(4)
v_mfma_f32_16x16x32_bf16 v[192:195], a[32:35], a[0:3], v[192:195]
ds_read_b64_tr_b16 a[16:17], v10 offset:16384
ds_read_b64_tr_b16 a[18:19], v10 offset:17408
v_mfma_f32_16x16x32_bf16 v[192:195], a[48:51], a[4:7], v[192:195]
s_add_u32 m0, s40, 4096
v_mfma_f32_16x16x32_bf16 v[196:199], a[36:39], a[0:3], v[196:199]
buffer_load_dwordx4 v22, s[12:15], s34 offen offset:0 lds
v_mfma_f32_16x16x32_bf16 v[196:199], a[52:55], a[4:7], v[196:199]
v_add_f32 v56, v56, v57
v_mfma_f32_16x16x32_bf16 v[200:203], a[40:43], a[0:3], v[200:203]
ds_read_b64_tr_b16 a[20:21], v10 offset:24576
v_mfma_f32_16x16x32_bf16 v[200:203], a[56:59], a[4:7], v[200:203]
ds_read_b64_tr_b16 a[22:23], v10 offset:25600
v_mfma_f32_16x16x32_bf16 v[204:207], a[44:47], a[0:3], v[204:207]
v_add_u32 v10, s41, v10
v_mfma_f32_16x16x32_bf16 v[204:207], a[60:63], a[4:7], v[204:207]
v_mov_b32 v57, v56
s_waitcnt lgkmcnt(4)
v_mfma_f32_16x16x32_bf16 v[208:211], a[32:35], a[8:11], v[208:211]
ds_read_b64_tr_b16 a[24:25], v11 offset:16384
v_mfma_f32_16x16x32_bf16 v[208:211], a[48:51], a[12:15], v[208:211]
ds_read_b64_tr_b16 a[26:27], v11 offset:17408
v_mfma_f32_16x16x32_bf16 v[212:215], a[36:39], a[8:11], v[212:215]
buffer_load_dwordx4 v23, s[12:15], s34 offen offset:1024 lds
v_mfma_f32_16x16x32_bf16 v[212:215], a[52:55], a[12:15], v[212:215]
v_permlane16_swap_b32 v56, v57
v_mfma_f32_16x16x32_bf16 v[216:219], a[40:43], a[8:11], v[216:219]
ds_read_b64_tr_b16 a[28:29], v11 offset:24576
ds_read_b64_tr_b16 a[30:31], v11 offset:25600
v_mfma_f32_16x16x32_bf16 v[216:219], a[56:59], a[12:15], v[216:219]
v_add_u32 v11, s41, v11
v_mfma_f32_16x16x32_bf16 v[220:223], a[44:47], a[8:11], v[220:223]
global_load_dword v0, v[60:61], off
v_lshl_add_u64 v[60:61], v[60:61], 0, v[62:63]
v_mfma_f32_16x16x32_bf16 v[220:223], a[60:63], a[12:15], v[220:223]
v_add_f32 v56, v56, v57
s_waitcnt lgkmcnt(4)
v_mfma_f32_16x16x32_bf16 v[224:227], a[32:35], a[16:19], v[224:227]
ds_read_b64_tr_b16 a[0:1], v12 offset:16384
v_mfma_f32_16x16x32_bf16 v[224:227], a[48:51], a[20:23], v[224:227]
ds_read_b64_tr_b16 a[2:3], v12 offset:17408
v_mfma_f32_16x16x32_bf16 v[228:231], a[36:39], a[16:19], v[228:231]
buffer_load_dwordx4 v22, s[12:15], s35 offen offset:2048 lds
v_mfma_f32_16x16x32_bf16 v[228:231], a[52:55], a[20:23], v[228:231]
v_add_f32_dpp v56, v56, v56 row_ror:8 row_mask:0xf bank_mask:0xf
v_mfma_f32_16x16x32_bf16 v[232:235], a[40:43], a[16:19], v[232:235]
ds_read_b64_tr_b16 a[4:5], v12 offset:24576
v_mfma_f32_16x16x32_bf16 v[232:235], a[56:59], a[20:23], v[232:235]
ds_read_b64_tr_b16 a[6:7], v12 offset:25600
v_mfma_f32_16x16x32_bf16 v[236:239], a[44:47], a[16:19], v[236:239]
v_add_u32 v12, s41, v12
v_mfma_f32_16x16x32_bf16 v[236:239], a[60:63], a[20:23], v[236:239]
v_add_f32_dpp v56, v56, v56 row_ror:4 row_mask:0xf bank_mask:0xf
s_waitcnt lgkmcnt(4)
v_mfma_f32_16x16x32_bf16 v[240:243], a[32:35], a[24:27], v[240:243]
ds_read_b64_tr_b16 a[8:9], v13 offset:16384
ds_read_b64_tr_b16 a[10:11], v13 offset:17408
buffer_load_dwordx4 v23, s[12:15], s35 offen offset:3072 lds
v_mfma_f32_16x16x32_bf16 v[240:243], a[48:51], a[28:31], v[240:243]
s_add_u32 s32, s32, 128
s_add_u32 s33, s33, 128
v_mfma_f32_16x16x32_bf16 v[244:247], a[36:39], a[24:27], v[244:247]
s_add_u32 s34, s34, 128
s_add_u32 s35, s35, 128
s_xor_b32 s40, s40, 0x8000
v_mfma_f32_16x16x32_bf16 v[244:247], a[52:55], a[28:31], v[244:247]
v_add_f32_dpp v56, v56, v56 row_ror:2 row_mask:0xf bank_mask:0xf
s_nop 1
v_add_f32_dpp v56, v56, v56 row_ror:1 row_mask:0xf bank_mask:0xf
v_mfma_f32_16x16x32_bf16 v[248:251], a[40:43], a[24:27], v[248:251]
ds_read_b64_tr_b16 a[12:13], v13 offset:24576
v_mfma_f32_16x16x32_bf16 v[248:251], a[56:59], a[28:31], v[248:251]
ds_read_b64_tr_b16 a[14:15], v13 offset:25600
v_mfma_f32_16x16x32_bf16 v[252:255], a[44:47], a[24:27], v[252:255]
v_add_u32 v13, s41, v13
v_mfma_f32_16x16x32_bf16 v[252:255], a[60:63], a[28:31], v[252:255]
v_mul_f32 v56, 0xbfb8aa3b, v56
s_waitcnt lgkmcnt(4)
v_mfma_f32_16x16x32_bf16 a[64:67], a[32:35], a[0:3], a[64:67]
ds_read_b64_tr_b16 a[16:17], v14 offset:16384
ds_read_b64_tr_b16 a[18:19], v14 offset:17408
v_mfma_f32_16x16x32_bf16 a[64:67], a[48:51], a[4:7], a[64:67]
ds_read_b64_tr_b16 a[20:21], v14 offset:24576
ds_read_b64_tr_b16 a[22:23], v14 offset:25600
v_mfma_f32_16x16x32_bf16 a[68:71], a[36:39], a[0:3], a[68:71]
v_add_u32 v14, s41, v14
s_add_u32 m0, s39, s46
v_mfma_f32_16x16x32_bf16 a[68:71], a[52:55], a[4:7], a[68:71]
buffer_load_dwordx4 v28, s[24:27], s38 offen offset:0 lds
v_exp_f32 v56, v56
v_mfma_f32_16x16x32_bf16 a[72:75], a[40:43], a[0:3], a[72:75]
ds_read_b64_tr_b16 a[24:25], v15 offset:16384
ds_read_b64_tr_b16 a[26:27], v15 offset:17408
ds_read_b64_tr_b16 a[28:29], v15 offset:24576
v_mfma_f32_16x16x32_bf16 a[72:75], a[56:59], a[4:7], a[72:75]
ds_read_b64_tr_b16 a[30:31], v15 offset:25600
v_add_u32 v15, s41, v15
v_mfma_f32_16x16x32_bf16 a[76:79], a[44:47], a[0:3], a[76:79]
v_add_u32 v16, s41, v16
v_add_u32 v17, s41, v17
global_load_dword v0, v[60:61], off
v_mfma_f32_16x16x32_bf16 a[76:79], a[60:63], a[4:7], a[76:79]
v_lshl_add_u64 v[60:61], v[60:61], 0, v[62:63]
v_add_f32 v56, 1.0, v56
s_waitcnt lgkmcnt(8)
v_mfma_f32_16x16x32_bf16 a[80:83], a[32:35], a[8:11], a[80:83]
buffer_load_dwordx4 v29, s[24:27], s38 offen offset:1024 lds
v_mfma_f32_16x16x32_bf16 a[80:83], a[48:51], a[12:15], a[80:83]
v_mfma_f32_16x16x32_bf16 a[84:87], a[36:39], a[8:11], a[84:87]
v_rcp_f32 v56, v56
v_mfma_f32_16x16x32_bf16 a[84:87], a[52:55], a[12:15], a[84:87]
v_mfma_f32_16x16x32_bf16 a[88:91], a[40:43], a[8:11], a[88:91]
v_lshrrev_b32 v57, 5, v1
v_mfma_f32_16x16x32_bf16 a[88:91], a[56:59], a[12:15], a[88:91]
v_mfma_f32_16x16x32_bf16 a[92:95], a[44:47], a[8:11], a[92:95]
v_mfma_f32_16x16x32_bf16 a[92:95], a[60:63], a[12:15], a[92:95]
s_waitcnt vmcnt(19)
s_waitcnt lgkmcnt(0)
s_barrier
v_mfma_f32_16x16x32_bf16 a[96:99], a[32:35], a[16:19], a[96:99]
ds_read_b64_tr_b16 a[0:1], v8 offset:0
ds_read_b64_tr_b16 a[2:3], v8 offset:1024
ds_read_b64_tr_b16 a[4:5], v8 offset:8192
v_mfma_f32_16x16x32_bf16 a[96:99], a[48:51], a[20:23], a[96:99]
ds_read_b64_tr_b16 a[6:7], v8 offset:9216
buffer_load_dwordx4 v30, s[24:27], s38 offen offset:2048 lds
s_add_u32 s36, s36, 524288
v_mfma_f32_16x16x32_bf16 a[112:115], a[32:35], a[24:27], a[112:115]
s_add_u32 s38, s38, 393216
s_add_u32 s39, s39, 0x8000
s_cmp_eq_u32 s39, 163840
v_mfma_f32_16x16x32_bf16 a[112:115], a[48:51], a[28:31], a[112:115]
s_cselect_b32 s39, 65536, s39
v_lshlrev_b32 v57, 2, v57
v_mfma_f32_16x16x32_bf16 a[100:103], a[36:39], a[16:19], a[100:103]
ds_read_b128 a[32:35], v18 offset:0
v_mfma_f32_16x16x32_bf16 a[100:103], a[52:55], a[20:23], a[100:103]
ds_read_b128 a[48:51], v19 offset:0
ds_read_b64_tr_b16 a[8:9], v9 offset:0
v_mfma_f32_16x16x32_bf16 a[116:119], a[36:39], a[24:27], a[116:119]
ds_read_b64_tr_b16 a[10:11], v9 offset:1024
ds_read_b64_tr_b16 a[12:13], v9 offset:8192
v_mfma_f32_16x16x32_bf16 a[116:119], a[52:55], a[28:31], a[116:119]
ds_read_b64_tr_b16 a[14:15], v9 offset:9216
buffer_store_dword v56, v57, s[28:31], s73 offen sc1
v_mfma_f32_16x16x32_bf16 a[104:107], a[40:43], a[16:19], a[104:107]
ds_read_b128 a[36:39], v18 offset:2048
v_mfma_f32_16x16x32_bf16 a[104:107], a[56:59], a[20:23], a[104:107]
v_mfma_f32_16x16x32_bf16 a[120:123], a[40:43], a[24:27], a[120:123]
ds_read_b128 a[52:55], v19 offset:2048
v_mfma_f32_16x16x32_bf16 a[120:123], a[56:59], a[28:31], a[120:123]
v_mfma_f32_16x16x32_bf16 a[108:111], a[44:47], a[16:19], a[108:111]
ds_read_b128 a[40:43], v18 offset:4096
v_mfma_f32_16x16x32_bf16 a[108:111], a[60:63], a[20:23], a[108:111]
ds_read_b128 a[56:59], v19 offset:4096
v_mfma_f32_16x16x32_bf16 a[124:127], a[44:47], a[24:27], a[124:127]
global_load_dword v0, v[60:61], off
v_mfma_f32_16x16x32_bf16 a[124:127], a[60:63], a[28:31], a[124:127]
v_lshl_add_u64 v[60:61], v[60:61], 0, v[62:63]
s_cmp_eq_u32 s39, 98304
s_cselect_b32 s41, s48, s49
s_waitcnt lgkmcnt(9)
v_mfma_f32_16x16x32_bf16 v[64:67], a[0:3], a[32:35], v[64:67]
ds_read_b128 a[44:47], v18 offset:6144
ds_read_b128 a[60:63], v19 offset:6144
s_waitcnt lgkmcnt(10)
v_mfma_f32_16x16x32_bf16 v[64:67], a[4:7], a[48:51], v[64:67]
ds_read_b64_tr_b16 a[16:17], v10 offset:0
s_waitcnt lgkmcnt(9)
v_mfma_f32_16x16x32_bf16 v[80:83], a[8:11], a[32:35], v[80:83]
ds_read_b64_tr_b16 a[18:19], v10 offset:1024
s_add_u32 m0, s39, s45
s_waitcnt lgkmcnt(8)
v_mfma_f32_16x16x32_bf16 v[80:83], a[12:15], a[48:51], v[80:83]
buffer_load_dwordx4 v24, s[20:23], s36 offen offset:0 lds
s_waitcnt lgkmcnt(7)
v_mfma_f32_16x16x32_bf16 v[68:71], a[0:3], a[36:39], v[68:71]
v_xor_b32 v18, 0x8000, v18
s_waitcnt lgkmcnt(6)
v_mfma_f32_16x16x32_bf16 v[68:71], a[4:7], a[52:55], v[68:71]
v_xor_b32 v19, 0x8000, v19
v_mfma_f32_16x16x32_bf16 v[84:87], a[8:11], a[36:39], v[84:87]
ds_read_b64_tr_b16 a[20:21], v10 offset:8192
v_mfma_f32_16x16x32_bf16 v[84:87], a[12:15], a[52:55], v[84:87]
ds_read_b64_tr_b16 a[22:23], v10 offset:9216
s_waitcnt lgkmcnt(7)
v_mfma_f32_16x16x32_bf16 v[72:75], a[0:3], a[40:43], v[72:75]
ds_read_b64_tr_b16 a[24:25], v11 offset:0
ds_read_b64_tr_b16 a[26:27], v11 offset:1024
s_mul_i32 s74, s4, 0x110000
s_waitcnt lgkmcnt(8)
v_mfma_f32_16x16x32_bf16 v[72:75], a[4:7], a[56:59], v[72:75]
s_lshl_b32 s75, s68, 9
s_add_u32 s75, s75, s74
s_lshl_b32 s74, s69, 9
v_mfma_f32_16x16x32_bf16 v[88:91], a[8:11], a[40:43], v[88:91]
s_add_u32 s74, s74, s75
s_add_u32 s76, s74, 0
s_add_u32 s77, s74, 4096
v_mfma_f32_16x16x32_bf16 v[88:91], a[12:15], a[56:59], v[88:91]
s_add_u32 s78, s74, 8192
s_add_u32 s79, s74, 12288
buffer_load_dwordx4 v25, s[20:23], s36 offen offset:1024 lds
s_waitcnt lgkmcnt(7)
v_mfma_f32_16x16x32_bf16 v[76:79], a[0:3], a[44:47], v[76:79]
ds_read_b64_tr_b16 a[28:29], v11 offset:8192
ds_read_b64_tr_b16 a[30:31], v11 offset:9216
s_waitcnt lgkmcnt(8)
v_mfma_f32_16x16x32_bf16 v[76:79], a[4:7], a[60:63], v[76:79]
s_add_u32 s80, s75, 0
s_add_u32 s81, s75, 4096
v_mfma_f32_16x16x32_bf16 v[92:95], a[8:11], a[44:47], v[92:95]
s_add_u32 s82, s75, 8192
s_add_u32 s83, s75, 12288
v_mfma_f32_16x16x32_bf16 v[92:95], a[12:15], a[60:63], v[92:95]
v_lshlrev_b32 v31, 4, v1
s_waitcnt lgkmcnt(4)
v_mfma_f32_16x16x32_bf16 v[96:99], a[16:19], a[32:35], v[96:99]
ds_read_b64_tr_b16 a[0:1], v12 offset:0
v_mfma_f32_16x16x32_bf16 v[96:99], a[20:23], a[48:51], v[96:99]
ds_read_b64_tr_b16 a[2:3], v12 offset:1024
v_mfma_f32_16x16x32_bf16 v[100:103], a[16:19], a[36:39], v[100:103]
buffer_load_dwordx4 v26, s[20:23], s36 offen offset:2048 lds
v_mfma_f32_16x16x32_bf16 v[100:103], a[20:23], a[52:55], v[100:103]
v_mfma_f32_16x16x32_bf16 v[104:107], a[16:19], a[40:43], v[104:107]
ds_read_b64_tr_b16 a[4:5], v12 offset:8192
ds_read_b64_tr_b16 a[6:7], v12 offset:9216
v_cvt_pk_bf16_f32 v32, v64, v65
v_mfma_f32_16x16x32_bf16 v[104:107], a[20:23], a[56:59], v[104:107]
v_cvt_pk_bf16_f32 v33, v66, v67
v_cvt_pk_bf16_f32 v34, v80, v81
v_cvt_pk_bf16_f32 v35, v82, v83
v_mfma_f32_16x16x32_bf16 v[108:111], a[16:19], a[44:47], v[108:111]
v_accvgpr_write_b32 a128, v32
v_accvgpr_write_b32 a129, v33
v_accvgpr_write_b32 a130, v34
v_mfma_f32_16x16x32_bf16 v[108:111], a[20:23], a[60:63], v[108:111]
v_accvgpr_write_b32 a131, v35
v_cvt_pk_bf16_f32 v36, v68, v69
s_waitcnt lgkmcnt(4)
v_mfma_f32_16x16x32_bf16 v[112:115], a[24:27], a[32:35], v[112:115]
ds_read_b64_tr_b16 a[8:9], v13 offset:0
ds_read_b64_tr_b16 a[10:11], v13 offset:1024
v_cvt_pk_bf16_f32 v37, v70, v71
v_mfma_f32_16x16x32_bf16 v[112:115], a[28:31], a[48:51], v[112:115]
v_cvt_pk_bf16_f32 v38, v84, v85
v_cvt_pk_bf16_f32 v39, v86, v87
v_accvgpr_write_b32 a144, v36
v_mfma_f32_16x16x32_bf16 v[116:119], a[24:27], a[36:39], v[116:119]
v_accvgpr_write_b32 a145, v37
v_accvgpr_write_b32 a146, v38
v_accvgpr_write_b32 a147, v39
v_mfma_f32_16x16x32_bf16 v[116:119], a[28:31], a[52:55], v[116:119]
v_cvt_pk_bf16_f32 v40, v72, v73
v_cvt_pk_bf16_f32 v41, v74, v75
buffer_load_dwordx4 v27, s[20:23], s36 offen offset:3072 lds
v_mfma_f32_16x16x32_bf16 v[120:123], a[24:27], a[40:43], v[120:123]
ds_read_b64_tr_b16 a[12:13], v13 offset:8192
ds_read_b64_tr_b16 a[14:15], v13 offset:9216
v_cvt_pk_bf16_f32 v42, v88, v89
v_cvt_pk_bf16_f32 v43, v90, v91
v_mfma_f32_16x16x32_bf16 v[120:123], a[28:31], a[56:59], v[120:123]
v_accvgpr_write_b32 a192, v40
v_accvgpr_write_b32 a193, v41
v_accvgpr_write_b32 a194, v42
v_mfma_f32_16x16x32_bf16 v[124:127], a[24:27], a[44:47], v[124:127]
v_accvgpr_write_b32 a195, v43
v_cvt_pk_bf16_f32 v44, v76, v77
v_cvt_pk_bf16_f32 v45, v78, v79
v_mfma_f32_16x16x32_bf16 v[124:127], a[28:31], a[60:63], v[124:127]
v_cvt_pk_bf16_f32 v46, v92, v93
global_load_dword v0, v[60:61], off
v_lshl_add_u64 v[60:61], v[60:61], 0, v[62:63]
s_waitcnt lgkmcnt(4)
v_mfma_f32_16x16x32_bf16 v[128:131], a[0:3], a[32:35], v[128:131]
ds_read_b64_tr_b16 a[16:17], v14 offset:0
ds_read_b64_tr_b16 a[18:19], v14 offset:1024
v_cvt_pk_bf16_f32 v47, v94, v95
v_mfma_f32_16x16x32_bf16 v[128:131], a[4:7], a[48:51], v[128:131]
v_accvgpr_write_b32 a208, v44
v_accvgpr_write_b32 a209, v45
v_mfma_f32_16x16x32_bf16 v[132:135], a[0:3], a[36:39], v[132:135]
v_accvgpr_write_b32 a210, v46
v_accvgpr_write_b32 a211, v47
v_mfma_f32_16x16x32_bf16 v[132:135], a[4:7], a[52:55], v[132:135]
s_mov_b32 m0, s40
s_nop 0
buffer_load_dwordx4 v22, s[12:15], s32 offen offset:0 lds
v_mfma_f32_16x16x32_bf16 v[136:139], a[0:3], a[40:43], v[136:139]
ds_read_b64_tr_b16 a[20:21], v14 offset:8192
ds_read_b64_tr_b16 a[22:23], v14 offset:9216
v_cvt_pk_bf16_f32 v32, v96, v97
v_mfma_f32_16x16x32_bf16 v[136:139], a[4:7], a[56:59], v[136:139]
v_cvt_pk_bf16_f32 v33, v98, v99
v_cvt_pk_bf16_f32 v34, v112, v113
v_cvt_pk_bf16_f32 v35, v114, v115
v_mfma_f32_16x16x32_bf16 v[140:143], a[0:3], a[44:47], v[140:143]
v_accvgpr_write_b32 a132, v32
v_accvgpr_write_b32 a133, v33
v_accvgpr_write_b32 a134, v34
v_mfma_f32_16x16x32_bf16 v[140:143], a[4:7], a[60:63], v[140:143]
v_accvgpr_write_b32 a135, v35
v_cvt_pk_bf16_f32 v36, v100, v101
s_waitcnt lgkmcnt(4)
v_mfma_f32_16x16x32_bf16 v[144:147], a[8:11], a[32:35], v[144:147]
ds_read_b64_tr_b16 a[24:25], v15 offset:0
ds_read_b64_tr_b16 a[26:27], v15 offset:1024
v_cvt_pk_bf16_f32 v37, v102, v103
v_mfma_f32_16x16x32_bf16 v[144:147], a[12:15], a[48:51], v[144:147]
v_cvt_pk_bf16_f32 v38, v116, v117
v_cvt_pk_bf16_f32 v39, v118, v119
v_accvgpr_write_b32 a148, v36
v_mfma_f32_16x16x32_bf16 v[148:151], a[8:11], a[36:39], v[148:151]
v_accvgpr_write_b32 a149, v37
v_accvgpr_write_b32 a150, v38
v_accvgpr_write_b32 a151, v39
v_mfma_f32_16x16x32_bf16 v[148:151], a[12:15], a[52:55], v[148:151]
v_cvt_pk_bf16_f32 v40, v104, v105
v_cvt_pk_bf16_f32 v41, v106, v107
buffer_load_dwordx4 v23, s[12:15], s32 offen offset:1024 lds
v_mfma_f32_16x16x32_bf16 v[152:155], a[8:11], a[40:43], v[152:155]
ds_read_b64_tr_b16 a[28:29], v15 offset:8192
ds_read_b64_tr_b16 a[30:31], v15 offset:9216
v_cvt_pk_bf16_f32 v42, v120, v121
v_mfma_f32_16x16x32_bf16 v[152:155], a[12:15], a[56:59], v[152:155]
v_cvt_pk_bf16_f32 v43, v122, v123
v_accvgpr_write_b32 a196, v40
v_accvgpr_write_b32 a197, v41
v_mfma_f32_16x16x32_bf16 v[156:159], a[8:11], a[44:47], v[156:159]
v_accvgpr_write_b32 a198, v42
v_accvgpr_write_b32 a199, v43
v_cvt_pk_bf16_f32 v44, v108, v109
v_mfma_f32_16x16x32_bf16 v[156:159], a[12:15], a[60:63], v[156:159]
v_cvt_pk_bf16_f32 v45, v110, v111
v_cvt_pk_bf16_f32 v46, v124, v125
s_waitcnt lgkmcnt(4)
v_mfma_f32_16x16x32_bf16 v[160:163], a[16:19], a[32:35], v[160:163]
ds_read_b64_tr_b16 a[0:1], v8 offset:16384
ds_read_b64_tr_b16 a[2:3], v8 offset:17408
v_mfma_f32_16x16x32_bf16 v[160:163], a[20:23], a[48:51], v[160:163]
v_cvt_pk_bf16_f32 v47, v126, v127
v_accvgpr_write_b32 a212, v44
v_mfma_f32_16x16x32_bf16 v[164:167], a[16:19], a[36:39], v[164:167]
v_accvgpr_write_b32 a213, v45
v_accvgpr_write_b32 a214, v46
v_mfma_f32_16x16x32_bf16 v[164:167], a[20:23], a[52:55], v[164:167]
v_accvgpr_write_b32 a215, v47
buffer_load_dwordx4 v22, s[12:15], s33 offen offset:2048 lds
v_mfma_f32_16x16x32_bf16 v[168:171], a[16:19], a[40:43], v[168:171]
ds_read_b64_tr_b16 a[4:5], v8 offset:24576
ds_read_b64_tr_b16 a[6:7], v8 offset:25600
v_add_u32 v8, s41, v8
v_cvt_pk_bf16_f32 v32, v128, v129
v_mfma_f32_16x16x32_bf16 v[168:171], a[20:23], a[56:59], v[168:171]
v_cvt_pk_bf16_f32 v33, v130, v131
v_cvt_pk_bf16_f32 v34, v144, v145
v_cvt_pk_bf16_f32 v35, v146, v147
v_mfma_f32_16x16x32_bf16 v[172:175], a[16:19], a[44:47], v[172:175]
v_accvgpr_write_b32 a136, v32
v_accvgpr_write_b32 a137, v33
v_accvgpr_write_b32 a138, v34
v_accvgpr_write_b32 a139, v35
v_mfma_f32_16x16x32_bf16 v[172:175], a[20:23], a[60:63], v[172:175]
v_cvt_pk_bf16_f32 v36, v132, v133
global_load_dword v0, v[60:61], off
v_lshl_add_u64 v[60:61], v[60:61], 0, v[62:63]
s_waitcnt lgkmcnt(4)
v_mfma_f32_16x16x32_bf16 v[176:179], a[24:27], a[32:35], v[176:179]
ds_read_b64_tr_b16 a[8:9], v9 offset:16384
ds_read_b64_tr_b16 a[10:11], v9 offset:17408
v_cvt_pk_bf16_f32 v37, v134, v135
v_mfma_f32_16x16x32_bf16 v[176:179], a[28:31], a[48:51], v[176:179]
v_cvt_pk_bf16_f32 v38, v148, v149
v_cvt_pk_bf16_f32 v39, v150, v151
v_accvgpr_write_b32 a152, v36
v_mfma_f32_16x16x32_bf16 v[180:183], a[24:27], a[36:39], v[180:183]
v_accvgpr_write_b32 a153, v37
v_accvgpr_write_b32 a154, v38
v_accvgpr_write_b32 a155, v39
v_mfma_f32_16x16x32_bf16 v[180:183], a[28:31], a[52:55], v[180:183]
v_cvt_pk_bf16_f32 v40, v136, v137
v_cvt_pk_bf16_f32 v41, v138, v139
buffer_load_dwordx4 v23, s[12:15], s33 offen offset:3072 lds
v_mfma_f32_16x16x32_bf16 v[184:187], a[24:27], a[40:43], v[184:187]
ds_read_b64_tr_b16 a[12:13], v9 offset:24576
ds_read_b64_tr_b16 a[14:15], v9 offset:25600
v_add_u32 v9, s41, v9
v_mfma_f32_16x16x32_bf16 v[184:187], a[28:31], a[56:59], v[184:187]
v_cvt_pk_bf16_f32 v42, v152, v153
v_cvt_pk_bf16_f32 v43, v154, v155
v_accvgpr_write_b32 a200, v40
v_mfma_f32_16x16x32_bf16 v[188:191], a[24:27], a[44:47], v[188:191]
v_accvgpr_write_b32 a201, v41
v_accvgpr_write_b32 a202, v42
v_accvgpr_write_b32 a203, v43
v_mfma_f32_16x16x32_bf16 v[188:191], a[28:31], a[60:63], v[188:191]
v_cvt_pk_bf16_f32 v44, v140, v141
v_cvt_pk_bf16_f32 v45, v142, v143
v_cvt_pk_bf16_f32 v46, v156, v157
s_waitcnt lgkmcnt(4)
v_mfma_f32_16x16x32_bf16 v[192:195], a[32:35], a[0:3], v[192:195]
ds_read_b64_tr_b16 a[16:17], v10 offset:16384
ds_read_b64_tr_b16 a[18:19], v10 offset:17408
v_cvt_pk_bf16_f32 v47, v158, v159
v_mfma_f32_16x16x32_bf16 v[192:195], a[48:51], a[4:7], v[192:195]
v_accvgpr_write_b32 a216, v44
v_accvgpr_write_b32 a217, v45
v_mfma_f32_16x16x32_bf16 v[196:199], a[36:39], a[0:3], v[196:199]
v_accvgpr_write_b32 a218, v46
v_accvgpr_write_b32 a219, v47
v_mfma_f32_16x16x32_bf16 v[196:199], a[52:55], a[4:7], v[196:199]
s_add_u32 m0, s40, 4096
s_nop 0
buffer_load_dwordx4 v22, s[12:15], s34 offen offset:0 lds
v_mfma_f32_16x16x32_bf16 v[200:203], a[40:43], a[0:3], v[200:203]
ds_read_b64_tr_b16 a[20:21], v10 offset:24576
ds_read_b64_tr_b16 a[22:23], v10 offset:25600
v_add_u32 v10, s41, v10
v_mfma_f32_16x16x32_bf16 v[200:203], a[56:59], a[4:7], v[200:203]
v_cvt_pk_bf16_f32 v32, v160, v161
v_cvt_pk_bf16_f32 v33, v162, v163
v_cvt_pk_bf16_f32 v34, v176, v177
v_mfma_f32_16x16x32_bf16 v[204:207], a[44:47], a[0:3], v[204:207]
v_cvt_pk_bf16_f32 v35, v178, v179
v_accvgpr_write_b32 a140, v32
v_accvgpr_write_b32 a141, v33
v_mfma_f32_16x16x32_bf16 v[204:207], a[60:63], a[4:7], v[204:207]
v_accvgpr_write_b32 a142, v34
v_accvgpr_write_b32 a143, v35
v_cvt_pk_bf16_f32 v36, v164, v165
s_waitcnt lgkmcnt(4)
v_mfma_f32_16x16x32_bf16 v[208:211], a[32:35], a[8:11], v[208:211]
ds_read_b64_tr_b16 a[24:25], v11 offset:16384
ds_read_b64_tr_b16 a[26:27], v11 offset:17408
v_cvt_pk_bf16_f32 v37, v166, v167
v_mfma_f32_16x16x32_bf16 v[208:211], a[48:51], a[12:15], v[208:211]
v_cvt_pk_bf16_f32 v38, v180, v181
v_cvt_pk_bf16_f32 v39, v182, v183
v_accvgpr_write_b32 a156, v36
v_mfma_f32_16x16x32_bf16 v[212:215], a[36:39], a[8:11], v[212:215]
v_accvgpr_write_b32 a157, v37
v_accvgpr_write_b32 a158, v38
v_accvgpr_write_b32 a159, v39
v_mfma_f32_16x16x32_bf16 v[212:215], a[52:55], a[12:15], v[212:215]
v_cvt_pk_bf16_f32 v40, v168, v169
v_cvt_pk_bf16_f32 v41, v170, v171
buffer_load_dwordx4 v23, s[12:15], s34 offen offset:1024 lds
v_mfma_f32_16x16x32_bf16 v[216:219], a[40:43], a[8:11], v[216:219]
ds_read_b64_tr_b16 a[28:29], v11 offset:24576
ds_read_b64_tr_b16 a[30:31], v11 offset:25600
v_add_u32 v11, s41, v11
v_cvt_pk_bf16_f32 v42, v184, v185
v_mfma_f32_16x16x32_bf16 v[216:219], a[56:59], a[12:15], v[216:219]
v_cvt_pk_bf16_f32 v43, v186, v187
v_accvgpr_write_b32 a204, v40
v_accvgpr_write_b32 a205, v41
v_mfma_f32_16x16x32_bf16 v[220:223], a[44:47], a[8:11], v[220:223]
v_accvgpr_write_b32 a206, v42
v_accvgpr_write_b32 a207, v43
v_cvt_pk_bf16_f32 v44, v172, v173
v_cvt_pk_bf16_f32 v45, v174, v175
v_mfma_f32_16x16x32_bf16 v[220:223], a[60:63], a[12:15], v[220:223]
v_cvt_pk_bf16_f32 v46, v188, v189
global_load_dword v0, v[60:61], off
v_lshl_add_u64 v[60:61], v[60:61], 0, v[62:63]
s_waitcnt lgkmcnt(4)
v_mfma_f32_16x16x32_bf16 v[224:227], a[32:35], a[16:19], v[224:227]
ds_read_b64_tr_b16 a[0:1], v12 offset:16384
ds_read_b64_tr_b16 a[2:3], v12 offset:17408
v_cvt_pk_bf16_f32 v47, v190, v191
v_mfma_f32_16x16x32_bf16 v[224:227], a[48:51], a[20:23], v[224:227]
v_accvgpr_write_b32 a220, v44
v_accvgpr_write_b32 a221, v45
v_accvgpr_write_b32 a222, v46
v_mfma_f32_16x16x32_bf16 v[228:231], a[36:39], a[16:19], v[228:231]
v_accvgpr_write_b32 a223, v47
v_cvt_pk_bf16_f32 v32, v192, v193
v_cvt_pk_bf16_f32 v33, v194, v195
v_mfma_f32_16x16x32_bf16 v[228:231], a[52:55], a[20:23], v[228:231]
v_cvt_pk_bf16_f32 v34, v196, v197
v_cvt_pk_bf16_f32 v35, v198, v199
buffer_load_dwordx4 v22, s[12:15], s35 offen offset:2048 lds
v_mfma_f32_16x16x32_bf16 v[232:235], a[40:43], a[16:19], v[232:235]
ds_read_b64_tr_b16 a[4:5], v12 offset:24576
ds_read_b64_tr_b16 a[6:7], v12 offset:25600
v_add_u32 v12, s41, v12
v_mfma_f32_16x16x32_bf16 v[232:235], a[56:59], a[20:23], v[232:235]
v_accvgpr_write_b32 a160, v32
v_accvgpr_write_b32 a161, v33
v_accvgpr_write_b32 a162, v34
v_mfma_f32_16x16x32_bf16 v[236:239], a[44:47], a[16:19], v[236:239]
v_accvgpr_write_b32 a163, v35
v_cvt_pk_bf16_f32 v36, v200, v201
v_cvt_pk_bf16_f32 v37, v202, v203
v_mfma_f32_16x16x32_bf16 v[236:239], a[60:63], a[20:23], v[236:239]
v_cvt_pk_bf16_f32 v38, v204, v205
v_cvt_pk_bf16_f32 v39, v206, v207
v_accvgpr_write_b32 a224, v36
s_waitcnt lgkmcnt(4)
v_mfma_f32_16x16x32_bf16 v[240:243], a[32:35], a[24:27], v[240:243]
ds_read_b64_tr_b16 a[8:9], v13 offset:16384
ds_read_b64_tr_b16 a[10:11], v13 offset:17408
v_accvgpr_write_b32 a225, v37
v_accvgpr_write_b32 a226, v38
v_accvgpr_write_b32 a227, v39
v_mfma_f32_16x16x32_bf16 v[240:243], a[48:51], a[28:31], v[240:243]
v_cvt_pk_bf16_f32 v40, v208, v209
v_cvt_pk_bf16_f32 v41, v210, v211
v_cvt_pk_bf16_f32 v42, v212, v213
v_cvt_pk_bf16_f32 v43, v214, v215
v_mfma_f32_16x16x32_bf16 v[244:247], a[36:39], a[24:27], v[244:247]
v_accvgpr_write_b32 a164, v40
v_accvgpr_write_b32 a165, v41
buffer_load_dwordx4 v23, s[12:15], s35 offen offset:3072 lds
s_add_u32 s32, s32, 128
v_mfma_f32_16x16x32_bf16 v[244:247], a[52:55], a[28:31], v[244:247]
s_add_u32 s33, s33, 128
s_add_u32 s34, s34, 128
s_add_u32 s35, s35, 128
s_xor_b32 s40, s40, 0x8000
v_mfma_f32_16x16x32_bf16 v[248:251], a[40:43], a[24:27], v[248:251]
ds_read_b64_tr_b16 a[12:13], v13 offset:24576
ds_read_b64_tr_b16 a[14:15], v13 offset:25600
v_add_u32 v13, s41, v13
v_mfma_f32_16x16x32_bf16 v[248:251], a[56:59], a[28:31], v[248:251]
v_accvgpr_write_b32 a166, v42
v_accvgpr_write_b32 a167, v43
v_cvt_pk_bf16_f32 v44, v216, v217
v_mfma_f32_16x16x32_bf16 v[252:255], a[44:47], a[24:27], v[252:255]
v_cvt_pk_bf16_f32 v45, v218, v219
v_cvt_pk_bf16_f32 v46, v220, v221
v_cvt_pk_bf16_f32 v47, v222, v223
v_mfma_f32_16x16x32_bf16 v[252:255], a[60:63], a[28:31], v[252:255]
v_accvgpr_write_b32 a228, v44
v_accvgpr_write_b32 a229, v45
v_accvgpr_write_b32 a230, v46
s_waitcnt lgkmcnt(4)
v_mfma_f32_16x16x32_bf16 a[64:67], a[32:35], a[0:3], a[64:67]
ds_read_b64_tr_b16 a[16:17], v14 offset:16384
ds_read_b64_tr_b16 a[18:19], v14 offset:17408
ds_read_b64_tr_b16 a[20:21], v14 offset:24576
ds_read_b64_tr_b16 a[22:23], v14 offset:25600
v_mfma_f32_16x16x32_bf16 a[64:67], a[48:51], a[4:7], a[64:67]
v_add_u32 v14, s41, v14
v_accvgpr_write_b32 a231, v47
v_cvt_pk_bf16_f32 v32, v224, v225
v_cvt_pk_bf16_f32 v33, v226, v227
v_mfma_f32_16x16x32_bf16 a[68:71], a[36:39], a[0:3], a[68:71]
v_cvt_pk_bf16_f32 v34, v228, v229
v_cvt_pk_bf16_f32 v35, v230, v231
v_accvgpr_write_b32 a168, v32
v_accvgpr_write_b32 a169, v33
v_mfma_f32_16x16x32_bf16 a[68:71], a[52:55], a[4:7], a[68:71]
v_accvgpr_write_b32 a170, v34
v_accvgpr_write_b32 a171, v35
s_add_u32 m0, s39, s46
s_nop 0
buffer_load_dwordx4 v28, s[24:27], s38 offen offset:0 lds
v_mfma_f32_16x16x32_bf16 a[72:75], a[40:43], a[0:3], a[72:75]
ds_read_b64_tr_b16 a[24:25], v15 offset:16384
ds_read_b64_tr_b16 a[26:27], v15 offset:17408
ds_read_b64_tr_b16 a[28:29], v15 offset:24576
ds_read_b64_tr_b16 a[30:31], v15 offset:25600
v_add_u32 v15, s41, v15
v_mfma_f32_16x16x32_bf16 a[72:75], a[56:59], a[4:7], a[72:75]
v_add_u32 v16, s41, v16
v_add_u32 v17, s41, v17
v_cvt_pk_bf16_f32 v36, v232, v233
v_cvt_pk_bf16_f32 v37, v234, v235
v_mfma_f32_16x16x32_bf16 a[76:79], a[44:47], a[0:3], a[76:79]
v_cvt_pk_bf16_f32 v38, v236, v237
v_cvt_pk_bf16_f32 v39, v238, v239
v_accvgpr_write_b32 a232, v36
v_accvgpr_write_b32 a233, v37
v_accvgpr_write_b32 a234, v38
v_mfma_f32_16x16x32_bf16 a[76:79], a[60:63], a[4:7], a[76:79]
v_accvgpr_write_b32 a235, v39
v_cvt_pk_bf16_f32 v40, v240, v241
global_load_dword v0, v[60:61], off
v_lshl_add_u64 v[60:61], v[60:61], 0, v[62:63]
s_waitcnt lgkmcnt(8)
v_mfma_f32_16x16x32_bf16 a[80:83], a[32:35], a[8:11], a[80:83]
v_cvt_pk_bf16_f32 v41, v242, v243
v_cvt_pk_bf16_f32 v42, v244, v245
v_cvt_pk_bf16_f32 v43, v246, v247
v_mfma_f32_16x16x32_bf16 a[80:83], a[48:51], a[12:15], a[80:83]
v_accvgpr_write_b32 a172, v40
v_accvgpr_write_b32 a173, v41
v_mfma_f32_16x16x32_bf16 a[84:87], a[36:39], a[8:11], a[84:87]
v_accvgpr_write_b32 a174, v42
v_accvgpr_write_b32 a175, v43
v_cvt_pk_bf16_f32 v44, v248, v249
v_mfma_f32_16x16x32_bf16 a[84:87], a[52:55], a[12:15], a[84:87]
v_cvt_pk_bf16_f32 v45, v250, v251
buffer_load_dwordx4 v29, s[24:27], s38 offen offset:1024 lds
v_mfma_f32_16x16x32_bf16 a[88:91], a[40:43], a[8:11], a[88:91]
v_cvt_pk_bf16_f32 v46, v252, v253
v_cvt_pk_bf16_f32 v47, v254, v255
v_mfma_f32_16x16x32_bf16 a[88:91], a[56:59], a[12:15], a[88:91]
v_accvgpr_write_b32 a236, v44
v_mfma_f32_16x16x32_bf16 a[92:95], a[44:47], a[8:11], a[92:95]
v_accvgpr_write_b32 a237, v45
v_accvgpr_write_b32 a238, v46
v_mfma_f32_16x16x32_bf16 a[92:95], a[60:63], a[12:15], a[92:95]
v_accvgpr_write_b32 a239, v47
s_waitcnt vmcnt(20)
s_waitcnt lgkmcnt(0)
s_barrier
v_mfma_f32_16x16x32_bf16 a[96:99], a[32:35], a[16:19], a[96:99]
ds_read_b64_tr_b16 a[0:1], v8 offset:0
ds_read_b64_tr_b16 a[2:3], v8 offset:1024
ds_read_b64_tr_b16 a[4:5], v8 offset:8192
v_mfma_f32_16x16x32_bf16 a[96:99], a[48:51], a[20:23], a[96:99]
ds_read_b64_tr_b16 a[6:7], v8 offset:9216
buffer_load_dwordx4 v30, s[24:27], s38 offen offset:2048 lds
v_mfma_f32_16x16x32_bf16 a[112:115], a[32:35], a[24:27], a[112:115]
s_add_u32 s36, s36, 524288
s_add_u32 s38, s38, 393216
s_add_u32 s39, s39, 0x8000
v_mfma_f32_16x16x32_bf16 a[112:115], a[48:51], a[28:31], a[112:115]
s_cmp_eq_u32 s39, 163840
s_cselect_b32 s39, 65536, s39
v_mfma_f32_16x16x32_bf16 a[100:103], a[36:39], a[16:19], a[100:103]
ds_read_b128 a[32:35], v18 offset:0
v_mfma_f32_16x16x32_bf16 a[100:103], a[52:55], a[20:23], a[100:103]
ds_read_b128 a[48:51], v19 offset:0
ds_read_b64_tr_b16 a[8:9], v9 offset:0
v_mfma_f32_16x16x32_bf16 a[116:119], a[36:39], a[24:27], a[116:119]
ds_read_b64_tr_b16 a[10:11], v9 offset:1024
ds_read_b64_tr_b16 a[12:13], v9 offset:8192
v_mfma_f32_16x16x32_bf16 a[116:119], a[52:55], a[28:31], a[116:119]
ds_read_b64_tr_b16 a[14:15], v9 offset:9216
v_mfma_f32_16x16x32_bf16 a[104:107], a[40:43], a[16:19], a[104:107]
ds_read_b128 a[36:39], v18 offset:2048
v_mfma_f32_16x16x32_bf16 a[104:107], a[56:59], a[20:23], a[104:107]
v_mfma_f32_16x16x32_bf16 a[120:123], a[40:43], a[24:27], a[120:123]
ds_read_b128 a[52:55], v19 offset:2048
v_mfma_f32_16x16x32_bf16 a[120:123], a[56:59], a[28:31], a[120:123]
v_mfma_f32_16x16x32_bf16 a[108:111], a[44:47], a[16:19], a[108:111]
ds_read_b128 a[40:43], v18 offset:4096
v_mfma_f32_16x16x32_bf16 a[108:111], a[60:63], a[20:23], a[108:111]
ds_read_b128 a[56:59], v19 offset:4096
v_mfma_f32_16x16x32_bf16 a[124:127], a[44:47], a[24:27], a[124:127]
global_load_dword v0, v[60:61], off
v_mfma_f32_16x16x32_bf16 a[124:127], a[60:63], a[28:31], a[124:127]
v_lshl_add_u64 v[60:61], v[60:61], 0, v[62:63]
s_cmp_eq_u32 s39, 98304
s_cselect_b32 s41, s48, s49
s_waitcnt lgkmcnt(9)
v_mfma_f32_16x16x32_bf16 v[64:67], a[0:3], a[32:35], 0
ds_read_b128 a[44:47], v18 offset:6144
ds_read_b128 a[60:63], v19 offset:6144
ds_read_b64_tr_b16 a[16:17], v10 offset:0
ds_read_b64_tr_b16 a[18:19], v10 offset:1024
s_waitcnt lgkmcnt(12)
v_mfma_f32_16x16x32_bf16 v[64:67], a[4:7], a[48:51], v[64:67]
v_accvgpr_read_b32 v48, a96
v_accvgpr_read_b32 v49, a97
v_accvgpr_read_b32 v50, a98
v_accvgpr_read_b32 v51, a99
s_waitcnt lgkmcnt(10)
v_mfma_f32_16x16x32_bf16 v[80:83], a[8:11], a[32:35], 0
v_cvt_pk_bf16_f32 v32, v48, v49
v_cvt_pk_bf16_f32 v33, v50, v51
v_accvgpr_read_b32 v48, a100
v_accvgpr_read_b32 v49, a101
s_waitcnt lgkmcnt(8)
v_mfma_f32_16x16x32_bf16 v[80:83], a[12:15], a[48:51], v[80:83]
v_accvgpr_read_b32 v50, a102
v_accvgpr_read_b32 v51, a103
s_add_u32 m0, s39, s45
s_nop 0
buffer_load_dwordx4 v24, s[20:23], s36 offen offset:0 lds
s_waitcnt lgkmcnt(7)
v_mfma_f32_16x16x32_bf16 v[68:71], a[0:3], a[36:39], 0
v_xor_b32 v18, 0x8000, v18
v_xor_b32 v19, 0x8000, v19
ds_read_b64_tr_b16 a[20:21], v10 offset:8192
ds_read_b64_tr_b16 a[22:23], v10 offset:9216
s_waitcnt lgkmcnt(8)
v_mfma_f32_16x16x32_bf16 v[68:71], a[4:7], a[52:55], v[68:71]
v_add_u32 v10, s41, v10
v_cvt_pk_bf16_f32 v34, v48, v49
v_cvt_pk_bf16_f32 v35, v50, v51
v_accvgpr_write_b32 a184, v32
v_mfma_f32_16x16x32_bf16 v[84:87], a[8:11], a[36:39], 0
v_accvgpr_write_b32 a185, v33
v_accvgpr_write_b32 a186, v34
v_accvgpr_write_b32 a187, v35
v_accvgpr_read_b32 v48, a104
v_mfma_f32_16x16x32_bf16 v[84:87], a[12:15], a[52:55], v[84:87]
v_accvgpr_read_b32 v49, a105
v_accvgpr_read_b32 v50, a106
v_accvgpr_read_b32 v51, a107
buffer_load_dwordx4 v25, s[20:23], s36 offen offset:1024 lds
s_waitcnt lgkmcnt(7)
v_mfma_f32_16x16x32_bf16 v[72:75], a[0:3], a[40:43], 0
ds_read_b64_tr_b16 a[24:25], v11 offset:0
ds_read_b64_tr_b16 a[26:27], v11 offset:1024
v_add_u32 v8, s41, v8
v_add_u32 v9, s41, v9
s_waitcnt lgkmcnt(8)
v_mfma_f32_16x16x32_bf16 v[72:75], a[4:7], a[56:59], v[72:75]
v_cvt_pk_bf16_f32 v36, v48, v49
v_cvt_pk_bf16_f32 v37, v50, v51
v_accvgpr_read_b32 v48, a108
v_accvgpr_read_b32 v49, a109
v_mfma_f32_16x16x32_bf16 v[88:91], a[8:11], a[40:43], 0
v_accvgpr_read_b32 v50, a110
v_accvgpr_read_b32 v51, a111
v_cvt_pk_bf16_f32 v38, v48, v49
v_cvt_pk_bf16_f32 v39, v50, v51
v_mfma_f32_16x16x32_bf16 v[88:91], a[12:15], a[56:59], v[88:91]
v_accvgpr_write_b32 a248, v36
v_accvgpr_write_b32 a249, v37
buffer_load_dwordx4 v26, s[20:23], s36 offen offset:2048 lds
s_waitcnt lgkmcnt(7)
v_mfma_f32_16x16x32_bf16 v[76:79], a[0:3], a[44:47], 0
ds_read_b64_tr_b16 a[28:29], v11 offset:8192
ds_read_b64_tr_b16 a[30:31], v11 offset:9216
v_add_u32 v11, s41, v11
v_accvgpr_write_b32 a250, v38
s_waitcnt lgkmcnt(8)
v_mfma_f32_16x16x32_bf16 v[76:79], a[4:7], a[60:63], v[76:79]
v_accvgpr_write_b32 a251, v39
v_accvgpr_read_b32 v48, a64
v_accvgpr_read_b32 v49, a65
v_mfma_f32_16x16x32_bf16 v[92:95], a[8:11], a[44:47], 0
v_accvgpr_read_b32 v50, a66
v_accvgpr_read_b32 v51, a67
v_cvt_pk_bf16_f32 v40, v48, v49
v_mfma_f32_16x16x32_bf16 v[92:95], a[12:15], a[60:63], v[92:95]
v_cvt_pk_bf16_f32 v41, v50, v51
v_accvgpr_read_b32 v48, a68
v_accvgpr_read_b32 v49, a69
s_waitcnt lgkmcnt(4)
v_mfma_f32_16x16x32_bf16 v[96:99], a[16:19], a[32:35], 0
ds_read_b64_tr_b16 a[96:97], v12 offset:0
ds_read_b64_tr_b16 a[98:99], v12 offset:1024
v_accvgpr_read_b32 v50, a70
v_accvgpr_read_b32 v51, a71
v_mfma_f32_16x16x32_bf16 v[96:99], a[20:23], a[48:51], v[96:99]
v_cvt_pk_bf16_f32 v42, v48, v49
v_cvt_pk_bf16_f32 v43, v50, v51
v_accvgpr_write_b32 a176, v40
v_mfma_f32_16x16x32_bf16 v[100:103], a[16:19], a[36:39], 0
v_accvgpr_write_b32 a177, v41
v_accvgpr_write_b32 a178, v42
v_accvgpr_write_b32 a179, v43
v_mfma_f32_16x16x32_bf16 v[100:103], a[20:23], a[52:55], v[100:103]
v_accvgpr_read_b32 v48, a72
v_accvgpr_read_b32 v49, a73
buffer_load_dwordx4 v27, s[20:23], s36 offen offset:3072 lds
v_mfma_f32_16x16x32_bf16 v[104:107], a[16:19], a[40:43], 0
ds_read_b64_tr_b16 a[100:101], v12 offset:8192
ds_read_b64_tr_b16 a[102:103], v12 offset:9216
v_add_u32 v12, s41, v12
v_accvgpr_read_b32 v50, a74
v_mfma_f32_16x16x32_bf16 v[104:107], a[20:23], a[56:59], v[104:107]
v_accvgpr_read_b32 v51, a75
v_cvt_pk_bf16_f32 v44, v48, v49
v_cvt_pk_bf16_f32 v45, v50, v51
v_mfma_f32_16x16x32_bf16 v[108:111], a[16:19], a[44:47], 0
v_accvgpr_read_b32 v48, a76
v_accvgpr_read_b32 v49, a77
v_accvgpr_read_b32 v50, a78
v_accvgpr_read_b32 v51, a79
v_mfma_f32_16x16x32_bf16 v[108:111], a[20:23], a[60:63], v[108:111]
v_cvt_pk_bf16_f32 v46, v48, v49
v_cvt_pk_bf16_f32 v47, v50, v51
buffer_store_dwordx4 a[128:131], v31, s[28:31], s76 offen offset:0 sc1
s_waitcnt lgkmcnt(4)
v_mfma_f32_16x16x32_bf16 v[112:115], a[24:27], a[32:35], 0
ds_read_b64_tr_b16 a[0:1], v13 offset:0
ds_read_b64_tr_b16 a[2:3], v13 offset:1024
v_accvgpr_write_b32 a240, v44
v_mfma_f32_16x16x32_bf16 v[112:115], a[28:31], a[48:51], v[112:115]
v_accvgpr_write_b32 a241, v45
v_accvgpr_write_b32 a242, v46
v_accvgpr_write_b32 a243, v47
v_mfma_f32_16x16x32_bf16 v[116:119], a[24:27], a[36:39], 0
v_accvgpr_read_b32 v48, a80
v_accvgpr_read_b32 v49, a81
v_accvgpr_read_b32 v50, a82
v_mfma_f32_16x16x32_bf16 v[116:119], a[28:31], a[52:55], v[116:119]
v_accvgpr_read_b32 v51, a83
v_cvt_pk_bf16_f32 v32, v48, v49
v_cvt_pk_bf16_f32 v33, v50, v51
v_mfma_f32_16x16x32_bf16 v[120:123], a[24:27], a[40:43], 0
ds_read_b64_tr_b16 a[4:5], v13 offset:8192
ds_read_b64_tr_b16 a[6:7], v13 offset:9216
v_add_u32 v13, s41, v13
v_accvgpr_read_b32 v48, a84
v_mfma_f32_16x16x32_bf16 v[120:123], a[28:31], a[56:59], v[120:123]
v_accvgpr_read_b32 v49, a85
v_accvgpr_read_b32 v50, a86
v_accvgpr_read_b32 v51, a87
v_cvt_pk_bf16_f32 v34, v48, v49
v_mfma_f32_16x16x32_bf16 v[124:127], a[24:27], a[44:47], 0
v_cvt_pk_bf16_f32 v35, v50, v51
v_accvgpr_write_b32 a180, v32
v_accvgpr_write_b32 a181, v33
v_accvgpr_write_b32 a182, v34
v_mfma_f32_16x16x32_bf16 v[124:127], a[28:31], a[60:63], v[124:127]
v_accvgpr_write_b32 a183, v35
s_mov_b32 m0, s40
s_nop 0
buffer_load_dwordx4 v22, s[12:15], s32 offen offset:0 lds
s_waitcnt lgkmcnt(4)
v_mfma_f32_16x16x32_bf16 v[128:131], a[96:99], a[32:35], 0
ds_read_b64_tr_b16 a[8:9], v14 offset:0
ds_read_b64_tr_b16 a[10:11], v14 offset:1024
v_accvgpr_read_b32 v48, a88
v_accvgpr_read_b32 v49, a89
v_mfma_f32_16x16x32_bf16 v[128:131], a[100:103], a[48:51], v[128:131]
v_accvgpr_read_b32 v50, a90
v_accvgpr_read_b32 v51, a91
v_cvt_pk_bf16_f32 v36, v48, v49
v_mfma_f32_16x16x32_bf16 v[132:135], a[96:99], a[36:39], 0
v_cvt_pk_bf16_f32 v37, v50, v51
v_accvgpr_read_b32 v48, a92
v_accvgpr_read_b32 v49, a93
v_mfma_f32_16x16x32_bf16 v[132:135], a[100:103], a[52:55], v[132:135]
v_accvgpr_read_b32 v50, a94
v_accvgpr_read_b32 v51, a95
buffer_load_dwordx4 v23, s[12:15], s32 offen offset:1024 lds
v_mfma_f32_16x16x32_bf16 v[136:139], a[96:99], a[40:43], 0
ds_read_b64_tr_b16 a[12:13], v14 offset:8192
ds_read_b64_tr_b16 a[14:15], v14 offset:9216
v_add_u32 v14, s41, v14
v_cvt_pk_bf16_f32 v38, v48, v49
v_mfma_f32_16x16x32_bf16 v[136:139], a[100:103], a[56:59], v[136:139]
v_cvt_pk_bf16_f32 v39, v50, v51
v_accvgpr_write_b32 a244, v36
v_accvgpr_write_b32 a245, v37
v_mfma_f32_16x16x32_bf16 v[140:143], a[96:99], a[44:47], 0
v_accvgpr_write_b32 a246, v38
v_accvgpr_write_b32 a247, v39
v_accvgpr_read_b32 v48, a112
v_accvgpr_read_b32 v49, a113
v_mfma_f32_16x16x32_bf16 v[140:143], a[100:103], a[60:63], v[140:143]
v_accvgpr_read_b32 v50, a114
v_accvgpr_read_b32 v51, a115
buffer_load_dwordx4 v22, s[12:15], s33 offen offset:2048 lds
s_waitcnt lgkmcnt(4)
v_mfma_f32_16x16x32_bf16 v[144:147], a[0:3], a[32:35], 0
ds_read_b64_tr_b16 a[16:17], v15 offset:0
ds_read_b64_tr_b16 a[18:19], v15 offset:1024
v_cvt_pk_bf16_f32 v40, v48, v49
v_mfma_f32_16x16x32_bf16 v[144:147], a[4:7], a[48:51], v[144:147]
v_cvt_pk_bf16_f32 v41, v50, v51
v_accvgpr_read_b32 v48, a116
v_accvgpr_read_b32 v49, a117
v_mfma_f32_16x16x32_bf16 v[148:151], a[0:3], a[36:39], 0
v_accvgpr_read_b32 v50, a118
v_accvgpr_read_b32 v51, a119
v_cvt_pk_bf16_f32 v42, v48, v49
v_mfma_f32_16x16x32_bf16 v[148:151], a[4:7], a[52:55], v[148:151]
v_cvt_pk_bf16_f32 v43, v50, v51
v_accvgpr_write_b32 a188, v40
v_accvgpr_write_b32 a189, v41
v_mfma_f32_16x16x32_bf16 v[152:155], a[0:3], a[40:43], 0
ds_read_b64_tr_b16 a[20:21], v15 offset:8192
ds_read_b64_tr_b16 a[22:23], v15 offset:9216
v_add_u32 v15, s41, v15
v_accvgpr_write_b32 a190, v42
v_mfma_f32_16x16x32_bf16 v[152:155], a[4:7], a[56:59], v[152:155]
v_accvgpr_write_b32 a191, v43
v_accvgpr_read_b32 v48, a120
v_accvgpr_read_b32 v49, a121
v_mfma_f32_16x16x32_bf16 v[156:159], a[0:3], a[44:47], 0
v_accvgpr_read_b32 v50, a122
v_accvgpr_read_b32 v51, a123
v_cvt_pk_bf16_f32 v44, v48, v49
v_cvt_pk_bf16_f32 v45, v50, v51
v_mfma_f32_16x16x32_bf16 v[156:159], a[4:7], a[60:63], v[156:159]
v_accvgpr_read_b32 v48, a124
v_accvgpr_read_b32 v49, a125
buffer_load_dwordx4 v23, s[12:15], s33 offen offset:3072 lds
s_waitcnt lgkmcnt(4)
v_mfma_f32_16x16x32_bf16 v[160:163], a[8:11], a[32:35], 0
ds_read_b64_tr_b16 a[24:25], v16 offset:0
ds_read_b64_tr_b16 a[26:27], v16 offset:768
v_accvgpr_read_b32 v50, a126
v_accvgpr_read_b32 v51, a127
v_mfma_f32_16x16x32_bf16 v[160:163], a[12:15], a[48:51], v[160:163]
v_cvt_pk_bf16_f32 v46, v48, v49
v_cvt_pk_bf16_f32 v47, v50, v51
v_accvgpr_write_b32 a252, v44
v_mfma_f32_16x16x32_bf16 v[164:167], a[8:11], a[36:39], 0
v_accvgpr_write_b32 a253, v45
v_accvgpr_write_b32 a254, v46
v_accvgpr_write_b32 a255, v47
v_mfma_f32_16x16x32_bf16 v[164:167], a[12:15], a[52:55], v[164:167]
s_lshl_b32 s74, s4, 11
s_and_b32 s75, s3, 1
buffer_store_dwordx4 a[192:195], v31, s[28:31], s80 offen offset:0 sc1
v_mfma_f32_16x16x32_bf16 v[168:171], a[8:11], a[40:43], 0
ds_read_b64_tr_b16 a[28:29], v16 offset:6144
ds_read_b64_tr_b16 a[30:31], v16 offset:6912
v_mfma_f32_16x16x32_bf16 v[168:171], a[12:15], a[56:59], v[168:171]
s_lshl_b32 s75, s75, 10
v_mfma_f32_16x16x32_bf16 v[172:175], a[8:11], a[44:47], 0
s_add_u32 s74, s74, s75
v_mfma_f32_16x16x32_bf16 v[172:175], a[12:15], a[60:63], v[172:175]
v_add_u32 v6, s74, v31
s_waitcnt lgkmcnt(4)
v_mfma_f32_16x16x32_bf16 v[176:179], a[16:19], a[32:35], 0
ds_read_b64_tr_b16 a[96:97], v17 offset:0
v_mfma_f32_16x16x32_bf16 v[176:179], a[20:23], a[48:51], v[176:179]
ds_read_b64_tr_b16 a[98:99], v17 offset:768
v_mfma_f32_16x16x32_bf16 v[180:183], a[16:19], a[36:39], 0
s_add_u32 m0, s40, 4096
v_mfma_f32_16x16x32_bf16 v[180:183], a[20:23], a[52:55], v[180:183]
buffer_load_dwordx4 v22, s[12:15], s34 offen offset:0 lds
v_mfma_f32_16x16x32_bf16 v[184:187], a[16:19], a[40:43], 0
ds_read_b64_tr_b16 a[100:101], v17 offset:6144
v_mfma_f32_16x16x32_bf16 v[184:187], a[20:23], a[56:59], v[184:187]
ds_read_b64_tr_b16 a[102:103], v17 offset:6912
v_mfma_f32_16x16x32_bf16 v[188:191], a[16:19], a[44:47], 0
buffer_load_dwordx4 v23, s[12:15], s34 offen offset:1024 lds
v_mfma_f32_16x16x32_bf16 v[188:191], a[20:23], a[60:63], v[188:191]
s_waitcnt lgkmcnt(4)
v_mfma_f32_16x16x32_bf16 v[192:195], a[24:27], a[32:35], 0
ds_read_b64_tr_b16 a[0:1], v16 offset:64
v_mfma_f32_16x16x32_bf16 v[192:195], a[28:31], a[48:51], v[192:195]
v_mfma_f32_16x16x32_bf16 v[196:199], a[24:27], a[36:39], 0
ds_read_b64_tr_b16 a[2:3], v16 offset:832
v_mfma_f32_16x16x32_bf16 v[196:199], a[28:31], a[52:55], v[196:199]
v_mfma_f32_16x16x32_bf16 v[200:203], a[24:27], a[40:43], 0
ds_read_b64_tr_b16 a[4:5], v16 offset:6208
v_mfma_f32_16x16x32_bf16 v[200:203], a[28:31], a[56:59], v[200:203]
ds_read_b64_tr_b16 a[6:7], v16 offset:6976
v_mfma_f32_16x16x32_bf16 v[204:207], a[24:27], a[44:47], 0
buffer_load_dwordx4 v22, s[12:15], s35 offen offset:2048 lds
v_mfma_f32_16x16x32_bf16 v[204:207], a[28:31], a[60:63], v[204:207]
s_waitcnt lgkmcnt(4)
v_mfma_f32_16x16x32_bf16 v[208:211], a[96:99], a[32:35], 0
ds_read_b64_tr_b16 a[8:9], v17 offset:64
v_mfma_f32_16x16x32_bf16 v[208:211], a[100:103], a[48:51], v[208:211]
ds_read_b64_tr_b16 a[10:11], v17 offset:832
v_mfma_f32_16x16x32_bf16 v[212:215], a[96:99], a[36:39], 0
buffer_load_dwordx4 v23, s[12:15], s35 offen offset:3072 lds
v_mfma_f32_16x16x32_bf16 v[212:215], a[100:103], a[52:55], v[212:215]
v_mfma_f32_16x16x32_bf16 v[216:219], a[96:99], a[40:43], 0
ds_read_b64_tr_b16 a[12:13], v17 offset:6208
ds_read_b64_tr_b16 a[14:15], v17 offset:6976
v_mfma_f32_16x16x32_bf16 v[216:219], a[100:103], a[56:59], v[216:219]
buffer_store_dwordx4 a[132:135], v31, s[28:31], s76 offen offset:1024 sc1
s_add_u32 s32, s32, 128
v_mfma_f32_16x16x32_bf16 v[220:223], a[96:99], a[44:47], 0
s_add_u32 s33, s33, 128
s_add_u32 s34, s34, 128
v_mfma_f32_16x16x32_bf16 v[220:223], a[100:103], a[60:63], v[220:223]
s_add_u32 s35, s35, 128
s_xor_b32 s40, s40, 0x8000
s_waitcnt lgkmcnt(4)
v_mfma_f32_16x16x32_bf16 v[224:227], a[0:3], a[32:35], 0
ds_read_b64_tr_b16 a[16:17], v16 offset:128
ds_read_b64_tr_b16 a[18:19], v16 offset:896
v_mfma_f32_16x16x32_bf16 v[224:227], a[4:7], a[48:51], v[224:227]
ds_read_b64_tr_b16 a[20:21], v16 offset:6272
v_mfma_f32_16x16x32_bf16 v[228:231], a[0:3], a[36:39], 0
ds_read_b64_tr_b16 a[22:23], v16 offset:7040
v_mfma_f32_16x16x32_bf16 v[228:231], a[4:7], a[52:55], v[228:231]
v_add_u32 v16, s41, v16
v_mfma_f32_16x16x32_bf16 v[232:235], a[0:3], a[40:43], 0
ds_read_b64_tr_b16 a[24:25], v17 offset:128
ds_read_b64_tr_b16 a[26:27], v17 offset:896
v_mfma_f32_16x16x32_bf16 v[232:235], a[4:7], a[56:59], v[232:235]
ds_read_b64_tr_b16 a[28:29], v17 offset:6272
ds_read_b64_tr_b16 a[30:31], v17 offset:7040
v_mfma_f32_16x16x32_bf16 v[236:239], a[0:3], a[44:47], 0
v_add_u32 v17, s41, v17
s_add_u32 m0, s39, s46
v_mfma_f32_16x16x32_bf16 v[236:239], a[4:7], a[60:63], v[236:239]
buffer_load_dwordx4 v28, s[24:27], s38 offen offset:0 lds
s_waitcnt lgkmcnt(8)
v_mfma_f32_16x16x32_bf16 v[240:243], a[8:11], a[32:35], 0
buffer_load_dwordx4 v29, s[24:27], s38 offen offset:1024 lds
v_mfma_f32_16x16x32_bf16 v[240:243], a[12:15], a[48:51], v[240:243]
v_mfma_f32_16x16x32_bf16 v[244:247], a[8:11], a[36:39], 0
v_mfma_f32_16x16x32_bf16 v[244:247], a[12:15], a[52:55], v[244:247]
v_mfma_f32_16x16x32_bf16 v[248:251], a[8:11], a[40:43], 0
v_mfma_f32_16x16x32_bf16 v[248:251], a[12:15], a[56:59], v[248:251]
v_mfma_f32_16x16x32_bf16 v[252:255], a[8:11], a[44:47], 0
v_mfma_f32_16x16x32_bf16 v[252:255], a[12:15], a[60:63], v[252:255]
s_waitcnt vmcnt(18)
s_waitcnt lgkmcnt(0)
s_barrier
v_mfma_f32_16x16x32_bf16 a[64:67], a[32:35], a[16:19], 0
ds_read_b64_tr_b16 a[0:1], v8 offset:0
ds_read_b64_tr_b16 a[2:3], v8 offset:1024
v_mfma_f32_16x16x32_bf16 a[64:67], a[48:51], a[20:23], a[64:67]
ds_read_b64_tr_b16 a[4:5], v8 offset:8192
v_mfma_f32_16x16x32_bf16 a[80:83], a[32:35], a[24:27], 0
ds_read_b64_tr_b16 a[6:7], v8 offset:9216
v_mfma_f32_16x16x32_bf16 a[80:83], a[48:51], a[28:31], a[80:83]
buffer_load_dwordx4 v30, s[24:27], s38 offen offset:2048 lds
v_mfma_f32_16x16x32_bf16 a[68:71], a[36:39], a[16:19], 0
ds_read_b128 a[32:35], v18 offset:0
ds_read_b128 a[48:51], v19 offset:0
ds_read_b64_tr_b16 a[8:9], v9 offset:0
v_mfma_f32_16x16x32_bf16 a[68:71], a[52:55], a[20:23], a[68:71]
ds_read_b64_tr_b16 a[10:11], v9 offset:1024
ds_read_b64_tr_b16 a[12:13], v9 offset:8192
ds_read_b64_tr_b16 a[14:15], v9 offset:9216
v_mfma_f32_16x16x32_bf16 a[84:87], a[36:39], a[24:27], 0
buffer_store_dwordx4 a[196:199], v31, s[28:31], s80 offen offset:1024 sc1
s_add_u32 s36, s36, 524288
s_add_u32 s38, s38, 393216
v_mfma_f32_16x16x32_bf16 a[84:87], a[52:55], a[28:31], a[84:87]
s_add_u32 s39, s39, 0x8000
s_cmp_eq_u32 s39, 163840
s_cselect_b32 s39, 65536, s39
v_mfma_f32_16x16x32_bf16 a[72:75], a[40:43], a[16:19], 0
ds_read_b128 a[36:39], v18 offset:2048
v_mfma_f32_16x16x32_bf16 a[72:75], a[56:59], a[20:23], a[72:75]
v_mfma_f32_16x16x32_bf16 a[88:91], a[40:43], a[24:27], 0
ds_read_b128 a[52:55], v19 offset:2048
v_mfma_f32_16x16x32_bf16 a[88:91], a[56:59], a[28:31], a[88:91]
v_mfma_f32_16x16x32_bf16 a[76:79], a[44:47], a[16:19], 0
ds_read_b128 a[40:43], v18 offset:4096
v_mfma_f32_16x16x32_bf16 a[76:79], a[60:63], a[20:23], a[76:79]
v_mfma_f32_16x16x32_bf16 a[92:95], a[44:47], a[24:27], 0
ds_read_b128 a[56:59], v19 offset:4096
v_mfma_f32_16x16x32_bf16 a[92:95], a[60:63], a[28:31], a[92:95]
s_add_u32 m0, s75, 94208
s_nop 0
global_load_lds_dwordx4 v6, s[64:65]
s_cmp_eq_u32 s39, 98304
s_cselect_b32 s41, s48, s49
s_waitcnt lgkmcnt(9)
v_mfma_f32_16x16x32_bf16 v[64:67], a[0:3], a[32:35], v[64:67]
ds_read_b128 a[44:47], v18 offset:6144
ds_read_b128 a[60:63], v19 offset:6144
s_waitcnt lgkmcnt(10)
v_mfma_f32_16x16x32_bf16 v[64:67], a[4:7], a[48:51], v[64:67]
ds_read_b64_tr_b16 a[16:17], v10 offset:0
s_waitcnt lgkmcnt(9)
v_mfma_f32_16x16x32_bf16 v[80:83], a[8:11], a[32:35], v[80:83]
ds_read_b64_tr_b16 a[18:19], v10 offset:1024
s_add_u32 m0, s39, s45
s_waitcnt lgkmcnt(8)
v_mfma_f32_16x16x32_bf16 v[80:83], a[12:15], a[48:51], v[80:83]
buffer_load_dwordx4 v24, s[20:23], s36 offen offset:0 lds
s_waitcnt lgkmcnt(7)
v_mfma_f32_16x16x32_bf16 v[68:71], a[0:3], a[36:39], v[68:71]
v_xor_b32 v18, 0x8000, v18
v_xor_b32 v19, 0x8000, v19
s_waitcnt lgkmcnt(6)
v_mfma_f32_16x16x32_bf16 v[68:71], a[4:7], a[52:55], v[68:71]
ds_read_b64_tr_b16 a[20:21], v10 offset:8192
v_mfma_f32_16x16x32_bf16 v[84:87], a[8:11], a[36:39], v[84:87]
ds_read_b64_tr_b16 a[22:23], v10 offset:9216
v_add_u32 v10, s41, v10
v_mfma_f32_16x16x32_bf16 v[84:87], a[12:15], a[52:55], v[84:87]
buffer_load_dwordx4 v25, s[20:23], s36 offen offset:1024 lds
s_waitcnt lgkmcnt(7)
v_mfma_f32_16x16x32_bf16 v[72:75], a[0:3], a[40:43], v[72:75]
ds_read_b64_tr_b16 a[24:25], v11 offset:0
ds_read_b64_tr_b16 a[26:27], v11 offset:1024
s_waitcnt lgkmcnt(8)
v_mfma_f32_16x16x32_bf16 v[72:75], a[4:7], a[56:59], v[72:75]
v_add_u32 v8, s41, v8
v_mfma_f32_16x16x32_bf16 v[88:91], a[8:11], a[40:43], v[88:91]
v_add_u32 v9, s41, v9
v_mfma_f32_16x16x32_bf16 v[88:91], a[12:15], a[56:59], v[88:91]
buffer_load_dwordx4 v26, s[20:23], s36 offen offset:2048 lds
s_waitcnt lgkmcnt(7)
v_mfma_f32_16x16x32_bf16 v[76:79], a[0:3], a[44:47], v[76:79]
ds_read_b64_tr_b16 a[28:29], v11 offset:8192
s_waitcnt lgkmcnt(7)
v_mfma_f32_16x16x32_bf16 v[76:79], a[4:7], a[60:63], v[76:79]
ds_read_b64_tr_b16 a[30:31], v11 offset:9216
v_mfma_f32_16x16x32_bf16 v[92:95], a[8:11], a[44:47], v[92:95]
v_add_u32 v11, s41, v11
v_mfma_f32_16x16x32_bf16 v[92:95], a[12:15], a[60:63], v[92:95]
s_waitcnt lgkmcnt(4)
v_mfma_f32_16x16x32_bf16 v[96:99], a[16:19], a[32:35], v[96:99]
ds_read_b64_tr_b16 a[96:97], v12 offset:0
v_mfma_f32_16x16x32_bf16 v[96:99], a[20:23], a[48:51], v[96:99]
ds_read_b64_tr_b16 a[98:99], v12 offset:1024
v_mfma_f32_16x16x32_bf16 v[100:103], a[16:19], a[36:39], v[100:103]
buffer_load_dwordx4 v27, s[20:23], s36 offen offset:3072 lds
v_mfma_f32_16x16x32_bf16 v[100:103], a[20:23], a[52:55], v[100:103]
v_mfma_f32_16x16x32_bf16 v[104:107], a[16:19], a[40:43], v[104:107]
ds_read_b64_tr_b16 a[100:101], v12 offset:8192
v_mfma_f32_16x16x32_bf16 v[104:107], a[20:23], a[56:59], v[104:107]
ds_read_b64_tr_b16 a[102:103], v12 offset:9216
v_mfma_f32_16x16x32_bf16 v[108:111], a[16:19], a[44:47], v[108:111]
v_add_u32 v12, s41, v12
v_mfma_f32_16x16x32_bf16 v[108:111], a[20:23], a[60:63], v[108:111]
buffer_store_dwordx4 a[136:139], v31, s[28:31], s76 offen offset:2048 sc1
s_waitcnt lgkmcnt(4)
v_mfma_f32_16x16x32_bf16 v[112:115], a[24:27], a[32:35], v[112:115]
ds_read_b64_tr_b16 a[0:1], v13 offset:0
v_mfma_f32_16x16x32_bf16 v[112:115], a[28:31], a[48:51], v[112:115]
v_mfma_f32_16x16x32_bf16 v[116:119], a[24:27], a[36:39], v[116:119]
ds_read_b64_tr_b16 a[2:3], v13 offset:1024
v_mfma_f32_16x16x32_bf16 v[116:119], a[28:31], a[52:55], v[116:119]
v_mfma_f32_16x16x32_bf16 v[120:123], a[24:27], a[40:43], v[120:123]
ds_read_b64_tr_b16 a[4:5], v13 offset:8192
ds_read_b64_tr_b16 a[6:7], v13 offset:9216
v_mfma_f32_16x16x32_bf16 v[120:123], a[28:31], a[56:59], v[120:123]
v_add_u32 v13, s41, v13
v_mfma_f32_16x16x32_bf16 v[124:127], a[24:27], a[44:47], v[124:127]
s_mov_b32 m0, s40
v_mfma_f32_16x16x32_bf16 v[124:127], a[28:31], a[60:63], v[124:127]
buffer_load_dwordx4 v22, s[12:15], s32 offen offset:0 lds
s_waitcnt lgkmcnt(4)
v_mfma_f32_16x16x32_bf16 v[128:131], a[96:99], a[32:35], v[128:131]
ds_read_b64_tr_b16 a[8:9], v14 offset:0
v_mfma_f32_16x16x32_bf16 v[128:131], a[100:103], a[48:51], v[128:131]
ds_read_b64_tr_b16 a[10:11], v14 offset:1024
v_mfma_f32_16x16x32_bf16 v[132:135], a[96:99], a[36:39], v[132:135]
buffer_load_dwordx4 v23, s[12:15], s32 offen offset:1024 lds
v_mfma_f32_16x16x32_bf16 v[132:135], a[100:103], a[52:55], v[132:135]
v_mfma_f32_16x16x32_bf16 v[136:139], a[96:99], a[40:43], v[136:139]
ds_read_b64_tr_b16 a[12:13], v14 offset:8192
v_mfma_f32_16x16x32_bf16 v[136:139], a[100:103], a[56:59], v[136:139]
ds_read_b64_tr_b16 a[14:15], v14 offset:9216
v_mfma_f32_16x16x32_bf16 v[140:143], a[96:99], a[44:47], v[140:143]
v_add_u32 v14, s41, v14
v_mfma_f32_16x16x32_bf16 v[140:143], a[100:103], a[60:63], v[140:143]
buffer_load_dwordx4 v22, s[12:15], s33 offen offset:2048 lds
s_waitcnt lgkmcnt(4)
v_mfma_f32_16x16x32_bf16 v[144:147], a[0:3], a[32:35], v[144:147]
ds_read_b64_tr_b16 a[16:17], v15 offset:0
v_mfma_f32_16x16x32_bf16 v[144:147], a[4:7], a[48:51], v[144:147]
v_mfma_f32_16x16x32_bf16 v[148:151], a[0:3], a[36:39], v[148:151]
ds_read_b64_tr_b16 a[18:19], v15 offset:1024
v_mfma_f32_16x16x32_bf16 v[148:151], a[4:7], a[52:55], v[148:151]
v_mfma_f32_16x16x32_bf16 v[152:155], a[0:3], a[40:43], v[152:155]
ds_read_b64_tr_b16 a[20:21], v15 offset:8192
v_mfma_f32_16x16x32_bf16 v[152:155], a[4:7], a[56:59], v[152:155]
ds_read_b64_tr_b16 a[22:23], v15 offset:9216
v_mfma_f32_16x16x32_bf16 v[156:159], a[0:3], a[44:47], v[156:159]
v_add_u32 v15, s41, v15
v_mfma_f32_16x16x32_bf16 v[156:159], a[4:7], a[60:63], v[156:159]
buffer_load_dwordx4 v23, s[12:15], s33 offen offset:3072 lds
s_waitcnt lgkmcnt(4)
v_mfma_f32_16x16x32_bf16 v[160:163], a[8:11], a[32:35], v[160:163]
ds_read_b64_tr_b16 a[24:25], v16 offset:0
v_mfma_f32_16x16x32_bf16 v[160:163], a[12:15], a[48:51], v[160:163]
ds_read_b64_tr_b16 a[26:27], v16 offset:768
v_mfma_f32_16x16x32_bf16 v[164:167], a[8:11], a[36:39], v[164:167]
buffer_store_dwordx4 a[200:203], v31, s[28:31], s80 offen offset:2048 sc1
v_mfma_f32_16x16x32_bf16 v[164:167], a[12:15], a[52:55], v[164:167]
v_mfma_f32_16x16x32_bf16 v[168:171], a[8:11], a[40:43], v[168:171]
ds_read_b64_tr_b16 a[28:29], v16 offset:6144
v_mfma_f32_16x16x32_bf16 v[168:171], a[12:15], a[56:59], v[168:171]
v_mfma_f32_16x16x32_bf16 v[172:175], a[8:11], a[44:47], v[172:175]
ds_read_b64_tr_b16 a[30:31], v16 offset:6912
v_mfma_f32_16x16x32_bf16 v[172:175], a[12:15], a[60:63], v[172:175]
s_waitcnt lgkmcnt(4)
v_mfma_f32_16x16x32_bf16 v[176:179], a[16:19], a[32:35], v[176:179]
ds_read_b64_tr_b16 a[96:97], v17 offset:0
v_mfma_f32_16x16x32_bf16 v[176:179], a[20:23], a[48:51], v[176:179]
ds_read_b64_tr_b16 a[98:99], v17 offset:768
v_mfma_f32_16x16x32_bf16 v[180:183], a[16:19], a[36:39], v[180:183]
s_add_u32 m0, s40, 4096
v_mfma_f32_16x16x32_bf16 v[180:183], a[20:23], a[52:55], v[180:183]
buffer_load_dwordx4 v22, s[12:15], s34 offen offset:0 lds
v_mfma_f32_16x16x32_bf16 v[184:187], a[16:19], a[40:43], v[184:187]
ds_read_b64_tr_b16 a[100:101], v17 offset:6144
v_mfma_f32_16x16x32_bf16 v[184:187], a[20:23], a[56:59], v[184:187]
ds_read_b64_tr_b16 a[102:103], v17 offset:6912
v_mfma_f32_16x16x32_bf16 v[188:191], a[16:19], a[44:47], v[188:191]
buffer_load_dwordx4 v23, s[12:15], s34 offen offset:1024 lds
v_mfma_f32_16x16x32_bf16 v[188:191], a[20:23], a[60:63], v[188:191]
s_waitcnt lgkmcnt(4)
v_mfma_f32_16x16x32_bf16 v[192:195], a[24:27], a[32:35], v[192:195]
ds_read_b64_tr_b16 a[0:1], v16 offset:64
v_mfma_f32_16x16x32_bf16 v[192:195], a[28:31], a[48:51], v[192:195]
v_mfma_f32_16x16x32_bf16 v[196:199], a[24:27], a[36:39], v[196:199]
ds_read_b64_tr_b16 a[2:3], v16 offset:832
v_mfma_f32_16x16x32_bf16 v[196:199], a[28:31], a[52:55], v[196:199]
v_mfma_f32_16x16x32_bf16 v[200:203], a[24:27], a[40:43], v[200:203]
ds_read_b64_tr_b16 a[4:5], v16 offset:6208
v_mfma_f32_16x16x32_bf16 v[200:203], a[28:31], a[56:59], v[200:203]
ds_read_b64_tr_b16 a[6:7], v16 offset:6976
v_mfma_f32_16x16x32_bf16 v[204:207], a[24:27], a[44:47], v[204:207]
buffer_load_dwordx4 v22, s[12:15], s35 offen offset:2048 lds
v_mfma_f32_16x16x32_bf16 v[204:207], a[28:31], a[60:63], v[204:207]
s_waitcnt lgkmcnt(4)
v_mfma_f32_16x16x32_bf16 v[208:211], a[96:99], a[32:35], v[208:211]
ds_read_b64_tr_b16 a[8:9], v17 offset:64
v_mfma_f32_16x16x32_bf16 v[208:211], a[100:103], a[48:51], v[208:211]
ds_read_b64_tr_b16 a[10:11], v17 offset:832
v_mfma_f32_16x16x32_bf16 v[212:215], a[96:99], a[36:39], v[212:215]
buffer_load_dwordx4 v23, s[12:15], s35 offen offset:3072 lds
v_mfma_f32_16x16x32_bf16 v[212:215], a[100:103], a[52:55], v[212:215]
v_mfma_f32_16x16x32_bf16 v[216:219], a[96:99], a[40:43], v[216:219]
ds_read_b64_tr_b16 a[12:13], v17 offset:6208
ds_read_b64_tr_b16 a[14:15], v17 offset:6976
v_mfma_f32_16x16x32_bf16 v[216:219], a[100:103], a[56:59], v[216:219]
buffer_store_dwordx4 a[140:143], v31, s[28:31], s76 offen offset:3072 sc1
s_add_u32 s32, s32, 128
v_mfma_f32_16x16x32_bf16 v[220:223], a[96:99], a[44:47], v[220:223]
s_add_u32 s33, s33, 128
s_add_u32 s34, s34, 128
v_mfma_f32_16x16x32_bf16 v[220:223], a[100:103], a[60:63], v[220:223]
s_add_u32 s35, s35, 128
s_xor_b32 s40, s40, 0x8000
s_waitcnt lgkmcnt(4)
v_mfma_f32_16x16x32_bf16 v[224:227], a[0:3], a[32:35], v[224:227]
ds_read_b64_tr_b16 a[16:17], v16 offset:128
ds_read_b64_tr_b16 a[18:19], v16 offset:896
v_mfma_f32_16x16x32_bf16 v[224:227], a[4:7], a[48:51], v[224:227]
ds_read_b64_tr_b16 a[20:21], v16 offset:6272
v_mfma_f32_16x16x32_bf16 v[228:231], a[0:3], a[36:39], v[228:231]
ds_read_b64_tr_b16 a[22:23], v16 offset:7040
v_mfma_f32_16x16x32_bf16 v[228:231], a[4:7], a[52:55], v[228:231]
v_add_u32 v16, s41, v16
v_mfma_f32_16x16x32_bf16 v[232:235], a[0:3], a[40:43], v[232:235]
ds_read_b64_tr_b16 a[24:25], v17 offset:128
ds_read_b64_tr_b16 a[26:27], v17 offset:896
v_mfma_f32_16x16x32_bf16 v[232:235], a[4:7], a[56:59], v[232:235]
ds_read_b64_tr_b16 a[28:29], v17 offset:6272
ds_read_b64_tr_b16 a[30:31], v17 offset:7040
v_mfma_f32_16x16x32_bf16 v[236:239], a[0:3], a[44:47], v[236:239]
v_add_u32 v17, s41, v17
s_add_u32 m0, s39, s46
v_mfma_f32_16x16x32_bf16 v[236:239], a[4:7], a[60:63], v[236:239]
buffer_load_dwordx4 v28, s[24:27], s38 offen offset:0 lds
s_waitcnt lgkmcnt(8)
v_mfma_f32_16x16x32_bf16 v[240:243], a[8:11], a[32:35], v[240:243]
buffer_load_dwordx4 v29, s[24:27], s38 offen offset:1024 lds
v_mfma_f32_16x16x32_bf16 v[240:243], a[12:15], a[48:51], v[240:243]
v_mfma_f32_16x16x32_bf16 v[244:247], a[8:11], a[36:39], v[244:247]
v_mfma_f32_16x16x32_bf16 v[244:247], a[12:15], a[52:55], v[244:247]
v_mfma_f32_16x16x32_bf16 v[248:251], a[8:11], a[40:43], v[248:251]
v_mfma_f32_16x16x32_bf16 v[248:251], a[12:15], a[56:59], v[248:251]
v_mfma_f32_16x16x32_bf16 v[252:255], a[8:11], a[44:47], v[252:255]
v_mfma_f32_16x16x32_bf16 v[252:255], a[12:15], a[60:63], v[252:255]
s_waitcnt vmcnt(19)
s_waitcnt lgkmcnt(0)
s_barrier
v_mfma_f32_16x16x32_bf16 a[64:67], a[32:35], a[16:19], a[64:67]
ds_read_b64_tr_b16 a[0:1], v8 offset:0
ds_read_b64_tr_b16 a[2:3], v8 offset:1024
v_mfma_f32_16x16x32_bf16 a[64:67], a[48:51], a[20:23], a[64:67]
ds_read_b64_tr_b16 a[4:5], v8 offset:8192
v_mfma_f32_16x16x32_bf16 a[80:83], a[32:35], a[24:27], a[80:83]
ds_read_b64_tr_b16 a[6:7], v8 offset:9216
v_mfma_f32_16x16x32_bf16 a[80:83], a[48:51], a[28:31], a[80:83]
buffer_load_dwordx4 v30, s[24:27], s38 offen offset:2048 lds
v_mfma_f32_16x16x32_bf16 a[68:71], a[36:39], a[16:19], a[68:71]
ds_read_b128 a[32:35], v18 offset:0
ds_read_b128 a[48:51], v19 offset:0
ds_read_b64_tr_b16 a[8:9], v9 offset:0
v_mfma_f32_16x16x32_bf16 a[68:71], a[52:55], a[20:23], a[68:71]
ds_read_b64_tr_b16 a[10:11], v9 offset:1024
ds_read_b64_tr_b16 a[12:13], v9 offset:8192
ds_read_b64_tr_b16 a[14:15], v9 offset:9216
v_mfma_f32_16x16x32_bf16 a[84:87], a[36:39], a[24:27], a[84:87]
buffer_store_dwordx4 a[204:207], v31, s[28:31], s80 offen offset:3072 sc1
s_add_u32 s36, s36, 524288
s_add_u32 s38, s38, 393216
v_mfma_f32_16x16x32_bf16 a[84:87], a[52:55], a[28:31], a[84:87]
s_add_u32 s39, s39, 0x8000
s_cmp_eq_u32 s39, 163840
s_cselect_b32 s39, 65536, s39
v_mfma_f32_16x16x32_bf16 a[72:75], a[40:43], a[16:19], a[72:75]
ds_read_b128 a[36:39], v18 offset:2048
v_mfma_f32_16x16x32_bf16 a[72:75], a[56:59], a[20:23], a[72:75]
v_mfma_f32_16x16x32_bf16 a[88:91], a[40:43], a[24:27], a[88:91]
ds_read_b128 a[52:55], v19 offset:2048
v_mfma_f32_16x16x32_bf16 a[88:91], a[56:59], a[28:31], a[88:91]
v_mfma_f32_16x16x32_bf16 a[76:79], a[44:47], a[16:19], a[76:79]
ds_read_b128 a[40:43], v18 offset:4096
v_mfma_f32_16x16x32_bf16 a[76:79], a[60:63], a[20:23], a[76:79]
v_mfma_f32_16x16x32_bf16 a[92:95], a[44:47], a[24:27], a[92:95]
ds_read_b128 a[56:59], v19 offset:4096
v_mfma_f32_16x16x32_bf16 a[92:95], a[60:63], a[28:31], a[92:95]
s_cmp_eq_u32 s39, 98304
s_cselect_b32 s41, s48, s49
s_waitcnt lgkmcnt(9)
v_mfma_f32_16x16x32_bf16 v[64:67], a[0:3], a[32:35], v[64:67]
ds_read_b128 a[44:47], v18 offset:6144
ds_read_b128 a[60:63], v19 offset:6144
s_waitcnt lgkmcnt(10)
v_mfma_f32_16x16x32_bf16 v[64:67], a[4:7], a[48:51], v[64:67]
ds_read_b64_tr_b16 a[16:17], v10 offset:0
s_waitcnt lgkmcnt(9)
v_mfma_f32_16x16x32_bf16 v[80:83], a[8:11], a[32:35], v[80:83]
ds_read_b64_tr_b16 a[18:19], v10 offset:1024
s_add_u32 m0, s39, s45
s_waitcnt lgkmcnt(8)
v_mfma_f32_16x16x32_bf16 v[80:83], a[12:15], a[48:51], v[80:83]
buffer_load_dwordx4 v24, s[20:23], s36 offen offset:0 lds
s_waitcnt lgkmcnt(7)
v_mfma_f32_16x16x32_bf16 v[68:71], a[0:3], a[36:39], v[68:71]
v_xor_b32 v18, 0x8000, v18
v_xor_b32 v19, 0x8000, v19
s_waitcnt lgkmcnt(6)
v_mfma_f32_16x16x32_bf16 v[68:71], a[4:7], a[52:55], v[68:71]
ds_read_b64_tr_b16 a[20:21], v10 offset:8192
v_mfma_f32_16x16x32_bf16 v[84:87], a[8:11], a[36:39], v[84:87]
ds_read_b64_tr_b16 a[22:23], v10 offset:9216
v_add_u32 v10, s41, v10
v_mfma_f32_16x16x32_bf16 v[84:87], a[12:15], a[52:55], v[84:87]
buffer_load_dwordx4 v25, s[20:23], s36 offen offset:1024 lds
s_waitcnt lgkmcnt(7)
v_mfma_f32_16x16x32_bf16 v[72:75], a[0:3], a[40:43], v[72:75]
ds_read_b64_tr_b16 a[24:25], v11 offset:0
ds_read_b64_tr_b16 a[26:27], v11 offset:1024
s_waitcnt lgkmcnt(8)
v_mfma_f32_16x16x32_bf16 v[72:75], a[4:7], a[56:59], v[72:75]
v_add_u32 v8, s41, v8
v_mfma_f32_16x16x32_bf16 v[88:91], a[8:11], a[40:43], v[88:91]
v_add_u32 v9, s41, v9
v_mfma_f32_16x16x32_bf16 v[88:91], a[12:15], a[56:59], v[88:91]
buffer_load_dwordx4 v26, s[20:23], s36 offen offset:2048 lds
s_waitcnt lgkmcnt(7)
v_mfma_f32_16x16x32_bf16 v[76:79], a[0:3], a[44:47], v[76:79]
ds_read_b64_tr_b16 a[28:29], v11 offset:8192
s_waitcnt lgkmcnt(7)
v_mfma_f32_16x16x32_bf16 v[76:79], a[4:7], a[60:63], v[76:79]
ds_read_b64_tr_b16 a[30:31], v11 offset:9216
v_mfma_f32_16x16x32_bf16 v[92:95], a[8:11], a[44:47], v[92:95]
v_add_u32 v11, s41, v11
v_mfma_f32_16x16x32_bf16 v[92:95], a[12:15], a[60:63], v[92:95]
s_waitcnt lgkmcnt(4)
v_mfma_f32_16x16x32_bf16 v[96:99], a[16:19], a[32:35], v[96:99]
ds_read_b64_tr_b16 a[96:97], v12 offset:0
v_mfma_f32_16x16x32_bf16 v[96:99], a[20:23], a[48:51], v[96:99]
ds_read_b64_tr_b16 a[98:99], v12 offset:1024
v_mfma_f32_16x16x32_bf16 v[100:103], a[16:19], a[36:39], v[100:103]
buffer_load_dwordx4 v27, s[20:23], s36 offen offset:3072 lds
v_mfma_f32_16x16x32_bf16 v[100:103], a[20:23], a[52:55], v[100:103]
v_mfma_f32_16x16x32_bf16 v[104:107], a[16:19], a[40:43], v[104:107]
ds_read_b64_tr_b16 a[100:101], v12 offset:8192
v_mfma_f32_16x16x32_bf16 v[104:107], a[20:23], a[56:59], v[104:107]
ds_read_b64_tr_b16 a[102:103], v12 offset:9216
v_mfma_f32_16x16x32_bf16 v[108:111], a[16:19], a[44:47], v[108:111]
v_add_u32 v12, s41, v12
v_mfma_f32_16x16x32_bf16 v[108:111], a[20:23], a[60:63], v[108:111]
buffer_store_dwordx4 a[144:147], v31, s[28:31], s77 offen offset:0 sc1
s_waitcnt lgkmcnt(4)
v_mfma_f32_16x16x32_bf16 v[112:115], a[24:27], a[32:35], v[112:115]
ds_read_b64_tr_b16 a[0:1], v13 offset:0
v_mfma_f32_16x16x32_bf16 v[112:115], a[28:31], a[48:51], v[112:115]
v_mfma_f32_16x16x32_bf16 v[116:119], a[24:27], a[36:39], v[116:119]
ds_read_b64_tr_b16 a[2:3], v13 offset:1024
v_mfma_f32_16x16x32_bf16 v[116:119], a[28:31], a[52:55], v[116:119]
v_mfma_f32_16x16x32_bf16 v[120:123], a[24:27], a[40:43], v[120:123]
ds_read_b64_tr_b16 a[4:5], v13 offset:8192
ds_read_b64_tr_b16 a[6:7], v13 offset:9216
v_mfma_f32_16x16x32_bf16 v[120:123], a[28:31], a[56:59], v[120:123]
v_add_u32 v13, s41, v13
v_mfma_f32_16x16x32_bf16 v[124:127], a[24:27], a[44:47], v[124:127]
s_mov_b32 m0, s40
v_mfma_f32_16x16x32_bf16 v[124:127], a[28:31], a[60:63], v[124:127]
buffer_load_dwordx4 v22, s[12:15], s32 offen offset:0 lds
s_waitcnt lgkmcnt(4)
v_mfma_f32_16x16x32_bf16 v[128:131], a[96:99], a[32:35], v[128:131]
ds_read_b64_tr_b16 a[8:9], v14 offset:0
v_mfma_f32_16x16x32_bf16 v[128:131], a[100:103], a[48:51], v[128:131]
ds_read_b64_tr_b16 a[10:11], v14 offset:1024
v_mfma_f32_16x16x32_bf16 v[132:135], a[96:99], a[36:39], v[132:135]
buffer_load_dwordx4 v23, s[12:15], s32 offen offset:1024 lds
v_mfma_f32_16x16x32_bf16 v[132:135], a[100:103], a[52:55], v[132:135]
v_mfma_f32_16x16x32_bf16 v[136:139], a[96:99], a[40:43], v[136:139]
ds_read_b64_tr_b16 a[12:13], v14 offset:8192
v_mfma_f32_16x16x32_bf16 v[136:139], a[100:103], a[56:59], v[136:139]
ds_read_b64_tr_b16 a[14:15], v14 offset:9216
v_mfma_f32_16x16x32_bf16 v[140:143], a[96:99], a[44:47], v[140:143]
v_add_u32 v14, s41, v14
v_mfma_f32_16x16x32_bf16 v[140:143], a[100:103], a[60:63], v[140:143]
buffer_load_dwordx4 v22, s[12:15], s33 offen offset:2048 lds
s_waitcnt lgkmcnt(4)
v_mfma_f32_16x16x32_bf16 v[144:147], a[0:3], a[32:35], v[144:147]
ds_read_b64_tr_b16 a[16:17], v15 offset:0
v_mfma_f32_16x16x32_bf16 v[144:147], a[4:7], a[48:51], v[144:147]
v_mfma_f32_16x16x32_bf16 v[148:151], a[0:3], a[36:39], v[148:151]
ds_read_b64_tr_b16 a[18:19], v15 offset:1024
v_mfma_f32_16x16x32_bf16 v[148:151], a[4:7], a[52:55], v[148:151]
v_mfma_f32_16x16x32_bf16 v[152:155], a[0:3], a[40:43], v[152:155]
ds_read_b64_tr_b16 a[20:21], v15 offset:8192
v_mfma_f32_16x16x32_bf16 v[152:155], a[4:7], a[56:59], v[152:155]
ds_read_b64_tr_b16 a[22:23], v15 offset:9216
v_mfma_f32_16x16x32_bf16 v[156:159], a[0:3], a[44:47], v[156:159]
v_add_u32 v15, s41, v15
v_mfma_f32_16x16x32_bf16 v[156:159], a[4:7], a[60:63], v[156:159]
buffer_load_dwordx4 v23, s[12:15], s33 offen offset:3072 lds
s_waitcnt lgkmcnt(4)
v_mfma_f32_16x16x32_bf16 v[160:163], a[8:11], a[32:35], v[160:163]
ds_read_b64_tr_b16 a[24:25], v16 offset:0
v_mfma_f32_16x16x32_bf16 v[160:163], a[12:15], a[48:51], v[160:163]
ds_read_b64_tr_b16 a[26:27], v16 offset:768
v_mfma_f32_16x16x32_bf16 v[164:167], a[8:11], a[36:39], v[164:167]
buffer_store_dwordx4 a[208:211], v31, s[28:31], s81 offen offset:0 sc1
v_mfma_f32_16x16x32_bf16 v[164:167], a[12:15], a[52:55], v[164:167]
v_mfma_f32_16x16x32_bf16 v[168:171], a[8:11], a[40:43], v[168:171]
ds_read_b64_tr_b16 a[28:29], v16 offset:6144
v_mfma_f32_16x16x32_bf16 v[168:171], a[12:15], a[56:59], v[168:171]
v_mfma_f32_16x16x32_bf16 v[172:175], a[8:11], a[44:47], v[172:175]
ds_read_b64_tr_b16 a[30:31], v16 offset:6912
v_mfma_f32_16x16x32_bf16 v[172:175], a[12:15], a[60:63], v[172:175]
s_waitcnt lgkmcnt(4)
v_mfma_f32_16x16x32_bf16 v[176:179], a[16:19], a[32:35], v[176:179]
ds_read_b64_tr_b16 a[96:97], v17 offset:0
v_mfma_f32_16x16x32_bf16 v[176:179], a[20:23], a[48:51], v[176:179]
ds_read_b64_tr_b16 a[98:99], v17 offset:768
v_mfma_f32_16x16x32_bf16 v[180:183], a[16:19], a[36:39], v[180:183]
s_add_u32 m0, s40, 4096
v_mfma_f32_16x16x32_bf16 v[180:183], a[20:23], a[52:55], v[180:183]
buffer_load_dwordx4 v22, s[12:15], s34 offen offset:0 lds
v_mfma_f32_16x16x32_bf16 v[184:187], a[16:19], a[40:43], v[184:187]
ds_read_b64_tr_b16 a[100:101], v17 offset:6144
v_mfma_f32_16x16x32_bf16 v[184:187], a[20:23], a[56:59], v[184:187]
ds_read_b64_tr_b16 a[102:103], v17 offset:6912
v_mfma_f32_16x16x32_bf16 v[188:191], a[16:19], a[44:47], v[188:191]
buffer_load_dwordx4 v23, s[12:15], s34 offen offset:1024 lds
v_mfma_f32_16x16x32_bf16 v[188:191], a[20:23], a[60:63], v[188:191]
s_waitcnt lgkmcnt(4)
v_mfma_f32_16x16x32_bf16 v[192:195], a[24:27], a[32:35], v[192:195]
ds_read_b64_tr_b16 a[0:1], v16 offset:64
v_mfma_f32_16x16x32_bf16 v[192:195], a[28:31], a[48:51], v[192:195]
v_mfma_f32_16x16x32_bf16 v[196:199], a[24:27], a[36:39], v[196:199]
ds_read_b64_tr_b16 a[2:3], v16 offset:832
v_mfma_f32_16x16x32_bf16 v[196:199], a[28:31], a[52:55], v[196:199]
v_mfma_f32_16x16x32_bf16 v[200:203], a[24:27], a[40:43], v[200:203]
ds_read_b64_tr_b16 a[4:5], v16 offset:6208
v_mfma_f32_16x16x32_bf16 v[200:203], a[28:31], a[56:59], v[200:203]
ds_read_b64_tr_b16 a[6:7], v16 offset:6976
v_mfma_f32_16x16x32_bf16 v[204:207], a[24:27], a[44:47], v[204:207]
buffer_load_dwordx4 v22, s[12:15], s35 offen offset:2048 lds
v_mfma_f32_16x16x32_bf16 v[204:207], a[28:31], a[60:63], v[204:207]
s_waitcnt lgkmcnt(4)
v_mfma_f32_16x16x32_bf16 v[208:211], a[96:99], a[32:35], v[208:211]
ds_read_b64_tr_b16 a[8:9], v17 offset:64
v_mfma_f32_16x16x32_bf16 v[208:211], a[100:103], a[48:51], v[208:211]
ds_read_b64_tr_b16 a[10:11], v17 offset:832
v_mfma_f32_16x16x32_bf16 v[212:215], a[96:99], a[36:39], v[212:215]
buffer_load_dwordx4 v23, s[12:15], s35 offen offset:3072 lds
v_mfma_f32_16x16x32_bf16 v[212:215], a[100:103], a[52:55], v[212:215]
v_mfma_f32_16x16x32_bf16 v[216:219], a[96:99], a[40:43], v[216:219]
ds_read_b64_tr_b16 a[12:13], v17 offset:6208
ds_read_b64_tr_b16 a[14:15], v17 offset:6976
v_mfma_f32_16x16x32_bf16 v[216:219], a[100:103], a[56:59], v[216:219]
buffer_store_dwordx4 a[148:151], v31, s[28:31], s77 offen offset:1024 sc1
s_add_u32 s32, s32, 128
v_mfma_f32_16x16x32_bf16 v[220:223], a[96:99], a[44:47], v[220:223]
s_add_u32 s33, s33, 128
s_add_u32 s34, s34, 128
v_mfma_f32_16x16x32_bf16 v[220:223], a[100:103], a[60:63], v[220:223]
s_add_u32 s35, s35, 128
s_xor_b32 s40, s40, 0x8000
s_waitcnt lgkmcnt(4)
v_mfma_f32_16x16x32_bf16 v[224:227], a[0:3], a[32:35], v[224:227]
ds_read_b64_tr_b16 a[16:17], v16 offset:128
ds_read_b64_tr_b16 a[18:19], v16 offset:896
v_mfma_f32_16x16x32_bf16 v[224:227], a[4:7], a[48:51], v[224:227]
ds_read_b64_tr_b16 a[20:21], v16 offset:6272
v_mfma_f32_16x16x32_bf16 v[228:231], a[0:3], a[36:39], v[228:231]
ds_read_b64_tr_b16 a[22:23], v16 offset:7040
v_mfma_f32_16x16x32_bf16 v[228:231], a[4:7], a[52:55], v[228:231]
v_add_u32 v16, s41, v16
v_mfma_f32_16x16x32_bf16 v[232:235], a[0:3], a[40:43], v[232:235]
ds_read_b64_tr_b16 a[24:25], v17 offset:128
ds_read_b64_tr_b16 a[26:27], v17 offset:896
v_mfma_f32_16x16x32_bf16 v[232:235], a[4:7], a[56:59], v[232:235]
ds_read_b64_tr_b16 a[28:29], v17 offset:6272
ds_read_b64_tr_b16 a[30:31], v17 offset:7040
v_mfma_f32_16x16x32_bf16 v[236:239], a[0:3], a[44:47], v[236:239]
v_add_u32 v17, s41, v17
s_add_u32 m0, s39, s46
v_mfma_f32_16x16x32_bf16 v[236:239], a[4:7], a[60:63], v[236:239]
buffer_load_dwordx4 v28, s[24:27], s38 offen offset:0 lds
s_waitcnt lgkmcnt(8)
v_mfma_f32_16x16x32_bf16 v[240:243], a[8:11], a[32:35], v[240:243]
buffer_load_dwordx4 v29, s[24:27], s38 offen offset:1024 lds
v_mfma_f32_16x16x32_bf16 v[240:243], a[12:15], a[48:51], v[240:243]
v_mfma_f32_16x16x32_bf16 v[244:247], a[8:11], a[36:39], v[244:247]
v_mfma_f32_16x16x32_bf16 v[244:247], a[12:15], a[52:55], v[244:247]
v_mfma_f32_16x16x32_bf16 v[248:251], a[8:11], a[40:43], v[248:251]
v_mfma_f32_16x16x32_bf16 v[248:251], a[12:15], a[56:59], v[248:251]
v_mfma_f32_16x16x32_bf16 v[252:255], a[8:11], a[44:47], v[252:255]
v_mfma_f32_16x16x32_bf16 v[252:255], a[12:15], a[60:63], v[252:255]
s_waitcnt vmcnt(18)
s_waitcnt lgkmcnt(0)
s_barrier
v_mfma_f32_16x16x32_bf16 a[64:67], a[32:35], a[16:19], a[64:67]
ds_read_b64_tr_b16 a[0:1], v8 offset:0
ds_read_b64_tr_b16 a[2:3], v8 offset:1024
v_mfma_f32_16x16x32_bf16 a[64:67], a[48:51], a[20:23], a[64:67]
ds_read_b64_tr_b16 a[4:5], v8 offset:8192
v_mfma_f32_16x16x32_bf16 a[80:83], a[32:35], a[24:27], a[80:83]
ds_read_b64_tr_b16 a[6:7], v8 offset:9216
v_mfma_f32_16x16x32_bf16 a[80:83], a[48:51], a[28:31], a[80:83]
buffer_load_dwordx4 v30, s[24:27], s38 offen offset:2048 lds
v_mfma_f32_16x16x32_bf16 a[68:71], a[36:39], a[16:19], a[68:71]
ds_read_b128 a[32:35], v18 offset:0
ds_read_b128 a[48:51], v19 offset:0
ds_read_b64_tr_b16 a[8:9], v9 offset:0
v_mfma_f32_16x16x32_bf16 a[68:71], a[52:55], a[20:23], a[68:71]
ds_read_b64_tr_b16 a[10:11], v9 offset:1024
ds_read_b64_tr_b16 a[12:13], v9 offset:8192
ds_read_b64_tr_b16 a[14:15], v9 offset:9216
v_mfma_f32_16x16x32_bf16 a[84:87], a[36:39], a[24:27], a[84:87]
buffer_store_dwordx4 a[212:215], v31, s[28:31], s81 offen offset:1024 sc1
s_add_u32 s36, s36, 524288
s_add_u32 s38, s38, 393216
v_mfma_f32_16x16x32_bf16 a[84:87], a[52:55], a[28:31], a[84:87]
s_add_u32 s39, s39, 0x8000
s_cmp_eq_u32 s39, 163840
s_cselect_b32 s39, 65536, s39
v_mfma_f32_16x16x32_bf16 a[72:75], a[40:43], a[16:19], a[72:75]
ds_read_b128 a[36:39], v18 offset:2048
v_mfma_f32_16x16x32_bf16 a[72:75], a[56:59], a[20:23], a[72:75]
v_mfma_f32_16x16x32_bf16 a[88:91], a[40:43], a[24:27], a[88:91]
ds_read_b128 a[52:55], v19 offset:2048
v_mfma_f32_16x16x32_bf16 a[88:91], a[56:59], a[28:31], a[88:91]
v_mfma_f32_16x16x32_bf16 a[76:79], a[44:47], a[16:19], a[76:79]
ds_read_b128 a[40:43], v18 offset:4096
v_mfma_f32_16x16x32_bf16 a[76:79], a[60:63], a[20:23], a[76:79]
v_mfma_f32_16x16x32_bf16 a[92:95], a[44:47], a[24:27], a[92:95]
ds_read_b128 a[56:59], v19 offset:4096
v_mfma_f32_16x16x32_bf16 a[92:95], a[60:63], a[28:31], a[92:95]
s_cmp_eq_u32 s39, 98304
s_cselect_b32 s41, s48, s49
s_waitcnt lgkmcnt(9)
v_mfma_f32_16x16x32_bf16 v[64:67], a[0:3], a[32:35], v[64:67]
ds_read_b128 a[44:47], v18 offset:6144
ds_read_b128 a[60:63], v19 offset:6144
s_waitcnt lgkmcnt(10)
v_mfma_f32_16x16x32_bf16 v[64:67], a[4:7], a[48:51], v[64:67]
ds_read_b64_tr_b16 a[16:17], v10 offset:0
s_waitcnt lgkmcnt(9)
v_mfma_f32_16x16x32_bf16 v[80:83], a[8:11], a[32:35], v[80:83]
ds_read_b64_tr_b16 a[18:19], v10 offset:1024
s_add_u32 m0, s39, s45
s_waitcnt lgkmcnt(8)
v_mfma_f32_16x16x32_bf16 v[80:83], a[12:15], a[48:51], v[80:83]
buffer_load_dwordx4 v24, s[20:23], s36 offen offset:0 lds
s_waitcnt lgkmcnt(7)
v_mfma_f32_16x16x32_bf16 v[68:71], a[0:3], a[36:39], v[68:71]
v_xor_b32 v18, 0x8000, v18
v_xor_b32 v19, 0x8000, v19
s_waitcnt lgkmcnt(6)
v_mfma_f32_16x16x32_bf16 v[68:71], a[4:7], a[52:55], v[68:71]
ds_read_b64_tr_b16 a[20:21], v10 offset:8192
v_mfma_f32_16x16x32_bf16 v[84:87], a[8:11], a[36:39], v[84:87]
ds_read_b64_tr_b16 a[22:23], v10 offset:9216
v_add_u32 v10, s41, v10
v_mfma_f32_16x16x32_bf16 v[84:87], a[12:15], a[52:55], v[84:87]
buffer_load_dwordx4 v25, s[20:23], s36 offen offset:1024 lds
s_waitcnt lgkmcnt(7)
v_mfma_f32_16x16x32_bf16 v[72:75], a[0:3], a[40:43], v[72:75]
ds_read_b64_tr_b16 a[24:25], v11 offset:0
ds_read_b64_tr_b16 a[26:27], v11 offset:1024
s_waitcnt lgkmcnt(8)
v_mfma_f32_16x16x32_bf16 v[72:75], a[4:7], a[56:59], v[72:75]
v_add_u32 v8, s41, v8
v_mfma_f32_16x16x32_bf16 v[88:91], a[8:11], a[40:43], v[88:91]
v_add_u32 v9, s41, v9
v_mfma_f32_16x16x32_bf16 v[88:91], a[12:15], a[56:59], v[88:91]
buffer_load_dwordx4 v26, s[20:23], s36 offen offset:2048 lds
s_waitcnt lgkmcnt(7)
v_mfma_f32_16x16x32_bf16 v[76:79], a[0:3], a[44:47], v[76:79]
ds_read_b64_tr_b16 a[28:29], v11 offset:8192
s_waitcnt lgkmcnt(7)
v_mfma_f32_16x16x32_bf16 v[76:79], a[4:7], a[60:63], v[76:79]
ds_read_b64_tr_b16 a[30:31], v11 offset:9216
v_mfma_f32_16x16x32_bf16 v[92:95], a[8:11], a[44:47], v[92:95]
v_add_u32 v11, s41, v11
v_mfma_f32_16x16x32_bf16 v[92:95], a[12:15], a[60:63], v[92:95]
s_waitcnt lgkmcnt(4)
v_mfma_f32_16x16x32_bf16 v[96:99], a[16:19], a[32:35], v[96:99]
ds_read_b64_tr_b16 a[96:97], v12 offset:0
v_mfma_f32_16x16x32_bf16 v[96:99], a[20:23], a[48:51], v[96:99]
ds_read_b64_tr_b16 a[98:99], v12 offset:1024
v_mfma_f32_16x16x32_bf16 v[100:103], a[16:19], a[36:39], v[100:103]
buffer_load_dwordx4 v27, s[20:23], s36 offen offset:3072 lds
v_mfma_f32_16x16x32_bf16 v[100:103], a[20:23], a[52:55], v[100:103]
v_mfma_f32_16x16x32_bf16 v[104:107], a[16:19], a[40:43], v[104:107]
ds_read_b64_tr_b16 a[100:101], v12 offset:8192
v_mfma_f32_16x16x32_bf16 v[104:107], a[20:23], a[56:59], v[104:107]
ds_read_b64_tr_b16 a[102:103], v12 offset:9216
v_mfma_f32_16x16x32_bf16 v[108:111], a[16:19], a[44:47], v[108:111]
v_add_u32 v12, s41, v12
v_mfma_f32_16x16x32_bf16 v[108:111], a[20:23], a[60:63], v[108:111]
buffer_store_dwordx4 a[152:155], v31, s[28:31], s77 offen offset:2048 sc1
s_waitcnt lgkmcnt(4)
v_mfma_f32_16x16x32_bf16 v[112:115], a[24:27], a[32:35], v[112:115]
ds_read_b64_tr_b16 a[0:1], v13 offset:0
v_mfma_f32_16x16x32_bf16 v[112:115], a[28:31], a[48:51], v[112:115]
v_mfma_f32_16x16x32_bf16 v[116:119], a[24:27], a[36:39], v[116:119]
ds_read_b64_tr_b16 a[2:3], v13 offset:1024
v_mfma_f32_16x16x32_bf16 v[116:119], a[28:31], a[52:55], v[116:119]
v_mfma_f32_16x16x32_bf16 v[120:123], a[24:27], a[40:43], v[120:123]
ds_read_b64_tr_b16 a[4:5], v13 offset:8192
ds_read_b64_tr_b16 a[6:7], v13 offset:9216
v_mfma_f32_16x16x32_bf16 v[120:123], a[28:31], a[56:59], v[120:123]
v_add_u32 v13, s41, v13
v_mfma_f32_16x16x32_bf16 v[124:127], a[24:27], a[44:47], v[124:127]
s_mov_b32 m0, s40
v_mfma_f32_16x16x32_bf16 v[124:127], a[28:31], a[60:63], v[124:127]
buffer_load_dwordx4 v22, s[12:15], s32 offen offset:0 lds
s_waitcnt lgkmcnt(4)
v_mfma_f32_16x16x32_bf16 v[128:131], a[96:99], a[32:35], v[128:131]
ds_read_b64_tr_b16 a[8:9], v14 offset:0
v_mfma_f32_16x16x32_bf16 v[128:131], a[100:103], a[48:51], v[128:131]
ds_read_b64_tr_b16 a[10:11], v14 offset:1024
v_mfma_f32_16x16x32_bf16 v[132:135], a[96:99], a[36:39], v[132:135]
buffer_load_dwordx4 v23, s[12:15], s32 offen offset:1024 lds
v_mfma_f32_16x16x32_bf16 v[132:135], a[100:103], a[52:55], v[132:135]
v_mfma_f32_16x16x32_bf16 v[136:139], a[96:99], a[40:43], v[136:139]
ds_read_b64_tr_b16 a[12:13], v14 offset:8192
v_mfma_f32_16x16x32_bf16 v[136:139], a[100:103], a[56:59], v[136:139]
ds_read_b64_tr_b16 a[14:15], v14 offset:9216
v_mfma_f32_16x16x32_bf16 v[140:143], a[96:99], a[44:47], v[140:143]
v_add_u32 v14, s41, v14
v_mfma_f32_16x16x32_bf16 v[140:143], a[100:103], a[60:63], v[140:143]
buffer_load_dwordx4 v22, s[12:15], s33 offen offset:2048 lds
s_waitcnt lgkmcnt(4)
v_mfma_f32_16x16x32_bf16 v[144:147], a[0:3], a[32:35], v[144:147]
ds_read_b64_tr_b16 a[16:17], v15 offset:0
v_mfma_f32_16x16x32_bf16 v[144:147], a[4:7], a[48:51], v[144:147]
v_mfma_f32_16x16x32_bf16 v[148:151], a[0:3], a[36:39], v[148:151]
ds_read_b64_tr_b16 a[18:19], v15 offset:1024
v_mfma_f32_16x16x32_bf16 v[148:151], a[4:7], a[52:55], v[148:151]
v_mfma_f32_16x16x32_bf16 v[152:155], a[0:3], a[40:43], v[152:155]
ds_read_b64_tr_b16 a[20:21], v15 offset:8192
v_mfma_f32_16x16x32_bf16 v[152:155], a[4:7], a[56:59], v[152:155]
ds_read_b64_tr_b16 a[22:23], v15 offset:9216
v_mfma_f32_16x16x32_bf16 v[156:159], a[0:3], a[44:47], v[156:159]
v_add_u32 v15, s41, v15
v_mfma_f32_16x16x32_bf16 v[156:159], a[4:7], a[60:63], v[156:159]
buffer_load_dwordx4 v23, s[12:15], s33 offen offset:3072 lds
s_waitcnt lgkmcnt(4)
v_mfma_f32_16x16x32_bf16 v[160:163], a[8:11], a[32:35], v[160:163]
ds_read_b64_tr_b16 a[24:25], v16 offset:0
v_mfma_f32_16x16x32_bf16 v[160:163], a[12:15], a[48:51], v[160:163]
ds_read_b64_tr_b16 a[26:27], v16 offset:768
v_mfma_f32_16x16x32_bf16 v[164:167], a[8:11], a[36:39], v[164:167]
buffer_store_dwordx4 a[216:219], v31, s[28:31], s81 offen offset:2048 sc1
v_mfma_f32_16x16x32_bf16 v[164:167], a[12:15], a[52:55], v[164:167]
v_mfma_f32_16x16x32_bf16 v[168:171], a[8:11], a[40:43], v[168:171]
ds_read_b64_tr_b16 a[28:29], v16 offset:6144
v_mfma_f32_16x16x32_bf16 v[168:171], a[12:15], a[56:59], v[168:171]
v_mfma_f32_16x16x32_bf16 v[172:175], a[8:11], a[44:47], v[172:175]
ds_read_b64_tr_b16 a[30:31], v16 offset:6912
v_mfma_f32_16x16x32_bf16 v[172:175], a[12:15], a[60:63], v[172:175]
s_waitcnt lgkmcnt(4)
v_mfma_f32_16x16x32_bf16 v[176:179], a[16:19], a[32:35], v[176:179]
ds_read_b64_tr_b16 a[96:97], v17 offset:0
v_mfma_f32_16x16x32_bf16 v[176:179], a[20:23], a[48:51], v[176:179]
ds_read_b64_tr_b16 a[98:99], v17 offset:768
v_mfma_f32_16x16x32_bf16 v[180:183], a[16:19], a[36:39], v[180:183]
s_add_u32 m0, s40, 4096
v_mfma_f32_16x16x32_bf16 v[180:183], a[20:23], a[52:55], v[180:183]
buffer_load_dwordx4 v22, s[12:15], s34 offen offset:0 lds
v_mfma_f32_16x16x32_bf16 v[184:187], a[16:19], a[40:43], v[184:187]
ds_read_b64_tr_b16 a[100:101], v17 offset:6144
v_mfma_f32_16x16x32_bf16 v[184:187], a[20:23], a[56:59], v[184:187]
ds_read_b64_tr_b16 a[102:103], v17 offset:6912
v_mfma_f32_16x16x32_bf16 v[188:191], a[16:19], a[44:47], v[188:191]
buffer_load_dwordx4 v23, s[12:15], s34 offen offset:1024 lds
v_mfma_f32_16x16x32_bf16 v[188:191], a[20:23], a[60:63], v[188:191]
s_waitcnt lgkmcnt(4)
v_mfma_f32_16x16x32_bf16 v[192:195], a[24:27], a[32:35], v[192:195]
ds_read_b64_tr_b16 a[0:1], v16 offset:64
v_mfma_f32_16x16x32_bf16 v[192:195], a[28:31], a[48:51], v[192:195]
v_mfma_f32_16x16x32_bf16 v[196:199], a[24:27], a[36:39], v[196:199]
ds_read_b64_tr_b16 a[2:3], v16 offset:832
v_mfma_f32_16x16x32_bf16 v[196:199], a[28:31], a[52:55], v[196:199]
v_mfma_f32_16x16x32_bf16 v[200:203], a[24:27], a[40:43], v[200:203]
ds_read_b64_tr_b16 a[4:5], v16 offset:6208
v_mfma_f32_16x16x32_bf16 v[200:203], a[28:31], a[56:59], v[200:203]
ds_read_b64_tr_b16 a[6:7], v16 offset:6976
v_mfma_f32_16x16x32_bf16 v[204:207], a[24:27], a[44:47], v[204:207]
buffer_load_dwordx4 v22, s[12:15], s35 offen offset:2048 lds
v_mfma_f32_16x16x32_bf16 v[204:207], a[28:31], a[60:63], v[204:207]
s_waitcnt lgkmcnt(4)
v_mfma_f32_16x16x32_bf16 v[208:211], a[96:99], a[32:35], v[208:211]
ds_read_b64_tr_b16 a[8:9], v17 offset:64
v_mfma_f32_16x16x32_bf16 v[208:211], a[100:103], a[48:51], v[208:211]
ds_read_b64_tr_b16 a[10:11], v17 offset:832
v_mfma_f32_16x16x32_bf16 v[212:215], a[96:99], a[36:39], v[212:215]
buffer_load_dwordx4 v23, s[12:15], s35 offen offset:3072 lds
v_mfma_f32_16x16x32_bf16 v[212:215], a[100:103], a[52:55], v[212:215]
v_mfma_f32_16x16x32_bf16 v[216:219], a[96:99], a[40:43], v[216:219]
ds_read_b64_tr_b16 a[12:13], v17 offset:6208
ds_read_b64_tr_b16 a[14:15], v17 offset:6976
v_mfma_f32_16x16x32_bf16 v[216:219], a[100:103], a[56:59], v[216:219]
buffer_store_dwordx4 a[156:159], v31, s[28:31], s77 offen offset:3072 sc1
s_add_u32 s32, s32, 128
v_mfma_f32_16x16x32_bf16 v[220:223], a[96:99], a[44:47], v[220:223]
s_add_u32 s33, s33, 128
s_add_u32 s34, s34, 128
v_mfma_f32_16x16x32_bf16 v[220:223], a[100:103], a[60:63], v[220:223]
s_add_u32 s35, s35, 128
s_xor_b32 s40, s40, 0x8000
s_waitcnt lgkmcnt(4)
v_mfma_f32_16x16x32_bf16 v[224:227], a[0:3], a[32:35], v[224:227]
ds_read_b64_tr_b16 a[16:17], v16 offset:128
ds_read_b64_tr_b16 a[18:19], v16 offset:896
v_mfma_f32_16x16x32_bf16 v[224:227], a[4:7], a[48:51], v[224:227]
ds_read_b64_tr_b16 a[20:21], v16 offset:6272
v_mfma_f32_16x16x32_bf16 v[228:231], a[0:3], a[36:39], v[228:231]
ds_read_b64_tr_b16 a[22:23], v16 offset:7040
v_mfma_f32_16x16x32_bf16 v[228:231], a[4:7], a[52:55], v[228:231]
v_add_u32 v16, s41, v16
v_mfma_f32_16x16x32_bf16 v[232:235], a[0:3], a[40:43], v[232:235]
ds_read_b64_tr_b16 a[24:25], v17 offset:128
ds_read_b64_tr_b16 a[26:27], v17 offset:896
v_mfma_f32_16x16x32_bf16 v[232:235], a[4:7], a[56:59], v[232:235]
ds_read_b64_tr_b16 a[28:29], v17 offset:6272
ds_read_b64_tr_b16 a[30:31], v17 offset:7040
v_mfma_f32_16x16x32_bf16 v[236:239], a[0:3], a[44:47], v[236:239]
v_add_u32 v17, s41, v17
s_add_u32 m0, s39, s46
v_mfma_f32_16x16x32_bf16 v[236:239], a[4:7], a[60:63], v[236:239]
buffer_load_dwordx4 v28, s[24:27], s38 offen offset:0 lds
s_waitcnt lgkmcnt(8)
v_mfma_f32_16x16x32_bf16 v[240:243], a[8:11], a[32:35], v[240:243]
buffer_load_dwordx4 v29, s[24:27], s38 offen offset:1024 lds
v_mfma_f32_16x16x32_bf16 v[240:243], a[12:15], a[48:51], v[240:243]
v_mfma_f32_16x16x32_bf16 v[244:247], a[8:11], a[36:39], v[244:247]
v_mfma_f32_16x16x32_bf16 v[244:247], a[12:15], a[52:55], v[244:247]
v_mfma_f32_16x16x32_bf16 v[248:251], a[8:11], a[40:43], v[248:251]
v_mfma_f32_16x16x32_bf16 v[248:251], a[12:15], a[56:59], v[248:251]
v_mfma_f32_16x16x32_bf16 v[252:255], a[8:11], a[44:47], v[252:255]
v_mfma_f32_16x16x32_bf16 v[252:255], a[12:15], a[60:63], v[252:255]
s_waitcnt vmcnt(18)
s_waitcnt lgkmcnt(0)
s_barrier
v_mfma_f32_16x16x32_bf16 a[64:67], a[32:35], a[16:19], a[64:67]
ds_read_b64_tr_b16 a[0:1], v8 offset:0
ds_read_b64_tr_b16 a[2:3], v8 offset:1024
v_mfma_f32_16x16x32_bf16 a[64:67], a[48:51], a[20:23], a[64:67]
ds_read_b64_tr_b16 a[4:5], v8 offset:8192
v_mfma_f32_16x16x32_bf16 a[80:83], a[32:35], a[24:27], a[80:83]
ds_read_b64_tr_b16 a[6:7], v8 offset:9216
v_mfma_f32_16x16x32_bf16 a[80:83], a[48:51], a[28:31], a[80:83]
buffer_load_dwordx4 v30, s[24:27], s38 offen offset:2048 lds
v_mfma_f32_16x16x32_bf16 a[68:71], a[36:39], a[16:19], a[68:71]
ds_read_b128 a[32:35], v18 offset:0
ds_read_b128 a[48:51], v19 offset:0
ds_read_b64_tr_b16 a[8:9], v9 offset:0
v_mfma_f32_16x16x32_bf16 a[68:71], a[52:55], a[20:23], a[68:71]
ds_read_b64_tr_b16 a[10:11], v9 offset:1024
ds_read_b64_tr_b16 a[12:13], v9 offset:8192
ds_read_b64_tr_b16 a[14:15], v9 offset:9216
v_mfma_f32_16x16x32_bf16 a[84:87], a[36:39], a[24:27], a[84:87]
buffer_store_dwordx4 a[220:223], v31, s[28:31], s81 offen offset:3072 sc1
s_add_u32 s36, s36, 524288
s_add_u32 s38, s38, 393216
v_mfma_f32_16x16x32_bf16 a[84:87], a[52:55], a[28:31], a[84:87]
s_add_u32 s39, s39, 0x8000
s_cmp_eq_u32 s39, 163840
s_cselect_b32 s39, 65536, s39
v_mfma_f32_16x16x32_bf16 a[72:75], a[40:43], a[16:19], a[72:75]
ds_read_b128 a[36:39], v18 offset:2048
v_mfma_f32_16x16x32_bf16 a[72:75], a[56:59], a[20:23], a[72:75]
v_mfma_f32_16x16x32_bf16 a[88:91], a[40:43], a[24:27], a[88:91]
ds_read_b128 a[52:55], v19 offset:2048
v_mfma_f32_16x16x32_bf16 a[88:91], a[56:59], a[28:31], a[88:91]
v_mfma_f32_16x16x32_bf16 a[76:79], a[44:47], a[16:19], a[76:79]
ds_read_b128 a[40:43], v18 offset:4096
v_mfma_f32_16x16x32_bf16 a[76:79], a[60:63], a[20:23], a[76:79]
v_mfma_f32_16x16x32_bf16 a[92:95], a[44:47], a[24:27], a[92:95]
ds_read_b128 a[56:59], v19 offset:4096
v_mfma_f32_16x16x32_bf16 a[92:95], a[60:63], a[28:31], a[92:95]
s_cmp_eq_u32 s39, 98304
s_cselect_b32 s41, s48, s49
s_waitcnt lgkmcnt(9)
v_mfma_f32_16x16x32_bf16 v[64:67], a[0:3], a[32:35], v[64:67]
ds_read_b128 a[44:47], v18 offset:6144
ds_read_b128 a[60:63], v19 offset:6144
s_waitcnt lgkmcnt(10)
v_mfma_f32_16x16x32_bf16 v[64:67], a[4:7], a[48:51], v[64:67]
ds_read_b64_tr_b16 a[16:17], v10 offset:0
s_waitcnt lgkmcnt(9)
v_mfma_f32_16x16x32_bf16 v[80:83], a[8:11], a[32:35], v[80:83]
ds_read_b64_tr_b16 a[18:19], v10 offset:1024
s_add_u32 m0, s39, s45
s_waitcnt lgkmcnt(8)
v_mfma_f32_16x16x32_bf16 v[80:83], a[12:15], a[48:51], v[80:83]
buffer_load_dwordx4 v24, s[20:23], s36 offen offset:0 lds
s_waitcnt lgkmcnt(7)
v_mfma_f32_16x16x32_bf16 v[68:71], a[0:3], a[36:39], v[68:71]
v_xor_b32 v18, 0x8000, v18
v_xor_b32 v19, 0x8000, v19
s_waitcnt lgkmcnt(6)
v_mfma_f32_16x16x32_bf16 v[68:71], a[4:7], a[52:55], v[68:71]
ds_read_b64_tr_b16 a[20:21], v10 offset:8192
v_mfma_f32_16x16x32_bf16 v[84:87], a[8:11], a[36:39], v[84:87]
ds_read_b64_tr_b16 a[22:23], v10 offset:9216
v_add_u32 v10, s41, v10
v_mfma_f32_16x16x32_bf16 v[84:87], a[12:15], a[52:55], v[84:87]
buffer_load_dwordx4 v25, s[20:23], s36 offen offset:1024 lds
s_waitcnt lgkmcnt(7)
v_mfma_f32_16x16x32_bf16 v[72:75], a[0:3], a[40:43], v[72:75]
ds_read_b64_tr_b16 a[24:25], v11 offset:0
ds_read_b64_tr_b16 a[26:27], v11 offset:1024
s_waitcnt lgkmcnt(8)
v_mfma_f32_16x16x32_bf16 v[72:75], a[4:7], a[56:59], v[72:75]
v_add_u32 v8, s41, v8
v_mfma_f32_16x16x32_bf16 v[88:91], a[8:11], a[40:43], v[88:91]
v_add_u32 v9, s41, v9
v_mfma_f32_16x16x32_bf16 v[88:91], a[12:15], a[56:59], v[88:91]
buffer_load_dwordx4 v26, s[20:23], s36 offen offset:2048 lds
s_waitcnt lgkmcnt(7)
v_mfma_f32_16x16x32_bf16 v[76:79], a[0:3], a[44:47], v[76:79]
ds_read_b64_tr_b16 a[28:29], v11 offset:8192
s_waitcnt lgkmcnt(7)
v_mfma_f32_16x16x32_bf16 v[76:79], a[4:7], a[60:63], v[76:79]
ds_read_b64_tr_b16 a[30:31], v11 offset:9216
v_mfma_f32_16x16x32_bf16 v[92:95], a[8:11], a[44:47], v[92:95]
v_add_u32 v11, s41, v11
v_mfma_f32_16x16x32_bf16 v[92:95], a[12:15], a[60:63], v[92:95]
s_waitcnt lgkmcnt(4)
v_mfma_f32_16x16x32_bf16 v[96:99], a[16:19], a[32:35], v[96:99]
ds_read_b64_tr_b16 a[96:97], v12 offset:0
v_mfma_f32_16x16x32_bf16 v[96:99], a[20:23], a[48:51], v[96:99]
ds_read_b64_tr_b16 a[98:99], v12 offset:1024
v_mfma_f32_16x16x32_bf16 v[100:103], a[16:19], a[36:39], v[100:103]
buffer_load_dwordx4 v27, s[20:23], s36 offen offset:3072 lds
v_mfma_f32_16x16x32_bf16 v[100:103], a[20:23], a[52:55], v[100:103]
v_mfma_f32_16x16x32_bf16 v[104:107], a[16:19], a[40:43], v[104:107]
ds_read_b64_tr_b16 a[100:101], v12 offset:8192
v_mfma_f32_16x16x32_bf16 v[104:107], a[20:23], a[56:59], v[104:107]
ds_read_b64_tr_b16 a[102:103], v12 offset:9216
v_mfma_f32_16x16x32_bf16 v[108:111], a[16:19], a[44:47], v[108:111]
v_add_u32 v12, s41, v12
v_mfma_f32_16x16x32_bf16 v[108:111], a[20:23], a[60:63], v[108:111]
buffer_store_dwordx4 a[160:163], v31, s[28:31], s78 offen offset:0 sc1
s_waitcnt lgkmcnt(4)
v_mfma_f32_16x16x32_bf16 v[112:115], a[24:27], a[32:35], v[112:115]
ds_read_b64_tr_b16 a[0:1], v13 offset:0
v_mfma_f32_16x16x32_bf16 v[112:115], a[28:31], a[48:51], v[112:115]
v_mfma_f32_16x16x32_bf16 v[116:119], a[24:27], a[36:39], v[116:119]
ds_read_b64_tr_b16 a[2:3], v13 offset:1024
v_mfma_f32_16x16x32_bf16 v[116:119], a[28:31], a[52:55], v[116:119]
v_mfma_f32_16x16x32_bf16 v[120:123], a[24:27], a[40:43], v[120:123]
ds_read_b64_tr_b16 a[4:5], v13 offset:8192
ds_read_b64_tr_b16 a[6:7], v13 offset:9216
v_mfma_f32_16x16x32_bf16 v[120:123], a[28:31], a[56:59], v[120:123]
v_add_u32 v13, s41, v13
v_mfma_f32_16x16x32_bf16 v[124:127], a[24:27], a[44:47], v[124:127]
s_mov_b32 m0, s40
v_mfma_f32_16x16x32_bf16 v[124:127], a[28:31], a[60:63], v[124:127]
buffer_load_dwordx4 v22, s[12:15], s32 offen offset:0 lds
s_waitcnt lgkmcnt(4)
v_mfma_f32_16x16x32_bf16 v[128:131], a[96:99], a[32:35], v[128:131]
ds_read_b64_tr_b16 a[8:9], v14 offset:0
v_mfma_f32_16x16x32_bf16 v[128:131], a[100:103], a[48:51], v[128:131]
ds_read_b64_tr_b16 a[10:11], v14 offset:1024
v_mfma_f32_16x16x32_bf16 v[132:135], a[96:99], a[36:39], v[132:135]
buffer_load_dwordx4 v23, s[12:15], s32 offen offset:1024 lds
v_mfma_f32_16x16x32_bf16 v[132:135], a[100:103], a[52:55], v[132:135]
v_mfma_f32_16x16x32_bf16 v[136:139], a[96:99], a[40:43], v[136:139]
ds_read_b64_tr_b16 a[12:13], v14 offset:8192
v_mfma_f32_16x16x32_bf16 v[136:139], a[100:103], a[56:59], v[136:139]
ds_read_b64_tr_b16 a[14:15], v14 offset:9216
v_mfma_f32_16x16x32_bf16 v[140:143], a[96:99], a[44:47], v[140:143]
v_add_u32 v14, s41, v14
v_mfma_f32_16x16x32_bf16 v[140:143], a[100:103], a[60:63], v[140:143]
buffer_load_dwordx4 v22, s[12:15], s33 offen offset:2048 lds
s_waitcnt lgkmcnt(4)
v_mfma_f32_16x16x32_bf16 v[144:147], a[0:3], a[32:35], v[144:147]
ds_read_b64_tr_b16 a[16:17], v15 offset:0
v_mfma_f32_16x16x32_bf16 v[144:147], a[4:7], a[48:51], v[144:147]
v_mfma_f32_16x16x32_bf16 v[148:151], a[0:3], a[36:39], v[148:151]
ds_read_b64_tr_b16 a[18:19], v15 offset:1024
v_mfma_f32_16x16x32_bf16 v[148:151], a[4:7], a[52:55], v[148:151]
v_mfma_f32_16x16x32_bf16 v[152:155], a[0:3], a[40:43], v[152:155]
ds_read_b64_tr_b16 a[20:21], v15 offset:8192
v_mfma_f32_16x16x32_bf16 v[152:155], a[4:7], a[56:59], v[152:155]
ds_read_b64_tr_b16 a[22:23], v15 offset:9216
v_mfma_f32_16x16x32_bf16 v[156:159], a[0:3], a[44:47], v[156:159]
v_add_u32 v15, s41, v15
v_mfma_f32_16x16x32_bf16 v[156:159], a[4:7], a[60:63], v[156:159]
buffer_load_dwordx4 v23, s[12:15], s33 offen offset:3072 lds
s_waitcnt lgkmcnt(4)
v_mfma_f32_16x16x32_bf16 v[160:163], a[8:11], a[32:35], v[160:163]
ds_read_b64_tr_b16 a[24:25], v16 offset:0
v_mfma_f32_16x16x32_bf16 v[160:163], a[12:15], a[48:51], v[160:163]
ds_read_b64_tr_b16 a[26:27], v16 offset:768
v_mfma_f32_16x16x32_bf16 v[164:167], a[8:11], a[36:39], v[164:167]
buffer_store_dwordx4 a[224:227], v31, s[28:31], s82 offen offset:0 sc1
v_mfma_f32_16x16x32_bf16 v[164:167], a[12:15], a[52:55], v[164:167]
v_mfma_f32_16x16x32_bf16 v[168:171], a[8:11], a[40:43], v[168:171]
ds_read_b64_tr_b16 a[28:29], v16 offset:6144
v_mfma_f32_16x16x32_bf16 v[168:171], a[12:15], a[56:59], v[168:171]
v_mfma_f32_16x16x32_bf16 v[172:175], a[8:11], a[44:47], v[172:175]
ds_read_b64_tr_b16 a[30:31], v16 offset:6912
v_mfma_f32_16x16x32_bf16 v[172:175], a[12:15], a[60:63], v[172:175]
s_waitcnt lgkmcnt(4)
v_mfma_f32_16x16x32_bf16 v[176:179], a[16:19], a[32:35], v[176:179]
ds_read_b64_tr_b16 a[96:97], v17 offset:0
v_mfma_f32_16x16x32_bf16 v[176:179], a[20:23], a[48:51], v[176:179]
ds_read_b64_tr_b16 a[98:99], v17 offset:768
v_mfma_f32_16x16x32_bf16 v[180:183], a[16:19], a[36:39], v[180:183]
s_add_u32 m0, s40, 4096
v_mfma_f32_16x16x32_bf16 v[180:183], a[20:23], a[52:55], v[180:183]
buffer_load_dwordx4 v22, s[12:15], s34 offen offset:0 lds
v_mfma_f32_16x16x32_bf16 v[184:187], a[16:19], a[40:43], v[184:187]
ds_read_b64_tr_b16 a[100:101], v17 offset:6144
v_mfma_f32_16x16x32_bf16 v[184:187], a[20:23], a[56:59], v[184:187]
ds_read_b64_tr_b16 a[102:103], v17 offset:6912
v_mfma_f32_16x16x32_bf16 v[188:191], a[16:19], a[44:47], v[188:191]
buffer_load_dwordx4 v23, s[12:15], s34 offen offset:1024 lds
v_mfma_f32_16x16x32_bf16 v[188:191], a[20:23], a[60:63], v[188:191]
s_waitcnt lgkmcnt(4)
v_mfma_f32_16x16x32_bf16 v[192:195], a[24:27], a[32:35], v[192:195]
ds_read_b64_tr_b16 a[0:1], v16 offset:64
v_mfma_f32_16x16x32_bf16 v[192:195], a[28:31], a[48:51], v[192:195]
v_mfma_f32_16x16x32_bf16 v[196:199], a[24:27], a[36:39], v[196:199]
ds_read_b64_tr_b16 a[2:3], v16 offset:832
v_mfma_f32_16x16x32_bf16 v[196:199], a[28:31], a[52:55], v[196:199]
v_mfma_f32_16x16x32_bf16 v[200:203], a[24:27], a[40:43], v[200:203]
ds_read_b64_tr_b16 a[4:5], v16 offset:6208
v_mfma_f32_16x16x32_bf16 v[200:203], a[28:31], a[56:59], v[200:203]
ds_read_b64_tr_b16 a[6:7], v16 offset:6976
v_mfma_f32_16x16x32_bf16 v[204:207], a[24:27], a[44:47], v[204:207]
buffer_load_dwordx4 v22, s[12:15], s35 offen offset:2048 lds
v_mfma_f32_16x16x32_bf16 v[204:207], a[28:31], a[60:63], v[204:207]
s_waitcnt lgkmcnt(4)
v_mfma_f32_16x16x32_bf16 v[208:211], a[96:99], a[32:35], v[208:211]
ds_read_b64_tr_b16 a[8:9], v17 offset:64
v_mfma_f32_16x16x32_bf16 v[208:211], a[100:103], a[48:51], v[208:211]
ds_read_b64_tr_b16 a[10:11], v17 offset:832
v_mfma_f32_16x16x32_bf16 v[212:215], a[96:99], a[36:39], v[212:215]
buffer_load_dwordx4 v23, s[12:15], s35 offen offset:3072 lds
v_mfma_f32_16x16x32_bf16 v[212:215], a[100:103], a[52:55], v[212:215]
v_mfma_f32_16x16x32_bf16 v[216:219], a[96:99], a[40:43], v[216:219]
ds_read_b64_tr_b16 a[12:13], v17 offset:6208
ds_read_b64_tr_b16 a[14:15], v17 offset:6976
v_mfma_f32_16x16x32_bf16 v[216:219], a[100:103], a[56:59], v[216:219]
buffer_store_dwordx4 a[164:167], v31, s[28:31], s78 offen offset:1024 sc1
s_add_u32 s32, s32, 128
v_mfma_f32_16x16x32_bf16 v[220:223], a[96:99], a[44:47], v[220:223]
s_add_u32 s33, s33, 128
s_add_u32 s34, s34, 128
v_mfma_f32_16x16x32_bf16 v[220:223], a[100:103], a[60:63], v[220:223]
s_add_u32 s35, s35, 128
s_xor_b32 s40, s40, 0x8000
s_waitcnt lgkmcnt(4)
v_mfma_f32_16x16x32_bf16 v[224:227], a[0:3], a[32:35], v[224:227]
ds_read_b64_tr_b16 a[16:17], v16 offset:128
ds_read_b64_tr_b16 a[18:19], v16 offset:896
v_mfma_f32_16x16x32_bf16 v[224:227], a[4:7], a[48:51], v[224:227]
ds_read_b64_tr_b16 a[20:21], v16 offset:6272
v_mfma_f32_16x16x32_bf16 v[228:231], a[0:3], a[36:39], v[228:231]
ds_read_b64_tr_b16 a[22:23], v16 offset:7040
v_mfma_f32_16x16x32_bf16 v[228:231], a[4:7], a[52:55], v[228:231]
v_add_u32 v16, s41, v16
v_mfma_f32_16x16x32_bf16 v[232:235], a[0:3], a[40:43], v[232:235]
ds_read_b64_tr_b16 a[24:25], v17 offset:128
ds_read_b64_tr_b16 a[26:27], v17 offset:896
v_mfma_f32_16x16x32_bf16 v[232:235], a[4:7], a[56:59], v[232:235]
ds_read_b64_tr_b16 a[28:29], v17 offset:6272
ds_read_b64_tr_b16 a[30:31], v17 offset:7040
v_mfma_f32_16x16x32_bf16 v[236:239], a[0:3], a[44:47], v[236:239]
v_add_u32 v17, s41, v17
s_add_u32 m0, s39, s46
v_mfma_f32_16x16x32_bf16 v[236:239], a[4:7], a[60:63], v[236:239]
buffer_load_dwordx4 v28, s[24:27], s38 offen offset:0 lds
s_waitcnt lgkmcnt(8)
v_mfma_f32_16x16x32_bf16 v[240:243], a[8:11], a[32:35], v[240:243]
buffer_load_dwordx4 v29, s[24:27], s38 offen offset:1024 lds
v_mfma_f32_16x16x32_bf16 v[240:243], a[12:15], a[48:51], v[240:243]
v_mfma_f32_16x16x32_bf16 v[244:247], a[8:11], a[36:39], v[244:247]
v_mfma_f32_16x16x32_bf16 v[244:247], a[12:15], a[52:55], v[244:247]
v_mfma_f32_16x16x32_bf16 v[248:251], a[8:11], a[40:43], v[248:251]
v_mfma_f32_16x16x32_bf16 v[248:251], a[12:15], a[56:59], v[248:251]
v_mfma_f32_16x16x32_bf16 v[252:255], a[8:11], a[44:47], v[252:255]
v_mfma_f32_16x16x32_bf16 v[252:255], a[12:15], a[60:63], v[252:255]
s_waitcnt vmcnt(18)
s_waitcnt lgkmcnt(0)
s_barrier
v_mfma_f32_16x16x32_bf16 a[64:67], a[32:35], a[16:19], a[64:67]
ds_read_b64_tr_b16 a[0:1], v8 offset:0
ds_read_b64_tr_b16 a[2:3], v8 offset:1024
v_mfma_f32_16x16x32_bf16 a[64:67], a[48:51], a[20:23], a[64:67]
ds_read_b64_tr_b16 a[4:5], v8 offset:8192
v_mfma_f32_16x16x32_bf16 a[80:83], a[32:35], a[24:27], a[80:83]
ds_read_b64_tr_b16 a[6:7], v8 offset:9216
v_mfma_f32_16x16x32_bf16 a[80:83], a[48:51], a[28:31], a[80:83]
buffer_load_dwordx4 v30, s[24:27], s38 offen offset:2048 lds
v_mfma_f32_16x16x32_bf16 a[68:71], a[36:39], a[16:19], a[68:71]
ds_read_b128 a[32:35], v18 offset:0
ds_read_b128 a[48:51], v19 offset:0
ds_read_b64_tr_b16 a[8:9], v9 offset:0
v_mfma_f32_16x16x32_bf16 a[68:71], a[52:55], a[20:23], a[68:71]
ds_read_b64_tr_b16 a[10:11], v9 offset:1024
ds_read_b64_tr_b16 a[12:13], v9 offset:8192
ds_read_b64_tr_b16 a[14:15], v9 offset:9216
v_mfma_f32_16x16x32_bf16 a[84:87], a[36:39], a[24:27], a[84:87]
buffer_store_dwordx4 a[228:231], v31, s[28:31], s82 offen offset:1024 sc1
s_add_u32 s36, s36, 524288
s_add_u32 s38, s38, 393216
v_mfma_f32_16x16x32_bf16 a[84:87], a[52:55], a[28:31], a[84:87]
s_add_u32 s39, s39, 0x8000
s_cmp_eq_u32 s39, 163840
s_cselect_b32 s39, 65536, s39
v_mfma_f32_16x16x32_bf16 a[72:75], a[40:43], a[16:19], a[72:75]
ds_read_b128 a[36:39], v18 offset:2048
v_mfma_f32_16x16x32_bf16 a[72:75], a[56:59], a[20:23], a[72:75]
v_mfma_f32_16x16x32_bf16 a[88:91], a[40:43], a[24:27], a[88:91]
ds_read_b128 a[52:55], v19 offset:2048
v_mfma_f32_16x16x32_bf16 a[88:91], a[56:59], a[28:31], a[88:91]
v_mfma_f32_16x16x32_bf16 a[76:79], a[44:47], a[16:19], a[76:79]
ds_read_b128 a[40:43], v18 offset:4096
v_mfma_f32_16x16x32_bf16 a[76:79], a[60:63], a[20:23], a[76:79]
v_mfma_f32_16x16x32_bf16 a[92:95], a[44:47], a[24:27], a[92:95]
ds_read_b128 a[56:59], v19 offset:4096
v_mfma_f32_16x16x32_bf16 a[92:95], a[60:63], a[28:31], a[92:95]
s_cmp_eq_u32 s39, 98304
s_cselect_b32 s41, s48, s49
s_waitcnt lgkmcnt(9)
v_mfma_f32_16x16x32_bf16 v[64:67], a[0:3], a[32:35], v[64:67]
ds_read_b128 a[44:47], v18 offset:6144
ds_read_b128 a[60:63], v19 offset:6144
s_waitcnt lgkmcnt(10)
v_mfma_f32_16x16x32_bf16 v[64:67], a[4:7], a[48:51], v[64:67]
ds_read_b64_tr_b16 a[16:17], v10 offset:0
s_waitcnt lgkmcnt(9)
v_mfma_f32_16x16x32_bf16 v[80:83], a[8:11], a[32:35], v[80:83]
ds_read_b64_tr_b16 a[18:19], v10 offset:1024
s_add_u32 m0, s39, s45
s_waitcnt lgkmcnt(8)
v_mfma_f32_16x16x32_bf16 v[80:83], a[12:15], a[48:51], v[80:83]
buffer_load_dwordx4 v24, s[20:23], s36 offen offset:0 lds
s_waitcnt lgkmcnt(7)
v_mfma_f32_16x16x32_bf16 v[68:71], a[0:3], a[36:39], v[68:71]
v_xor_b32 v18, 0x8000, v18
v_xor_b32 v19, 0x8000, v19
s_waitcnt lgkmcnt(6)
v_mfma_f32_16x16x32_bf16 v[68:71], a[4:7], a[52:55], v[68:71]
ds_read_b64_tr_b16 a[20:21], v10 offset:8192
v_mfma_f32_16x16x32_bf16 v[84:87], a[8:11], a[36:39], v[84:87]
ds_read_b64_tr_b16 a[22:23], v10 offset:9216
v_add_u32 v10, s41, v10
v_mfma_f32_16x16x32_bf16 v[84:87], a[12:15], a[52:55], v[84:87]
buffer_load_dwordx4 v25, s[20:23], s36 offen offset:1024 lds
s_waitcnt lgkmcnt(7)
v_mfma_f32_16x16x32_bf16 v[72:75], a[0:3], a[40:43], v[72:75]
ds_read_b64_tr_b16 a[24:25], v11 offset:0
ds_read_b64_tr_b16 a[26:27], v11 offset:1024
s_waitcnt lgkmcnt(8)
v_mfma_f32_16x16x32_bf16 v[72:75], a[4:7], a[56:59], v[72:75]
v_add_u32 v8, s41, v8
v_mfma_f32_16x16x32_bf16 v[88:91], a[8:11], a[40:43], v[88:91]
v_add_u32 v9, s41, v9
v_mfma_f32_16x16x32_bf16 v[88:91], a[12:15], a[56:59], v[88:91]
buffer_load_dwordx4 v26, s[20:23], s36 offen offset:2048 lds
s_waitcnt lgkmcnt(7)
v_mfma_f32_16x16x32_bf16 v[76:79], a[0:3], a[44:47], v[76:79]
ds_read_b64_tr_b16 a[28:29], v11 offset:8192
s_waitcnt lgkmcnt(7)
v_mfma_f32_16x16x32_bf16 v[76:79], a[4:7], a[60:63], v[76:79]
ds_read_b64_tr_b16 a[30:31], v11 offset:9216
v_mfma_f32_16x16x32_bf16 v[92:95], a[8:11], a[44:47], v[92:95]
v_add_u32 v11, s41, v11
v_mfma_f32_16x16x32_bf16 v[92:95], a[12:15], a[60:63], v[92:95]
s_waitcnt lgkmcnt(4)
v_mfma_f32_16x16x32_bf16 v[96:99], a[16:19], a[32:35], v[96:99]
ds_read_b64_tr_b16 a[96:97], v12 offset:0
v_mfma_f32_16x16x32_bf16 v[96:99], a[20:23], a[48:51], v[96:99]
ds_read_b64_tr_b16 a[98:99], v12 offset:1024
v_mfma_f32_16x16x32_bf16 v[100:103], a[16:19], a[36:39], v[100:103]
buffer_load_dwordx4 v27, s[20:23], s36 offen offset:3072 lds
v_mfma_f32_16x16x32_bf16 v[100:103], a[20:23], a[52:55], v[100:103]
v_mfma_f32_16x16x32_bf16 v[104:107], a[16:19], a[40:43], v[104:107]
ds_read_b64_tr_b16 a[100:101], v12 offset:8192
v_mfma_f32_16x16x32_bf16 v[104:107], a[20:23], a[56:59], v[104:107]
ds_read_b64_tr_b16 a[102:103], v12 offset:9216
v_mfma_f32_16x16x32_bf16 v[108:111], a[16:19], a[44:47], v[108:111]
v_add_u32 v12, s41, v12
v_mfma_f32_16x16x32_bf16 v[108:111], a[20:23], a[60:63], v[108:111]
buffer_store_dwordx4 a[168:171], v31, s[28:31], s78 offen offset:2048 sc1
s_waitcnt lgkmcnt(4)
v_mfma_f32_16x16x32_bf16 v[112:115], a[24:27], a[32:35], v[112:115]
ds_read_b64_tr_b16 a[0:1], v13 offset:0
v_mfma_f32_16x16x32_bf16 v[112:115], a[28:31], a[48:51], v[112:115]
v_mfma_f32_16x16x32_bf16 v[116:119], a[24:27], a[36:39], v[116:119]
ds_read_b64_tr_b16 a[2:3], v13 offset:1024
v_mfma_f32_16x16x32_bf16 v[116:119], a[28:31], a[52:55], v[116:119]
v_mfma_f32_16x16x32_bf16 v[120:123], a[24:27], a[40:43], v[120:123]
ds_read_b64_tr_b16 a[4:5], v13 offset:8192
ds_read_b64_tr_b16 a[6:7], v13 offset:9216
v_mfma_f32_16x16x32_bf16 v[120:123], a[28:31], a[56:59], v[120:123]
v_add_u32 v13, s41, v13
v_mfma_f32_16x16x32_bf16 v[124:127], a[24:27], a[44:47], v[124:127]
s_mov_b32 m0, s40
v_mfma_f32_16x16x32_bf16 v[124:127], a[28:31], a[60:63], v[124:127]
buffer_load_dwordx4 v22, s[12:15], s32 offen offset:0 lds
s_waitcnt lgkmcnt(4)
v_mfma_f32_16x16x32_bf16 v[128:131], a[96:99], a[32:35], v[128:131]
ds_read_b64_tr_b16 a[8:9], v14 offset:0
v_mfma_f32_16x16x32_bf16 v[128:131], a[100:103], a[48:51], v[128:131]
ds_read_b64_tr_b16 a[10:11], v14 offset:1024
v_mfma_f32_16x16x32_bf16 v[132:135], a[96:99], a[36:39], v[132:135]
buffer_load_dwordx4 v23, s[12:15], s32 offen offset:1024 lds
v_mfma_f32_16x16x32_bf16 v[132:135], a[100:103], a[52:55], v[132:135]
v_mfma_f32_16x16x32_bf16 v[136:139], a[96:99], a[40:43], v[136:139]
ds_read_b64_tr_b16 a[12:13], v14 offset:8192
v_mfma_f32_16x16x32_bf16 v[136:139], a[100:103], a[56:59], v[136:139]
ds_read_b64_tr_b16 a[14:15], v14 offset:9216
v_mfma_f32_16x16x32_bf16 v[140:143], a[96:99], a[44:47], v[140:143]
v_add_u32 v14, s41, v14
v_mfma_f32_16x16x32_bf16 v[140:143], a[100:103], a[60:63], v[140:143]
buffer_load_dwordx4 v22, s[12:15], s33 offen offset:2048 lds
s_waitcnt lgkmcnt(4)
v_mfma_f32_16x16x32_bf16 v[144:147], a[0:3], a[32:35], v[144:147]
ds_read_b64_tr_b16 a[16:17], v15 offset:0
v_mfma_f32_16x16x32_bf16 v[144:147], a[4:7], a[48:51], v[144:147]
v_mfma_f32_16x16x32_bf16 v[148:151], a[0:3], a[36:39], v[148:151]
ds_read_b64_tr_b16 a[18:19], v15 offset:1024
v_mfma_f32_16x16x32_bf16 v[148:151], a[4:7], a[52:55], v[148:151]
v_mfma_f32_16x16x32_bf16 v[152:155], a[0:3], a[40:43], v[152:155]
ds_read_b64_tr_b16 a[20:21], v15 offset:8192
v_mfma_f32_16x16x32_bf16 v[152:155], a[4:7], a[56:59], v[152:155]
ds_read_b64_tr_b16 a[22:23], v15 offset:9216
v_mfma_f32_16x16x32_bf16 v[156:159], a[0:3], a[44:47], v[156:159]
v_add_u32 v15, s41, v15
v_mfma_f32_16x16x32_bf16 v[156:159], a[4:7], a[60:63], v[156:159]
buffer_load_dwordx4 v23, s[12:15], s33 offen offset:3072 lds
s_waitcnt lgkmcnt(4)
v_mfma_f32_16x16x32_bf16 v[160:163], a[8:11], a[32:35], v[160:163]
ds_read_b64_tr_b16 a[24:25], v16 offset:0
v_mfma_f32_16x16x32_bf16 v[160:163], a[12:15], a[48:51], v[160:163]
ds_read_b64_tr_b16 a[26:27], v16 offset:768
v_mfma_f32_16x16x32_bf16 v[164:167], a[8:11], a[36:39], v[164:167]
buffer_store_dwordx4 a[232:235], v31, s[28:31], s82 offen offset:2048 sc1
v_mfma_f32_16x16x32_bf16 v[164:167], a[12:15], a[52:55], v[164:167]
v_mfma_f32_16x16x32_bf16 v[168:171], a[8:11], a[40:43], v[168:171]
ds_read_b64_tr_b16 a[28:29], v16 offset:6144
v_mfma_f32_16x16x32_bf16 v[168:171], a[12:15], a[56:59], v[168:171]
v_mfma_f32_16x16x32_bf16 v[172:175], a[8:11], a[44:47], v[172:175]
ds_read_b64_tr_b16 a[30:31], v16 offset:6912
v_mfma_f32_16x16x32_bf16 v[172:175], a[12:15], a[60:63], v[172:175]
s_waitcnt lgkmcnt(4)
v_mfma_f32_16x16x32_bf16 v[176:179], a[16:19], a[32:35], v[176:179]
ds_read_b64_tr_b16 a[96:97], v17 offset:0
v_mfma_f32_16x16x32_bf16 v[176:179], a[20:23], a[48:51], v[176:179]
ds_read_b64_tr_b16 a[98:99], v17 offset:768
v_mfma_f32_16x16x32_bf16 v[180:183], a[16:19], a[36:39], v[180:183]
s_add_u32 m0, s40, 4096
v_mfma_f32_16x16x32_bf16 v[180:183], a[20:23], a[52:55], v[180:183]
buffer_load_dwordx4 v22, s[12:15], s34 offen offset:0 lds
v_mfma_f32_16x16x32_bf16 v[184:187], a[16:19], a[40:43], v[184:187]
ds_read_b64_tr_b16 a[100:101], v17 offset:6144
v_mfma_f32_16x16x32_bf16 v[184:187], a[20:23], a[56:59], v[184:187]
ds_read_b64_tr_b16 a[102:103], v17 offset:6912
v_mfma_f32_16x16x32_bf16 v[188:191], a[16:19], a[44:47], v[188:191]
buffer_load_dwordx4 v23, s[12:15], s34 offen offset:1024 lds
v_mfma_f32_16x16x32_bf16 v[188:191], a[20:23], a[60:63], v[188:191]
s_waitcnt lgkmcnt(4)
v_mfma_f32_16x16x32_bf16 v[192:195], a[24:27], a[32:35], v[192:195]
ds_read_b64_tr_b16 a[0:1], v16 offset:64
v_mfma_f32_16x16x32_bf16 v[192:195], a[28:31], a[48:51], v[192:195]
v_mfma_f32_16x16x32_bf16 v[196:199], a[24:27], a[36:39], v[196:199]
ds_read_b64_tr_b16 a[2:3], v16 offset:832
v_mfma_f32_16x16x32_bf16 v[196:199], a[28:31], a[52:55], v[196:199]
v_mfma_f32_16x16x32_bf16 v[200:203], a[24:27], a[40:43], v[200:203]
ds_read_b64_tr_b16 a[4:5], v16 offset:6208
v_mfma_f32_16x16x32_bf16 v[200:203], a[28:31], a[56:59], v[200:203]
ds_read_b64_tr_b16 a[6:7], v16 offset:6976
v_mfma_f32_16x16x32_bf16 v[204:207], a[24:27], a[44:47], v[204:207]
buffer_load_dwordx4 v22, s[12:15], s35 offen offset:2048 lds
v_mfma_f32_16x16x32_bf16 v[204:207], a[28:31], a[60:63], v[204:207]
s_waitcnt lgkmcnt(4)
v_mfma_f32_16x16x32_bf16 v[208:211], a[96:99], a[32:35], v[208:211]
ds_read_b64_tr_b16 a[8:9], v17 offset:64
v_mfma_f32_16x16x32_bf16 v[208:211], a[100:103], a[48:51], v[208:211]
ds_read_b64_tr_b16 a[10:11], v17 offset:832
v_mfma_f32_16x16x32_bf16 v[212:215], a[96:99], a[36:39], v[212:215]
buffer_load_dwordx4 v23, s[12:15], s35 offen offset:3072 lds
v_mfma_f32_16x16x32_bf16 v[212:215], a[100:103], a[52:55], v[212:215]
v_mfma_f32_16x16x32_bf16 v[216:219], a[96:99], a[40:43], v[216:219]
ds_read_b64_tr_b16 a[12:13], v17 offset:6208
ds_read_b64_tr_b16 a[14:15], v17 offset:6976
v_mfma_f32_16x16x32_bf16 v[216:219], a[100:103], a[56:59], v[216:219]
buffer_store_dwordx4 a[172:175], v31, s[28:31], s78 offen offset:3072 sc1
s_add_u32 s32, s32, 128
v_mfma_f32_16x16x32_bf16 v[220:223], a[96:99], a[44:47], v[220:223]
s_add_u32 s33, s33, 128
s_add_u32 s34, s34, 128
v_mfma_f32_16x16x32_bf16 v[220:223], a[100:103], a[60:63], v[220:223]
s_add_u32 s35, s35, 128
s_xor_b32 s40, s40, 0x8000
s_waitcnt lgkmcnt(4)
v_mfma_f32_16x16x32_bf16 v[224:227], a[0:3], a[32:35], v[224:227]
ds_read_b64_tr_b16 a[16:17], v16 offset:128
ds_read_b64_tr_b16 a[18:19], v16 offset:896
v_mfma_f32_16x16x32_bf16 v[224:227], a[4:7], a[48:51], v[224:227]
ds_read_b64_tr_b16 a[20:21], v16 offset:6272
v_mfma_f32_16x16x32_bf16 v[228:231], a[0:3], a[36:39], v[228:231]
ds_read_b64_tr_b16 a[22:23], v16 offset:7040
v_mfma_f32_16x16x32_bf16 v[228:231], a[4:7], a[52:55], v[228:231]
v_add_u32 v16, s41, v16
v_mfma_f32_16x16x32_bf16 v[232:235], a[0:3], a[40:43], v[232:235]
ds_read_b64_tr_b16 a[24:25], v17 offset:128
ds_read_b64_tr_b16 a[26:27], v17 offset:896
v_mfma_f32_16x16x32_bf16 v[232:235], a[4:7], a[56:59], v[232:235]
ds_read_b64_tr_b16 a[28:29], v17 offset:6272
ds_read_b64_tr_b16 a[30:31], v17 offset:7040
v_mfma_f32_16x16x32_bf16 v[236:239], a[0:3], a[44:47], v[236:239]
v_add_u32 v17, s41, v17
s_add_u32 m0, s39, s46
v_mfma_f32_16x16x32_bf16 v[236:239], a[4:7], a[60:63], v[236:239]
buffer_load_dwordx4 v28, s[24:27], s38 offen offset:0 lds
s_waitcnt lgkmcnt(8)
v_mfma_f32_16x16x32_bf16 v[240:243], a[8:11], a[32:35], v[240:243]
buffer_load_dwordx4 v29, s[24:27], s38 offen offset:1024 lds
v_mfma_f32_16x16x32_bf16 v[240:243], a[12:15], a[48:51], v[240:243]
v_mfma_f32_16x16x32_bf16 v[244:247], a[8:11], a[36:39], v[244:247]
v_mfma_f32_16x16x32_bf16 v[244:247], a[12:15], a[52:55], v[244:247]
v_mfma_f32_16x16x32_bf16 v[248:251], a[8:11], a[40:43], v[248:251]
v_mfma_f32_16x16x32_bf16 v[248:251], a[12:15], a[56:59], v[248:251]
v_mfma_f32_16x16x32_bf16 v[252:255], a[8:11], a[44:47], v[252:255]
v_mfma_f32_16x16x32_bf16 v[252:255], a[12:15], a[60:63], v[252:255]
s_waitcnt vmcnt(18)
s_waitcnt lgkmcnt(0)
s_barrier
v_mfma_f32_16x16x32_bf16 a[64:67], a[32:35], a[16:19], a[64:67]
ds_read_b64_tr_b16 a[0:1], v8 offset:0
ds_read_b64_tr_b16 a[2:3], v8 offset:1024
v_mfma_f32_16x16x32_bf16 a[64:67], a[48:51], a[20:23], a[64:67]
ds_read_b64_tr_b16 a[4:5], v8 offset:8192
v_mfma_f32_16x16x32_bf16 a[80:83], a[32:35], a[24:27], a[80:83]
ds_read_b64_tr_b16 a[6:7], v8 offset:9216
v_mfma_f32_16x16x32_bf16 a[80:83], a[48:51], a[28:31], a[80:83]
buffer_load_dwordx4 v30, s[24:27], s38 offen offset:2048 lds
v_mfma_f32_16x16x32_bf16 a[68:71], a[36:39], a[16:19], a[68:71]
ds_read_b128 a[32:35], v18 offset:0
ds_read_b128 a[48:51], v19 offset:0
ds_read_b64_tr_b16 a[8:9], v9 offset:0
v_mfma_f32_16x16x32_bf16 a[68:71], a[52:55], a[20:23], a[68:71]
ds_read_b64_tr_b16 a[10:11], v9 offset:1024
ds_read_b64_tr_b16 a[12:13], v9 offset:8192
ds_read_b64_tr_b16 a[14:15], v9 offset:9216
v_mfma_f32_16x16x32_bf16 a[84:87], a[36:39], a[24:27], a[84:87]
buffer_store_dwordx4 a[236:239], v31, s[28:31], s82 offen offset:3072 sc1
s_add_u32 s36, s36, 524288
s_add_u32 s38, s38, 393216
v_mfma_f32_16x16x32_bf16 a[84:87], a[52:55], a[28:31], a[84:87]
s_add_u32 s39, s39, 0x8000
s_cmp_eq_u32 s39, 163840
s_cselect_b32 s39, 65536, s39
v_mfma_f32_16x16x32_bf16 a[72:75], a[40:43], a[16:19], a[72:75]
ds_read_b128 a[36:39], v18 offset:2048
v_mfma_f32_16x16x32_bf16 a[72:75], a[56:59], a[20:23], a[72:75]
v_mfma_f32_16x16x32_bf16 a[88:91], a[40:43], a[24:27], a[88:91]
ds_read_b128 a[52:55], v19 offset:2048
v_mfma_f32_16x16x32_bf16 a[88:91], a[56:59], a[28:31], a[88:91]
v_mfma_f32_16x16x32_bf16 a[76:79], a[44:47], a[16:19], a[76:79]
ds_read_b128 a[40:43], v18 offset:4096
v_mfma_f32_16x16x32_bf16 a[76:79], a[60:63], a[20:23], a[76:79]
v_mfma_f32_16x16x32_bf16 a[92:95], a[44:47], a[24:27], a[92:95]
ds_read_b128 a[56:59], v19 offset:4096
v_mfma_f32_16x16x32_bf16 a[92:95], a[60:63], a[28:31], a[92:95]
s_cmp_eq_u32 s39, 98304
s_cselect_b32 s41, s48, s49
s_waitcnt lgkmcnt(9)
v_mfma_f32_16x16x32_bf16 v[64:67], a[0:3], a[32:35], v[64:67]
ds_read_b128 a[44:47], v18 offset:6144
ds_read_b128 a[60:63], v19 offset:6144
s_waitcnt lgkmcnt(10)
v_mfma_f32_16x16x32_bf16 v[64:67], a[4:7], a[48:51], v[64:67]
ds_read_b64_tr_b16 a[16:17], v10 offset:0
s_waitcnt lgkmcnt(9)
v_mfma_f32_16x16x32_bf16 v[80:83], a[8:11], a[32:35], v[80:83]
ds_read_b64_tr_b16 a[18:19], v10 offset:1024
s_add_u32 m0, s39, s45
s_waitcnt lgkmcnt(8)
v_mfma_f32_16x16x32_bf16 v[80:83], a[12:15], a[48:51], v[80:83]
buffer_load_dwordx4 v24, s[20:23], s36 offen offset:0 lds
s_waitcnt lgkmcnt(7)
v_mfma_f32_16x16x32_bf16 v[68:71], a[0:3], a[36:39], v[68:71]
v_xor_b32 v18, 0x8000, v18
v_xor_b32 v19, 0x8000, v19
s_waitcnt lgkmcnt(6)
v_mfma_f32_16x16x32_bf16 v[68:71], a[4:7], a[52:55], v[68:71]
ds_read_b64_tr_b16 a[20:21], v10 offset:8192
v_mfma_f32_16x16x32_bf16 v[84:87], a[8:11], a[36:39], v[84:87]
ds_read_b64_tr_b16 a[22:23], v10 offset:9216
v_add_u32 v10, s41, v10
v_mfma_f32_16x16x32_bf16 v[84:87], a[12:15], a[52:55], v[84:87]
buffer_load_dwordx4 v25, s[20:23], s36 offen offset:1024 lds
s_waitcnt lgkmcnt(7)
v_mfma_f32_16x16x32_bf16 v[72:75], a[0:3], a[40:43], v[72:75]
ds_read_b64_tr_b16 a[24:25], v11 offset:0
ds_read_b64_tr_b16 a[26:27], v11 offset:1024
s_waitcnt lgkmcnt(8)
v_mfma_f32_16x16x32_bf16 v[72:75], a[4:7], a[56:59], v[72:75]
v_add_u32 v8, s41, v8
v_mfma_f32_16x16x32_bf16 v[88:91], a[8:11], a[40:43], v[88:91]
v_add_u32 v9, s41, v9
v_mfma_f32_16x16x32_bf16 v[88:91], a[12:15], a[56:59], v[88:91]
buffer_load_dwordx4 v26, s[20:23], s36 offen offset:2048 lds
s_waitcnt lgkmcnt(7)
v_mfma_f32_16x16x32_bf16 v[76:79], a[0:3], a[44:47], v[76:79]
ds_read_b64_tr_b16 a[28:29], v11 offset:8192
s_waitcnt lgkmcnt(7)
v_mfma_f32_16x16x32_bf16 v[76:79], a[4:7], a[60:63], v[76:79]
ds_read_b64_tr_b16 a[30:31], v11 offset:9216
v_mfma_f32_16x16x32_bf16 v[92:95], a[8:11], a[44:47], v[92:95]
v_add_u32 v11, s41, v11
v_mfma_f32_16x16x32_bf16 v[92:95], a[12:15], a[60:63], v[92:95]
s_waitcnt lgkmcnt(4)
v_mfma_f32_16x16x32_bf16 v[96:99], a[16:19], a[32:35], v[96:99]
ds_read_b64_tr_b16 a[96:97], v12 offset:0
v_mfma_f32_16x16x32_bf16 v[96:99], a[20:23], a[48:51], v[96:99]
ds_read_b64_tr_b16 a[98:99], v12 offset:1024
v_mfma_f32_16x16x32_bf16 v[100:103], a[16:19], a[36:39], v[100:103]
buffer_load_dwordx4 v27, s[20:23], s36 offen offset:3072 lds
v_mfma_f32_16x16x32_bf16 v[100:103], a[20:23], a[52:55], v[100:103]
v_mfma_f32_16x16x32_bf16 v[104:107], a[16:19], a[40:43], v[104:107]
ds_read_b64_tr_b16 a[100:101], v12 offset:8192
v_mfma_f32_16x16x32_bf16 v[104:107], a[20:23], a[56:59], v[104:107]
ds_read_b64_tr_b16 a[102:103], v12 offset:9216
v_mfma_f32_16x16x32_bf16 v[108:111], a[16:19], a[44:47], v[108:111]
v_add_u32 v12, s41, v12
v_mfma_f32_16x16x32_bf16 v[108:111], a[20:23], a[60:63], v[108:111]
buffer_store_dwordx4 a[176:179], v31, s[28:31], s79 offen offset:0 sc1
s_waitcnt lgkmcnt(4)
v_mfma_f32_16x16x32_bf16 v[112:115], a[24:27], a[32:35], v[112:115]
ds_read_b64_tr_b16 a[0:1], v13 offset:0
v_mfma_f32_16x16x32_bf16 v[112:115], a[28:31], a[48:51], v[112:115]
v_mfma_f32_16x16x32_bf16 v[116:119], a[24:27], a[36:39], v[116:119]
ds_read_b64_tr_b16 a[2:3], v13 offset:1024
v_mfma_f32_16x16x32_bf16 v[116:119], a[28:31], a[52:55], v[116:119]
v_mfma_f32_16x16x32_bf16 v[120:123], a[24:27], a[40:43], v[120:123]
ds_read_b64_tr_b16 a[4:5], v13 offset:8192
ds_read_b64_tr_b16 a[6:7], v13 offset:9216
v_mfma_f32_16x16x32_bf16 v[120:123], a[28:31], a[56:59], v[120:123]
v_add_u32 v13, s41, v13
v_mfma_f32_16x16x32_bf16 v[124:127], a[24:27], a[44:47], v[124:127]
s_mov_b32 m0, s40
v_mfma_f32_16x16x32_bf16 v[124:127], a[28:31], a[60:63], v[124:127]
buffer_load_dwordx4 v22, s[12:15], s32 offen offset:0 lds
s_waitcnt lgkmcnt(4)
v_mfma_f32_16x16x32_bf16 v[128:131], a[96:99], a[32:35], v[128:131]
ds_read_b64_tr_b16 a[8:9], v14 offset:0
v_mfma_f32_16x16x32_bf16 v[128:131], a[100:103], a[48:51], v[128:131]
ds_read_b64_tr_b16 a[10:11], v14 offset:1024
v_mfma_f32_16x16x32_bf16 v[132:135], a[96:99], a[36:39], v[132:135]
buffer_load_dwordx4 v23, s[12:15], s32 offen offset:1024 lds
v_mfma_f32_16x16x32_bf16 v[132:135], a[100:103], a[52:55], v[132:135]
v_mfma_f32_16x16x32_bf16 v[136:139], a[96:99], a[40:43], v[136:139]
ds_read_b64_tr_b16 a[12:13], v14 offset:8192
v_mfma_f32_16x16x32_bf16 v[136:139], a[100:103], a[56:59], v[136:139]
ds_read_b64_tr_b16 a[14:15], v14 offset:9216
v_mfma_f32_16x16x32_bf16 v[140:143], a[96:99], a[44:47], v[140:143]
v_add_u32 v14, s41, v14
v_mfma_f32_16x16x32_bf16 v[140:143], a[100:103], a[60:63], v[140:143]
buffer_load_dwordx4 v22, s[12:15], s33 offen offset:2048 lds
s_waitcnt lgkmcnt(4)
v_mfma_f32_16x16x32_bf16 v[144:147], a[0:3], a[32:35], v[144:147]
ds_read_b64_tr_b16 a[16:17], v15 offset:0
v_mfma_f32_16x16x32_bf16 v[144:147], a[4:7], a[48:51], v[144:147]
v_mfma_f32_16x16x32_bf16 v[148:151], a[0:3], a[36:39], v[148:151]
ds_read_b64_tr_b16 a[18:19], v15 offset:1024
v_mfma_f32_16x16x32_bf16 v[148:151], a[4:7], a[52:55], v[148:151]
v_mfma_f32_16x16x32_bf16 v[152:155], a[0:3], a[40:43], v[152:155]
ds_read_b64_tr_b16 a[20:21], v15 offset:8192
v_mfma_f32_16x16x32_bf16 v[152:155], a[4:7], a[56:59], v[152:155]
ds_read_b64_tr_b16 a[22:23], v15 offset:9216
v_mfma_f32_16x16x32_bf16 v[156:159], a[0:3], a[44:47], v[156:159]
v_add_u32 v15, s41, v15
v_mfma_f32_16x16x32_bf16 v[156:159], a[4:7], a[60:63], v[156:159]
buffer_load_dwordx4 v23, s[12:15], s33 offen offset:3072 lds
s_waitcnt lgkmcnt(4)
v_mfma_f32_16x16x32_bf16 v[160:163], a[8:11], a[32:35], v[160:163]
ds_read_b64_tr_b16 a[24:25], v16 offset:0
v_mfma_f32_16x16x32_bf16 v[160:163], a[12:15], a[48:51], v[160:163]
ds_read_b64_tr_b16 a[26:27], v16 offset:768
v_mfma_f32_16x16x32_bf16 v[164:167], a[8:11], a[36:39], v[164:167]
buffer_store_dwordx4 a[240:243], v31, s[28:31], s83 offen offset:0 sc1
v_mfma_f32_16x16x32_bf16 v[164:167], a[12:15], a[52:55], v[164:167]
v_mfma_f32_16x16x32_bf16 v[168:171], a[8:11], a[40:43], v[168:171]
ds_read_b64_tr_b16 a[28:29], v16 offset:6144
v_mfma_f32_16x16x32_bf16 v[168:171], a[12:15], a[56:59], v[168:171]
v_mfma_f32_16x16x32_bf16 v[172:175], a[8:11], a[44:47], v[172:175]
ds_read_b64_tr_b16 a[30:31], v16 offset:6912
v_mfma_f32_16x16x32_bf16 v[172:175], a[12:15], a[60:63], v[172:175]
s_waitcnt lgkmcnt(4)
v_mfma_f32_16x16x32_bf16 v[176:179], a[16:19], a[32:35], v[176:179]
ds_read_b64_tr_b16 a[96:97], v17 offset:0
v_mfma_f32_16x16x32_bf16 v[176:179], a[20:23], a[48:51], v[176:179]
ds_read_b64_tr_b16 a[98:99], v17 offset:768
v_mfma_f32_16x16x32_bf16 v[180:183], a[16:19], a[36:39], v[180:183]
s_add_u32 m0, s40, 4096
v_mfma_f32_16x16x32_bf16 v[180:183], a[20:23], a[52:55], v[180:183]
buffer_load_dwordx4 v22, s[12:15], s34 offen offset:0 lds
v_mfma_f32_16x16x32_bf16 v[184:187], a[16:19], a[40:43], v[184:187]
ds_read_b64_tr_b16 a[100:101], v17 offset:6144
v_mfma_f32_16x16x32_bf16 v[184:187], a[20:23], a[56:59], v[184:187]
ds_read_b64_tr_b16 a[102:103], v17 offset:6912
v_mfma_f32_16x16x32_bf16 v[188:191], a[16:19], a[44:47], v[188:191]
buffer_load_dwordx4 v23, s[12:15], s34 offen offset:1024 lds
v_mfma_f32_16x16x32_bf16 v[188:191], a[20:23], a[60:63], v[188:191]
s_waitcnt lgkmcnt(4)
v_mfma_f32_16x16x32_bf16 v[192:195], a[24:27], a[32:35], v[192:195]
ds_read_b64_tr_b16 a[0:1], v16 offset:64
v_mfma_f32_16x16x32_bf16 v[192:195], a[28:31], a[48:51], v[192:195]
v_mfma_f32_16x16x32_bf16 v[196:199], a[24:27], a[36:39], v[196:199]
ds_read_b64_tr_b16 a[2:3], v16 offset:832
v_mfma_f32_16x16x32_bf16 v[196:199], a[28:31], a[52:55], v[196:199]
v_mfma_f32_16x16x32_bf16 v[200:203], a[24:27], a[40:43], v[200:203]
ds_read_b64_tr_b16 a[4:5], v16 offset:6208
v_mfma_f32_16x16x32_bf16 v[200:203], a[28:31], a[56:59], v[200:203]
ds_read_b64_tr_b16 a[6:7], v16 offset:6976
v_mfma_f32_16x16x32_bf16 v[204:207], a[24:27], a[44:47], v[204:207]
buffer_load_dwordx4 v22, s[12:15], s35 offen offset:2048 lds
v_mfma_f32_16x16x32_bf16 v[204:207], a[28:31], a[60:63], v[204:207]
s_waitcnt lgkmcnt(4)
v_mfma_f32_16x16x32_bf16 v[208:211], a[96:99], a[32:35], v[208:211]
ds_read_b64_tr_b16 a[8:9], v17 offset:64
v_mfma_f32_16x16x32_bf16 v[208:211], a[100:103], a[48:51], v[208:211]
ds_read_b64_tr_b16 a[10:11], v17 offset:832
v_mfma_f32_16x16x32_bf16 v[212:215], a[96:99], a[36:39], v[212:215]
buffer_load_dwordx4 v23, s[12:15], s35 offen offset:3072 lds
v_mfma_f32_16x16x32_bf16 v[212:215], a[100:103], a[52:55], v[212:215]
v_mfma_f32_16x16x32_bf16 v[216:219], a[96:99], a[40:43], v[216:219]
ds_read_b64_tr_b16 a[12:13], v17 offset:6208
ds_read_b64_tr_b16 a[14:15], v17 offset:6976
v_mfma_f32_16x16x32_bf16 v[216:219], a[100:103], a[56:59], v[216:219]
buffer_store_dwordx4 a[180:183], v31, s[28:31], s79 offen offset:1024 sc1
s_add_u32 s32, s32, 128
v_mfma_f32_16x16x32_bf16 v[220:223], a[96:99], a[44:47], v[220:223]
s_add_u32 s33, s33, 128
s_add_u32 s34, s34, 128
v_mfma_f32_16x16x32_bf16 v[220:223], a[100:103], a[60:63], v[220:223]
s_add_u32 s35, s35, 128
s_xor_b32 s40, s40, 0x8000
s_waitcnt lgkmcnt(4)
v_mfma_f32_16x16x32_bf16 v[224:227], a[0:3], a[32:35], v[224:227]
ds_read_b64_tr_b16 a[16:17], v16 offset:128
ds_read_b64_tr_b16 a[18:19], v16 offset:896
v_mfma_f32_16x16x32_bf16 v[224:227], a[4:7], a[48:51], v[224:227]
ds_read_b64_tr_b16 a[20:21], v16 offset:6272
v_mfma_f32_16x16x32_bf16 v[228:231], a[0:3], a[36:39], v[228:231]
ds_read_b64_tr_b16 a[22:23], v16 offset:7040
v_mfma_f32_16x16x32_bf16 v[228:231], a[4:7], a[52:55], v[228:231]
v_add_u32 v16, s41, v16
v_mfma_f32_16x16x32_bf16 v[232:235], a[0:3], a[40:43], v[232:235]
ds_read_b64_tr_b16 a[24:25], v17 offset:128
ds_read_b64_tr_b16 a[26:27], v17 offset:896
v_mfma_f32_16x16x32_bf16 v[232:235], a[4:7], a[56:59], v[232:235]
ds_read_b64_tr_b16 a[28:29], v17 offset:6272
ds_read_b64_tr_b16 a[30:31], v17 offset:7040
v_mfma_f32_16x16x32_bf16 v[236:239], a[0:3], a[44:47], v[236:239]
v_add_u32 v17, s41, v17
s_add_u32 m0, s39, s46
v_mfma_f32_16x16x32_bf16 v[236:239], a[4:7], a[60:63], v[236:239]
buffer_load_dwordx4 v28, s[24:27], s38 offen offset:0 lds
s_waitcnt lgkmcnt(8)
v_mfma_f32_16x16x32_bf16 v[240:243], a[8:11], a[32:35], v[240:243]
buffer_load_dwordx4 v29, s[24:27], s38 offen offset:1024 lds
v_mfma_f32_16x16x32_bf16 v[240:243], a[12:15], a[48:51], v[240:243]
v_mfma_f32_16x16x32_bf16 v[244:247], a[8:11], a[36:39], v[244:247]
v_mfma_f32_16x16x32_bf16 v[244:247], a[12:15], a[52:55], v[244:247]
v_mfma_f32_16x16x32_bf16 v[248:251], a[8:11], a[40:43], v[248:251]
v_mfma_f32_16x16x32_bf16 v[248:251], a[12:15], a[56:59], v[248:251]
v_mfma_f32_16x16x32_bf16 v[252:255], a[8:11], a[44:47], v[252:255]
v_mfma_f32_16x16x32_bf16 v[252:255], a[12:15], a[60:63], v[252:255]
s_waitcnt vmcnt(18)
s_waitcnt lgkmcnt(0)
s_barrier
v_mfma_f32_16x16x32_bf16 a[64:67], a[32:35], a[16:19], a[64:67]
ds_read_b64_tr_b16 a[0:1], v8 offset:0
ds_read_b64_tr_b16 a[2:3], v8 offset:1024
v_mfma_f32_16x16x32_bf16 a[64:67], a[48:51], a[20:23], a[64:67]
ds_read_b64_tr_b16 a[4:5], v8 offset:8192
v_mfma_f32_16x16x32_bf16 a[80:83], a[32:35], a[24:27], a[80:83]
ds_read_b64_tr_b16 a[6:7], v8 offset:9216
v_mfma_f32_16x16x32_bf16 a[80:83], a[48:51], a[28:31], a[80:83]
buffer_load_dwordx4 v30, s[24:27], s38 offen offset:2048 lds
v_mfma_f32_16x16x32_bf16 a[68:71], a[36:39], a[16:19], a[68:71]
ds_read_b128 a[32:35], v18 offset:0
ds_read_b128 a[48:51], v19 offset:0
ds_read_b64_tr_b16 a[8:9], v9 offset:0
v_mfma_f32_16x16x32_bf16 a[68:71], a[52:55], a[20:23], a[68:71]
ds_read_b64_tr_b16 a[10:11], v9 offset:1024
ds_read_b64_tr_b16 a[12:13], v9 offset:8192
ds_read_b64_tr_b16 a[14:15], v9 offset:9216
v_mfma_f32_16x16x32_bf16 a[84:87], a[36:39], a[24:27], a[84:87]
buffer_store_dwordx4 a[244:247], v31, s[28:31], s83 offen offset:1024 sc1
s_add_u32 s36, s36, 524288
s_add_u32 s38, s38, 393216
v_mfma_f32_16x16x32_bf16 a[84:87], a[52:55], a[28:31], a[84:87]
s_add_u32 s39, s39, 0x8000
s_cmp_eq_u32 s39, 163840
s_cselect_b32 s39, 65536, s39
v_mfma_f32_16x16x32_bf16 a[72:75], a[40:43], a[16:19], a[72:75]
ds_read_b128 a[36:39], v18 offset:2048
v_mfma_f32_16x16x32_bf16 a[72:75], a[56:59], a[20:23], a[72:75]
v_mfma_f32_16x16x32_bf16 a[88:91], a[40:43], a[24:27], a[88:91]
ds_read_b128 a[52:55], v19 offset:2048
v_mfma_f32_16x16x32_bf16 a[88:91], a[56:59], a[28:31], a[88:91]
v_mfma_f32_16x16x32_bf16 a[76:79], a[44:47], a[16:19], a[76:79]
ds_read_b128 a[40:43], v18 offset:4096
v_mfma_f32_16x16x32_bf16 a[76:79], a[60:63], a[20:23], a[76:79]
v_mfma_f32_16x16x32_bf16 a[92:95], a[44:47], a[24:27], a[92:95]
ds_read_b128 a[56:59], v19 offset:4096
v_mfma_f32_16x16x32_bf16 a[92:95], a[60:63], a[28:31], a[92:95]
s_cmp_eq_u32 s39, 98304
s_cselect_b32 s41, s48, s49
s_waitcnt lgkmcnt(9)
v_mfma_f32_16x16x32_bf16 v[64:67], a[0:3], a[32:35], v[64:67]
ds_read_b128 a[44:47], v18 offset:6144
ds_read_b128 a[60:63], v19 offset:6144
s_waitcnt lgkmcnt(10)
v_mfma_f32_16x16x32_bf16 v[64:67], a[4:7], a[48:51], v[64:67]
ds_read_b64_tr_b16 a[16:17], v10 offset:0
s_waitcnt lgkmcnt(9)
v_mfma_f32_16x16x32_bf16 v[80:83], a[8:11], a[32:35], v[80:83]
ds_read_b64_tr_b16 a[18:19], v10 offset:1024
s_add_u32 m0, s39, s45
s_waitcnt lgkmcnt(8)
v_mfma_f32_16x16x32_bf16 v[80:83], a[12:15], a[48:51], v[80:83]
buffer_load_dwordx4 v24, s[20:23], s36 offen offset:0 lds
s_waitcnt lgkmcnt(7)
v_mfma_f32_16x16x32_bf16 v[68:71], a[0:3], a[36:39], v[68:71]
v_xor_b32 v18, 0x8000, v18
v_xor_b32 v19, 0x8000, v19
s_waitcnt lgkmcnt(6)
v_mfma_f32_16x16x32_bf16 v[68:71], a[4:7], a[52:55], v[68:71]
ds_read_b64_tr_b16 a[20:21], v10 offset:8192
v_mfma_f32_16x16x32_bf16 v[84:87], a[8:11], a[36:39], v[84:87]
ds_read_b64_tr_b16 a[22:23], v10 offset:9216
v_add_u32 v10, s41, v10
v_mfma_f32_16x16x32_bf16 v[84:87], a[12:15], a[52:55], v[84:87]
buffer_load_dwordx4 v25, s[20:23], s36 offen offset:1024 lds
s_waitcnt lgkmcnt(7)
v_mfma_f32_16x16x32_bf16 v[72:75], a[0:3], a[40:43], v[72:75]
ds_read_b64_tr_b16 a[24:25], v11 offset:0
ds_read_b64_tr_b16 a[26:27], v11 offset:1024
s_waitcnt lgkmcnt(8)
v_mfma_f32_16x16x32_bf16 v[72:75], a[4:7], a[56:59], v[72:75]
v_add_u32 v8, s41, v8
v_mfma_f32_16x16x32_bf16 v[88:91], a[8:11], a[40:43], v[88:91]
v_add_u32 v9, s41, v9
v_mfma_f32_16x16x32_bf16 v[88:91], a[12:15], a[56:59], v[88:91]
buffer_load_dwordx4 v26, s[20:23], s36 offen offset:2048 lds
s_waitcnt lgkmcnt(7)
v_mfma_f32_16x16x32_bf16 v[76:79], a[0:3], a[44:47], v[76:79]
ds_read_b64_tr_b16 a[28:29], v11 offset:8192
s_waitcnt lgkmcnt(7)
v_mfma_f32_16x16x32_bf16 v[76:79], a[4:7], a[60:63], v[76:79]
ds_read_b64_tr_b16 a[30:31], v11 offset:9216
v_mfma_f32_16x16x32_bf16 v[92:95], a[8:11], a[44:47], v[92:95]
v_add_u32 v11, s41, v11
v_mfma_f32_16x16x32_bf16 v[92:95], a[12:15], a[60:63], v[92:95]
s_waitcnt lgkmcnt(4)
v_mfma_f32_16x16x32_bf16 v[96:99], a[16:19], a[32:35], v[96:99]
ds_read_b64_tr_b16 a[96:97], v12 offset:0
v_mfma_f32_16x16x32_bf16 v[96:99], a[20:23], a[48:51], v[96:99]
ds_read_b64_tr_b16 a[98:99], v12 offset:1024
v_mfma_f32_16x16x32_bf16 v[100:103], a[16:19], a[36:39], v[100:103]
buffer_load_dwordx4 v27, s[20:23], s36 offen offset:3072 lds
v_mfma_f32_16x16x32_bf16 v[100:103], a[20:23], a[52:55], v[100:103]
v_mfma_f32_16x16x32_bf16 v[104:107], a[16:19], a[40:43], v[104:107]
ds_read_b64_tr_b16 a[100:101], v12 offset:8192
v_mfma_f32_16x16x32_bf16 v[104:107], a[20:23], a[56:59], v[104:107]
ds_read_b64_tr_b16 a[102:103], v12 offset:9216
v_mfma_f32_16x16x32_bf16 v[108:111], a[16:19], a[44:47], v[108:111]
v_add_u32 v12, s41, v12
v_mfma_f32_16x16x32_bf16 v[108:111], a[20:23], a[60:63], v[108:111]
buffer_store_dwordx4 a[184:187], v31, s[28:31], s79 offen offset:2048 sc1
s_waitcnt lgkmcnt(4)
v_mfma_f32_16x16x32_bf16 v[112:115], a[24:27], a[32:35], v[112:115]
ds_read_b64_tr_b16 a[0:1], v13 offset:0
v_mfma_f32_16x16x32_bf16 v[112:115], a[28:31], a[48:51], v[112:115]
v_mfma_f32_16x16x32_bf16 v[116:119], a[24:27], a[36:39], v[116:119]
ds_read_b64_tr_b16 a[2:3], v13 offset:1024
v_mfma_f32_16x16x32_bf16 v[116:119], a[28:31], a[52:55], v[116:119]
v_mfma_f32_16x16x32_bf16 v[120:123], a[24:27], a[40:43], v[120:123]
ds_read_b64_tr_b16 a[4:5], v13 offset:8192
ds_read_b64_tr_b16 a[6:7], v13 offset:9216
v_mfma_f32_16x16x32_bf16 v[120:123], a[28:31], a[56:59], v[120:123]
v_add_u32 v13, s41, v13
v_mfma_f32_16x16x32_bf16 v[124:127], a[24:27], a[44:47], v[124:127]
s_mov_b32 m0, s40
v_mfma_f32_16x16x32_bf16 v[124:127], a[28:31], a[60:63], v[124:127]
buffer_load_dwordx4 v22, s[12:15], s32 offen offset:0 lds
s_waitcnt lgkmcnt(4)
v_mfma_f32_16x16x32_bf16 v[128:131], a[96:99], a[32:35], v[128:131]
ds_read_b64_tr_b16 a[8:9], v14 offset:0
v_mfma_f32_16x16x32_bf16 v[128:131], a[100:103], a[48:51], v[128:131]
ds_read_b64_tr_b16 a[10:11], v14 offset:1024
v_mfma_f32_16x16x32_bf16 v[132:135], a[96:99], a[36:39], v[132:135]
buffer_load_dwordx4 v23, s[12:15], s32 offen offset:1024 lds
v_mfma_f32_16x16x32_bf16 v[132:135], a[100:103], a[52:55], v[132:135]
v_mfma_f32_16x16x32_bf16 v[136:139], a[96:99], a[40:43], v[136:139]
ds_read_b64_tr_b16 a[12:13], v14 offset:8192
v_mfma_f32_16x16x32_bf16 v[136:139], a[100:103], a[56:59], v[136:139]
ds_read_b64_tr_b16 a[14:15], v14 offset:9216
v_mfma_f32_16x16x32_bf16 v[140:143], a[96:99], a[44:47], v[140:143]
v_add_u32 v14, s41, v14
v_mfma_f32_16x16x32_bf16 v[140:143], a[100:103], a[60:63], v[140:143]
buffer_load_dwordx4 v22, s[12:15], s33 offen offset:2048 lds
s_waitcnt lgkmcnt(4)
v_mfma_f32_16x16x32_bf16 v[144:147], a[0:3], a[32:35], v[144:147]
ds_read_b64_tr_b16 a[16:17], v15 offset:0
v_mfma_f32_16x16x32_bf16 v[144:147], a[4:7], a[48:51], v[144:147]
v_mfma_f32_16x16x32_bf16 v[148:151], a[0:3], a[36:39], v[148:151]
ds_read_b64_tr_b16 a[18:19], v15 offset:1024
v_mfma_f32_16x16x32_bf16 v[148:151], a[4:7], a[52:55], v[148:151]
v_mfma_f32_16x16x32_bf16 v[152:155], a[0:3], a[40:43], v[152:155]
ds_read_b64_tr_b16 a[20:21], v15 offset:8192
v_mfma_f32_16x16x32_bf16 v[152:155], a[4:7], a[56:59], v[152:155]
ds_read_b64_tr_b16 a[22:23], v15 offset:9216
v_mfma_f32_16x16x32_bf16 v[156:159], a[0:3], a[44:47], v[156:159]
v_add_u32 v15, s41, v15
v_mfma_f32_16x16x32_bf16 v[156:159], a[4:7], a[60:63], v[156:159]
buffer_load_dwordx4 v23, s[12:15], s33 offen offset:3072 lds
s_waitcnt lgkmcnt(4)
v_mfma_f32_16x16x32_bf16 v[160:163], a[8:11], a[32:35], v[160:163]
ds_read_b64_tr_b16 a[24:25], v16 offset:0
v_mfma_f32_16x16x32_bf16 v[160:163], a[12:15], a[48:51], v[160:163]
ds_read_b64_tr_b16 a[26:27], v16 offset:768
v_mfma_f32_16x16x32_bf16 v[164:167], a[8:11], a[36:39], v[164:167]
buffer_store_dwordx4 a[248:251], v31, s[28:31], s83 offen offset:2048 sc1
v_mfma_f32_16x16x32_bf16 v[164:167], a[12:15], a[52:55], v[164:167]
v_mfma_f32_16x16x32_bf16 v[168:171], a[8:11], a[40:43], v[168:171]
ds_read_b64_tr_b16 a[28:29], v16 offset:6144
v_mfma_f32_16x16x32_bf16 v[168:171], a[12:15], a[56:59], v[168:171]
v_mfma_f32_16x16x32_bf16 v[172:175], a[8:11], a[44:47], v[172:175]
ds_read_b64_tr_b16 a[30:31], v16 offset:6912
v_mfma_f32_16x16x32_bf16 v[172:175], a[12:15], a[60:63], v[172:175]
s_waitcnt lgkmcnt(4)
v_mfma_f32_16x16x32_bf16 v[176:179], a[16:19], a[32:35], v[176:179]
ds_read_b64_tr_b16 a[96:97], v17 offset:0
v_mfma_f32_16x16x32_bf16 v[176:179], a[20:23], a[48:51], v[176:179]
ds_read_b64_tr_b16 a[98:99], v17 offset:768
v_mfma_f32_16x16x32_bf16 v[180:183], a[16:19], a[36:39], v[180:183]
s_add_u32 m0, s40, 4096
v_mfma_f32_16x16x32_bf16 v[180:183], a[20:23], a[52:55], v[180:183]
buffer_load_dwordx4 v22, s[12:15], s34 offen offset:0 lds
v_mfma_f32_16x16x32_bf16 v[184:187], a[16:19], a[40:43], v[184:187]
ds_read_b64_tr_b16 a[100:101], v17 offset:6144
v_mfma_f32_16x16x32_bf16 v[184:187], a[20:23], a[56:59], v[184:187]
ds_read_b64_tr_b16 a[102:103], v17 offset:6912
v_mfma_f32_16x16x32_bf16 v[188:191], a[16:19], a[44:47], v[188:191]
buffer_load_dwordx4 v23, s[12:15], s34 offen offset:1024 lds
v_mfma_f32_16x16x32_bf16 v[188:191], a[20:23], a[60:63], v[188:191]
s_waitcnt lgkmcnt(4)
v_mfma_f32_16x16x32_bf16 v[192:195], a[24:27], a[32:35], v[192:195]
ds_read_b64_tr_b16 a[0:1], v16 offset:64
v_mfma_f32_16x16x32_bf16 v[192:195], a[28:31], a[48:51], v[192:195]
v_mfma_f32_16x16x32_bf16 v[196:199], a[24:27], a[36:39], v[196:199]
ds_read_b64_tr_b16 a[2:3], v16 offset:832
v_mfma_f32_16x16x32_bf16 v[196:199], a[28:31], a[52:55], v[196:199]
v_mfma_f32_16x16x32_bf16 v[200:203], a[24:27], a[40:43], v[200:203]
ds_read_b64_tr_b16 a[4:5], v16 offset:6208
v_mfma_f32_16x16x32_bf16 v[200:203], a[28:31], a[56:59], v[200:203]
ds_read_b64_tr_b16 a[6:7], v16 offset:6976
v_mfma_f32_16x16x32_bf16 v[204:207], a[24:27], a[44:47], v[204:207]
buffer_load_dwordx4 v22, s[12:15], s35 offen offset:2048 lds
v_mfma_f32_16x16x32_bf16 v[204:207], a[28:31], a[60:63], v[204:207]
s_waitcnt lgkmcnt(4)
v_mfma_f32_16x16x32_bf16 v[208:211], a[96:99], a[32:35], v[208:211]
ds_read_b64_tr_b16 a[8:9], v17 offset:64
v_mfma_f32_16x16x32_bf16 v[208:211], a[100:103], a[48:51], v[208:211]
ds_read_b64_tr_b16 a[10:11], v17 offset:832
v_mfma_f32_16x16x32_bf16 v[212:215], a[96:99], a[36:39], v[212:215]
buffer_load_dwordx4 v23, s[12:15], s35 offen offset:3072 lds
v_mfma_f32_16x16x32_bf16 v[212:215], a[100:103], a[52:55], v[212:215]
v_mfma_f32_16x16x32_bf16 v[216:219], a[96:99], a[40:43], v[216:219]
ds_read_b64_tr_b16 a[12:13], v17 offset:6208
ds_read_b64_tr_b16 a[14:15], v17 offset:6976
v_mfma_f32_16x16x32_bf16 v[216:219], a[100:103], a[56:59], v[216:219]
buffer_store_dwordx4 a[188:191], v31, s[28:31], s79 offen offset:3072 sc1
s_add_u32 s32, s32, 128
v_mfma_f32_16x16x32_bf16 v[220:223], a[96:99], a[44:47], v[220:223]
s_add_u32 s33, s33, 128
s_add_u32 s34, s34, 128
v_mfma_f32_16x16x32_bf16 v[220:223], a[100:103], a[60:63], v[220:223]
s_add_u32 s35, s35, 128
s_xor_b32 s40, s40, 0x8000
s_waitcnt lgkmcnt(4)
v_mfma_f32_16x16x32_bf16 v[224:227], a[0:3], a[32:35], v[224:227]
ds_read_b64_tr_b16 a[16:17], v16 offset:128
ds_read_b64_tr_b16 a[18:19], v16 offset:896
v_mfma_f32_16x16x32_bf16 v[224:227], a[4:7], a[48:51], v[224:227]
ds_read_b64_tr_b16 a[20:21], v16 offset:6272
v_mfma_f32_16x16x32_bf16 v[228:231], a[0:3], a[36:39], v[228:231]
ds_read_b64_tr_b16 a[22:23], v16 offset:7040
v_mfma_f32_16x16x32_bf16 v[228:231], a[4:7], a[52:55], v[228:231]
v_add_u32 v16, s41, v16
v_mfma_f32_16x16x32_bf16 v[232:235], a[0:3], a[40:43], v[232:235]
ds_read_b64_tr_b16 a[24:25], v17 offset:128
ds_read_b64_tr_b16 a[26:27], v17 offset:896
v_mfma_f32_16x16x32_bf16 v[232:235], a[4:7], a[56:59], v[232:235]
ds_read_b64_tr_b16 a[28:29], v17 offset:6272
ds_read_b64_tr_b16 a[30:31], v17 offset:7040
v_mfma_f32_16x16x32_bf16 v[236:239], a[0:3], a[44:47], v[236:239]
v_add_u32 v17, s41, v17
s_add_u32 m0, s39, s46
v_mfma_f32_16x16x32_bf16 v[236:239], a[4:7], a[60:63], v[236:239]
buffer_load_dwordx4 v28, s[24:27], s38 offen offset:0 lds
s_waitcnt lgkmcnt(8)
v_mfma_f32_16x16x32_bf16 v[240:243], a[8:11], a[32:35], v[240:243]
buffer_load_dwordx4 v29, s[24:27], s38 offen offset:1024 lds
v_mfma_f32_16x16x32_bf16 v[240:243], a[12:15], a[48:51], v[240:243]
v_mfma_f32_16x16x32_bf16 v[244:247], a[8:11], a[36:39], v[244:247]
v_mfma_f32_16x16x32_bf16 v[244:247], a[12:15], a[52:55], v[244:247]
v_mfma_f32_16x16x32_bf16 v[248:251], a[8:11], a[40:43], v[248:251]
v_mfma_f32_16x16x32_bf16 v[248:251], a[12:15], a[56:59], v[248:251]
v_mfma_f32_16x16x32_bf16 v[252:255], a[8:11], a[44:47], v[252:255]
v_mfma_f32_16x16x32_bf16 v[252:255], a[12:15], a[60:63], v[252:255]
s_waitcnt vmcnt(18)
s_waitcnt lgkmcnt(0)
s_barrier
v_mfma_f32_16x16x32_bf16 a[64:67], a[32:35], a[16:19], a[64:67]
ds_read_b64_tr_b16 a[0:1], v8 offset:0
ds_read_b64_tr_b16 a[2:3], v8 offset:1024
v_mfma_f32_16x16x32_bf16 a[64:67], a[48:51], a[20:23], a[64:67]
ds_read_b64_tr_b16 a[4:5], v8 offset:8192
v_mfma_f32_16x16x32_bf16 a[80:83], a[32:35], a[24:27], a[80:83]
ds_read_b64_tr_b16 a[6:7], v8 offset:9216
v_mfma_f32_16x16x32_bf16 a[80:83], a[48:51], a[28:31], a[80:83]
buffer_load_dwordx4 v30, s[24:27], s38 offen offset:2048 lds
v_mfma_f32_16x16x32_bf16 a[68:71], a[36:39], a[16:19], a[68:71]
ds_read_b128 a[32:35], v18 offset:0
ds_read_b128 a[48:51], v19 offset:0
ds_read_b64_tr_b16 a[8:9], v9 offset:0
v_mfma_f32_16x16x32_bf16 a[68:71], a[52:55], a[20:23], a[68:71]
ds_read_b64_tr_b16 a[10:11], v9 offset:1024
ds_read_b64_tr_b16 a[12:13], v9 offset:8192
ds_read_b64_tr_b16 a[14:15], v9 offset:9216
v_mfma_f32_16x16x32_bf16 a[84:87], a[36:39], a[24:27], a[84:87]
buffer_store_dwordx4 a[252:255], v31, s[28:31], s83 offen offset:3072 sc1
s_add_u32 s36, s36, 524288
s_add_u32 s38, s38, 393216
v_mfma_f32_16x16x32_bf16 a[84:87], a[52:55], a[28:31], a[84:87]
s_add_u32 s39, s39, 0x8000
s_cmp_eq_u32 s39, 163840
s_cselect_b32 s39, 65536, s39
v_mfma_f32_16x16x32_bf16 a[72:75], a[40:43], a[16:19], a[72:75]
ds_read_b128 a[36:39], v18 offset:2048
v_mfma_f32_16x16x32_bf16 a[72:75], a[56:59], a[20:23], a[72:75]
v_mfma_f32_16x16x32_bf16 a[88:91], a[40:43], a[24:27], a[88:91]
ds_read_b128 a[52:55], v19 offset:2048
v_mfma_f32_16x16x32_bf16 a[88:91], a[56:59], a[28:31], a[88:91]
v_mfma_f32_16x16x32_bf16 a[76:79], a[44:47], a[16:19], a[76:79]
ds_read_b128 a[40:43], v18 offset:4096
v_mfma_f32_16x16x32_bf16 a[76:79], a[60:63], a[20:23], a[76:79]
v_mfma_f32_16x16x32_bf16 a[92:95], a[44:47], a[24:27], a[92:95]
ds_read_b128 a[56:59], v19 offset:4096
v_mfma_f32_16x16x32_bf16 a[92:95], a[60:63], a[28:31], a[92:95]
s_mov_b32 s42, 6
L_p2a:
s_cmp_eq_u32 s39, 98304
s_cselect_b32 s41, s48, s49
s_waitcnt lgkmcnt(9)
v_mfma_f32_16x16x32_bf16 v[64:67], a[0:3], a[32:35], v[64:67]
ds_read_b128 a[44:47], v18 offset:6144
ds_read_b128 a[60:63], v19 offset:6144
s_waitcnt lgkmcnt(10)
v_mfma_f32_16x16x32_bf16 v[64:67], a[4:7], a[48:51], v[64:67]
ds_read_b64_tr_b16 a[16:17], v10 offset:0
s_waitcnt lgkmcnt(9)
v_mfma_f32_16x16x32_bf16 v[80:83], a[8:11], a[32:35], v[80:83]
ds_read_b64_tr_b16 a[18:19], v10 offset:1024
s_add_u32 m0, s39, s45
s_waitcnt lgkmcnt(8)
v_mfma_f32_16x16x32_bf16 v[80:83], a[12:15], a[48:51], v[80:83]
buffer_load_dwordx4 v24, s[20:23], s36 offen offset:0 lds
s_waitcnt lgkmcnt(7)
v_mfma_f32_16x16x32_bf16 v[68:71], a[0:3], a[36:39], v[68:71]
v_xor_b32 v18, 0x8000, v18
v_xor_b32 v19, 0x8000, v19
s_waitcnt lgkmcnt(6)
v_mfma_f32_16x16x32_bf16 v[68:71], a[4:7], a[52:55], v[68:71]
ds_read_b64_tr_b16 a[20:21], v10 offset:8192
v_mfma_f32_16x16x32_bf16 v[84:87], a[8:11], a[36:39], v[84:87]
ds_read_b64_tr_b16 a[22:23], v10 offset:9216
v_add_u32 v10, s41, v10
v_mfma_f32_16x16x32_bf16 v[84:87], a[12:15], a[52:55], v[84:87]
buffer_load_dwordx4 v25, s[20:23], s36 offen offset:1024 lds
s_waitcnt lgkmcnt(7)
v_mfma_f32_16x16x32_bf16 v[72:75], a[0:3], a[40:43], v[72:75]
ds_read_b64_tr_b16 a[24:25], v11 offset:0
s_waitcnt lgkmcnt(7)
v_mfma_f32_16x16x32_bf16 v[72:75], a[4:7], a[56:59], v[72:75]
ds_read_b64_tr_b16 a[26:27], v11 offset:1024
v_mfma_f32_16x16x32_bf16 v[88:91], a[8:11], a[40:43], v[88:91]
v_add_u32 v8, s41, v8
v_mfma_f32_16x16x32_bf16 v[88:91], a[12:15], a[56:59], v[88:91]
v_add_u32 v9, s41, v9
s_waitcnt lgkmcnt(7)
v_mfma_f32_16x16x32_bf16 v[76:79], a[0:3], a[44:47], v[76:79]
ds_read_b64_tr_b16 a[28:29], v11 offset:8192
s_waitcnt lgkmcnt(7)
v_mfma_f32_16x16x32_bf16 v[76:79], a[4:7], a[60:63], v[76:79]
ds_read_b64_tr_b16 a[30:31], v11 offset:9216
v_mfma_f32_16x16x32_bf16 v[92:95], a[8:11], a[44:47], v[92:95]
v_add_u32 v11, s41, v11
v_mfma_f32_16x16x32_bf16 v[92:95], a[12:15], a[60:63], v[92:95]
buffer_load_dwordx4 v26, s[20:23], s36 offen offset:2048 lds
s_waitcnt lgkmcnt(4)
v_mfma_f32_16x16x32_bf16 v[96:99], a[16:19], a[32:35], v[96:99]
ds_read_b64_tr_b16 a[96:97], v12 offset:0
v_mfma_f32_16x16x32_bf16 v[96:99], a[20:23], a[48:51], v[96:99]
v_mfma_f32_16x16x32_bf16 v[100:103], a[16:19], a[36:39], v[100:103]
ds_read_b64_tr_b16 a[98:99], v12 offset:1024
v_mfma_f32_16x16x32_bf16 v[100:103], a[20:23], a[52:55], v[100:103]
v_mfma_f32_16x16x32_bf16 v[104:107], a[16:19], a[40:43], v[104:107]
ds_read_b64_tr_b16 a[100:101], v12 offset:8192
v_mfma_f32_16x16x32_bf16 v[104:107], a[20:23], a[56:59], v[104:107]
ds_read_b64_tr_b16 a[102:103], v12 offset:9216
v_mfma_f32_16x16x32_bf16 v[108:111], a[16:19], a[44:47], v[108:111]
v_add_u32 v12, s41, v12
v_mfma_f32_16x16x32_bf16 v[108:111], a[20:23], a[60:63], v[108:111]
buffer_load_dwordx4 v27, s[20:23], s36 offen offset:3072 lds
s_waitcnt lgkmcnt(4)
v_mfma_f32_16x16x32_bf16 v[112:115], a[24:27], a[32:35], v[112:115]
ds_read_b64_tr_b16 a[0:1], v13 offset:0
v_mfma_f32_16x16x32_bf16 v[112:115], a[28:31], a[48:51], v[112:115]
v_mfma_f32_16x16x32_bf16 v[116:119], a[24:27], a[36:39], v[116:119]
ds_read_b64_tr_b16 a[2:3], v13 offset:1024
v_mfma_f32_16x16x32_bf16 v[116:119], a[28:31], a[52:55], v[116:119]
v_mfma_f32_16x16x32_bf16 v[120:123], a[24:27], a[40:43], v[120:123]
ds_read_b64_tr_b16 a[4:5], v13 offset:8192
ds_read_b64_tr_b16 a[6:7], v13 offset:9216
v_mfma_f32_16x16x32_bf16 v[120:123], a[28:31], a[56:59], v[120:123]
v_add_u32 v13, s41, v13
v_mfma_f32_16x16x32_bf16 v[124:127], a[24:27], a[44:47], v[124:127]
s_mov_b32 m0, s40
v_mfma_f32_16x16x32_bf16 v[124:127], a[28:31], a[60:63], v[124:127]
buffer_load_dwordx4 v22, s[12:15], s32 offen offset:0 lds
s_waitcnt lgkmcnt(4)
v_mfma_f32_16x16x32_bf16 v[128:131], a[96:99], a[32:35], v[128:131]
ds_read_b64_tr_b16 a[8:9], v14 offset:0
v_mfma_f32_16x16x32_bf16 v[128:131], a[100:103], a[48:51], v[128:131]
v_mfma_f32_16x16x32_bf16 v[132:135], a[96:99], a[36:39], v[132:135]
ds_read_b64_tr_b16 a[10:11], v14 offset:1024
v_mfma_f32_16x16x32_bf16 v[132:135], a[100:103], a[52:55], v[132:135]
v_mfma_f32_16x16x32_bf16 v[136:139], a[96:99], a[40:43], v[136:139]
ds_read_b64_tr_b16 a[12:13], v14 offset:8192
v_mfma_f32_16x16x32_bf16 v[136:139], a[100:103], a[56:59], v[136:139]
ds_read_b64_tr_b16 a[14:15], v14 offset:9216
v_mfma_f32_16x16x32_bf16 v[140:143], a[96:99], a[44:47], v[140:143]
v_add_u32 v14, s41, v14
v_mfma_f32_16x16x32_bf16 v[140:143], a[100:103], a[60:63], v[140:143]
buffer_load_dwordx4 v23, s[12:15], s32 offen offset:1024 lds
s_waitcnt lgkmcnt(4)
v_mfma_f32_16x16x32_bf16 v[144:147], a[0:3], a[32:35], v[144:147]
ds_read_b64_tr_b16 a[16:17], v15 offset:0
v_mfma_f32_16x16x32_bf16 v[144:147], a[4:7], a[48:51], v[144:147]
ds_read_b64_tr_b16 a[18:19], v15 offset:1024
v_mfma_f32_16x16x32_bf16 v[148:151], a[0:3], a[36:39], v[148:151]
buffer_load_dwordx4 v22, s[12:15], s33 offen offset:2048 lds
v_mfma_f32_16x16x32_bf16 v[148:151], a[4:7], a[52:55], v[148:151]
v_mfma_f32_16x16x32_bf16 v[152:155], a[0:3], a[40:43], v[152:155]
ds_read_b64_tr_b16 a[20:21], v15 offset:8192
v_mfma_f32_16x16x32_bf16 v[152:155], a[4:7], a[56:59], v[152:155]
ds_read_b64_tr_b16 a[22:23], v15 offset:9216
v_mfma_f32_16x16x32_bf16 v[156:159], a[0:3], a[44:47], v[156:159]
v_add_u32 v15, s41, v15
v_mfma_f32_16x16x32_bf16 v[156:159], a[4:7], a[60:63], v[156:159]
s_waitcnt lgkmcnt(4)
v_mfma_f32_16x16x32_bf16 v[160:163], a[8:11], a[32:35], v[160:163]
ds_read_b64_tr_b16 a[24:25], v16 offset:0
v_mfma_f32_16x16x32_bf16 v[160:163], a[12:15], a[48:51], v[160:163]
ds_read_b64_tr_b16 a[26:27], v16 offset:768
v_mfma_f32_16x16x32_bf16 v[164:167], a[8:11], a[36:39], v[164:167]
buffer_load_dwordx4 v23, s[12:15], s33 offen offset:3072 lds
v_mfma_f32_16x16x32_bf16 v[164:167], a[12:15], a[52:55], v[164:167]
v_mfma_f32_16x16x32_bf16 v[168:171], a[8:11], a[40:43], v[168:171]
ds_read_b64_tr_b16 a[28:29], v16 offset:6144
v_mfma_f32_16x16x32_bf16 v[168:171], a[12:15], a[56:59], v[168:171]
v_mfma_f32_16x16x32_bf16 v[172:175], a[8:11], a[44:47], v[172:175]
ds_read_b64_tr_b16 a[30:31], v16 offset:6912
v_mfma_f32_16x16x32_bf16 v[172:175], a[12:15], a[60:63], v[172:175]
s_waitcnt lgkmcnt(4)
v_mfma_f32_16x16x32_bf16 v[176:179], a[16:19], a[32:35], v[176:179]
ds_read_b64_tr_b16 a[96:97], v17 offset:0
v_mfma_f32_16x16x32_bf16 v[176:179], a[20:23], a[48:51], v[176:179]
ds_read_b64_tr_b16 a[98:99], v17 offset:768
v_mfma_f32_16x16x32_bf16 v[180:183], a[16:19], a[36:39], v[180:183]
s_add_u32 m0, s40, 4096
v_mfma_f32_16x16x32_bf16 v[180:183], a[20:23], a[52:55], v[180:183]
buffer_load_dwordx4 v22, s[12:15], s34 offen offset:0 lds
v_mfma_f32_16x16x32_bf16 v[184:187], a[16:19], a[40:43], v[184:187]
ds_read_b64_tr_b16 a[100:101], v17 offset:6144
v_mfma_f32_16x16x32_bf16 v[184:187], a[20:23], a[56:59], v[184:187]
v_mfma_f32_16x16x32_bf16 v[188:191], a[16:19], a[44:47], v[188:191]
ds_read_b64_tr_b16 a[102:103], v17 offset:6912
v_mfma_f32_16x16x32_bf16 v[188:191], a[20:23], a[60:63], v[188:191]
s_waitcnt lgkmcnt(4)
v_mfma_f32_16x16x32_bf16 v[192:195], a[24:27], a[32:35], v[192:195]
ds_read_b64_tr_b16 a[0:1], v16 offset:64
v_mfma_f32_16x16x32_bf16 v[192:195], a[28:31], a[48:51], v[192:195]
ds_read_b64_tr_b16 a[2:3], v16 offset:832
v_mfma_f32_16x16x32_bf16 v[196:199], a[24:27], a[36:39], v[196:199]
buffer_load_dwordx4 v23, s[12:15], s34 offen offset:1024 lds
v_mfma_f32_16x16x32_bf16 v[196:199], a[28:31], a[52:55], v[196:199]
v_mfma_f32_16x16x32_bf16 v[200:203], a[24:27], a[40:43], v[200:203]
ds_read_b64_tr_b16 a[4:5], v16 offset:6208
v_mfma_f32_16x16x32_bf16 v[200:203], a[28:31], a[56:59], v[200:203]
v_mfma_f32_16x16x32_bf16 v[204:207], a[24:27], a[44:47], v[204:207]
ds_read_b64_tr_b16 a[6:7], v16 offset:6976
v_mfma_f32_16x16x32_bf16 v[204:207], a[28:31], a[60:63], v[204:207]
s_waitcnt lgkmcnt(4)
v_mfma_f32_16x16x32_bf16 v[208:211], a[96:99], a[32:35], v[208:211]
ds_read_b64_tr_b16 a[8:9], v17 offset:64
v_mfma_f32_16x16x32_bf16 v[208:211], a[100:103], a[48:51], v[208:211]
ds_read_b64_tr_b16 a[10:11], v17 offset:832
v_mfma_f32_16x16x32_bf16 v[212:215], a[96:99], a[36:39], v[212:215]
buffer_load_dwordx4 v22, s[12:15], s35 offen offset:2048 lds
v_mfma_f32_16x16x32_bf16 v[212:215], a[100:103], a[52:55], v[212:215]
v_mfma_f32_16x16x32_bf16 v[216:219], a[96:99], a[40:43], v[216:219]
ds_read_b64_tr_b16 a[12:13], v17 offset:6208
ds_read_b64_tr_b16 a[14:15], v17 offset:6976
v_mfma_f32_16x16x32_bf16 v[216:219], a[100:103], a[56:59], v[216:219]
buffer_load_dwordx4 v23, s[12:15], s35 offen offset:3072 lds
s_add_u32 s32, s32, 128
v_mfma_f32_16x16x32_bf16 v[220:223], a[96:99], a[44:47], v[220:223]
s_add_u32 s33, s33, 128
s_add_u32 s34, s34, 128
v_mfma_f32_16x16x32_bf16 v[220:223], a[100:103], a[60:63], v[220:223]
s_add_u32 s35, s35, 128
s_xor_b32 s40, s40, 0x8000
s_waitcnt lgkmcnt(4)
v_mfma_f32_16x16x32_bf16 v[224:227], a[0:3], a[32:35], v[224:227]
ds_read_b64_tr_b16 a[16:17], v16 offset:128
ds_read_b64_tr_b16 a[18:19], v16 offset:896
v_mfma_f32_16x16x32_bf16 v[224:227], a[4:7], a[48:51], v[224:227]
ds_read_b64_tr_b16 a[20:21], v16 offset:6272
v_mfma_f32_16x16x32_bf16 v[228:231], a[0:3], a[36:39], v[228:231]
ds_read_b64_tr_b16 a[22:23], v16 offset:7040
v_mfma_f32_16x16x32_bf16 v[228:231], a[4:7], a[52:55], v[228:231]
v_add_u32 v16, s41, v16
v_mfma_f32_16x16x32_bf16 v[232:235], a[0:3], a[40:43], v[232:235]
ds_read_b64_tr_b16 a[24:25], v17 offset:128
ds_read_b64_tr_b16 a[26:27], v17 offset:896
v_mfma_f32_16x16x32_bf16 v[232:235], a[4:7], a[56:59], v[232:235]
ds_read_b64_tr_b16 a[28:29], v17 offset:6272
ds_read_b64_tr_b16 a[30:31], v17 offset:7040
v_mfma_f32_16x16x32_bf16 v[236:239], a[0:3], a[44:47], v[236:239]
v_add_u32 v17, s41, v17
s_add_u32 m0, s39, s46
v_mfma_f32_16x16x32_bf16 v[236:239], a[4:7], a[60:63], v[236:239]
buffer_load_dwordx4 v28, s[24:27], s38 offen offset:0 lds
s_waitcnt lgkmcnt(8)
v_mfma_f32_16x16x32_bf16 v[240:243], a[8:11], a[32:35], v[240:243]
v_mfma_f32_16x16x32_bf16 v[240:243], a[12:15], a[48:51], v[240:243]
v_mfma_f32_16x16x32_bf16 v[244:247], a[8:11], a[36:39], v[244:247]
v_mfma_f32_16x16x32_bf16 v[244:247], a[12:15], a[52:55], v[244:247]
v_mfma_f32_16x16x32_bf16 v[248:251], a[8:11], a[40:43], v[248:251]
buffer_load_dwordx4 v29, s[24:27], s38 offen offset:1024 lds
v_mfma_f32_16x16x32_bf16 v[248:251], a[12:15], a[56:59], v[248:251]
v_mfma_f32_16x16x32_bf16 v[252:255], a[8:11], a[44:47], v[252:255]
v_mfma_f32_16x16x32_bf16 v[252:255], a[12:15], a[60:63], v[252:255]
s_waitcnt vmcnt(14)
s_waitcnt lgkmcnt(0)
s_barrier
s_cmp_lg_u32 s42, 5
s_cbranch_scc1 L_sig1
s_getpc_b64 s[74:75]
L_pf9:
s_add_u32 s74, s74, L_e2-L_pf9
s_addc_u32 s75, s75, 0
v_lshlrev_b32 v58, 7, v1
v_lshl_add_u32 v58, s3, 13, v58
v_min_u32 v58, L_end-L_e2, v58
global_load_dword v0, v58, s[74:75]
s_cmp_lg_u32 s3, 0
s_cbranch_scc1 L_sig1
s_lshl_b32 s74, s4, 2
v_mov_b32 v58, 128
v_mov_b32 v59, 1
v_writelane_b32 v58, s74, 0
s_mov_b64 exec, 3
global_atomic_add v58, v59, s[6:7] sc1
s_mov_b64 exec, -1
L_sig1:
v_mfma_f32_16x16x32_bf16 a[64:67], a[32:35], a[16:19], a[64:67]
ds_read_b64_tr_b16 a[0:1], v8 offset:0
v_mfma_f32_16x16x32_bf16 a[64:67], a[48:51], a[20:23], a[64:67]
ds_read_b64_tr_b16 a[2:3], v8 offset:1024
v_mfma_f32_16x16x32_bf16 a[80:83], a[32:35], a[24:27], a[80:83]
ds_read_b64_tr_b16 a[4:5], v8 offset:8192
v_mfma_f32_16x16x32_bf16 a[80:83], a[48:51], a[28:31], a[80:83]
ds_read_b64_tr_b16 a[6:7], v8 offset:9216
v_mfma_f32_16x16x32_bf16 a[68:71], a[36:39], a[16:19], a[68:71]
ds_read_b128 a[32:35], v18 offset:0
ds_read_b128 a[48:51], v19 offset:0
ds_read_b64_tr_b16 a[8:9], v9 offset:0
v_mfma_f32_16x16x32_bf16 a[68:71], a[52:55], a[20:23], a[68:71]
ds_read_b64_tr_b16 a[10:11], v9 offset:1024
ds_read_b64_tr_b16 a[12:13], v9 offset:8192
ds_read_b64_tr_b16 a[14:15], v9 offset:9216
v_mfma_f32_16x16x32_bf16 a[84:87], a[36:39], a[24:27], a[84:87]
buffer_load_dwordx4 v30, s[24:27], s38 offen offset:2048 lds
s_add_u32 s36, s36, 524288
s_add_u32 s38, s38, 393216
v_mfma_f32_16x16x32_bf16 a[84:87], a[52:55], a[28:31], a[84:87]
s_add_u32 s39, s39, 0x8000
s_cmp_eq_u32 s39, 163840
s_cselect_b32 s39, 65536, s39
v_mfma_f32_16x16x32_bf16 a[72:75], a[40:43], a[16:19], a[72:75]
ds_read_b128 a[36:39], v18 offset:2048
v_mfma_f32_16x16x32_bf16 a[72:75], a[56:59], a[20:23], a[72:75]
v_mfma_f32_16x16x32_bf16 a[88:91], a[40:43], a[24:27], a[88:91]
ds_read_b128 a[52:55], v19 offset:2048
v_mfma_f32_16x16x32_bf16 a[88:91], a[56:59], a[28:31], a[88:91]
v_mfma_f32_16x16x32_bf16 a[76:79], a[44:47], a[16:19], a[76:79]
ds_read_b128 a[40:43], v18 offset:4096
v_mfma_f32_16x16x32_bf16 a[76:79], a[60:63], a[20:23], a[76:79]
v_mfma_f32_16x16x32_bf16 a[92:95], a[44:47], a[24:27], a[92:95]
ds_read_b128 a[56:59], v19 offset:4096
v_mfma_f32_16x16x32_bf16 a[92:95], a[60:63], a[28:31], a[92:95]
s_sub_u32 s42, s42, 1
s_cmp_lg_u32 s42, 0
s_cbranch_scc1 L_p2a
L_e2:
s_lshl_b32 s74, s4, 2
v_mov_b32 v58, s74
s_mul_i32 s32, s4, 0x110000
s_lshl_b32 s33, s3, 13
s_add_u32 s32, s32, s33
global_load_dword v59, v58, s[6:7] sc1
s_cmp_eq_u32 s39, 98304
s_cselect_b32 s41, s48, s49
s_waitcnt lgkmcnt(9)
v_mfma_f32_16x16x32_bf16 v[64:67], a[0:3], a[32:35], v[64:67]
ds_read_b128 a[44:47], v18 offset:6144
ds_read_b128 a[60:63], v19 offset:6144
s_waitcnt lgkmcnt(10)
v_mfma_f32_16x16x32_bf16 v[64:67], a[4:7], a[48:51], v[64:67]
ds_read_b64_tr_b16 a[16:17], v10 offset:0
ds_read_b64_tr_b16 a[18:19], v10 offset:1024
s_waitcnt lgkmcnt(10)
v_mfma_f32_16x16x32_bf16 v[80:83], a[8:11], a[32:35], v[80:83]
s_add_u32 s39, s39, 0x8000
s_cmp_eq_u32 s39, 163840
s_waitcnt lgkmcnt(8)
v_mfma_f32_16x16x32_bf16 v[80:83], a[12:15], a[48:51], v[80:83]
s_cselect_b32 s39, 65536, s39
s_waitcnt lgkmcnt(7)
v_mfma_f32_16x16x32_bf16 v[68:71], a[0:3], a[36:39], v[68:71]
v_xor_b32 v18, 0x8000, v18
v_xor_b32 v19, 0x8000, v19
s_waitcnt lgkmcnt(6)
v_mfma_f32_16x16x32_bf16 v[68:71], a[4:7], a[52:55], v[68:71]
ds_read_b64_tr_b16 a[20:21], v10 offset:8192
v_mfma_f32_16x16x32_bf16 v[84:87], a[8:11], a[36:39], v[84:87]
ds_read_b64_tr_b16 a[22:23], v10 offset:9216
v_mfma_f32_16x16x32_bf16 v[84:87], a[12:15], a[52:55], v[84:87]
v_add_u32 v10, s41, v10
s_waitcnt lgkmcnt(7)
v_mfma_f32_16x16x32_bf16 v[72:75], a[0:3], a[40:43], v[72:75]
ds_read_b64_tr_b16 a[24:25], v11 offset:0
s_waitcnt lgkmcnt(7)
v_mfma_f32_16x16x32_bf16 v[72:75], a[4:7], a[56:59], v[72:75]
ds_read_b64_tr_b16 a[26:27], v11 offset:1024
v_mfma_f32_16x16x32_bf16 v[88:91], a[8:11], a[40:43], v[88:91]
v_add_u32 v8, s41, v8
v_mfma_f32_16x16x32_bf16 v[88:91], a[12:15], a[56:59], v[88:91]
v_add_u32 v9, s41, v9
s_waitcnt lgkmcnt(7)
v_mfma_f32_16x16x32_bf16 v[76:79], a[0:3], a[44:47], v[76:79]
ds_read_b64_tr_b16 a[28:29], v11 offset:8192
s_waitcnt lgkmcnt(7)
v_mfma_f32_16x16x32_bf16 v[76:79], a[4:7], a[60:63], v[76:79]
ds_read_b64_tr_b16 a[30:31], v11 offset:9216
v_mfma_f32_16x16x32_bf16 v[92:95], a[8:11], a[44:47], v[92:95]
v_add_u32 v11, s41, v11
v_mfma_f32_16x16x32_bf16 v[92:95], a[12:15], a[60:63], v[92:95]
s_waitcnt lgkmcnt(4)
v_mfma_f32_16x16x32_bf16 v[96:99], a[16:19], a[32:35], v[96:99]
ds_read_b64_tr_b16 a[96:97], v12 offset:0
v_mfma_f32_16x16x32_bf16 v[96:99], a[20:23], a[48:51], v[96:99]
v_mfma_f32_16x16x32_bf16 v[100:103], a[16:19], a[36:39], v[100:103]
ds_read_b64_tr_b16 a[98:99], v12 offset:1024
v_mfma_f32_16x16x32_bf16 v[100:103], a[20:23], a[52:55], v[100:103]
v_mfma_f32_16x16x32_bf16 v[104:107], a[16:19], a[40:43], v[104:107]
ds_read_b64_tr_b16 a[100:101], v12 offset:8192
v_mfma_f32_16x16x32_bf16 v[104:107], a[20:23], a[56:59], v[104:107]
ds_read_b64_tr_b16 a[102:103], v12 offset:9216
v_mfma_f32_16x16x32_bf16 v[108:111], a[16:19], a[44:47], v[108:111]
v_add_u32 v12, s41, v12
v_mfma_f32_16x16x32_bf16 v[108:111], a[20:23], a[60:63], v[108:111]
s_waitcnt lgkmcnt(4)
v_mfma_f32_16x16x32_bf16 v[112:115], a[24:27], a[32:35], v[112:115]
ds_read_b64_tr_b16 a[0:1], v13 offset:0
v_mfma_f32_16x16x32_bf16 v[112:115], a[28:31], a[48:51], v[112:115]
v_mfma_f32_16x16x32_bf16 v[116:119], a[24:27], a[36:39], v[116:119]
ds_read_b64_tr_b16 a[2:3], v13 offset:1024
v_mfma_f32_16x16x32_bf16 v[116:119], a[28:31], a[52:55], v[116:119]
v_mfma_f32_16x16x32_bf16 v[120:123], a[24:27], a[40:43], v[120:123]
ds_read_b64_tr_b16 a[4:5], v13 offset:8192
v_mfma_f32_16x16x32_bf16 v[120:123], a[28:31], a[56:59], v[120:123]
ds_read_b64_tr_b16 a[6:7], v13 offset:9216
v_mfma_f32_16x16x32_bf16 v[124:127], a[24:27], a[44:47], v[124:127]
v_add_u32 v13, s41, v13
v_mfma_f32_16x16x32_bf16 v[124:127], a[28:31], a[60:63], v[124:127]
s_waitcnt lgkmcnt(4)
v_mfma_f32_16x16x32_bf16 v[128:131], a[96:99], a[32:35], v[128:131]
ds_read_b64_tr_b16 a[8:9], v14 offset:0
v_mfma_f32_16x16x32_bf16 v[128:131], a[100:103], a[48:51], v[128:131]
v_mfma_f32_16x16x32_bf16 v[132:135], a[96:99], a[36:39], v[132:135]
ds_read_b64_tr_b16 a[10:11], v14 offset:1024
v_mfma_f32_16x16x32_bf16 v[132:135], a[100:103], a[52:55], v[132:135]
v_mfma_f32_16x16x32_bf16 v[136:139], a[96:99], a[40:43], v[136:139]
ds_read_b64_tr_b16 a[12:13], v14 offset:8192
v_mfma_f32_16x16x32_bf16 v[136:139], a[100:103], a[56:59], v[136:139]
ds_read_b64_tr_b16 a[14:15], v14 offset:9216
v_mfma_f32_16x16x32_bf16 v[140:143], a[96:99], a[44:47], v[140:143]
v_add_u32 v14, s41, v14
v_mfma_f32_16x16x32_bf16 v[140:143], a[100:103], a[60:63], v[140:143]
s_waitcnt lgkmcnt(4)
v_mfma_f32_16x16x32_bf16 v[144:147], a[0:3], a[32:35], v[144:147]
ds_read_b64_tr_b16 a[16:17], v15 offset:0
v_mfma_f32_16x16x32_bf16 v[144:147], a[4:7], a[48:51], v[144:147]
v_mfma_f32_16x16x32_bf16 v[148:151], a[0:3], a[36:39], v[148:151]
ds_read_b64_tr_b16 a[18:19], v15 offset:1024
v_mfma_f32_16x16x32_bf16 v[148:151], a[4:7], a[52:55], v[148:151]
v_mfma_f32_16x16x32_bf16 v[152:155], a[0:3], a[40:43], v[152:155]
ds_read_b64_tr_b16 a[20:21], v15 offset:8192
v_mfma_f32_16x16x32_bf16 v[152:155], a[4:7], a[56:59], v[152:155]
ds_read_b64_tr_b16 a[22:23], v15 offset:9216
v_mfma_f32_16x16x32_bf16 v[156:159], a[0:3], a[44:47], v[156:159]
v_add_u32 v15, s41, v15
v_mfma_f32_16x16x32_bf16 v[156:159], a[4:7], a[60:63], v[156:159]
s_waitcnt vmcnt(0)
L_pl1:
v_readlane_b32 s74, v59, 0
s_bfe_u32 s74, s74, 524288
s_cmp_ge_u32 s74, 8
s_cbranch_scc1 L_pl1x
s_sleep 2
global_load_dword v59, v58, s[6:7] sc1
s_waitcnt vmcnt(0)
s_branch L_pl1
L_pl1x:
s_waitcnt lgkmcnt(4)
v_mfma_f32_16x16x32_bf16 v[160:163], a[8:11], a[32:35], v[160:163]
ds_read_b64_tr_b16 a[24:25], v16 offset:0
v_mfma_f32_16x16x32_bf16 v[160:163], a[12:15], a[48:51], v[160:163]
ds_read_b64_tr_b16 a[26:27], v16 offset:768
v_mfma_f32_16x16x32_bf16 v[164:167], a[8:11], a[36:39], v[164:167]
s_mov_b32 m0, s33
v_mfma_f32_16x16x32_bf16 v[164:167], a[12:15], a[52:55], v[164:167]
buffer_load_dwordx4 v31, s[28:31], s32 offen offset:0 sc1 lds
v_mfma_f32_16x16x32_bf16 v[168:171], a[8:11], a[40:43], v[168:171]
ds_read_b64_tr_b16 a[28:29], v16 offset:6144
v_mfma_f32_16x16x32_bf16 v[168:171], a[12:15], a[56:59], v[168:171]
v_mfma_f32_16x16x32_bf16 v[172:175], a[8:11], a[44:47], v[172:175]
ds_read_b64_tr_b16 a[30:31], v16 offset:6912
v_mfma_f32_16x16x32_bf16 v[172:175], a[12:15], a[60:63], v[172:175]
s_waitcnt lgkmcnt(4)
v_mfma_f32_16x16x32_bf16 v[176:179], a[16:19], a[32:35], v[176:179]
ds_read_b64_tr_b16 a[96:97], v17 offset:0
v_mfma_f32_16x16x32_bf16 v[176:179], a[20:23], a[48:51], v[176:179]
ds_read_b64_tr_b16 a[98:99], v17 offset:768
v_mfma_f32_16x16x32_bf16 v[180:183], a[16:19], a[36:39], v[180:183]
buffer_load_dwordx4 v31, s[28:31], s32 offen offset:1024 sc1 lds
v_mfma_f32_16x16x32_bf16 v[180:183], a[20:23], a[52:55], v[180:183]
v_mfma_f32_16x16x32_bf16 v[184:187], a[16:19], a[40:43], v[184:187]
ds_read_b64_tr_b16 a[100:101], v17 offset:6144
v_mfma_f32_16x16x32_bf16 v[184:187], a[20:23], a[56:59], v[184:187]
v_mfma_f32_16x16x32_bf16 v[188:191], a[16:19], a[44:47], v[188:191]
ds_read_b64_tr_b16 a[102:103], v17 offset:6912
v_mfma_f32_16x16x32_bf16 v[188:191], a[20:23], a[60:63], v[188:191]
s_waitcnt lgkmcnt(4)
v_mfma_f32_16x16x32_bf16 v[192:195], a[24:27], a[32:35], v[192:195]
ds_read_b64_tr_b16 a[0:1], v16 offset:64
v_mfma_f32_16x16x32_bf16 v[192:195], a[28:31], a[48:51], v[192:195]
ds_read_b64_tr_b16 a[2:3], v16 offset:832
v_mfma_f32_16x16x32_bf16 v[196:199], a[24:27], a[36:39], v[196:199]
buffer_load_dwordx4 v31, s[28:31], s32 offen offset:2048 sc1 lds
v_mfma_f32_16x16x32_bf16 v[196:199], a[28:31], a[52:55], v[196:199]
v_mfma_f32_16x16x32_bf16 v[200:203], a[24:27], a[40:43], v[200:203]
ds_read_b64_tr_b16 a[4:5], v16 offset:6208
v_mfma_f32_16x16x32_bf16 v[200:203], a[28:31], a[56:59], v[200:203]
v_mfma_f32_16x16x32_bf16 v[204:207], a[24:27], a[44:47], v[204:207]
ds_read_b64_tr_b16 a[6:7], v16 offset:6976
v_mfma_f32_16x16x32_bf16 v[204:207], a[28:31], a[60:63], v[204:207]
s_waitcnt lgkmcnt(4)
v_mfma_f32_16x16x32_bf16 v[208:211], a[96:99], a[32:35], v[208:211]
ds_read_b64_tr_b16 a[8:9], v17 offset:64
v_mfma_f32_16x16x32_bf16 v[208:211], a[100:103], a[48:51], v[208:211]
ds_read_b64_tr_b16 a[10:11], v17 offset:832
v_mfma_f32_16x16x32_bf16 v[212:215], a[96:99], a[36:39], v[212:215]
buffer_load_dwordx4 v31, s[28:31], s32 offen offset:3072 sc1 lds
v_mfma_f32_16x16x32_bf16 v[212:215], a[100:103], a[52:55], v[212:215]
v_mfma_f32_16x16x32_bf16 v[216:219], a[96:99], a[40:43], v[216:219]
ds_read_b64_tr_b16 a[12:13], v17 offset:6208
v_mfma_f32_16x16x32_bf16 v[216:219], a[100:103], a[56:59], v[216:219]
v_mfma_f32_16x16x32_bf16 v[220:223], a[96:99], a[44:47], v[220:223]
ds_read_b64_tr_b16 a[14:15], v17 offset:6976
v_mfma_f32_16x16x32_bf16 v[220:223], a[100:103], a[60:63], v[220:223]
s_waitcnt lgkmcnt(4)
v_mfma_f32_16x16x32_bf16 v[224:227], a[0:3], a[32:35], v[224:227]
ds_read_b64_tr_b16 a[16:17], v16 offset:128
ds_read_b64_tr_b16 a[18:19], v16 offset:896
v_mfma_f32_16x16x32_bf16 v[224:227], a[4:7], a[48:51], v[224:227]
ds_read_b64_tr_b16 a[20:21], v16 offset:6272
ds_read_b64_tr_b16 a[22:23], v16 offset:7040
v_mfma_f32_16x16x32_bf16 v[228:231], a[0:3], a[36:39], v[228:231]
v_add_u32 v16, s41, v16
s_add_u32 m0, s33, 4096
v_mfma_f32_16x16x32_bf16 v[228:231], a[4:7], a[52:55], v[228:231]
s_add_u32 s32, s32, 4096
buffer_load_dwordx4 v31, s[28:31], s32 offen offset:0 sc1 lds
v_mfma_f32_16x16x32_bf16 v[232:235], a[0:3], a[40:43], v[232:235]
ds_read_b64_tr_b16 a[24:25], v17 offset:128
ds_read_b64_tr_b16 a[26:27], v17 offset:896
v_mfma_f32_16x16x32_bf16 v[232:235], a[4:7], a[56:59], v[232:235]
ds_read_b64_tr_b16 a[28:29], v17 offset:6272
v_mfma_f32_16x16x32_bf16 v[236:239], a[0:3], a[44:47], v[236:239]
ds_read_b64_tr_b16 a[30:31], v17 offset:7040
v_mfma_f32_16x16x32_bf16 v[236:239], a[4:7], a[60:63], v[236:239]
v_add_u32 v17, s41, v17
s_waitcnt lgkmcnt(8)
v_mfma_f32_16x16x32_bf16 v[240:243], a[8:11], a[32:35], v[240:243]
buffer_load_dwordx4 v31, s[28:31], s32 offen offset:1024 sc1 lds
v_mfma_f32_16x16x32_bf16 v[240:243], a[12:15], a[48:51], v[240:243]
v_mfma_f32_16x16x32_bf16 v[244:247], a[8:11], a[36:39], v[244:247]
v_mfma_f32_16x16x32_bf16 v[244:247], a[12:15], a[52:55], v[244:247]
v_mfma_f32_16x16x32_bf16 v[248:251], a[8:11], a[40:43], v[248:251]
v_mfma_f32_16x16x32_bf16 v[248:251], a[12:15], a[56:59], v[248:251]
v_mfma_f32_16x16x32_bf16 v[252:255], a[8:11], a[44:47], v[252:255]
v_mfma_f32_16x16x32_bf16 v[252:255], a[12:15], a[60:63], v[252:255]
s_waitcnt lgkmcnt(0)
s_barrier
v_mfma_f32_16x16x32_bf16 a[64:67], a[32:35], a[16:19], a[64:67]
ds_read_b64_tr_b16 a[0:1], v8 offset:0
ds_read_b64_tr_b16 a[2:3], v8 offset:1024
v_mfma_f32_16x16x32_bf16 a[64:67], a[48:51], a[20:23], a[64:67]
ds_read_b64_tr_b16 a[4:5], v8 offset:8192
v_mfma_f32_16x16x32_bf16 a[80:83], a[32:35], a[24:27], a[80:83]
ds_read_b64_tr_b16 a[6:7], v8 offset:9216
v_mfma_f32_16x16x32_bf16 a[80:83], a[48:51], a[28:31], a[80:83]
buffer_load_dwordx4 v31, s[28:31], s32 offen offset:2048 sc1 lds
v_mfma_f32_16x16x32_bf16 a[68:71], a[36:39], a[16:19], a[68:71]
ds_read_b128 a[32:35], v18 offset:0
v_mfma_f32_16x16x32_bf16 a[68:71], a[52:55], a[20:23], a[68:71]
ds_read_b128 a[48:51], v19 offset:0
ds_read_b64_tr_b16 a[8:9], v9 offset:0
v_mfma_f32_16x16x32_bf16 a[84:87], a[36:39], a[24:27], a[84:87]
ds_read_b64_tr_b16 a[10:11], v9 offset:1024
ds_read_b64_tr_b16 a[12:13], v9 offset:8192
v_mfma_f32_16x16x32_bf16 a[84:87], a[52:55], a[28:31], a[84:87]
ds_read_b64_tr_b16 a[14:15], v9 offset:9216
v_mfma_f32_16x16x32_bf16 a[72:75], a[40:43], a[16:19], a[72:75]
ds_read_b128 a[36:39], v18 offset:2048
ds_read_b128 a[52:55], v19 offset:2048
v_mfma_f32_16x16x32_bf16 a[72:75], a[56:59], a[20:23], a[72:75]
buffer_load_dwordx4 v31, s[28:31], s32 offen offset:3072 sc1 lds
v_mfma_f32_16x16x32_bf16 a[88:91], a[40:43], a[24:27], a[88:91]
s_add_u32 s32, s32, 28672
s_add_u32 s33, s33, 0x8000
v_mfma_f32_16x16x32_bf16 a[88:91], a[56:59], a[28:31], a[88:91]
s_and_b32 s33, s33, 0x1ffff
v_mfma_f32_16x16x32_bf16 a[76:79], a[44:47], a[16:19], a[76:79]
ds_read_b128 a[40:43], v18 offset:4096
v_mfma_f32_16x16x32_bf16 a[76:79], a[60:63], a[20:23], a[76:79]
v_mfma_f32_16x16x32_bf16 a[92:95], a[44:47], a[24:27], a[92:95]
ds_read_b128 a[56:59], v19 offset:4096
v_mfma_f32_16x16x32_bf16 a[92:95], a[60:63], a[28:31], a[92:95]
s_cmp_eq_u32 s39, 98304
s_cselect_b32 s41, s48, s49
s_waitcnt lgkmcnt(9)
v_mfma_f32_16x16x32_bf16 v[64:67], a[0:3], a[32:35], v[64:67]
ds_read_b128 a[44:47], v18 offset:6144
ds_read_b128 a[60:63], v19 offset:6144
s_waitcnt lgkmcnt(10)
v_mfma_f32_16x16x32_bf16 v[64:67], a[4:7], a[48:51], v[64:67]
ds_read_b64_tr_b16 a[16:17], v10 offset:0
ds_read_b64_tr_b16 a[18:19], v10 offset:1024
s_waitcnt lgkmcnt(10)
v_mfma_f32_16x16x32_bf16 v[80:83], a[8:11], a[32:35], v[80:83]
s_add_u32 s39, s39, 0x8000
s_cmp_eq_u32 s39, 163840
s_waitcnt lgkmcnt(8)
v_mfma_f32_16x16x32_bf16 v[80:83], a[12:15], a[48:51], v[80:83]
s_cselect_b32 s39, 65536, s39
s_waitcnt lgkmcnt(7)
v_mfma_f32_16x16x32_bf16 v[68:71], a[0:3], a[36:39], v[68:71]
v_xor_b32 v18, 0x8000, v18
v_xor_b32 v19, 0x8000, v19
s_waitcnt lgkmcnt(6)
v_mfma_f32_16x16x32_bf16 v[68:71], a[4:7], a[52:55], v[68:71]
ds_read_b64_tr_b16 a[20:21], v10 offset:8192
v_mfma_f32_16x16x32_bf16 v[84:87], a[8:11], a[36:39], v[84:87]
ds_read_b64_tr_b16 a[22:23], v10 offset:9216
v_mfma_f32_16x16x32_bf16 v[84:87], a[12:15], a[52:55], v[84:87]
v_add_u32 v10, s41, v10
s_waitcnt lgkmcnt(7)
v_mfma_f32_16x16x32_bf16 v[72:75], a[0:3], a[40:43], v[72:75]
ds_read_b64_tr_b16 a[24:25], v11 offset:0
ds_read_b64_tr_b16 a[26:27], v11 offset:1024
v_add_u32 v8, s41, v8
v_add_u32 v9, s41, v9
s_waitcnt lgkmcnt(8)
v_mfma_f32_16x16x32_bf16 v[72:75], a[4:7], a[56:59], v[72:75]
s_mov_b32 s76, 0x3e0293ee
s_mov_b32 s77, 0x3e0293ee
v_lshrrev_b32 v6, 2, v3
v_lshl_add_u32 v7, v2, 2, v6
v_mfma_f32_16x16x32_bf16 v[88:91], a[8:11], a[40:43], v[88:91]
v_and_b32 v28, 3, v3
v_lshlrev_b32 v20, 6, v7
v_lshl_add_u32 v20, v28, 3, v20
v_add_u32 v20, 94208, v20
v_mfma_f32_16x16x32_bf16 v[88:91], a[12:15], a[56:59], v[88:91]
s_lshl_b32 s74, s3, 13
s_add_u32 s75, s74, 131072
v_add_u32 v21, s75, v31
s_waitcnt lgkmcnt(7)
v_mfma_f32_16x16x32_bf16 v[76:79], a[0:3], a[44:47], v[76:79]
ds_read_b64_tr_b16 a[28:29], v11 offset:8192
ds_read_b64_tr_b16 a[30:31], v11 offset:9216
v_add_u32 v11, s41, v11
s_lshl_b32 s75, s3, 12
s_waitcnt lgkmcnt(8)
v_mfma_f32_16x16x32_bf16 v[76:79], a[4:7], a[60:63], v[76:79]
s_add_u32 s75, s75, 65536
v_add_u32 v22, s75, v31
s_add_u32 s75, s74, 98304
v_mfma_f32_16x16x32_bf16 v[92:95], a[8:11], a[44:47], v[92:95]
v_xor_b32 v6, v2, v3
v_lshlrev_b32 v6, 3, v6
v_lshl_add_u32 v6, v3, 7, v6
v_add_u32 v23, s75, v6
v_mfma_f32_16x16x32_bf16 v[92:95], a[12:15], a[60:63], v[92:95]
v_xor_b32 v33, 32, v23
v_xor_b32 v34, 64, v23
v_xor_b32 v35, 96, v23
s_waitcnt lgkmcnt(4)
v_mfma_f32_16x16x32_bf16 v[96:99], a[16:19], a[32:35], v[96:99]
ds_read_b64_tr_b16 a[96:97], v12 offset:0
ds_read_b64_tr_b16 a[98:99], v12 offset:1024
v_mfma_f32_16x16x32_bf16 v[96:99], a[20:23], a[48:51], v[96:99]
ds_read_b64_tr_b16 v[24:25], v20 offset:0
ds_read_b64_tr_b16 v[26:27], v20 offset:1024
v_mfma_f32_16x16x32_bf16 v[100:103], a[16:19], a[36:39], v[100:103]
ds_read_b64_tr_b16 v[40:41], v20 offset:32
ds_read_b64_tr_b16 v[42:43], v20 offset:1056
v_mfma_f32_16x16x32_bf16 v[100:103], a[20:23], a[52:55], v[100:103]
s_mov_b32 m0, s33
s_nop 0
buffer_load_dwordx4 v31, s[28:31], s32 offen offset:0 sc1 lds
v_mfma_f32_16x16x32_bf16 v[104:107], a[16:19], a[40:43], v[104:107]
ds_read_b64_tr_b16 a[100:101], v12 offset:8192
ds_read_b64_tr_b16 a[102:103], v12 offset:9216
v_add_u32 v12, s41, v12
v_pk_mul_f32 v[64:65], v[64:65], s[76:77]
v_mfma_f32_16x16x32_bf16 v[104:107], a[20:23], a[56:59], v[104:107]
v_pk_mul_f32 v[66:67], v[66:67], s[76:77]
v_pk_mul_f32 v[80:81], v[80:81], s[76:77]
v_pk_mul_f32 v[82:83], v[82:83], s[76:77]
v_mfma_f32_16x16x32_bf16 v[108:111], a[16:19], a[44:47], v[108:111]
v_cvt_pk_bf16_f32 v64, v64, v65
v_cvt_pk_bf16_f32 v65, v66, v67
v_cvt_pk_bf16_f32 v66, v80, v81
v_cvt_pk_bf16_f32 v67, v82, v83
v_mfma_f32_16x16x32_bf16 v[108:111], a[20:23], a[60:63], v[108:111]
v_pk_mul_f32 v[68:69], v[68:69], s[76:77]
v_pk_mul_f32 v[70:71], v[70:71], s[76:77]
v_pk_mul_f32 v[84:85], v[84:85], s[76:77]
s_waitcnt lgkmcnt(8)
v_mfma_f32_16x16x32_bf16 v[112:115], a[24:27], a[32:35], v[112:115]
ds_read_b64_tr_b16 a[0:1], v13 offset:0
ds_read_b64_tr_b16 a[2:3], v13 offset:1024
v_pk_mul_f32 v[86:87], v[86:87], s[76:77]
v_cvt_pk_bf16_f32 v68, v68, v69
v_mfma_f32_16x16x32_bf16 v[112:115], a[28:31], a[48:51], v[112:115]
v_cvt_pk_bf16_f32 v69, v70, v71
v_cvt_pk_bf16_f32 v70, v84, v85
v_cvt_pk_bf16_f32 v71, v86, v87
v_mfma_f32_16x16x32_bf16 v[116:119], a[24:27], a[36:39], v[116:119]
v_pk_mul_f32 v[72:73], v[72:73], s[76:77]
v_pk_mul_f32 v[74:75], v[74:75], s[76:77]
v_pk_mul_f32 v[88:89], v[88:89], s[76:77]
v_mfma_f32_16x16x32_bf16 v[116:119], a[28:31], a[52:55], v[116:119]
v_pk_mul_f32 v[90:91], v[90:91], s[76:77]
v_cvt_pk_bf16_f32 v72, v72, v73
v_cvt_pk_bf16_f32 v73, v74, v75
v_mfma_f32_16x16x32_bf16 v[120:123], a[24:27], a[40:43], v[120:123]
ds_read_b64_tr_b16 a[4:5], v13 offset:8192
ds_read_b64_tr_b16 a[6:7], v13 offset:9216
v_add_u32 v13, s41, v13
v_cvt_pk_bf16_f32 v74, v88, v89
v_mfma_f32_16x16x32_bf16 v[120:123], a[28:31], a[56:59], v[120:123]
v_cvt_pk_bf16_f32 v75, v90, v91
v_pk_mul_f32 v[76:77], v[76:77], s[76:77]
v_pk_mul_f32 v[78:79], v[78:79], s[76:77]
v_mfma_f32_16x16x32_bf16 v[124:127], a[24:27], a[44:47], v[124:127]
v_pk_mul_f32 v[92:93], v[92:93], s[76:77]
v_pk_mul_f32 v[94:95], v[94:95], s[76:77]
v_cvt_pk_bf16_f32 v76, v76, v77
v_cvt_pk_bf16_f32 v77, v78, v79
v_mfma_f32_16x16x32_bf16 v[124:127], a[28:31], a[60:63], v[124:127]
v_cvt_pk_bf16_f32 v78, v92, v93
v_cvt_pk_bf16_f32 v79, v94, v95
buffer_load_dwordx4 v31, s[28:31], s32 offen offset:1024 sc1 lds
s_waitcnt lgkmcnt(4)
v_mfma_f32_16x16x32_bf16 v[128:131], a[96:99], a[32:35], v[128:131]
ds_read_b64_tr_b16 a[8:9], v14 offset:0
v_mfma_f32_16x16x32_bf16 v[128:131], a[100:103], a[48:51], v[128:131]
v_mfma_f32_16x16x32_bf16 v[132:135], a[96:99], a[36:39], v[132:135]
ds_read_b64_tr_b16 a[10:11], v14 offset:1024
v_mfma_f32_16x16x32_bf16 v[132:135], a[100:103], a[52:55], v[132:135]
v_mfma_f32_16x16x32_bf16 v[136:139], a[96:99], a[40:43], v[136:139]
ds_read_b64_tr_b16 a[12:13], v14 offset:8192
ds_read_b64_tr_b16 a[14:15], v14 offset:9216
v_add_u32 v14, s41, v14
v_pk_mul_f32 v[96:97], v[96:97], s[76:77]
v_mfma_f32_16x16x32_bf16 v[136:139], a[100:103], a[56:59], v[136:139]
v_pk_mul_f32 v[98:99], v[98:99], s[76:77]
v_pk_mul_f32 v[112:113], v[112:113], s[76:77]
v_pk_mul_f32 v[114:115], v[114:115], s[76:77]
v_mfma_f32_16x16x32_bf16 v[140:143], a[96:99], a[44:47], v[140:143]
v_cvt_pk_bf16_f32 v80, v96, v97
v_cvt_pk_bf16_f32 v81, v98, v99
v_cvt_pk_bf16_f32 v82, v112, v113
v_cvt_pk_bf16_f32 v83, v114, v115
v_mfma_f32_16x16x32_bf16 v[140:143], a[100:103], a[60:63], v[140:143]
v_pk_mul_f32 v[100:101], v[100:101], s[76:77]
v_pk_mul_f32 v[102:103], v[102:103], s[76:77]
v_pk_mul_f32 v[116:117], v[116:117], s[76:77]
s_waitcnt lgkmcnt(4)
v_mfma_f32_16x16x32_bf16 v[144:147], a[0:3], a[32:35], v[144:147]
ds_read_b64_tr_b16 a[16:17], v15 offset:0
ds_read_b64_tr_b16 a[18:19], v15 offset:1024
v_pk_mul_f32 v[118:119], v[118:119], s[76:77]
v_cvt_pk_bf16_f32 v84, v100, v101
v_mfma_f32_16x16x32_bf16 v[144:147], a[4:7], a[48:51], v[144:147]
v_cvt_pk_bf16_f32 v85, v102, v103
v_cvt_pk_bf16_f32 v86, v116, v117
v_cvt_pk_bf16_f32 v87, v118, v119
v_mfma_f32_16x16x32_bf16 v[148:151], a[0:3], a[36:39], v[148:151]
v_pk_mul_f32 v[104:105], v[104:105], s[76:77]
v_pk_mul_f32 v[106:107], v[106:107], s[76:77]
v_pk_mul_f32 v[120:121], v[120:121], s[76:77]
v_mfma_f32_16x16x32_bf16 v[148:151], a[4:7], a[52:55], v[148:151]
v_pk_mul_f32 v[122:123], v[122:123], s[76:77]
v_cvt_pk_bf16_f32 v88, v104, v105
v_cvt_pk_bf16_f32 v89, v106, v107
v_mfma_f32_16x16x32_bf16 v[152:155], a[0:3], a[40:43], v[152:155]
ds_read_b64_tr_b16 a[20:21], v15 offset:8192
ds_read_b64_tr_b16 a[22:23], v15 offset:9216
v_add_u32 v15, s41, v15
v_cvt_pk_bf16_f32 v90, v120, v121
v_mfma_f32_16x16x32_bf16 v[152:155], a[4:7], a[56:59], v[152:155]
v_cvt_pk_bf16_f32 v91, v122, v123
v_pk_mul_f32 v[108:109], v[108:109], s[76:77]
v_pk_mul_f32 v[110:111], v[110:111], s[76:77]
v_mfma_f32_16x16x32_bf16 v[156:159], a[0:3], a[44:47], v[156:159]
v_pk_mul_f32 v[124:125], v[124:125], s[76:77]
v_pk_mul_f32 v[126:127], v[126:127], s[76:77]
v_cvt_pk_bf16_f32 v92, v108, v109
v_cvt_pk_bf16_f32 v93, v110, v111
v_mfma_f32_16x16x32_bf16 v[156:159], a[4:7], a[60:63], v[156:159]
v_cvt_pk_bf16_f32 v94, v124, v125
v_cvt_pk_bf16_f32 v95, v126, v127
buffer_load_dwordx4 v31, s[28:31], s32 offen offset:2048 sc1 lds
s_waitcnt lgkmcnt(4)
v_mfma_f32_16x16x32_bf16 v[160:163], a[8:11], a[32:35], v[160:163]
ds_read_b64_tr_b16 a[24:25], v16 offset:0
v_mfma_f32_16x16x32_bf16 v[160:163], a[12:15], a[48:51], v[160:163]
ds_read_b64_tr_b16 a[26:27], v16 offset:768
v_mfma_f32_16x16x32_bf16 v[164:167], a[8:11], a[36:39], v[164:167]
buffer_load_dwordx4 v31, s[28:31], s32 offen offset:3072 sc1 lds
v_mfma_f32_16x16x32_bf16 v[164:167], a[12:15], a[52:55], v[164:167]
v_mfma_f32_16x16x32_bf16 v[168:171], a[8:11], a[40:43], v[168:171]
ds_read_b64_tr_b16 a[28:29], v16 offset:6144
ds_read_b64_tr_b16 a[30:31], v16 offset:6912
v_pk_mul_f32 v[128:129], v[128:129], s[76:77]
v_pk_mul_f32 v[130:131], v[130:131], s[76:77]
v_mfma_f32_16x16x32_bf16 v[168:171], a[12:15], a[56:59], v[168:171]
v_pk_mul_f32 v[144:145], v[144:145], s[76:77]
v_pk_mul_f32 v[146:147], v[146:147], s[76:77]
v_cvt_pk_bf16_f32 v96, v128, v129
v_mfma_f32_16x16x32_bf16 v[172:175], a[8:11], a[44:47], v[172:175]
v_cvt_pk_bf16_f32 v97, v130, v131
v_cvt_pk_bf16_f32 v98, v144, v145
v_cvt_pk_bf16_f32 v99, v146, v147
v_mfma_f32_16x16x32_bf16 v[172:175], a[12:15], a[60:63], v[172:175]
v_pk_mul_f32 v[132:133], v[132:133], s[76:77]
v_pk_mul_f32 v[134:135], v[134:135], s[76:77]
v_pk_mul_f32 v[148:149], v[148:149], s[76:77]
s_waitcnt lgkmcnt(4)
v_mfma_f32_16x16x32_bf16 v[176:179], a[16:19], a[32:35], v[176:179]
ds_read_b64_tr_b16 a[96:97], v17 offset:0
ds_read_b64_tr_b16 a[98:99], v17 offset:768
v_pk_mul_f32 v[150:151], v[150:151], s[76:77]
v_cvt_pk_bf16_f32 v100, v132, v133
v_mfma_f32_16x16x32_bf16 v[176:179], a[20:23], a[48:51], v[176:179]
v_cvt_pk_bf16_f32 v101, v134, v135
v_cvt_pk_bf16_f32 v102, v148, v149
v_cvt_pk_bf16_f32 v103, v150, v151
v_mfma_f32_16x16x32_bf16 v[180:183], a[16:19], a[36:39], v[180:183]
v_pk_mul_f32 v[136:137], v[136:137], s[76:77]
v_pk_mul_f32 v[138:139], v[138:139], s[76:77]
v_pk_mul_f32 v[152:153], v[152:153], s[76:77]
v_mfma_f32_16x16x32_bf16 v[180:183], a[20:23], a[52:55], v[180:183]
v_pk_mul_f32 v[154:155], v[154:155], s[76:77]
v_cvt_pk_bf16_f32 v104, v136, v137
v_cvt_pk_bf16_f32 v105, v138, v139
v_mfma_f32_16x16x32_bf16 v[184:187], a[16:19], a[40:43], v[184:187]
ds_read_b64_tr_b16 a[100:101], v17 offset:6144
ds_read_b64_tr_b16 a[102:103], v17 offset:6912
v_cvt_pk_bf16_f32 v106, v152, v153
v_cvt_pk_bf16_f32 v107, v154, v155
v_mfma_f32_16x16x32_bf16 v[184:187], a[20:23], a[56:59], v[184:187]
v_pk_mul_f32 v[140:141], v[140:141], s[76:77]
v_pk_mul_f32 v[142:143], v[142:143], s[76:77]
v_pk_mul_f32 v[156:157], v[156:157], s[76:77]
v_mfma_f32_16x16x32_bf16 v[188:191], a[16:19], a[44:47], v[188:191]
v_pk_mul_f32 v[158:159], v[158:159], s[76:77]
v_cvt_pk_bf16_f32 v108, v140, v141
v_cvt_pk_bf16_f32 v109, v142, v143
v_mfma_f32_16x16x32_bf16 v[188:191], a[20:23], a[60:63], v[188:191]
v_cvt_pk_bf16_f32 v110, v156, v157
v_cvt_pk_bf16_f32 v111, v158, v159
s_add_u32 m0, s33, 4096
s_waitcnt lgkmcnt(4)
v_mfma_f32_16x16x32_bf16 v[192:195], a[24:27], a[32:35], v[192:195]
ds_read_b64_tr_b16 a[0:1], v16 offset:64
ds_read_b64_tr_b16 a[2:3], v16 offset:832
v_mfma_f32_16x16x32_bf16 v[192:195], a[28:31], a[48:51], v[192:195]
s_add_u32 s32, s32, 4096
v_mfma_f32_16x16x32_bf16 v[196:199], a[24:27], a[36:39], v[196:199]
buffer_load_dwordx4 v31, s[28:31], s32 offen offset:0 sc1 lds
v_mfma_f32_16x16x32_bf16 v[196:199], a[28:31], a[52:55], v[196:199]
buffer_load_dwordx4 v31, s[28:31], s32 offen offset:1024 sc1 lds
v_mfma_f32_16x16x32_bf16 v[200:203], a[24:27], a[40:43], v[200:203]
ds_read_b64_tr_b16 a[4:5], v16 offset:6208
ds_read_b64_tr_b16 a[6:7], v16 offset:6976
v_pk_mul_f32 v[160:161], v[160:161], s[76:77]
v_pk_mul_f32 v[162:163], v[162:163], s[76:77]
v_mfma_f32_16x16x32_bf16 v[200:203], a[28:31], a[56:59], v[200:203]
v_pk_mul_f32 v[176:177], v[176:177], s[76:77]
v_pk_mul_f32 v[178:179], v[178:179], s[76:77]
v_cvt_pk_bf16_f32 v112, v160, v161
v_mfma_f32_16x16x32_bf16 v[204:207], a[24:27], a[44:47], v[204:207]
v_cvt_pk_bf16_f32 v113, v162, v163
v_cvt_pk_bf16_f32 v114, v176, v177
v_cvt_pk_bf16_f32 v115, v178, v179
v_mfma_f32_16x16x32_bf16 v[204:207], a[28:31], a[60:63], v[204:207]
v_pk_mul_f32 v[164:165], v[164:165], s[76:77]
v_pk_mul_f32 v[166:167], v[166:167], s[76:77]
v_pk_mul_f32 v[180:181], v[180:181], s[76:77]
s_waitcnt lgkmcnt(4)
v_mfma_f32_16x16x32_bf16 v[208:211], a[96:99], a[32:35], v[208:211]
ds_read_b64_tr_b16 a[8:9], v17 offset:64
ds_read_b64_tr_b16 a[10:11], v17 offset:832
v_pk_mul_f32 v[182:183], v[182:183], s[76:77]
v_cvt_pk_bf16_f32 v116, v164, v165
v_mfma_f32_16x16x32_bf16 v[208:211], a[100:103], a[48:51], v[208:211]
v_cvt_pk_bf16_f32 v117, v166, v167
v_cvt_pk_bf16_f32 v118, v180, v181
v_cvt_pk_bf16_f32 v119, v182, v183
v_mfma_f32_16x16x32_bf16 v[212:215], a[96:99], a[36:39], v[212:215]
v_pk_mul_f32 v[168:169], v[168:169], s[76:77]
v_pk_mul_f32 v[170:171], v[170:171], s[76:77]
v_pk_mul_f32 v[184:185], v[184:185], s[76:77]
v_mfma_f32_16x16x32_bf16 v[212:215], a[100:103], a[52:55], v[212:215]
v_pk_mul_f32 v[186:187], v[186:187], s[76:77]
v_cvt_pk_bf16_f32 v120, v168, v169
v_cvt_pk_bf16_f32 v121, v170, v171
v_mfma_f32_16x16x32_bf16 v[216:219], a[96:99], a[40:43], v[216:219]
ds_read_b64_tr_b16 a[12:13], v17 offset:6208
ds_read_b64_tr_b16 a[14:15], v17 offset:6976
v_cvt_pk_bf16_f32 v122, v184, v185
v_cvt_pk_bf16_f32 v123, v186, v187
v_mfma_f32_16x16x32_bf16 v[216:219], a[100:103], a[56:59], v[216:219]
v_pk_mul_f32 v[172:173], v[172:173], s[76:77]
v_pk_mul_f32 v[174:175], v[174:175], s[76:77]
v_pk_mul_f32 v[188:189], v[188:189], s[76:77]
v_mfma_f32_16x16x32_bf16 v[220:223], a[96:99], a[44:47], v[220:223]
v_pk_mul_f32 v[190:191], v[190:191], s[76:77]
v_cvt_pk_bf16_f32 v124, v172, v173
v_cvt_pk_bf16_f32 v125, v174, v175
v_mfma_f32_16x16x32_bf16 v[220:223], a[100:103], a[60:63], v[220:223]
v_cvt_pk_bf16_f32 v126, v188, v189
v_cvt_pk_bf16_f32 v127, v190, v191
buffer_load_dwordx4 v31, s[28:31], s32 offen offset:2048 sc1 lds
s_waitcnt lgkmcnt(4)
v_mfma_f32_16x16x32_bf16 v[224:227], a[0:3], a[32:35], v[224:227]
ds_read_b64_tr_b16 a[16:17], v16 offset:128
ds_read_b64_tr_b16 a[18:19], v16 offset:896
v_mfma_f32_16x16x32_bf16 v[224:227], a[4:7], a[48:51], v[224:227]
ds_read_b64_tr_b16 a[20:21], v16 offset:6272
v_mfma_f32_16x16x32_bf16 v[228:231], a[0:3], a[36:39], v[228:231]
ds_read_b64_tr_b16 a[22:23], v16 offset:7040
v_mfma_f32_16x16x32_bf16 v[228:231], a[4:7], a[52:55], v[228:231]
v_add_u32 v16, s41, v16
v_mfma_f32_16x16x32_bf16 v[232:235], a[0:3], a[40:43], v[232:235]
ds_read_b64_tr_b16 a[24:25], v17 offset:128
ds_read_b64_tr_b16 a[26:27], v17 offset:896
ds_read_b64_tr_b16 a[28:29], v17 offset:6272
v_mfma_f32_16x16x32_bf16 v[232:235], a[4:7], a[56:59], v[232:235]
ds_read_b64_tr_b16 a[30:31], v17 offset:7040
v_add_u32 v17, s41, v17
v_mfma_f32_16x16x32_bf16 v[236:239], a[0:3], a[44:47], v[236:239]
buffer_load_dwordx4 v31, s[28:31], s32 offen offset:3072 sc1 lds
s_add_u32 s32, s32, 28672
v_mfma_f32_16x16x32_bf16 v[236:239], a[4:7], a[60:63], v[236:239]
s_add_u32 s33, s33, 0x8000
s_and_b32 s33, s33, 0x1ffff
s_waitcnt lgkmcnt(8)
v_mfma_f32_16x16x32_bf16 v[240:243], a[8:11], a[32:35], v[240:243]
s_add_u32 s40, s68, s69
s_mov_b32 s41, s68
s_lshr_b32 s78, s40, 4
v_mfma_f32_16x16x32_bf16 v[240:243], a[12:15], a[48:51], v[240:243]
s_mul_i32 s78, s78, 163840
s_mul_i32 s79, s4, 5120
s_add_u32 s78, s78, s79
v_mfma_f32_16x16x32_bf16 v[244:247], a[8:11], a[36:39], v[244:247]
s_add_u32 s42, s78, 37748736
s_lshr_b32 s78, s41, 4
s_mul_i32 s78, s78, 163840
v_mfma_f32_16x16x32_bf16 v[244:247], a[12:15], a[52:55], v[244:247]
s_mul_i32 s79, s4, 5120
s_add_u32 s78, s78, s79
v_mfma_f32_16x16x32_bf16 v[248:251], a[8:11], a[40:43], v[248:251]
s_add_u32 s43, s78, 37748736
v_lshlrev_b32 v10, 2, v2
v_sub_u32 v10, v10, v3
v_mfma_f32_16x16x32_bf16 v[248:251], a[12:15], a[56:59], v[248:251]
v_mov_b32 v16, 0xf149f2ca
v_mov_b32 v17, 0x5d800000
v_mfma_f32_16x16x32_bf16 v[252:255], a[8:11], a[44:47], v[252:255]
v_mov_b32 v12, 0xff61b1e6
v_mov_b32 v13, 0xff61b1e6
v_mov_b32 v14, 0xff61b1e6
v_mfma_f32_16x16x32_bf16 v[252:255], a[12:15], a[60:63], v[252:255]
v_mov_b32 v15, 0xff61b1e6
s_mov_b32 s38, 0
s_waitcnt lgkmcnt(0)
s_barrier
v_mfma_f32_16x16x32_bf16 a[64:67], a[32:35], a[16:19], a[64:67]
v_cvt_pk_bf16_f32 v44, v192, v193
v_cvt_pk_bf16_f32 v45, v194, v195
v_cvt_pk_bf16_f32 v46, v208, v209
v_mfma_f32_16x16x32_bf16 a[64:67], a[48:51], a[20:23], a[64:67]
v_cvt_pk_bf16_f32 v47, v210, v211
ds_write_b128 v21, v[44:47] offset:0
v_cvt_pk_bf16_f32 v48, v196, v197
v_mfma_f32_16x16x32_bf16 a[80:83], a[32:35], a[24:27], a[80:83]
v_cvt_pk_bf16_f32 v49, v198, v199
v_cvt_pk_bf16_f32 v50, v212, v213
v_cvt_pk_bf16_f32 v51, v214, v215
v_mfma_f32_16x16x32_bf16 a[80:83], a[48:51], a[28:31], a[80:83]
ds_write_b128 v21, v[48:51] offset:2048
v_cvt_pk_bf16_f32 v52, v200, v201
v_mfma_f32_16x16x32_bf16 a[68:71], a[36:39], a[16:19], a[68:71]
v_cvt_pk_bf16_f32 v53, v202, v203
v_cvt_pk_bf16_f32 v54, v216, v217
v_cvt_pk_bf16_f32 v55, v218, v219
v_mfma_f32_16x16x32_bf16 a[68:71], a[52:55], a[20:23], a[68:71]
ds_write_b128 v21, v[52:55] offset:4096
v_cvt_pk_bf16_f32 v56, v204, v205
v_cvt_pk_bf16_f32 v57, v206, v207
v_mfma_f32_16x16x32_bf16 a[84:87], a[36:39], a[24:27], a[84:87]
v_cvt_pk_bf16_f32 v58, v220, v221
v_cvt_pk_bf16_f32 v59, v222, v223
ds_write_b128 v21, v[56:59] offset:6144
v_mfma_f32_16x16x32_bf16 a[84:87], a[52:55], a[28:31], a[84:87]
v_cvt_pk_bf16_f32 v44, v224, v225
v_cvt_pk_bf16_f32 v45, v226, v227
v_mfma_f32_16x16x32_bf16 a[72:75], a[40:43], a[16:19], a[72:75]
v_cvt_pk_bf16_f32 v46, v240, v241
v_cvt_pk_bf16_f32 v47, v242, v243
ds_write_b128 v21, v[44:47] offset:1024
v_mfma_f32_16x16x32_bf16 a[72:75], a[56:59], a[20:23], a[72:75]
v_cvt_pk_bf16_f32 v48, v228, v229
v_cvt_pk_bf16_f32 v49, v230, v231
v_cvt_pk_bf16_f32 v50, v244, v245
v_mfma_f32_16x16x32_bf16 a[88:91], a[40:43], a[24:27], a[88:91]
v_cvt_pk_bf16_f32 v51, v246, v247
ds_write_b128 v21, v[48:51] offset:3072
v_cvt_pk_bf16_f32 v52, v232, v233
v_mfma_f32_16x16x32_bf16 a[88:91], a[56:59], a[28:31], a[88:91]
v_cvt_pk_bf16_f32 v53, v234, v235
v_cvt_pk_bf16_f32 v54, v248, v249
v_mfma_f32_16x16x32_bf16 a[76:79], a[44:47], a[16:19], a[76:79]
v_cvt_pk_bf16_f32 v55, v250, v251
ds_write_b128 v21, v[52:55] offset:5120
v_mfma_f32_16x16x32_bf16 a[76:79], a[60:63], a[20:23], a[76:79]
v_cvt_pk_bf16_f32 v56, v236, v237
v_cvt_pk_bf16_f32 v57, v238, v239
v_mfma_f32_16x16x32_bf16 a[92:95], a[44:47], a[24:27], a[92:95]
v_cvt_pk_bf16_f32 v58, v252, v253
v_cvt_pk_bf16_f32 v59, v254, v255
v_mfma_f32_16x16x32_bf16 a[92:95], a[60:63], a[28:31], a[92:95]
ds_write_b128 v21, v[56:59] offset:7168
v_accvgpr_read_b32 v52, a64
v_accvgpr_read_b32 v53, a65
v_accvgpr_read_b32 v54, a66
v_accvgpr_read_b32 v55, a67
v_cvt_pk_bf16_f32 v44, v52, v53
v_cvt_pk_bf16_f32 v45, v54, v55
v_accvgpr_read_b32 v52, a68
v_accvgpr_read_b32 v53, a69
v_accvgpr_read_b32 v54, a70
v_accvgpr_read_b32 v55, a71
v_cvt_pk_bf16_f32 v46, v52, v53
v_cvt_pk_bf16_f32 v47, v54, v55
ds_write_b128 v22, v[44:47] offset:0
v_accvgpr_read_b32 v52, a72
v_accvgpr_read_b32 v53, a73
v_accvgpr_read_b32 v54, a74
v_accvgpr_read_b32 v55, a75
v_cvt_pk_bf16_f32 v48, v52, v53
v_cvt_pk_bf16_f32 v49, v54, v55
v_accvgpr_read_b32 v52, a76
v_accvgpr_read_b32 v53, a77
v_accvgpr_read_b32 v54, a78
v_accvgpr_read_b32 v55, a79
v_cvt_pk_bf16_f32 v50, v52, v53
v_cvt_pk_bf16_f32 v51, v54, v55
ds_write_b128 v22, v[48:51] offset:2048
v_accvgpr_read_b32 v52, a80
v_accvgpr_read_b32 v53, a81
v_accvgpr_read_b32 v54, a82
v_accvgpr_read_b32 v55, a83
v_cvt_pk_bf16_f32 v44, v52, v53
v_cvt_pk_bf16_f32 v45, v54, v55
v_accvgpr_read_b32 v52, a84
v_accvgpr_read_b32 v53, a85
v_accvgpr_read_b32 v54, a86
v_accvgpr_read_b32 v55, a87
v_cvt_pk_bf16_f32 v46, v52, v53
v_cvt_pk_bf16_f32 v47, v54, v55
ds_write_b128 v22, v[44:47] offset:1024
v_accvgpr_read_b32 v52, a88
v_accvgpr_read_b32 v53, a89
v_accvgpr_read_b32 v54, a90
v_accvgpr_read_b32 v55, a91
v_cvt_pk_bf16_f32 v48, v52, v53
v_cvt_pk_bf16_f32 v49, v54, v55
v_accvgpr_read_b32 v52, a92
v_accvgpr_read_b32 v53, a93
v_accvgpr_read_b32 v54, a94
v_accvgpr_read_b32 v55, a95
v_cvt_pk_bf16_f32 v50, v52, v53
v_cvt_pk_bf16_f32 v51, v54, v55
ds_write_b128 v22, v[48:51] offset:3072
s_mov_b32 s78, 0x3fb8aa3b
s_mov_b32 s79, 0x3fb8aa3b
global_load_dword v0, v5, s[84:85]
v_add_u32 v56, 0x400000, v5
global_load_dword v0, v56, s[84:85]
v_lshrrev_b32 v56, 1, v5
global_load_dword v0, v56, s[88:89]
s_mov_b32 s73, 2
L_phi:
ds_read_b128 v[224:227], v21 offset:0
ds_read_b128 v[228:231], v21 offset:1024
ds_read_b128 v[232:235], v21 offset:2048
ds_read_b128 v[236:239], v21 offset:3072
s_waitcnt lgkmcnt(3)
v_mfma_f32_16x16x32_bf16 v[128:131], v[24:27], v[224:227], 0
v_mfma_f32_16x16x32_bf16 v[132:135], v[40:43], v[224:227], 0
s_waitcnt lgkmcnt(2)
v_mfma_f32_16x16x32_bf16 v[144:147], v[24:27], v[228:231], 0
v_mfma_f32_16x16x32_bf16 v[148:151], v[40:43], v[228:231], 0
s_waitcnt lgkmcnt(1)
v_mfma_f32_16x16x32_bf16 v[160:163], v[24:27], v[232:235], 0
v_mfma_f32_16x16x32_bf16 v[164:167], v[40:43], v[232:235], 0
s_waitcnt lgkmcnt(0)
v_mfma_f32_16x16x32_bf16 v[176:179], v[24:27], v[236:239], 0
v_mfma_f32_16x16x32_bf16 v[180:183], v[40:43], v[236:239], 0
v_max3_f32 v44, v128, v129, v130
v_max3_f32 v44, v44, v131, v132
v_max3_f32 v44, v44, v133, v134
v_max_f32_e64 v44, v44, v135
v_max3_f32 v46, -v128, -v129, -v130
v_max3_f32 v46, v46, -v131, -v132
v_max3_f32 v46, v46, -v133, -v134
v_max_f32_e64 v46, v46, -v135
v_max3_f32 v48, v144, v145, v146
v_max3_f32 v48, v48, v147, v148
v_max3_f32 v48, v48, v149, v150
v_max_f32_e64 v48, v48, v151
v_max3_f32 v50, -v144, -v145, -v146
v_max3_f32 v50, v50, -v147, -v148
v_max3_f32 v50, v50, -v149, -v150
v_max_f32_e64 v50, v50, -v151
v_max3_f32 v52, v160, v161, v162
v_permlane16_swap_b32 v44, v46
v_max3_f32 v52, v52, v163, v164
v_permlane16_swap_b32 v48, v50
v_max3_f32 v52, v52, v165, v166
v_max_f32 v44, v44, v46
v_max_f32_e64 v52, v52, v167
v_max_f32 v48, v48, v50
v_max3_f32 v54, -v160, -v161, -v162
s_nop 0
v_permlane32_swap_b32 v44, v48
v_max3_f32 v54, v54, -v163, -v164
v_max_f32 v44, v44, v48
v_max3_f32 v54, v54, -v165, -v166
v_mov_b32 v48, v44
v_max_f32_e64 v54, v54, -v167
s_nop 0
v_permlane32_swap_b32 v44, v48
v_max3_f32 v56, v176, v177, v178
v_mov_b32 v46, v44
v_max3_f32 v56, v56, v179, v180
v_mov_b32 v50, v48
v_max3_f32 v56, v56, v181, v182
v_permlane16_swap_b32 v44, v46
v_max_f32_e64 v56, v56, v183
v_permlane16_swap_b32 v48, v50
s_nop 0
v_max3_f32 v58, -v176, -v177, -v178
v_max3_f32 v58, v58, -v179, -v180
v_max3_f32 v58, v58, -v181, -v182
v_max_f32_e64 v58, v58, -v183
v_mul_f32 v44, s78, v44
v_permlane16_swap_b32 v52, v54
v_mul_f32 v46, s78, v46
v_permlane16_swap_b32 v56, v58
v_pk_fma_f32 v[136:137], v[128:129], s[78:79], v[46:47] op_sel_hi:[1,1,0] neg_lo:[1,0,1] neg_hi:[1,0,1]
v_max_f32 v52, v52, v54
v_pk_fma_f32 v[138:139], v[130:131], s[78:79], v[46:47] op_sel_hi:[1,1,0] neg_lo:[1,0,1] neg_hi:[1,0,1]
v_max_f32 v56, v56, v58
v_pk_fma_f32 v[140:141], v[132:133], s[78:79], v[46:47] op_sel_hi:[1,1,0] neg_lo:[1,0,1] neg_hi:[1,0,1]
s_nop 0
v_permlane32_swap_b32 v52, v56
v_pk_fma_f32 v[142:143], v[134:135], s[78:79], v[46:47] op_sel_hi:[1,1,0] neg_lo:[1,0,1] neg_hi:[1,0,1]
v_max_f32 v52, v52, v56
v_pk_fma_f32 v[128:129], v[128:129], s[78:79], v[44:45] op_sel_hi:[1,1,0] neg_lo:[0,0,1] neg_hi:[0,0,1]
v_mov_b32 v56, v52
v_pk_fma_f32 v[130:131], v[130:131], s[78:79], v[44:45] op_sel_hi:[1,1,0] neg_lo:[0,0,1] neg_hi:[0,0,1]
s_nop 0
v_permlane32_swap_b32 v52, v56
v_pk_fma_f32 v[132:133], v[132:133], s[78:79], v[44:45] op_sel_hi:[1,1,0] neg_lo:[0,0,1] neg_hi:[0,0,1]
v_mov_b32 v54, v52
v_pk_fma_f32 v[134:135], v[134:135], s[78:79], v[44:45] op_sel_hi:[1,1,0] neg_lo:[0,0,1] neg_hi:[0,0,1]
v_mov_b32 v58, v56
v_mul_f32 v48, s78, v48
v_permlane16_swap_b32 v52, v54
v_mul_f32 v50, s78, v50
v_permlane16_swap_b32 v56, v58
v_pk_fma_f32 v[152:153], v[144:145], s[78:79], v[50:51] op_sel_hi:[1,1,0] neg_lo:[1,0,1] neg_hi:[1,0,1]
v_pk_fma_f32 v[154:155], v[146:147], s[78:79], v[50:51] op_sel_hi:[1,1,0] neg_lo:[1,0,1] neg_hi:[1,0,1]
v_pk_fma_f32 v[156:157], v[148:149], s[78:79], v[50:51] op_sel_hi:[1,1,0] neg_lo:[1,0,1] neg_hi:[1,0,1]
v_pk_fma_f32 v[158:159], v[150:151], s[78:79], v[50:51] op_sel_hi:[1,1,0] neg_lo:[1,0,1] neg_hi:[1,0,1]
v_pk_fma_f32 v[144:145], v[144:145], s[78:79], v[48:49] op_sel_hi:[1,1,0] neg_lo:[0,0,1] neg_hi:[0,0,1]
v_pk_fma_f32 v[146:147], v[146:147], s[78:79], v[48:49] op_sel_hi:[1,1,0] neg_lo:[0,0,1] neg_hi:[0,0,1]
v_pk_fma_f32 v[148:149], v[148:149], s[78:79], v[48:49] op_sel_hi:[1,1,0] neg_lo:[0,0,1] neg_hi:[0,0,1]
v_pk_fma_f32 v[150:151], v[150:151], s[78:79], v[48:49] op_sel_hi:[1,1,0] neg_lo:[0,0,1] neg_hi:[0,0,1]
v_exp_f32 v136, v136
v_mul_f32 v52, s78, v52
v_exp_f32 v137, v137
v_mul_f32 v54, s78, v54
v_exp_f32 v138, v138
v_pk_fma_f32 v[168:169], v[160:161], s[78:79], v[54:55] op_sel_hi:[1,1,0] neg_lo:[1,0,1] neg_hi:[1,0,1]
v_exp_f32 v139, v139
v_pk_fma_f32 v[170:171], v[162:163], s[78:79], v[54:55] op_sel_hi:[1,1,0] neg_lo:[1,0,1] neg_hi:[1,0,1]
v_exp_f32 v140, v140
v_pk_fma_f32 v[172:173], v[164:165], s[78:79], v[54:55] op_sel_hi:[1,1,0] neg_lo:[1,0,1] neg_hi:[1,0,1]
v_exp_f32 v141, v141
v_pk_fma_f32 v[174:175], v[166:167], s[78:79], v[54:55] op_sel_hi:[1,1,0] neg_lo:[1,0,1] neg_hi:[1,0,1]
v_exp_f32 v142, v142
v_pk_fma_f32 v[160:161], v[160:161], s[78:79], v[52:53] op_sel_hi:[1,1,0] neg_lo:[0,0,1] neg_hi:[0,0,1]
v_exp_f32 v143, v143
v_pk_fma_f32 v[162:163], v[162:163], s[78:79], v[52:53] op_sel_hi:[1,1,0] neg_lo:[0,0,1] neg_hi:[0,0,1]
v_exp_f32 v128, v128
v_pk_fma_f32 v[164:165], v[164:165], s[78:79], v[52:53] op_sel_hi:[1,1,0] neg_lo:[0,0,1] neg_hi:[0,0,1]
v_exp_f32 v129, v129
v_pk_fma_f32 v[166:167], v[166:167], s[78:79], v[52:53] op_sel_hi:[1,1,0] neg_lo:[0,0,1] neg_hi:[0,0,1]
v_exp_f32 v130, v130
v_mul_f32 v56, s78, v56
v_exp_f32 v131, v131
v_mul_f32 v58, s78, v58
v_exp_f32 v132, v132
v_pk_fma_f32 v[184:185], v[176:177], s[78:79], v[58:59] op_sel_hi:[1,1,0] neg_lo:[1,0,1] neg_hi:[1,0,1]
v_exp_f32 v133, v133
v_pk_fma_f32 v[186:187], v[178:179], s[78:79], v[58:59] op_sel_hi:[1,1,0] neg_lo:[1,0,1] neg_hi:[1,0,1]
v_exp_f32 v134, v134
v_pk_fma_f32 v[188:189], v[180:181], s[78:79], v[58:59] op_sel_hi:[1,1,0] neg_lo:[1,0,1] neg_hi:[1,0,1]
v_exp_f32 v135, v135
v_pk_fma_f32 v[190:191], v[182:183], s[78:79], v[58:59] op_sel_hi:[1,1,0] neg_lo:[1,0,1] neg_hi:[1,0,1]
v_exp_f32 v152, v152
v_pk_fma_f32 v[176:177], v[176:177], s[78:79], v[56:57] op_sel_hi:[1,1,0] neg_lo:[0,0,1] neg_hi:[0,0,1]
v_exp_f32 v153, v153
v_pk_fma_f32 v[178:179], v[178:179], s[78:79], v[56:57] op_sel_hi:[1,1,0] neg_lo:[0,0,1] neg_hi:[0,0,1]
v_exp_f32 v154, v154
v_pk_fma_f32 v[180:181], v[180:181], s[78:79], v[56:57] op_sel_hi:[1,1,0] neg_lo:[0,0,1] neg_hi:[0,0,1]
v_exp_f32 v155, v155
v_pk_fma_f32 v[182:183], v[182:183], s[78:79], v[56:57] op_sel_hi:[1,1,0] neg_lo:[0,0,1] neg_hi:[0,0,1]
v_exp_f32 v156, v156
v_exp_f32 v157, v157
v_exp_f32 v158, v158
v_exp_f32 v159, v159
v_exp_f32 v144, v144
v_exp_f32 v145, v145
v_exp_f32 v146, v146
v_exp_f32 v147, v147
v_exp_f32 v148, v148
v_exp_f32 v149, v149
v_exp_f32 v150, v150
v_exp_f32 v151, v151
v_exp_f32 v168, v168
v_pk_add_f32 v[240:241], v[128:129], v[130:131]
v_exp_f32 v169, v169
v_pk_add_f32 v[242:243], v[132:133], v[134:135]
v_exp_f32 v170, v170
v_pk_add_f32 v[240:241], v[240:241], v[242:243]
v_exp_f32 v171, v171
v_add_f32 v44, v240, v241
v_exp_f32 v172, v172
v_pk_add_f32 v[240:241], v[136:137], v[138:139]
v_exp_f32 v173, v173
v_pk_add_f32 v[242:243], v[140:141], v[142:143]
v_exp_f32 v174, v174
v_pk_add_f32 v[240:241], v[240:241], v[242:243]
v_exp_f32 v175, v175
v_add_f32 v46, v240, v241
v_exp_f32 v160, v160
v_pk_add_f32 v[244:245], v[144:145], v[146:147]
v_exp_f32 v161, v161
v_pk_add_f32 v[246:247], v[148:149], v[150:151]
v_exp_f32 v162, v162
v_pk_add_f32 v[244:245], v[244:245], v[246:247]
v_exp_f32 v163, v163
v_add_f32 v48, v244, v245
v_exp_f32 v164, v164
v_pk_add_f32 v[244:245], v[152:153], v[154:155]
v_exp_f32 v165, v165
v_pk_add_f32 v[246:247], v[156:157], v[158:159]
v_exp_f32 v166, v166
v_pk_add_f32 v[244:245], v[244:245], v[246:247]
v_exp_f32 v167, v167
v_add_f32 v50, v244, v245
v_exp_f32 v184, v184
v_permlane16_swap_b32 v44, v46
v_exp_f32 v185, v185
v_permlane16_swap_b32 v48, v50
v_exp_f32 v186, v186
v_add_f32 v44, v44, v46
v_exp_f32 v187, v187
v_add_f32 v48, v48, v50
v_exp_f32 v188, v188
s_nop 0
v_permlane32_swap_b32 v44, v48
v_exp_f32 v189, v189
v_add_f32 v44, v44, v48
v_exp_f32 v190, v190
v_mov_b32 v48, v44
v_exp_f32 v191, v191
s_nop 0
v_permlane32_swap_b32 v44, v48
v_exp_f32 v176, v176
v_mov_b32 v46, v44
v_exp_f32 v177, v177
v_mov_b32 v50, v48
v_exp_f32 v178, v178
v_permlane16_swap_b32 v44, v46
v_exp_f32 v179, v179
v_permlane16_swap_b32 v48, v50
v_exp_f32 v180, v180
v_exp_f32 v181, v181
v_exp_f32 v182, v182
v_exp_f32 v183, v183
v_rcp_f32 v44, v44
v_rcp_f32 v46, v46
v_rcp_f32 v48, v48
v_rcp_f32 v50, v50
v_pk_mul_f32 v[128:129], v[128:129], v[44:45] op_sel_hi:[1,0]
v_pk_add_f32 v[248:249], v[160:161], v[162:163]
v_pk_mul_f32 v[130:131], v[130:131], v[44:45] op_sel_hi:[1,0]
v_pk_add_f32 v[250:251], v[164:165], v[166:167]
v_pk_mul_f32 v[132:133], v[132:133], v[44:45] op_sel_hi:[1,0]
v_pk_add_f32 v[248:249], v[248:249], v[250:251]
v_pk_mul_f32 v[134:135], v[134:135], v[44:45] op_sel_hi:[1,0]
v_add_f32_e64 v52, v248, v249
v_cvt_pk_bf16_f32 v192, v128, v129
v_pk_add_f32 v[248:249], v[168:169], v[170:171]
v_cvt_pk_bf16_f32 v193, v130, v131
v_pk_add_f32 v[250:251], v[172:173], v[174:175]
v_cvt_pk_bf16_f32 v194, v132, v133
v_pk_add_f32 v[248:249], v[248:249], v[250:251]
v_cvt_pk_bf16_f32 v195, v134, v135
v_add_f32_e64 v54, v248, v249
ds_write_b128 v21, v[192:195] offset:0
v_pk_add_f32 v[252:253], v[176:177], v[178:179]
v_pk_mul_f32 v[136:137], v[136:137], v[46:47] op_sel_hi:[1,0]
v_pk_add_f32 v[254:255], v[180:181], v[182:183]
v_pk_mul_f32 v[138:139], v[138:139], v[46:47] op_sel_hi:[1,0]
v_pk_add_f32 v[252:253], v[252:253], v[254:255]
v_pk_mul_f32 v[140:141], v[140:141], v[46:47] op_sel_hi:[1,0]
v_add_f32_e64 v56, v252, v253
v_pk_mul_f32 v[142:143], v[142:143], v[46:47] op_sel_hi:[1,0]
v_pk_add_f32 v[252:253], v[184:185], v[186:187]
v_cvt_pk_bf16_f32 v196, v136, v137
v_pk_add_f32 v[254:255], v[188:189], v[190:191]
v_cvt_pk_bf16_f32 v197, v138, v139
v_pk_add_f32 v[252:253], v[252:253], v[254:255]
v_cvt_pk_bf16_f32 v198, v140, v141
v_add_f32 v58, v252, v253
v_cvt_pk_bf16_f32 v199, v142, v143
v_permlane16_swap_b32 v52, v54
ds_write_b128 v21, v[196:199] offset:1024
v_permlane16_swap_b32 v56, v58
v_pk_mul_f32 v[144:145], v[144:145], v[48:49] op_sel_hi:[1,0]
v_add_f32 v52, v52, v54
v_pk_mul_f32 v[146:147], v[146:147], v[48:49] op_sel_hi:[1,0]
v_add_f32 v56, v56, v58
v_pk_mul_f32 v[148:149], v[148:149], v[48:49] op_sel_hi:[1,0]
s_nop 0
v_permlane32_swap_b32 v52, v56
v_pk_mul_f32 v[150:151], v[150:151], v[48:49] op_sel_hi:[1,0]
v_add_f32 v52, v52, v56
v_cvt_pk_bf16_f32 v200, v144, v145
v_mov_b32 v56, v52
v_cvt_pk_bf16_f32 v201, v146, v147
s_nop 0
v_permlane32_swap_b32 v52, v56
v_cvt_pk_bf16_f32 v202, v148, v149
v_mov_b32 v54, v52
v_cvt_pk_bf16_f32 v203, v150, v151
v_mov_b32 v58, v56
ds_write_b64 v23, v[200:201] offset:0
v_permlane16_swap_b32 v52, v54
ds_write_b64 v33, v[202:203] offset:0
v_permlane16_swap_b32 v56, v58
v_pk_mul_f32 v[152:153], v[152:153], v[50:51] op_sel_hi:[1,0]
v_rcp_f32 v52, v52
v_pk_mul_f32 v[154:155], v[154:155], v[50:51] op_sel_hi:[1,0]
v_rcp_f32 v54, v54
v_pk_mul_f32 v[156:157], v[156:157], v[50:51] op_sel_hi:[1,0]
v_rcp_f32 v56, v56
v_pk_mul_f32 v[158:159], v[158:159], v[50:51] op_sel_hi:[1,0]
v_rcp_f32_e64 v58, v58
v_cvt_pk_bf16_f32 v204, v152, v153
v_cvt_pk_bf16_f32 v205, v154, v155
v_cvt_pk_bf16_f32 v206, v156, v157
v_cvt_pk_bf16_f32 v207, v158, v159
ds_write_b64 v34, v[204:205] offset:0
ds_write_b64 v35, v[206:207] offset:0
v_pk_mul_f32 v[160:161], v[160:161], v[52:53] op_sel_hi:[1,0]
v_pk_mul_f32 v[162:163], v[162:163], v[52:53] op_sel_hi:[1,0]
v_pk_mul_f32 v[164:165], v[164:165], v[52:53] op_sel_hi:[1,0]
v_pk_mul_f32 v[166:167], v[166:167], v[52:53] op_sel_hi:[1,0]
v_cvt_pk_bf16_f32 v208, v160, v161
v_cvt_pk_bf16_f32 v209, v162, v163
v_cvt_pk_bf16_f32 v210, v164, v165
v_cvt_pk_bf16_f32 v211, v166, v167
ds_write_b128 v21, v[208:211] offset:2048
v_pk_mul_f32 v[168:169], v[168:169], v[54:55] op_sel_hi:[1,0]
v_pk_mul_f32 v[170:171], v[170:171], v[54:55] op_sel_hi:[1,0]
v_pk_mul_f32 v[172:173], v[172:173], v[54:55] op_sel_hi:[1,0]
v_pk_mul_f32 v[174:175], v[174:175], v[54:55] op_sel_hi:[1,0]
v_cvt_pk_bf16_f32 v212, v168, v169
v_cvt_pk_bf16_f32 v213, v170, v171
v_cvt_pk_bf16_f32 v214, v172, v173
v_cvt_pk_bf16_f32 v215, v174, v175
ds_write_b128 v21, v[212:215] offset:3072
v_pk_mul_f32 v[176:177], v[176:177], v[56:57] op_sel_hi:[1,0]
v_pk_mul_f32 v[178:179], v[178:179], v[56:57] op_sel_hi:[1,0]
v_pk_mul_f32 v[180:181], v[180:181], v[56:57] op_sel_hi:[1,0]
v_pk_mul_f32 v[182:183], v[182:183], v[56:57] op_sel_hi:[1,0]
v_cvt_pk_bf16_f32 v216, v176, v177
v_cvt_pk_bf16_f32 v217, v178, v179
v_cvt_pk_bf16_f32 v218, v180, v181
v_cvt_pk_bf16_f32 v219, v182, v183
ds_write_b64 v23, v[216:217] offset:2048
ds_write_b64 v33, v[218:219] offset:2048
v_pk_mul_f32 v[184:185], v[184:185], v[58:59] op_sel_hi:[1,0]
v_pk_mul_f32 v[186:187], v[186:187], v[58:59] op_sel_hi:[1,0]
v_pk_mul_f32 v[188:189], v[188:189], v[58:59] op_sel_hi:[1,0]
v_pk_mul_f32 v[190:191], v[190:191], v[58:59] op_sel_hi:[1,0]
v_cvt_pk_bf16_f32 v220, v184, v185
v_cvt_pk_bf16_f32 v221, v186, v187
v_cvt_pk_bf16_f32 v222, v188, v189
v_cvt_pk_bf16_f32 v223, v190, v191
ds_write_b64 v34, v[220:221] offset:2048
ds_write_b64 v35, v[222:223] offset:2048
v_add_u32 v21, 4096, v21
v_add_u32 v23, 4096, v23
v_add_u32 v33, 4096, v33
v_add_u32 v34, 4096, v34
v_add_u32 v35, 4096, v35
s_sub_u32 s73, s73, 1
s_cmp_lg_u32 s73, 0
s_cbranch_scc1 L_phi
v_subrev_u32 v21, 8192, v21
v_mov_b32 v60, 0
v_mov_b32 v61, 0
v_mov_b32 v62, 0
v_mov_b32 v63, 0
s_nop 1
v_mfma_f32_32x32x16_bf16 a[128:143], v[60:63], v[60:63], 0
ds_read_b128 a[64:67], v21 offset:0
ds_read_b128 a[68:71], v21 offset:1024
ds_read_b128 a[72:75], v21 offset:2048
ds_read_b128 a[76:79], v21 offset:3072
v_mfma_f32_32x32x16_bf16 a[144:159], v[60:63], v[60:63], 0
ds_read_b128 a[80:83], v21 offset:4096
ds_read_b128 a[84:87], v21 offset:5120
ds_read_b128 a[88:91], v21 offset:6144
ds_read_b128 a[92:95], v21 offset:7168
v_mfma_f32_32x32x16_bf16 a[160:175], v[60:63], v[60:63], 0
ds_write_b128 v21, v[64:67] offset:0
ds_write_b128 v21, v[68:71] offset:1024
ds_write_b128 v21, v[80:83] offset:2048
ds_write_b128 v21, v[84:87] offset:3072
v_mfma_f32_32x32x16_bf16 a[176:191], v[60:63], v[60:63], 0
ds_write_b128 v21, v[96:99] offset:4096
ds_write_b128 v21, v[100:103] offset:5120
ds_write_b128 v21, v[112:115] offset:6144
ds_write_b128 v21, v[116:119] offset:7168
v_mfma_f32_32x32x16_bf16 a[192:207], v[60:63], v[60:63], 0
v_xor_b32 v21, 0x2000, v21
v_lshlrev_b32 v6, 2, v2
s_lshl_b32 s74, s3, 2
v_xor_b32 v6, s74, v6
v_mfma_f32_32x32x16_bf16 a[208:223], v[60:63], v[60:63], 0
v_lshrrev_b32 v20, 2, v3
v_xor_b32 v20, v20, v28
v_add_u32 v6, v6, v20
v_lshlrev_b32 v6, 3, v6
v_mfma_f32_32x32x16_bf16 a[224:239], v[60:63], v[60:63], 0
v_lshl_add_u32 v20, v7, 7, v6
v_add_u32 v20, 98304, v20
v_add_u32 v22, 65536, v31
v_mov_b32 v56, 0x3f803f80
v_mfma_f32_32x32x16_bf16 a[240:255], v[60:63], v[60:63], 0
v_mov_b32 v57, 0x3f803f80
v_mov_b32 v58, 0x3f803f80
v_mov_b32 v59, 0x3f803f80
v_accvgpr_write_b32 a112, v56
v_mfma_f32_32x32x16_bf16 a[96:111], v[60:63], v[60:63], 0
v_accvgpr_write_b32 a113, v57
v_accvgpr_write_b32 a114, v58
v_accvgpr_write_b32 a115, v59
s_waitcnt lgkmcnt(0)
s_barrier
ds_read_b128 a[32:35], v21 offset:0
ds_read_b128 a[36:39], v21 offset:1024
ds_read_b128 a[40:43], v21 offset:2048
ds_read_b128 a[44:47], v21 offset:3072
ds_read_b128 a[48:51], v21 offset:4096
ds_read_b128 a[52:55], v21 offset:5120
ds_read_b128 a[56:59], v21 offset:6144
ds_read_b128 a[60:63], v21 offset:7168
ds_read_b64_tr_b16 v[128:129], v20 offset:0
ds_read_b64_tr_b16 v[130:131], v20 offset:2048
ds_read_b128 v[132:135], v22 offset:0
ds_read_b128 v[136:139], v22 offset:1024
ds_read_b64_tr_b16 v[140:141], v20 offset:4096
ds_read_b64_tr_b16 v[142:143], v20 offset:6144
ds_read_b128 v[144:147], v22 offset:2048
ds_read_b128 v[148:151], v22 offset:3072
ds_read_b64_tr_b16 v[152:153], v20 offset:8192
ds_read_b64_tr_b16 v[154:155], v20 offset:10240
ds_read_b128 v[156:159], v22 offset:4096
ds_read_b128 v[160:163], v22 offset:5120
s_waitcnt lgkmcnt(8)
v_mfma_f32_16x16x32_bf16 v[44:47], v[128:131], v[132:135], 0
v_mfma_f32_16x16x32_bf16 v[48:51], v[128:131], v[136:139], 0
v_mfma_f32_16x16x32_bf16 v[52:55], v[128:131], v[56:59], 0
ds_read_b64_tr_b16 v[164:165], v20 offset:12288
ds_read_b64_tr_b16 v[166:167], v20 offset:14336
ds_read_b128 v[168:171], v22 offset:6144
ds_read_b128 v[172:175], v22 offset:7168
s_waitcnt lgkmcnt(8)
v_mfma_f32_16x16x32_bf16 v[44:47], v[140:143], v[144:147], v[44:47]
v_mfma_f32_16x16x32_bf16 v[48:51], v[140:143], v[148:151], v[48:51]
v_mfma_f32_16x16x32_bf16 v[52:55], v[140:143], v[56:59], v[52:55]
ds_read_b64_tr_b16 v[176:177], v20 offset:16384
ds_read_b64_tr_b16 v[178:179], v20 offset:18432
ds_read_b128 v[180:183], v22 offset:8192
ds_read_b128 v[184:187], v22 offset:9216
s_waitcnt lgkmcnt(8)
v_mfma_f32_16x16x32_bf16 v[44:47], v[152:155], v[156:159], v[44:47]
v_mfma_f32_16x16x32_bf16 v[48:51], v[152:155], v[160:163], v[48:51]
v_mfma_f32_16x16x32_bf16 v[52:55], v[152:155], v[56:59], v[52:55]
ds_read_b64_tr_b16 v[188:189], v20 offset:20480
ds_read_b64_tr_b16 v[190:191], v20 offset:22528
ds_read_b128 v[192:195], v22 offset:10240
ds_read_b128 v[196:199], v22 offset:11264
s_waitcnt lgkmcnt(8)
v_mfma_f32_16x16x32_bf16 v[44:47], v[164:167], v[168:171], v[44:47]
v_mfma_f32_16x16x32_bf16 v[48:51], v[164:167], v[172:175], v[48:51]
v_mfma_f32_16x16x32_bf16 v[52:55], v[164:167], v[56:59], v[52:55]
ds_read_b64_tr_b16 v[200:201], v20 offset:24576
ds_read_b64_tr_b16 v[202:203], v20 offset:26624
ds_read_b128 v[204:207], v22 offset:12288
ds_read_b128 v[208:211], v22 offset:13312
s_waitcnt lgkmcnt(8)
v_mfma_f32_16x16x32_bf16 v[44:47], v[176:179], v[180:183], v[44:47]
v_mfma_f32_16x16x32_bf16 v[48:51], v[176:179], v[184:187], v[48:51]
v_mfma_f32_16x16x32_bf16 v[52:55], v[176:179], v[56:59], v[52:55]
ds_read_b64_tr_b16 v[212:213], v20 offset:28672
ds_read_b64_tr_b16 v[214:215], v20 offset:30720
ds_read_b128 v[216:219], v22 offset:14336
ds_read_b128 v[220:223], v22 offset:15360
s_waitcnt lgkmcnt(8)
v_mfma_f32_16x16x32_bf16 v[44:47], v[188:191], v[192:195], v[44:47]
v_mfma_f32_16x16x32_bf16 v[48:51], v[188:191], v[196:199], v[48:51]
v_mfma_f32_16x16x32_bf16 v[52:55], v[188:191], v[56:59], v[52:55]
s_waitcnt lgkmcnt(4)
v_mfma_f32_16x16x32_bf16 v[44:47], v[200:203], v[204:207], v[44:47]
v_mfma_f32_16x16x32_bf16 v[48:51], v[200:203], v[208:211], v[48:51]
v_mfma_f32_16x16x32_bf16 v[52:55], v[200:203], v[56:59], v[52:55]
s_waitcnt lgkmcnt(0)
v_mfma_f32_16x16x32_bf16 v[44:47], v[212:215], v[216:219], v[44:47]
v_mfma_f32_16x16x32_bf16 v[48:51], v[212:215], v[220:223], v[48:51]
v_mfma_f32_16x16x32_bf16 v[52:55], v[212:215], v[56:59], v[52:55]
s_lshl_b32 s74, s4, 3
s_add_u32 s74, s74, s5
s_lshl_b32 s74, s74, 2
s_add_u32 s74, s74, s3
s_mul_i32 s74, s74, 3072
s_add_u32 s74, s74, 58720256
buffer_store_dwordx4 v[44:47], v31, s[28:31], s74 offen offset:0 sc1
buffer_store_dwordx4 v[48:51], v31, s[28:31], s74 offen offset:1024 sc1
buffer_store_dwordx4 v[52:55], v31, s[28:31], s74 offen offset:2048 sc1
L_att:
v_mov_b32 v8, v31
v_mov_b32 v9, v31
s_mov_b32 s34, 1
v_sub_u32 v11, s41, v10
v_mov_b32 v20, 128
global_load_dword v21, v20, s[6:7] sc1
s_waitcnt vmcnt(15)
s_barrier
s_nop 0
ds_read_b128 a[0:3], v8 offset:0
ds_read_b128 a[4:7], v8 offset:1024
ds_read_b128 a[8:11], v8 offset:2048
ds_read_b128 a[12:15], v8 offset:3072
v_cmp_le_i32_e64 s[48:49], -16, v11
v_cmp_le_i32_e64 s[50:51], -15, v11
v_cmp_le_i32_e64 s[52:53], -14, v11
v_cmp_le_i32_e64 s[54:55], -13, v11
v_cmp_le_i32_e64 s[56:57], 0, v11
v_cmp_le_i32_e64 s[58:59], 1, v11
v_cmp_le_i32_e64 s[60:61], 2, v11
v_cmp_le_i32_e64 s[62:63], 3, v11
v_cmp_le_i32_e64 s[64:65], 16, v11
v_cmp_le_i32_e64 s[66:67], 17, v11
v_cmp_le_i32_e64 s[90:91], 18, v11
v_cmp_le_i32_e64 s[92:93], 19, v11
v_cndmask_b32_e64 v240, v16, 0, s[56:57]
v_cndmask_b32_e64 v241, v16, 0, s[58:59]
v_cndmask_b32_e64 v242, v16, 0, s[60:61]
v_cndmask_b32_e64 v243, v16, 0, s[62:63]
v_cndmask_b32_e64 v244, v16, 0, s[48:49]
v_cndmask_b32_e64 v245, v16, 0, s[50:51]
v_cndmask_b32_e64 v246, v16, 0, s[52:53]
v_cndmask_b32_e64 v247, v16, 0, s[54:55]
v_cndmask_b32_e64 v248, v16, 0, s[64:65]
v_cndmask_b32_e64 v249, v16, 0, s[66:67]
v_cndmask_b32_e64 v250, v16, 0, s[90:91]
v_cndmask_b32_e64 v251, v16, 0, s[92:93]
v_cndmask_b32_e64 v252, v16, 0, s[56:57]
v_cndmask_b32_e64 v253, v16, 0, s[58:59]
v_cndmask_b32_e64 v254, v16, 0, s[60:61]
v_cndmask_b32_e64 v255, v16, 0, s[62:63]
v_subrev_u32 v11, 32, v11
s_waitcnt lgkmcnt(0)
v_mfma_f32_16x16x32_bf16 v[128:131], a[0:3], v[64:67], 0
ds_read_b128 a[16:19], v8 offset:4096
v_mfma_f32_16x16x32_bf16 v[128:131], a[4:7], v[80:83], v[128:131]
v_mfma_f32_16x16x32_bf16 v[128:131], a[8:11], v[96:99], v[128:131]
ds_read_b128 a[20:23], v8 offset:5120
v_mfma_f32_16x16x32_bf16 v[128:131], a[12:15], v[112:115], v[128:131]
v_mfma_f32_16x16x32_bf16 v[136:139], a[0:3], v[68:71], 0
ds_read_b128 a[24:27], v8 offset:6144
s_mov_b32 m0, s33
v_mfma_f32_16x16x32_bf16 v[136:139], a[4:7], v[84:87], v[136:139]
buffer_load_dwordx4 v31, s[28:31], s32 offen offset:0 sc1 lds
buffer_load_dwordx4 v31, s[28:31], s32 offen offset:1024 sc1 lds
v_mfma_f32_16x16x32_bf16 v[136:139], a[8:11], v[100:103], v[136:139]
ds_read_b128 a[28:31], v8 offset:7168
v_mfma_f32_16x16x32_bf16 v[136:139], a[12:15], v[116:119], v[136:139]
v_mfma_f32_16x16x32_bf16 v[144:147], a[0:3], v[72:75], v[240:243]
v_mfma_f32_16x16x32_bf16 v[144:147], a[4:7], v[88:91], v[144:147]
buffer_load_dwordx4 v31, s[28:31], s32 offen offset:2048 sc1 lds
v_mfma_f32_16x16x32_bf16 v[144:147], a[8:11], v[104:107], v[144:147]
v_mfma_f32_16x16x32_bf16 v[144:147], a[12:15], v[120:123], v[144:147]
v_mfma_f32_16x16x32_bf16 v[152:155], a[0:3], v[76:79], v[244:247]
v_mfma_f32_16x16x32_bf16 v[152:155], a[4:7], v[92:95], v[152:155]
buffer_load_dwordx4 v31, s[28:31], s32 offen offset:3072 sc1 lds
v_mfma_f32_16x16x32_bf16 v[152:155], a[8:11], v[108:111], v[152:155]
v_mfma_f32_16x16x32_bf16 v[152:155], a[12:15], v[124:127], v[152:155]
s_waitcnt lgkmcnt(0)
v_mfma_f32_16x16x32_bf16 v[132:135], a[16:19], v[64:67], 0
ds_read_b128 a[0:3], v8 offset:16384
s_add_u32 m0, s33, 4096
s_add_u32 s32, s32, 4096
v_mfma_f32_16x16x32_bf16 v[132:135], a[20:23], v[80:83], v[132:135]
buffer_load_dwordx4 v31, s[28:31], s32 offen offset:0 sc1 lds
v_mfma_f32_16x16x32_bf16 v[132:135], a[24:27], v[96:99], v[132:135]
v_mfma_f32_16x16x32_bf16 v[132:135], a[28:31], v[112:115], v[132:135]
v_mfma_f32_16x16x32_bf16 v[140:143], a[16:19], v[68:71], 0
ds_read_b128 a[4:7], v8 offset:17408
v_mfma_f32_16x16x32_bf16 v[140:143], a[20:23], v[84:87], v[140:143]
buffer_load_dwordx4 v31, s[28:31], s32 offen offset:1024 sc1 lds
v_mfma_f32_16x16x32_bf16 v[140:143], a[24:27], v[100:103], v[140:143]
v_mfma_f32_16x16x32_bf16 v[140:143], a[28:31], v[116:119], v[140:143]
v_mfma_f32_16x16x32_bf16 v[148:151], a[16:19], v[72:75], v[248:251]
ds_read_b128 a[8:11], v8 offset:18432
v_mfma_f32_16x16x32_bf16 v[148:151], a[20:23], v[88:91], v[148:151]
buffer_load_dwordx4 v31, s[28:31], s32 offen offset:2048 sc1 lds
v_mfma_f32_16x16x32_bf16 v[148:151], a[24:27], v[104:107], v[148:151]
v_mfma_f32_16x16x32_bf16 v[148:151], a[28:31], v[120:123], v[148:151]
v_mfma_f32_16x16x32_bf16 v[156:159], a[16:19], v[76:79], v[252:255]
ds_read_b128 a[12:15], v8 offset:19456
v_mfma_f32_16x16x32_bf16 v[156:159], a[20:23], v[92:95], v[156:159]
buffer_load_dwordx4 v31, s[28:31], s32 offen offset:3072 sc1 lds
s_add_u32 s32, s32, 28672
s_add_u32 s33, s33, 0x8000
s_and_b32 s33, s33, 0x1ffff
v_mfma_f32_16x16x32_bf16 v[156:159], a[24:27], v[108:111], v[156:159]
v_mfma_f32_16x16x32_bf16 v[156:159], a[28:31], v[124:127], v[156:159]
v_max3_f32 v52, v128, v129, v130
v_max3_f32 v52, v52, v131, v132
v_max3_f32 v52, v52, v133, v134
v_max3_f32 v52, v52, v135, v12
v_max3_f32 v53, v136, v137, v138
v_max3_f32 v53, v53, v139, v140
v_max3_f32 v53, v53, v141, v142
v_max3_f32 v53, v53, v143, v13
v_max3_f32 v54, v144, v145, v146
v_max3_f32 v54, v54, v147, v148
v_max3_f32 v54, v54, v149, v150
v_max3_f32 v54, v54, v151, v14
v_max3_f32 v55, v152, v153, v154
v_max3_f32 v55, v55, v155, v156
v_max3_f32 v55, v55, v157, v158
v_max3_f32 v55, v55, v159, v15
s_lshl_b32 s74, s3, 9
s_add_u32 s74, s74, 147456
v_lshl_add_u32 v56, v1, 3, s74
v_permlane16_swap_b32 v52, v53
v_permlane16_swap_b32 v54, v55
v_max_f32 v52, v52, v53
v_max_f32 v54, v54, v55
s_nop 1
v_permlane32_swap_b32 v52, v54
v_max_f32 v52, v52, v54
v_mov_b32 v54, v52
s_nop 1
v_permlane32_swap_b32 v52, v54
v_mov_b32 v53, v52
v_mov_b32 v55, v54
s_nop 0
v_permlane16_swap_b32 v52, v53
v_permlane16_swap_b32 v54, v55
ds_write_b64 v56, v[52:53]
v_sub_f32 v224, 0, v52
v_sub_f32 v225, 0, v52
v_sub_f32 v226, 0, v52
v_sub_f32 v227, 0, v52
v_sub_f32 v228, 0, v53
v_sub_f32 v229, 0, v53
v_sub_f32 v230, 0, v53
v_sub_f32 v231, 0, v53
v_sub_f32 v232, 0, v54
v_sub_f32 v233, 0, v54
v_sub_f32 v234, 0, v54
v_sub_f32 v235, 0, v54
v_sub_f32 v236, 0, v55
v_sub_f32 v237, 0, v55
v_sub_f32 v238, 0, v55
v_sub_f32 v239, 0, v55
v_pk_add_f32 v[128:129], v[128:129], v[224:225]
v_pk_add_f32 v[130:131], v[130:131], v[224:225]
v_pk_add_f32 v[132:133], v[132:133], v[224:225]
v_pk_add_f32 v[134:135], v[134:135], v[224:225]
v_pk_add_f32 v[136:137], v[136:137], v[228:229]
v_pk_add_f32 v[138:139], v[138:139], v[228:229]
v_pk_add_f32 v[140:141], v[140:141], v[228:229]
v_pk_add_f32 v[142:143], v[142:143], v[228:229]
v_pk_add_f32 v[144:145], v[144:145], v[232:233]
v_pk_add_f32 v[146:147], v[146:147], v[232:233]
v_pk_add_f32 v[148:149], v[148:149], v[232:233]
v_pk_add_f32 v[150:151], v[150:151], v[232:233]
v_pk_add_f32 v[152:153], v[152:153], v[236:237]
v_pk_add_f32 v[154:155], v[154:155], v[236:237]
v_pk_add_f32 v[156:157], v[156:157], v[236:237]
v_pk_add_f32 v[158:159], v[158:159], v[236:237]
v_cmp_le_i32_e64 s[48:49], -16, v11
v_cmp_le_i32_e64 s[50:51], -15, v11
v_cmp_le_i32_e64 s[52:53], -14, v11
v_cmp_le_i32_e64 s[54:55], -13, v11
v_cmp_le_i32_e64 s[56:57], 0, v11
v_cmp_le_i32_e64 s[58:59], 1, v11
v_cmp_le_i32_e64 s[60:61], 2, v11
v_cmp_le_i32_e64 s[62:63], 3, v11
v_cmp_le_i32_e64 s[64:65], 16, v11
v_cmp_le_i32_e64 s[66:67], 17, v11
v_cmp_le_i32_e64 s[90:91], 18, v11
v_cmp_le_i32_e64 s[92:93], 19, v11
v_cndmask_b32_e64 v240, v16, v232, s[56:57]
v_cndmask_b32_e64 v241, v16, v232, s[58:59]
v_cndmask_b32_e64 v242, v16, v232, s[60:61]
v_cndmask_b32_e64 v243, v16, v232, s[62:63]
v_cndmask_b32_e64 v244, v16, v236, s[48:49]
v_cndmask_b32_e64 v245, v16, v236, s[50:51]
v_cndmask_b32_e64 v246, v16, v236, s[52:53]
v_cndmask_b32_e64 v247, v16, v236, s[54:55]
v_cndmask_b32_e64 v248, v16, v232, s[64:65]
v_cndmask_b32_e64 v249, v16, v232, s[66:67]
v_cndmask_b32_e64 v250, v16, v232, s[90:91]
v_cndmask_b32_e64 v251, v16, v232, s[92:93]
v_cndmask_b32_e64 v252, v16, v236, s[56:57]
v_cndmask_b32_e64 v253, v16, v236, s[58:59]
v_cndmask_b32_e64 v254, v16, v236, s[60:61]
v_cndmask_b32_e64 v255, v16, v236, s[62:63]
s_waitcnt lgkmcnt(1)
v_mfma_f32_16x16x32_bf16 v[160:163], a[0:3], v[64:67], v[224:227]
ds_read_b128 a[16:19], v8 offset:20480
v_exp_f32 v128, v128
v_mfma_f32_16x16x32_bf16 v[160:163], a[4:7], v[80:83], v[160:163]
v_exp_f32 v144, v144
v_mfma_f32_16x16x32_bf16 v[160:163], a[8:11], v[96:99], v[160:163]
ds_read_b128 a[20:23], v8 offset:21504
v_exp_f32 v129, v129
v_mfma_f32_16x16x32_bf16 v[160:163], a[12:15], v[112:115], v[160:163]
v_exp_f32 v145, v145
v_exp_f32 v130, v130
v_mfma_f32_16x16x32_bf16 v[168:171], a[0:3], v[68:71], v[228:231]
ds_read_b128 a[24:27], v8 offset:22528
v_exp_f32 v146, v146
v_mfma_f32_16x16x32_bf16 v[168:171], a[4:7], v[84:87], v[168:171]
v_exp_f32 v131, v131
v_exp_f32 v147, v147
v_mfma_f32_16x16x32_bf16 v[168:171], a[8:11], v[100:103], v[168:171]
ds_read_b128 a[28:31], v8 offset:23552
v_exp_f32 v136, v136
v_mfma_f32_16x16x32_bf16 v[168:171], a[12:15], v[116:119], v[168:171]
v_exp_f32 v152, v152
v_mfma_f32_16x16x32_bf16 v[176:179], a[0:3], v[72:75], v[240:243]
v_exp_f32 v137, v137
v_exp_f32 v153, v153
v_mfma_f32_16x16x32_bf16 v[176:179], a[4:7], v[88:91], v[176:179]
v_cvt_pk_bf16_f32 v192, v128, v129
v_cvt_pk_bf16_f32 v200, v144, v145
v_mfma_f32_16x16x32_bf16 v[176:179], a[8:11], v[104:107], v[176:179]
v_exp_f32 v138, v138
v_mfma_f32_16x16x32_bf16 v[176:179], a[12:15], v[120:123], v[176:179]
v_exp_f32 v154, v154
v_exp_f32 v139, v139
v_mfma_f32_16x16x32_bf16 v[184:187], a[0:3], v[76:79], v[244:247]
v_exp_f32 v155, v155
v_mfma_f32_16x16x32_bf16 v[184:187], a[4:7], v[92:95], v[184:187]
v_cvt_pk_bf16_f32 v193, v130, v131
v_cvt_pk_bf16_f32 v201, v146, v147
v_mfma_f32_16x16x32_bf16 v[184:187], a[8:11], v[108:111], v[184:187]
v_exp_f32 v132, v132
v_exp_f32 v148, v148
v_mfma_f32_16x16x32_bf16 v[184:187], a[12:15], v[124:127], v[184:187]
v_exp_f32 v133, v133
s_waitcnt lgkmcnt(0)
v_mfma_f32_16x16x32_bf16 v[164:167], a[16:19], v[64:67], v[224:227]
ds_read_b128 a[0:3], v9 offset:8192
v_exp_f32 v149, v149
v_mfma_f32_16x16x32_bf16 v[164:167], a[20:23], v[80:83], v[164:167]
v_cvt_pk_bf16_f32 v196, v136, v137
v_cvt_pk_bf16_f32 v204, v152, v153
v_exp_f32 v134, v134
v_mfma_f32_16x16x32_bf16 v[164:167], a[24:27], v[96:99], v[164:167]
v_exp_f32 v150, v150
v_mfma_f32_16x16x32_bf16 v[164:167], a[28:31], v[112:115], v[164:167]
v_exp_f32 v135, v135
v_mfma_f32_16x16x32_bf16 v[172:175], a[16:19], v[68:71], v[228:231]
ds_read_b128 a[4:7], v9 offset:9216
v_exp_f32 v151, v151
v_cvt_pk_bf16_f32 v197, v138, v139
v_mfma_f32_16x16x32_bf16 v[172:175], a[20:23], v[84:87], v[172:175]
v_cvt_pk_bf16_f32 v205, v154, v155
v_exp_f32 v140, v140
v_mfma_f32_16x16x32_bf16 v[172:175], a[24:27], v[100:103], v[172:175]
v_exp_f32 v156, v156
v_mfma_f32_16x16x32_bf16 v[172:175], a[28:31], v[116:119], v[172:175]
v_exp_f32 v141, v141
v_exp_f32 v157, v157
v_mfma_f32_16x16x32_bf16 v[180:183], a[16:19], v[72:75], v[248:251]
ds_read_b128 a[8:11], v9 offset:10240
v_cvt_pk_bf16_f32 v194, v132, v133
v_cvt_pk_bf16_f32 v202, v148, v149
v_mfma_f32_16x16x32_bf16 v[180:183], a[20:23], v[88:91], v[180:183]
v_exp_f32 v142, v142
v_mfma_f32_16x16x32_bf16 v[180:183], a[24:27], v[104:107], v[180:183]
v_add_u32 v8, 0x8000, v8
v_exp_f32 v158, v158
v_cvt_pk_bf16_f32 v195, v134, v135
v_mfma_f32_16x16x32_bf16 v[180:183], a[28:31], v[120:123], v[180:183]
v_exp_f32 v143, v143
v_exp_f32 v159, v159
v_mfma_f32_16x16x32_bf16 v[188:191], a[16:19], v[76:79], v[252:255]
ds_read_b128 a[12:15], v9 offset:11264
v_cvt_pk_bf16_f32 v203, v150, v151
v_mfma_f32_16x16x32_bf16 v[188:191], a[20:23], v[92:95], v[188:191]
v_cvt_pk_bf16_f32 v198, v140, v141
v_cvt_pk_bf16_f32 v206, v156, v157
v_cvt_pk_bf16_f32 v199, v142, v143
v_cvt_pk_bf16_f32 v207, v158, v159
v_mfma_f32_16x16x32_bf16 v[188:191], a[24:27], v[108:111], v[188:191]
v_mfma_f32_16x16x32_bf16 v[188:191], a[28:31], v[124:127], v[188:191]
s_waitcnt vmcnt(8)
L_plg:
v_readfirstlane_b32 s74, v21
s_cmp_ge_u32 s74, 256
s_cbranch_scc1 L_plgx
s_sleep 2
global_load_dword v21, v20, s[6:7] sc1
s_waitcnt vmcnt(0)
s_branch L_plg
L_plgx:
v_lshlrev_b32 v7, 2, v3
s_lshl_b32 s95, s40, 2
s_add_u32 s95, s95, 62914560
s_lshl_b32 s96, s41, 2
s_add_u32 s96, s96, 62914560
buffer_load_dword v28, v7, s[28:31], s95 offen offset:0 sc1
buffer_load_dword v29, v7, s[28:31], s95 offen offset:64 sc1
buffer_load_dword v30, v7, s[28:31], s96 offen offset:0 sc1
buffer_load_dword v5, v7, s[28:31], s96 offen offset:64 sc1
s_barrier
s_cmp_lg_u32 s38, 0
s_cbranch_scc1 L_sig2
s_cmp_lg_u32 s3, 0
s_cbranch_scc1 L_sig2
s_lshl_b32 s74, s4, 2
v_mov_b32 v58, 128
v_mov_b32 v59, 256
v_writelane_b32 v58, s74, 0
s_mov_b64 exec, 1
global_atomic_add v58, v59, s[6:7] sc1
s_mov_b64 exec, -1
L_sig2:
s_mov_b64 s[36:37], 0
s_lshl_b32 s44, s5, 1
s_sub_u32 s44, s44, 1
s_cmp_eq_u32 s5, 0
s_cselect_b32 s44, 0, s44
s_cselect_b32 s45, 1, 2
s_lshl_b32 s46, s5, 1
s_sub_u32 s46, 13, s46
s_cmp_eq_u32 s5, 7
s_cselect_b32 s46, 0, s46
s_cmp_eq_u32 s44, 0
s_cbranch_scc1 L_dd_x
L_dd:
s_waitcnt vmcnt(8)
s_barrier
v_mfma_f32_16x16x32_bf16 a[96:99], a[112:115], v[192:195], a[96:99]
v_exp_f32 v160, v160
v_mfma_f32_16x16x32_bf16 a[100:103], a[112:115], v[196:199], a[100:103]
v_exp_f32 v176, v176
v_mfma_f32_16x16x32_bf16 a[104:107], a[112:115], v[200:203], a[104:107]
v_mfma_f32_16x16x32_bf16 a[108:111], a[112:115], v[204:207], a[108:111]
v_exp_f32 v161, v161
s_waitcnt lgkmcnt(2)
v_mfma_f32_16x16x32_bf16 a[128:131], a[0:3], v[192:195], a[128:131]
ds_read_b128 a[16:19], v9 offset:12288
v_mfma_f32_16x16x32_bf16 a[160:163], a[0:3], v[196:199], a[160:163]
v_exp_f32 v177, v177
v_mfma_f32_16x16x32_bf16 a[192:195], a[0:3], v[200:203], a[192:195]
v_exp_f32 v162, v162
v_mfma_f32_16x16x32_bf16 a[224:227], a[0:3], v[204:207], a[224:227]
v_mfma_f32_16x16x32_bf16 a[132:135], a[4:7], v[192:195], a[132:135]
ds_read_b128 a[20:23], v9 offset:13312
s_mov_b32 m0, s33
v_mfma_f32_16x16x32_bf16 a[164:167], a[4:7], v[196:199], a[164:167]
buffer_load_dwordx4 v31, s[28:31], s32 offen offset:0 sc1 lds
v_cvt_pk_bf16_f32 v208, v160, v161
v_mfma_f32_16x16x32_bf16 a[196:199], a[4:7], v[200:203], a[196:199]
v_exp_f32 v178, v178
v_mfma_f32_16x16x32_bf16 a[228:231], a[4:7], v[204:207], a[228:231]
v_exp_f32 v163, v163
s_waitcnt lgkmcnt(2)
v_mfma_f32_16x16x32_bf16 a[136:139], a[8:11], v[192:195], a[136:139]
ds_read_b128 a[24:27], v9 offset:14336
v_cvt_pk_bf16_f32 v216, v176, v177
v_mfma_f32_16x16x32_bf16 a[168:171], a[8:11], v[196:199], a[168:171]
v_exp_f32 v179, v179
v_mfma_f32_16x16x32_bf16 a[200:203], a[8:11], v[200:203], a[200:203]
v_exp_f32 v168, v168
v_mfma_f32_16x16x32_bf16 a[232:235], a[8:11], v[204:207], a[232:235]
v_mfma_f32_16x16x32_bf16 a[140:143], a[12:15], v[192:195], a[140:143]
ds_read_b128 a[28:31], v9 offset:15360
v_cvt_pk_bf16_f32 v209, v162, v163
v_mfma_f32_16x16x32_bf16 a[172:175], a[12:15], v[196:199], a[172:175]
v_exp_f32 v184, v184
v_mfma_f32_16x16x32_bf16 a[204:207], a[12:15], v[200:203], a[204:207]
v_exp_f32 v169, v169
v_mfma_f32_16x16x32_bf16 a[236:239], a[12:15], v[204:207], a[236:239]
s_waitcnt lgkmcnt(2)
v_mfma_f32_16x16x32_bf16 a[144:147], a[16:19], v[192:195], a[144:147]
ds_read_b128 a[0:3], v8 offset:0
v_cvt_pk_bf16_f32 v217, v178, v179
v_mfma_f32_16x16x32_bf16 a[176:179], a[16:19], v[196:199], a[176:179]
buffer_load_dwordx4 v31, s[28:31], s32 offen offset:1024 sc1 lds
v_mfma_f32_16x16x32_bf16 a[208:211], a[16:19], v[200:203], a[208:211]
ds_read_b128 a[4:7], v8 offset:1024
v_mfma_f32_16x16x32_bf16 a[240:243], a[16:19], v[204:207], a[240:243]
v_exp_f32 v185, v185
v_mfma_f32_16x16x32_bf16 a[148:151], a[20:23], v[192:195], a[148:151]
ds_read_b128 a[8:11], v8 offset:2048
v_mfma_f32_16x16x32_bf16 a[180:183], a[20:23], v[196:199], a[180:183]
v_exp_f32 v170, v170
v_mfma_f32_16x16x32_bf16 a[212:215], a[20:23], v[200:203], a[212:215]
ds_read_b128 a[12:15], v8 offset:3072
v_cvt_pk_bf16_f32 v212, v168, v169
v_mfma_f32_16x16x32_bf16 a[244:247], a[20:23], v[204:207], a[244:247]
v_exp_f32 v186, v186
s_waitcnt lgkmcnt(4)
v_mfma_f32_16x16x32_bf16 a[152:155], a[24:27], v[192:195], a[152:155]
ds_read_b128 a[16:19], v8 offset:4096
v_cvt_pk_bf16_f32 v220, v184, v185
v_mfma_f32_16x16x32_bf16 a[184:187], a[24:27], v[196:199], a[184:187]
v_exp_f32 v171, v171
v_mfma_f32_16x16x32_bf16 a[216:219], a[24:27], v[200:203], a[216:219]
v_exp_f32 v187, v187
v_mfma_f32_16x16x32_bf16 a[248:251], a[24:27], v[204:207], a[248:251]
v_exp_f32 v164, v164
v_mfma_f32_16x16x32_bf16 a[156:159], a[28:31], v[192:195], a[156:159]
ds_read_b128 a[20:23], v8 offset:5120
v_mfma_f32_16x16x32_bf16 a[188:191], a[28:31], v[196:199], a[188:191]
v_exp_f32 v180, v180
v_mfma_f32_16x16x32_bf16 a[220:223], a[28:31], v[200:203], a[220:223]
v_exp_f32 v165, v165
v_mfma_f32_16x16x32_bf16 a[252:255], a[28:31], v[204:207], a[252:255]
s_waitcnt lgkmcnt(2)
v_mfma_f32_16x16x32_bf16 v[128:131], a[0:3], v[64:67], v[224:227]
ds_read_b128 a[24:27], v8 offset:6144
v_cvt_pk_bf16_f32 v213, v170, v171
v_mfma_f32_16x16x32_bf16 v[128:131], a[4:7], v[80:83], v[128:131]
buffer_load_dwordx4 v31, s[28:31], s32 offen offset:2048 sc1 lds
v_cvt_pk_bf16_f32 v221, v186, v187
v_mfma_f32_16x16x32_bf16 v[128:131], a[8:11], v[96:99], v[128:131]
v_exp_f32 v181, v181
v_mfma_f32_16x16x32_bf16 v[128:131], a[12:15], v[112:115], v[128:131]
v_exp_f32 v166, v166
v_mfma_f32_16x16x32_bf16 v[136:139], a[0:3], v[68:71], v[228:231]
ds_read_b128 a[28:31], v8 offset:7168
v_mfma_f32_16x16x32_bf16 v[136:139], a[4:7], v[84:87], v[136:139]
v_exp_f32 v182, v182
v_mfma_f32_16x16x32_bf16 v[136:139], a[8:11], v[100:103], v[136:139]
v_exp_f32 v167, v167
v_mfma_f32_16x16x32_bf16 v[136:139], a[12:15], v[116:119], v[136:139]
v_mfma_f32_16x16x32_bf16 v[144:147], a[0:3], v[72:75], v[232:235]
v_exp_f32 v183, v183
v_mfma_f32_16x16x32_bf16 v[144:147], a[4:7], v[88:91], v[144:147]
v_mfma_f32_16x16x32_bf16 v[144:147], a[8:11], v[104:107], v[144:147]
v_exp_f32 v172, v172
v_mfma_f32_16x16x32_bf16 v[144:147], a[12:15], v[120:123], v[144:147]
v_exp_f32 v188, v188
v_mfma_f32_16x16x32_bf16 v[152:155], a[0:3], v[76:79], v[236:239]
v_mfma_f32_16x16x32_bf16 v[152:155], a[4:7], v[92:95], v[152:155]
v_exp_f32 v173, v173
v_mfma_f32_16x16x32_bf16 v[152:155], a[8:11], v[108:111], v[152:155]
v_mfma_f32_16x16x32_bf16 v[152:155], a[12:15], v[124:127], v[152:155]
v_exp_f32 v189, v189
s_waitcnt lgkmcnt(0)
v_mfma_f32_16x16x32_bf16 v[132:135], a[16:19], v[64:67], v[224:227]
ds_read_b128 a[0:3], v9 offset:24576
v_cvt_pk_bf16_f32 v210, v164, v165
v_mfma_f32_16x16x32_bf16 v[132:135], a[20:23], v[80:83], v[132:135]
buffer_load_dwordx4 v31, s[28:31], s32 offen offset:3072 sc1 lds
v_cvt_pk_bf16_f32 v218, v180, v181
v_mfma_f32_16x16x32_bf16 v[132:135], a[24:27], v[96:99], v[132:135]
v_exp_f32 v174, v174
v_mfma_f32_16x16x32_bf16 v[132:135], a[28:31], v[112:115], v[132:135]
v_mfma_f32_16x16x32_bf16 v[140:143], a[16:19], v[68:71], v[228:231]
ds_read_b128 a[4:7], v9 offset:25600
v_cvt_pk_bf16_f32 v211, v166, v167
v_mfma_f32_16x16x32_bf16 v[140:143], a[20:23], v[84:87], v[140:143]
v_exp_f32 v190, v190
v_mfma_f32_16x16x32_bf16 v[140:143], a[24:27], v[100:103], v[140:143]
v_exp_f32 v175, v175
v_mfma_f32_16x16x32_bf16 v[140:143], a[28:31], v[116:119], v[140:143]
v_mfma_f32_16x16x32_bf16 v[148:151], a[16:19], v[72:75], v[232:235]
ds_read_b128 a[8:11], v9 offset:26624
v_cvt_pk_bf16_f32 v219, v182, v183
v_mfma_f32_16x16x32_bf16 v[148:151], a[20:23], v[88:91], v[148:151]
v_exp_f32 v191, v191
v_mfma_f32_16x16x32_bf16 v[148:151], a[24:27], v[104:107], v[148:151]
v_cvt_pk_bf16_f32 v214, v172, v173
v_mfma_f32_16x16x32_bf16 v[148:151], a[28:31], v[120:123], v[148:151]
v_cvt_pk_bf16_f32 v222, v188, v189
v_mfma_f32_16x16x32_bf16 v[156:159], a[16:19], v[76:79], v[236:239]
ds_read_b128 a[12:15], v9 offset:27648
v_cvt_pk_bf16_f32 v215, v174, v175
v_mfma_f32_16x16x32_bf16 v[156:159], a[20:23], v[92:95], v[156:159]
v_cvt_pk_bf16_f32 v223, v190, v191
v_mfma_f32_16x16x32_bf16 v[156:159], a[24:27], v[108:111], v[156:159]
v_mfma_f32_16x16x32_bf16 v[156:159], a[28:31], v[124:127], v[156:159]
v_mfma_f32_16x16x32_bf16 a[96:99], a[112:115], v[208:211], a[96:99]
v_exp_f32 v128, v128
v_mfma_f32_16x16x32_bf16 a[100:103], a[112:115], v[212:215], a[100:103]
v_exp_f32 v144, v144
v_mfma_f32_16x16x32_bf16 a[104:107], a[112:115], v[216:219], a[104:107]
v_mfma_f32_16x16x32_bf16 a[108:111], a[112:115], v[220:223], a[108:111]
v_exp_f32 v129, v129
s_waitcnt lgkmcnt(2)
v_mfma_f32_16x16x32_bf16 a[128:131], a[0:3], v[208:211], a[128:131]
ds_read_b128 a[16:19], v9 offset:28672
v_mfma_f32_16x16x32_bf16 a[160:163], a[0:3], v[212:215], a[160:163]
v_exp_f32 v145, v145
v_mfma_f32_16x16x32_bf16 a[192:195], a[0:3], v[216:219], a[192:195]
v_exp_f32 v130, v130
v_mfma_f32_16x16x32_bf16 a[224:227], a[0:3], v[220:223], a[224:227]
v_mfma_f32_16x16x32_bf16 a[132:135], a[4:7], v[208:211], a[132:135]
ds_read_b128 a[20:23], v9 offset:29696
s_add_u32 m0, s33, 4096
s_add_u32 s32, s32, 4096
v_mfma_f32_16x16x32_bf16 a[164:167], a[4:7], v[212:215], a[164:167]
buffer_load_dwordx4 v31, s[28:31], s32 offen offset:0 sc1 lds
v_cvt_pk_bf16_f32 v192, v128, v129
v_mfma_f32_16x16x32_bf16 a[196:199], a[4:7], v[216:219], a[196:199]
v_exp_f32 v146, v146
v_mfma_f32_16x16x32_bf16 a[228:231], a[4:7], v[220:223], a[228:231]
v_exp_f32 v131, v131
s_waitcnt lgkmcnt(2)
v_mfma_f32_16x16x32_bf16 a[136:139], a[8:11], v[208:211], a[136:139]
ds_read_b128 a[24:27], v9 offset:30720
v_cvt_pk_bf16_f32 v200, v144, v145
v_mfma_f32_16x16x32_bf16 a[168:171], a[8:11], v[212:215], a[168:171]
v_exp_f32 v147, v147
v_mfma_f32_16x16x32_bf16 a[200:203], a[8:11], v[216:219], a[200:203]
v_exp_f32 v136, v136
v_mfma_f32_16x16x32_bf16 a[232:235], a[8:11], v[220:223], a[232:235]
v_mfma_f32_16x16x32_bf16 a[140:143], a[12:15], v[208:211], a[140:143]
ds_read_b128 a[28:31], v9 offset:31744
v_cvt_pk_bf16_f32 v193, v130, v131
v_mfma_f32_16x16x32_bf16 a[172:175], a[12:15], v[212:215], a[172:175]
v_exp_f32 v152, v152
v_mfma_f32_16x16x32_bf16 a[204:207], a[12:15], v[216:219], a[204:207]
v_exp_f32 v137, v137
v_mfma_f32_16x16x32_bf16 a[236:239], a[12:15], v[220:223], a[236:239]
s_waitcnt lgkmcnt(2)
v_mfma_f32_16x16x32_bf16 a[144:147], a[16:19], v[208:211], a[144:147]
ds_read_b128 a[0:3], v8 offset:16384
v_cvt_pk_bf16_f32 v201, v146, v147
v_mfma_f32_16x16x32_bf16 a[176:179], a[16:19], v[212:215], a[176:179]
buffer_load_dwordx4 v31, s[28:31], s32 offen offset:1024 sc1 lds
v_mfma_f32_16x16x32_bf16 a[208:211], a[16:19], v[216:219], a[208:211]
ds_read_b128 a[4:7], v8 offset:17408
v_mfma_f32_16x16x32_bf16 a[240:243], a[16:19], v[220:223], a[240:243]
v_exp_f32 v153, v153
v_mfma_f32_16x16x32_bf16 a[148:151], a[20:23], v[208:211], a[148:151]
ds_read_b128 a[8:11], v8 offset:18432
v_mfma_f32_16x16x32_bf16 a[180:183], a[20:23], v[212:215], a[180:183]
v_exp_f32 v138, v138
v_mfma_f32_16x16x32_bf16 a[212:215], a[20:23], v[216:219], a[212:215]
ds_read_b128 a[12:15], v8 offset:19456
s_add_u32 s34, s34, 1
v_mfma_f32_16x16x32_bf16 a[244:247], a[20:23], v[220:223], a[244:247]
v_exp_f32 v154, v154
s_waitcnt lgkmcnt(4)
v_mfma_f32_16x16x32_bf16 a[152:155], a[24:27], v[208:211], a[152:155]
ds_read_b128 a[16:19], v8 offset:20480
v_cvt_pk_bf16_f32 v196, v136, v137
v_mfma_f32_16x16x32_bf16 a[184:187], a[24:27], v[212:215], a[184:187]
v_exp_f32 v139, v139
v_mfma_f32_16x16x32_bf16 a[216:219], a[24:27], v[216:219], a[216:219]
v_mov_b32 v9, v8
v_cvt_pk_bf16_f32 v204, v152, v153
v_mfma_f32_16x16x32_bf16 a[248:251], a[24:27], v[220:223], a[248:251]
v_exp_f32 v155, v155
v_mfma_f32_16x16x32_bf16 a[156:159], a[28:31], v[208:211], a[156:159]
ds_read_b128 a[20:23], v8 offset:21504
v_mfma_f32_16x16x32_bf16 a[188:191], a[28:31], v[212:215], a[188:191]
v_exp_f32 v132, v132
v_mfma_f32_16x16x32_bf16 a[220:223], a[28:31], v[216:219], a[220:223]
v_exp_f32 v148, v148
v_mfma_f32_16x16x32_bf16 a[252:255], a[28:31], v[220:223], a[252:255]
v_exp_f32 v133, v133
s_waitcnt lgkmcnt(2)
v_mfma_f32_16x16x32_bf16 v[160:163], a[0:3], v[64:67], v[224:227]
ds_read_b128 a[24:27], v8 offset:22528
v_cvt_pk_bf16_f32 v197, v138, v139
v_mfma_f32_16x16x32_bf16 v[160:163], a[4:7], v[80:83], v[160:163]
buffer_load_dwordx4 v31, s[28:31], s32 offen offset:2048 sc1 lds
v_cvt_pk_bf16_f32 v205, v154, v155
v_mfma_f32_16x16x32_bf16 v[160:163], a[8:11], v[96:99], v[160:163]
v_exp_f32 v149, v149
v_mfma_f32_16x16x32_bf16 v[160:163], a[12:15], v[112:115], v[160:163]
v_exp_f32 v134, v134
v_mfma_f32_16x16x32_bf16 v[168:171], a[0:3], v[68:71], v[228:231]
ds_read_b128 a[28:31], v8 offset:23552
v_mfma_f32_16x16x32_bf16 v[168:171], a[4:7], v[84:87], v[168:171]
v_exp_f32 v150, v150
v_mfma_f32_16x16x32_bf16 v[168:171], a[8:11], v[100:103], v[168:171]
v_exp_f32 v135, v135
v_mfma_f32_16x16x32_bf16 v[168:171], a[12:15], v[116:119], v[168:171]
v_mfma_f32_16x16x32_bf16 v[176:179], a[0:3], v[72:75], v[232:235]
v_exp_f32 v151, v151
v_mfma_f32_16x16x32_bf16 v[176:179], a[4:7], v[88:91], v[176:179]
v_mfma_f32_16x16x32_bf16 v[176:179], a[8:11], v[104:107], v[176:179]
v_exp_f32 v140, v140
v_mfma_f32_16x16x32_bf16 v[176:179], a[12:15], v[120:123], v[176:179]
v_exp_f32 v156, v156
v_mfma_f32_16x16x32_bf16 v[184:187], a[0:3], v[76:79], v[236:239]
v_mfma_f32_16x16x32_bf16 v[184:187], a[4:7], v[92:95], v[184:187]
v_exp_f32 v141, v141
v_mfma_f32_16x16x32_bf16 v[184:187], a[8:11], v[108:111], v[184:187]
v_mfma_f32_16x16x32_bf16 v[184:187], a[12:15], v[124:127], v[184:187]
v_exp_f32 v157, v157
s_waitcnt lgkmcnt(0)
v_mfma_f32_16x16x32_bf16 v[164:167], a[16:19], v[64:67], v[224:227]
ds_read_b128 a[0:3], v9 offset:8192
v_cvt_pk_bf16_f32 v194, v132, v133
v_mfma_f32_16x16x32_bf16 v[164:167], a[20:23], v[80:83], v[164:167]
buffer_load_dwordx4 v31, s[28:31], s32 offen offset:3072 sc1 lds
s_add_u32 s32, s32, 28672
s_add_u32 s33, s33, 0x8000
s_and_b32 s33, s33, 0x1ffff
v_mfma_f32_16x16x32_bf16 v[164:167], a[24:27], v[96:99], v[164:167]
v_cvt_pk_bf16_f32 v202, v148, v149
v_cvt_pk_bf16_f32 v195, v134, v135
v_mfma_f32_16x16x32_bf16 v[164:167], a[28:31], v[112:115], v[164:167]
v_exp_f32 v142, v142
v_mfma_f32_16x16x32_bf16 v[172:175], a[16:19], v[68:71], v[228:231]
ds_read_b128 a[4:7], v9 offset:9216
v_cvt_pk_bf16_f32 v203, v150, v151
v_mfma_f32_16x16x32_bf16 v[172:175], a[20:23], v[84:87], v[172:175]
v_exp_f32 v158, v158
v_mfma_f32_16x16x32_bf16 v[172:175], a[24:27], v[100:103], v[172:175]
v_add_u32 v8, 0x8000, v8
v_mfma_f32_16x16x32_bf16 v[172:175], a[28:31], v[116:119], v[172:175]
v_exp_f32 v143, v143
v_mfma_f32_16x16x32_bf16 v[180:183], a[16:19], v[72:75], v[232:235]
ds_read_b128 a[8:11], v9 offset:10240
v_mfma_f32_16x16x32_bf16 v[180:183], a[20:23], v[88:91], v[180:183]
v_exp_f32 v159, v159
v_mfma_f32_16x16x32_bf16 v[180:183], a[24:27], v[104:107], v[180:183]
v_and_b32 v8, 0x1ffff, v8
v_cvt_pk_bf16_f32 v198, v140, v141
v_mfma_f32_16x16x32_bf16 v[180:183], a[28:31], v[120:123], v[180:183]
v_cvt_pk_bf16_f32 v206, v156, v157
v_mfma_f32_16x16x32_bf16 v[188:191], a[16:19], v[76:79], v[236:239]
ds_read_b128 a[12:15], v9 offset:11264
v_cvt_pk_bf16_f32 v199, v142, v143
v_mfma_f32_16x16x32_bf16 v[188:191], a[20:23], v[92:95], v[188:191]
v_cvt_pk_bf16_f32 v207, v158, v159
v_mfma_f32_16x16x32_bf16 v[188:191], a[24:27], v[108:111], v[188:191]
s_sub_u32 s44, s44, 1
s_cmp_lg_u32 s44, 0
v_mfma_f32_16x16x32_bf16 v[188:191], a[28:31], v[124:127], v[188:191]
s_cbranch_scc1 L_dd
L_dd_x:
s_cmp_eq_u32 s45, 0
s_cbranch_scc1 L_dm_x
L_dm:
s_lshl_b32 s74, s34, 6
s_sub_u32 s74, s41, s74
v_sub_u32 v11, s74, v10
s_waitcnt vmcnt(8)
s_barrier
v_mfma_f32_16x16x32_bf16 a[96:99], a[112:115], v[192:195], a[96:99]
v_cmp_le_i32_e64 s[48:49], -16, v11
v_mfma_f32_16x16x32_bf16 a[100:103], a[112:115], v[196:199], a[100:103]
v_cmp_le_i32_e64 s[50:51], -15, v11
v_mfma_f32_16x16x32_bf16 a[104:107], a[112:115], v[200:203], a[104:107]
v_cmp_le_i32_e64 s[52:53], -14, v11
v_exp_f32 v160, v160
v_mfma_f32_16x16x32_bf16 a[108:111], a[112:115], v[204:207], a[108:111]
v_cmp_le_i32_e64 s[54:55], -13, v11
s_waitcnt lgkmcnt(2)
v_mfma_f32_16x16x32_bf16 a[128:131], a[0:3], v[192:195], a[128:131]
ds_read_b128 a[16:19], v9 offset:12288
v_cmp_le_i32_e64 s[56:57], 0, v11
v_mfma_f32_16x16x32_bf16 a[160:163], a[0:3], v[196:199], a[160:163]
v_exp_f32 v176, v176
v_mfma_f32_16x16x32_bf16 a[192:195], a[0:3], v[200:203], a[192:195]
v_cmp_le_i32_e64 s[58:59], 1, v11
v_exp_f32 v161, v161
v_mfma_f32_16x16x32_bf16 a[224:227], a[0:3], v[204:207], a[224:227]
v_cmp_le_i32_e64 s[60:61], 2, v11
v_exp_f32 v177, v177
v_mfma_f32_16x16x32_bf16 a[132:135], a[4:7], v[192:195], a[132:135]
ds_read_b128 a[20:23], v9 offset:13312
s_mov_b32 m0, s33
v_mfma_f32_16x16x32_bf16 a[164:167], a[4:7], v[196:199], a[164:167]
buffer_load_dwordx4 v31, s[28:31], s32 offen offset:0 sc1 lds
v_cmp_le_i32_e64 s[62:63], 3, v11
v_mfma_f32_16x16x32_bf16 a[196:199], a[4:7], v[200:203], a[196:199]
v_cmp_le_i32_e64 s[64:65], 16, v11
v_cmp_le_i32_e64 s[66:67], 17, v11
v_mfma_f32_16x16x32_bf16 a[228:231], a[4:7], v[204:207], a[228:231]
v_exp_f32 v162, v162
v_cvt_pk_bf16_f32 v208, v160, v161
s_waitcnt lgkmcnt(2)
v_mfma_f32_16x16x32_bf16 a[136:139], a[8:11], v[192:195], a[136:139]
ds_read_b128 a[24:27], v9 offset:14336
v_cmp_le_i32_e64 s[90:91], 18, v11
v_cvt_pk_bf16_f32 v216, v176, v177
v_mfma_f32_16x16x32_bf16 a[168:171], a[8:11], v[196:199], a[168:171]
v_cmp_le_i32_e64 s[92:93], 19, v11
v_exp_f32 v178, v178
v_mfma_f32_16x16x32_bf16 a[200:203], a[8:11], v[200:203], a[200:203]
v_cndmask_b32_e64 v240, v16, v232, s[56:57]
v_exp_f32 v163, v163
v_mfma_f32_16x16x32_bf16 a[232:235], a[8:11], v[204:207], a[232:235]
v_cndmask_b32_e64 v241, v16, v232, s[58:59]
v_mfma_f32_16x16x32_bf16 a[140:143], a[12:15], v[192:195], a[140:143]
ds_read_b128 a[28:31], v9 offset:15360
v_cndmask_b32_e64 v242, v16, v232, s[60:61]
v_mfma_f32_16x16x32_bf16 a[172:175], a[12:15], v[196:199], a[172:175]
v_exp_f32 v179, v179
v_mfma_f32_16x16x32_bf16 a[204:207], a[12:15], v[200:203], a[204:207]
v_cndmask_b32_e64 v243, v16, v232, s[62:63]
v_exp_f32 v168, v168
v_mfma_f32_16x16x32_bf16 a[236:239], a[12:15], v[204:207], a[236:239]
v_cndmask_b32_e64 v244, v16, v236, s[48:49]
v_exp_f32 v184, v184
s_waitcnt lgkmcnt(2)
v_mfma_f32_16x16x32_bf16 a[144:147], a[16:19], v[192:195], a[144:147]
ds_read_b128 a[0:3], v8 offset:0
v_cndmask_b32_e64 v245, v16, v236, s[50:51]
v_mfma_f32_16x16x32_bf16 a[176:179], a[16:19], v[196:199], a[176:179]
buffer_load_dwordx4 v31, s[28:31], s32 offen offset:1024 sc1 lds
v_cndmask_b32_e64 v246, v16, v236, s[52:53]
v_cvt_pk_bf16_f32 v209, v162, v163
v_mfma_f32_16x16x32_bf16 a[208:211], a[16:19], v[200:203], a[208:211]
ds_read_b128 a[4:7], v8 offset:1024
v_cndmask_b32_e64 v247, v16, v236, s[54:55]
v_cvt_pk_bf16_f32 v217, v178, v179
v_mfma_f32_16x16x32_bf16 a[240:243], a[16:19], v[204:207], a[240:243]
v_exp_f32 v169, v169
v_mfma_f32_16x16x32_bf16 a[148:151], a[20:23], v[192:195], a[148:151]
ds_read_b128 a[8:11], v8 offset:2048
v_cndmask_b32_e64 v248, v16, v232, s[64:65]
v_mfma_f32_16x16x32_bf16 a[180:183], a[20:23], v[196:199], a[180:183]
v_cndmask_b32_e64 v249, v16, v232, s[66:67]
v_exp_f32 v185, v185
v_mfma_f32_16x16x32_bf16 a[212:215], a[20:23], v[200:203], a[212:215]
ds_read_b128 a[12:15], v8 offset:3072
v_cndmask_b32_e64 v250, v16, v232, s[90:91]
v_mfma_f32_16x16x32_bf16 a[244:247], a[20:23], v[204:207], a[244:247]
v_cndmask_b32_e64 v251, v16, v232, s[92:93]
v_exp_f32 v170, v170
s_waitcnt lgkmcnt(4)
v_mfma_f32_16x16x32_bf16 a[152:155], a[24:27], v[192:195], a[152:155]
ds_read_b128 a[16:19], v8 offset:4096
v_cndmask_b32_e64 v252, v16, v236, s[56:57]
v_cvt_pk_bf16_f32 v212, v168, v169
v_mfma_f32_16x16x32_bf16 a[184:187], a[24:27], v[196:199], a[184:187]
v_exp_f32 v186, v186
v_mfma_f32_16x16x32_bf16 a[216:219], a[24:27], v[200:203], a[216:219]
v_cndmask_b32_e64 v253, v16, v236, s[58:59]
v_exp_f32 v171, v171
v_mfma_f32_16x16x32_bf16 a[248:251], a[24:27], v[204:207], a[248:251]
v_cndmask_b32_e64 v254, v16, v236, s[60:61]
v_exp_f32 v187, v187
v_mfma_f32_16x16x32_bf16 a[156:159], a[28:31], v[192:195], a[156:159]
ds_read_b128 a[20:23], v8 offset:5120
v_cndmask_b32_e64 v255, v16, v236, s[62:63]
v_mfma_f32_16x16x32_bf16 a[188:191], a[28:31], v[196:199], a[188:191]
v_subrev_u32 v11, 32, v11
v_exp_f32 v164, v164
v_mfma_f32_16x16x32_bf16 a[220:223], a[28:31], v[200:203], a[220:223]
v_exp_f32 v180, v180
v_mfma_f32_16x16x32_bf16 a[252:255], a[28:31], v[204:207], a[252:255]
v_exp_f32 v165, v165
s_waitcnt lgkmcnt(2)
v_mfma_f32_16x16x32_bf16 v[128:131], a[0:3], v[64:67], v[224:227]
ds_read_b128 a[24:27], v8 offset:6144
v_cvt_pk_bf16_f32 v220, v184, v185
v_mfma_f32_16x16x32_bf16 v[128:131], a[4:7], v[80:83], v[128:131]
buffer_load_dwordx4 v31, s[28:31], s32 offen offset:2048 sc1 lds
v_cvt_pk_bf16_f32 v213, v170, v171
v_mfma_f32_16x16x32_bf16 v[128:131], a[8:11], v[96:99], v[128:131]
v_exp_f32 v181, v181
v_mfma_f32_16x16x32_bf16 v[128:131], a[12:15], v[112:115], v[128:131]
v_exp_f32 v166, v166
v_mfma_f32_16x16x32_bf16 v[136:139], a[0:3], v[68:71], v[228:231]
ds_read_b128 a[28:31], v8 offset:7168
v_cvt_pk_bf16_f32 v221, v186, v187
v_mfma_f32_16x16x32_bf16 v[136:139], a[4:7], v[84:87], v[136:139]
v_exp_f32 v182, v182
v_mfma_f32_16x16x32_bf16 v[136:139], a[8:11], v[100:103], v[136:139]
v_exp_f32 v167, v167
v_mfma_f32_16x16x32_bf16 v[136:139], a[12:15], v[116:119], v[136:139]
v_exp_f32 v183, v183
v_mfma_f32_16x16x32_bf16 v[144:147], a[0:3], v[72:75], v[240:243]
v_exp_f32 v172, v172
v_mfma_f32_16x16x32_bf16 v[144:147], a[4:7], v[88:91], v[144:147]
v_exp_f32 v188, v188
v_mfma_f32_16x16x32_bf16 v[144:147], a[8:11], v[104:107], v[144:147]
v_exp_f32 v173, v173
v_mfma_f32_16x16x32_bf16 v[144:147], a[12:15], v[120:123], v[144:147]
v_exp_f32 v189, v189
v_mfma_f32_16x16x32_bf16 v[152:155], a[0:3], v[76:79], v[244:247]
v_exp_f32 v174, v174
v_mfma_f32_16x16x32_bf16 v[152:155], a[4:7], v[92:95], v[152:155]
v_exp_f32 v190, v190
v_mfma_f32_16x16x32_bf16 v[152:155], a[8:11], v[108:111], v[152:155]
v_exp_f32 v175, v175
v_mfma_f32_16x16x32_bf16 v[152:155], a[12:15], v[124:127], v[152:155]
v_exp_f32 v191, v191
s_waitcnt lgkmcnt(0)
v_mfma_f32_16x16x32_bf16 v[132:135], a[16:19], v[64:67], v[224:227]
ds_read_b128 a[0:3], v9 offset:24576
v_cvt_pk_bf16_f32 v210, v164, v165
v_mfma_f32_16x16x32_bf16 v[132:135], a[20:23], v[80:83], v[132:135]
buffer_load_dwordx4 v31, s[28:31], s32 offen offset:3072 sc1 lds
v_cvt_pk_bf16_f32 v218, v180, v181
v_mfma_f32_16x16x32_bf16 v[132:135], a[24:27], v[96:99], v[132:135]
v_cvt_pk_bf16_f32 v211, v166, v167
v_cvt_pk_bf16_f32 v219, v182, v183
v_mfma_f32_16x16x32_bf16 v[132:135], a[28:31], v[112:115], v[132:135]
v_cvt_pk_bf16_f32 v214, v172, v173
v_cvt_pk_bf16_f32 v222, v188, v189
v_mfma_f32_16x16x32_bf16 v[140:143], a[16:19], v[68:71], v[228:231]
ds_read_b128 a[4:7], v9 offset:25600
v_cvt_pk_bf16_f32 v215, v174, v175
v_mfma_f32_16x16x32_bf16 v[140:143], a[20:23], v[84:87], v[140:143]
v_cvt_pk_bf16_f32 v223, v190, v191
v_mfma_f32_16x16x32_bf16 v[140:143], a[24:27], v[100:103], v[140:143]
v_mfma_f32_16x16x32_bf16 v[140:143], a[28:31], v[116:119], v[140:143]
v_mfma_f32_16x16x32_bf16 v[148:151], a[16:19], v[72:75], v[248:251]
ds_read_b128 a[8:11], v9 offset:26624
v_mfma_f32_16x16x32_bf16 v[148:151], a[20:23], v[88:91], v[148:151]
v_mfma_f32_16x16x32_bf16 v[148:151], a[24:27], v[104:107], v[148:151]
v_mfma_f32_16x16x32_bf16 v[148:151], a[28:31], v[120:123], v[148:151]
v_mfma_f32_16x16x32_bf16 v[156:159], a[16:19], v[76:79], v[252:255]
ds_read_b128 a[12:15], v9 offset:27648
v_mfma_f32_16x16x32_bf16 v[156:159], a[20:23], v[92:95], v[156:159]
v_mfma_f32_16x16x32_bf16 v[156:159], a[24:27], v[108:111], v[156:159]
v_mfma_f32_16x16x32_bf16 v[156:159], a[28:31], v[124:127], v[156:159]
v_mfma_f32_16x16x32_bf16 a[96:99], a[112:115], v[208:211], a[96:99]
v_cmp_le_i32_e64 s[48:49], -16, v11
v_mfma_f32_16x16x32_bf16 a[100:103], a[112:115], v[212:215], a[100:103]
v_cmp_le_i32_e64 s[50:51], -15, v11
v_mfma_f32_16x16x32_bf16 a[104:107], a[112:115], v[216:219], a[104:107]
v_cmp_le_i32_e64 s[52:53], -14, v11
v_exp_f32 v128, v128
v_mfma_f32_16x16x32_bf16 a[108:111], a[112:115], v[220:223], a[108:111]
v_cmp_le_i32_e64 s[54:55], -13, v11
s_waitcnt lgkmcnt(2)
v_mfma_f32_16x16x32_bf16 a[128:131], a[0:3], v[208:211], a[128:131]
ds_read_b128 a[16:19], v9 offset:28672
v_exp_f32 v144, v144
v_mfma_f32_16x16x32_bf16 a[160:163], a[0:3], v[212:215], a[160:163]
v_cmp_le_i32_e64 s[56:57], 0, v11
v_mfma_f32_16x16x32_bf16 a[192:195], a[0:3], v[216:219], a[192:195]
v_cmp_le_i32_e64 s[58:59], 1, v11
v_exp_f32 v129, v129
v_mfma_f32_16x16x32_bf16 a[224:227], a[0:3], v[220:223], a[224:227]
v_cmp_le_i32_e64 s[60:61], 2, v11
v_exp_f32 v145, v145
v_mfma_f32_16x16x32_bf16 a[132:135], a[4:7], v[208:211], a[132:135]
ds_read_b128 a[20:23], v9 offset:29696
s_add_u32 m0, s33, 4096
s_add_u32 s32, s32, 4096
v_mfma_f32_16x16x32_bf16 a[164:167], a[4:7], v[212:215], a[164:167]
buffer_load_dwordx4 v31, s[28:31], s32 offen offset:0 sc1 lds
v_cmp_le_i32_e64 s[62:63], 3, v11
v_mfma_f32_16x16x32_bf16 a[196:199], a[4:7], v[216:219], a[196:199]
v_cmp_le_i32_e64 s[64:65], 16, v11
v_exp_f32 v130, v130
v_mfma_f32_16x16x32_bf16 a[228:231], a[4:7], v[220:223], a[228:231]
v_cmp_le_i32_e64 s[66:67], 17, v11
v_exp_f32 v146, v146
s_waitcnt lgkmcnt(2)
v_mfma_f32_16x16x32_bf16 a[136:139], a[8:11], v[208:211], a[136:139]
ds_read_b128 a[24:27], v9 offset:30720
v_cmp_le_i32_e64 s[90:91], 18, v11
v_cvt_pk_bf16_f32 v192, v128, v129
v_mfma_f32_16x16x32_bf16 a[168:171], a[8:11], v[212:215], a[168:171]
v_cmp_le_i32_e64 s[92:93], 19, v11
v_exp_f32 v131, v131
v_mfma_f32_16x16x32_bf16 a[200:203], a[8:11], v[216:219], a[200:203]
v_exp_f32 v147, v147
v_mfma_f32_16x16x32_bf16 a[232:235], a[8:11], v[220:223], a[232:235]
v_cndmask_b32_e64 v240, v16, v232, s[56:57]
v_cvt_pk_bf16_f32 v200, v144, v145
v_mfma_f32_16x16x32_bf16 a[140:143], a[12:15], v[208:211], a[140:143]
ds_read_b128 a[28:31], v9 offset:31744
v_cndmask_b32_e64 v241, v16, v232, s[58:59]
v_mfma_f32_16x16x32_bf16 a[172:175], a[12:15], v[212:215], a[172:175]
v_cndmask_b32_e64 v242, v16, v232, s[60:61]
v_exp_f32 v136, v136
v_mfma_f32_16x16x32_bf16 a[204:207], a[12:15], v[216:219], a[204:207]
v_cndmask_b32_e64 v243, v16, v232, s[62:63]
v_cvt_pk_bf16_f32 v193, v130, v131
v_mfma_f32_16x16x32_bf16 a[236:239], a[12:15], v[220:223], a[236:239]
v_exp_f32 v152, v152
s_waitcnt lgkmcnt(2)
v_mfma_f32_16x16x32_bf16 a[144:147], a[16:19], v[208:211], a[144:147]
ds_read_b128 a[0:3], v8 offset:16384
v_cndmask_b32_e64 v244, v16, v236, s[48:49]
v_mfma_f32_16x16x32_bf16 a[176:179], a[16:19], v[212:215], a[176:179]
buffer_load_dwordx4 v31, s[28:31], s32 offen offset:1024 sc1 lds
v_cndmask_b32_e64 v245, v16, v236, s[50:51]
v_cvt_pk_bf16_f32 v201, v146, v147
v_mfma_f32_16x16x32_bf16 a[208:211], a[16:19], v[216:219], a[208:211]
ds_read_b128 a[4:7], v8 offset:17408
v_cndmask_b32_e64 v246, v16, v236, s[52:53]
v_mfma_f32_16x16x32_bf16 a[240:243], a[16:19], v[220:223], a[240:243]
v_cndmask_b32_e64 v247, v16, v236, s[54:55]
v_exp_f32 v137, v137
v_mfma_f32_16x16x32_bf16 a[148:151], a[20:23], v[208:211], a[148:151]
ds_read_b128 a[8:11], v8 offset:18432
v_exp_f32 v153, v153
v_mfma_f32_16x16x32_bf16 a[180:183], a[20:23], v[212:215], a[180:183]
v_cndmask_b32_e64 v248, v16, v232, s[64:65]
v_exp_f32 v138, v138
v_mfma_f32_16x16x32_bf16 a[212:215], a[20:23], v[216:219], a[212:215]
ds_read_b128 a[12:15], v8 offset:19456
s_add_u32 s34, s34, 1
v_mfma_f32_16x16x32_bf16 a[244:247], a[20:23], v[220:223], a[244:247]
v_cndmask_b32_e64 v249, v16, v232, s[66:67]
v_cndmask_b32_e64 v250, v16, v232, s[90:91]
v_cvt_pk_bf16_f32 v196, v136, v137
s_waitcnt lgkmcnt(4)
v_mfma_f32_16x16x32_bf16 a[152:155], a[24:27], v[208:211], a[152:155]
ds_read_b128 a[16:19], v8 offset:20480
v_cndmask_b32_e64 v251, v16, v232, s[92:93]
v_cvt_pk_bf16_f32 v204, v152, v153
v_mfma_f32_16x16x32_bf16 a[184:187], a[24:27], v[212:215], a[184:187]
v_exp_f32 v154, v154
v_mfma_f32_16x16x32_bf16 a[216:219], a[24:27], v[216:219], a[216:219]
v_mov_b32 v9, v8
v_cndmask_b32_e64 v252, v16, v236, s[56:57]
v_mfma_f32_16x16x32_bf16 a[248:251], a[24:27], v[220:223], a[248:251]
v_cndmask_b32_e64 v253, v16, v236, s[58:59]
v_exp_f32 v139, v139
v_mfma_f32_16x16x32_bf16 a[156:159], a[28:31], v[208:211], a[156:159]
ds_read_b128 a[20:23], v8 offset:21504
v_cndmask_b32_e64 v254, v16, v236, s[60:61]
v_mfma_f32_16x16x32_bf16 a[188:191], a[28:31], v[212:215], a[188:191]
v_cndmask_b32_e64 v255, v16, v236, s[62:63]
v_exp_f32 v155, v155
v_mfma_f32_16x16x32_bf16 a[220:223], a[28:31], v[216:219], a[220:223]
v_exp_f32 v132, v132
v_mfma_f32_16x16x32_bf16 a[252:255], a[28:31], v[220:223], a[252:255]
v_exp_f32 v148, v148
s_waitcnt lgkmcnt(2)
v_mfma_f32_16x16x32_bf16 v[160:163], a[0:3], v[64:67], v[224:227]
ds_read_b128 a[24:27], v8 offset:22528
v_cvt_pk_bf16_f32 v197, v138, v139
v_mfma_f32_16x16x32_bf16 v[160:163], a[4:7], v[80:83], v[160:163]
buffer_load_dwordx4 v31, s[28:31], s32 offen offset:2048 sc1 lds
v_cvt_pk_bf16_f32 v205, v154, v155
v_mfma_f32_16x16x32_bf16 v[160:163], a[8:11], v[96:99], v[160:163]
v_exp_f32 v133, v133
v_mfma_f32_16x16x32_bf16 v[160:163], a[12:15], v[112:115], v[160:163]
v_exp_f32 v149, v149
v_mfma_f32_16x16x32_bf16 v[168:171], a[0:3], v[68:71], v[228:231]
ds_read_b128 a[28:31], v8 offset:23552
v_mfma_f32_16x16x32_bf16 v[168:171], a[4:7], v[84:87], v[168:171]
v_exp_f32 v134, v134
v_mfma_f32_16x16x32_bf16 v[168:171], a[8:11], v[100:103], v[168:171]
v_exp_f32 v150, v150
v_mfma_f32_16x16x32_bf16 v[168:171], a[12:15], v[116:119], v[168:171]
v_exp_f32 v135, v135
v_mfma_f32_16x16x32_bf16 v[176:179], a[0:3], v[72:75], v[240:243]
v_exp_f32 v151, v151
v_mfma_f32_16x16x32_bf16 v[176:179], a[4:7], v[88:91], v[176:179]
v_exp_f32 v140, v140
v_mfma_f32_16x16x32_bf16 v[176:179], a[8:11], v[104:107], v[176:179]
v_exp_f32 v156, v156
v_mfma_f32_16x16x32_bf16 v[176:179], a[12:15], v[120:123], v[176:179]
v_exp_f32 v141, v141
v_mfma_f32_16x16x32_bf16 v[184:187], a[0:3], v[76:79], v[244:247]
v_exp_f32 v157, v157
v_mfma_f32_16x16x32_bf16 v[184:187], a[4:7], v[92:95], v[184:187]
v_exp_f32 v142, v142
v_mfma_f32_16x16x32_bf16 v[184:187], a[8:11], v[108:111], v[184:187]
v_exp_f32 v158, v158
v_mfma_f32_16x16x32_bf16 v[184:187], a[12:15], v[124:127], v[184:187]
v_exp_f32 v143, v143
s_waitcnt lgkmcnt(0)
v_mfma_f32_16x16x32_bf16 v[164:167], a[16:19], v[64:67], v[224:227]
ds_read_b128 a[0:3], v9 offset:8192
v_cvt_pk_bf16_f32 v194, v132, v133
v_mfma_f32_16x16x32_bf16 v[164:167], a[20:23], v[80:83], v[164:167]
buffer_load_dwordx4 v31, s[28:31], s32 offen offset:3072 sc1 lds
s_add_u32 s32, s32, 28672
s_add_u32 s33, s33, 0x8000
s_and_b32 s33, s33, 0x1ffff
v_mfma_f32_16x16x32_bf16 v[164:167], a[24:27], v[96:99], v[164:167]
v_exp_f32 v159, v159
v_mfma_f32_16x16x32_bf16 v[164:167], a[28:31], v[112:115], v[164:167]
v_cvt_pk_bf16_f32 v202, v148, v149
v_cvt_pk_bf16_f32 v195, v134, v135
v_mfma_f32_16x16x32_bf16 v[172:175], a[16:19], v[68:71], v[228:231]
ds_read_b128 a[4:7], v9 offset:9216
v_cvt_pk_bf16_f32 v203, v150, v151
v_mfma_f32_16x16x32_bf16 v[172:175], a[20:23], v[84:87], v[172:175]
v_cvt_pk_bf16_f32 v198, v140, v141
v_cvt_pk_bf16_f32 v206, v156, v157
v_mfma_f32_16x16x32_bf16 v[172:175], a[24:27], v[100:103], v[172:175]
v_add_u32 v8, 0x8000, v8
v_cvt_pk_bf16_f32 v199, v142, v143
v_mfma_f32_16x16x32_bf16 v[172:175], a[28:31], v[116:119], v[172:175]
v_cvt_pk_bf16_f32 v207, v158, v159
v_mfma_f32_16x16x32_bf16 v[180:183], a[16:19], v[72:75], v[248:251]
ds_read_b128 a[8:11], v9 offset:10240
v_mfma_f32_16x16x32_bf16 v[180:183], a[20:23], v[88:91], v[180:183]
v_mfma_f32_16x16x32_bf16 v[180:183], a[24:27], v[104:107], v[180:183]
v_and_b32 v8, 0x1ffff, v8
v_mfma_f32_16x16x32_bf16 v[180:183], a[28:31], v[120:123], v[180:183]
v_mfma_f32_16x16x32_bf16 v[188:191], a[16:19], v[76:79], v[252:255]
ds_read_b128 a[12:15], v9 offset:11264
v_mfma_f32_16x16x32_bf16 v[188:191], a[20:23], v[92:95], v[188:191]
v_mfma_f32_16x16x32_bf16 v[188:191], a[24:27], v[108:111], v[188:191]
s_sub_u32 s45, s45, 1
s_cmp_lg_u32 s45, 0
v_mfma_f32_16x16x32_bf16 v[188:191], a[28:31], v[124:127], v[188:191]
s_cbranch_scc1 L_dm
L_dm_x:
s_getpc_b64 s[74:75]
L_pf10:
s_add_u32 s74, s74, L_fin1-L_pf10
s_addc_u32 s75, s75, 0
v_lshlrev_b32 v60, 7, v1
v_lshl_add_u32 v60, s3, 13, v60
v_min_u32 v60, L_end-L_fin1, v60
global_load_dword v0, v60, s[74:75]
s_lshl_b32 s74, s4, 2
v_mov_b32 v20, 128
v_writelane_b32 v20, s74, 0
global_load_dword v21, v20, s[6:7] sc1
s_lshl_b32 s94, s4, 5
s_add_u32 s94, s94, s3
s_mul_i32 s94, s94, 3072
s_add_u32 s94, s94, 58720256
v_and_b32 v6, 7, v3
v_mul_u32_u24 v6, 0x3000, v6
v_lshl_add_u32 v6, v2, 8, v6
s_xor_b32 s74, s3, 1
s_lshl_b32 s74, s74, 9
s_add_u32 s74, s74, 147456
v_lshl_add_u32 v22, v1, 3, s74
ds_read_b64 v[22:23], v22
s_and_b32 s47, s3, 1
s_lshl_b32 s74, s34, 1
s_add_u32 s74, s74, s47
s_lshl_b32 s74, s74, 5
s_sub_u32 s75, s40, s74
v_sub_u32 v11, s75, v10
s_xor_b32 s75, s40, 32
s_sub_u32 s75, s75, s74
v_sub_u32 v18, s75, v10
s_lshl_b32 s47, s47, 14
v_add_u32 v8, s47, v8
v_lshlrev_b32 v7, 2, v3
s_lshl_b32 s95, s40, 2
s_add_u32 s95, s95, 62914560
s_lshl_b32 s96, s41, 2
s_add_u32 s96, s96, 62914560
s_waitcnt vmcnt(10)
s_barrier
s_waitcnt lgkmcnt(0)
v_mfma_f32_16x16x32_bf16 a[96:99], a[112:115], v[192:195], a[96:99]
v_sub_f32 v232, 0, v22
v_exp_f32 v160, v160
v_mfma_f32_16x16x32_bf16 a[100:103], a[112:115], v[196:199], a[100:103]
v_exp_f32 v176, v176
v_mfma_f32_16x16x32_bf16 a[104:107], a[112:115], v[200:203], a[104:107]
v_exp_f32 v161, v161
v_mfma_f32_16x16x32_bf16 a[108:111], a[112:115], v[204:207], a[108:111]
v_exp_f32 v177, v177
v_mfma_f32_16x16x32_bf16 a[128:131], a[0:3], v[192:195], a[128:131]
ds_read_b128 a[16:19], v9 offset:12288
v_sub_f32 v233, 0, v22
v_exp_f32 v162, v162
v_mfma_f32_16x16x32_bf16 a[160:163], a[0:3], v[196:199], a[160:163]
v_exp_f32 v178, v178
v_exp_f32 v163, v163
v_mfma_f32_16x16x32_bf16 a[192:195], a[0:3], v[200:203], a[192:195]
v_exp_f32 v179, v179
v_mfma_f32_16x16x32_bf16 a[224:227], a[0:3], v[204:207], a[224:227]
v_exp_f32 v168, v168
v_mfma_f32_16x16x32_bf16 a[132:135], a[4:7], v[192:195], a[132:135]
ds_read_b128 a[20:23], v9 offset:13312
s_mov_b32 m0, s33
v_exp_f32 v184, v184
v_mfma_f32_16x16x32_bf16 a[164:167], a[4:7], v[196:199], a[164:167]
buffer_load_dwordx4 v31, s[28:31], s32 offen offset:0 sc1 lds
v_sub_f32 v234, 0, v22
v_exp_f32 v169, v169
v_mfma_f32_16x16x32_bf16 a[196:199], a[4:7], v[200:203], a[196:199]
v_exp_f32 v185, v185
v_cvt_pk_bf16_f32 v208, v160, v161
v_mfma_f32_16x16x32_bf16 a[228:231], a[4:7], v[204:207], a[228:231]
v_cvt_pk_bf16_f32 v216, v176, v177
v_exp_f32 v170, v170
v_mfma_f32_16x16x32_bf16 a[136:139], a[8:11], v[192:195], a[136:139]
ds_read_b128 a[24:27], v9 offset:14336
v_exp_f32 v186, v186
v_mfma_f32_16x16x32_bf16 a[168:171], a[8:11], v[196:199], a[168:171]
buffer_load_dwordx4 v31, s[28:31], s32 offen offset:1024 sc1 lds
v_sub_f32 v235, 0, v22
v_exp_f32 v171, v171
v_mfma_f32_16x16x32_bf16 a[200:203], a[8:11], v[200:203], a[200:203]
v_exp_f32 v187, v187
v_mfma_f32_16x16x32_bf16 a[232:235], a[8:11], v[204:207], a[232:235]
v_cvt_pk_bf16_f32 v209, v162, v163
v_cvt_pk_bf16_f32 v217, v178, v179
v_exp_f32 v164, v164
v_mfma_f32_16x16x32_bf16 a[140:143], a[12:15], v[192:195], a[140:143]
ds_read_b128 a[28:31], v9 offset:15360
v_exp_f32 v180, v180
v_mfma_f32_16x16x32_bf16 a[172:175], a[12:15], v[196:199], a[172:175]
v_sub_f32 v236, 0, v23
v_exp_f32 v165, v165
v_mfma_f32_16x16x32_bf16 a[204:207], a[12:15], v[200:203], a[204:207]
v_exp_f32 v181, v181
v_mfma_f32_16x16x32_bf16 a[236:239], a[12:15], v[204:207], a[236:239]
v_cvt_pk_bf16_f32 v212, v168, v169
v_cvt_pk_bf16_f32 v220, v184, v185
s_waitcnt lgkmcnt(2)
v_mfma_f32_16x16x32_bf16 a[144:147], a[16:19], v[192:195], a[144:147]
ds_read_b128 a[0:3], v9 offset:24576
v_exp_f32 v166, v166
v_mfma_f32_16x16x32_bf16 a[176:179], a[16:19], v[196:199], a[176:179]
buffer_load_dwordx4 v31, s[28:31], s32 offen offset:2048 sc1 lds
v_sub_f32 v237, 0, v23
v_exp_f32 v182, v182
v_mfma_f32_16x16x32_bf16 a[208:211], a[16:19], v[200:203], a[208:211]
v_exp_f32 v167, v167
v_exp_f32 v183, v183
v_mfma_f32_16x16x32_bf16 a[240:243], a[16:19], v[204:207], a[240:243]
v_cvt_pk_bf16_f32 v213, v170, v171
v_cvt_pk_bf16_f32 v221, v186, v187
v_mfma_f32_16x16x32_bf16 a[148:151], a[20:23], v[192:195], a[148:151]
ds_read_b128 a[4:7], v9 offset:25600
v_exp_f32 v172, v172
v_mfma_f32_16x16x32_bf16 a[180:183], a[20:23], v[196:199], a[180:183]
v_exp_f32 v188, v188
v_mfma_f32_16x16x32_bf16 a[212:215], a[20:23], v[200:203], a[212:215]
v_sub_f32 v238, 0, v23
v_exp_f32 v173, v173
v_cvt_pk_bf16_f32 v210, v164, v165
v_mfma_f32_16x16x32_bf16 a[244:247], a[20:23], v[204:207], a[244:247]
v_exp_f32 v189, v189
s_waitcnt lgkmcnt(2)
v_mfma_f32_16x16x32_bf16 a[152:155], a[24:27], v[192:195], a[152:155]
ds_read_b128 a[8:11], v9 offset:26624
v_cvt_pk_bf16_f32 v218, v180, v181
v_exp_f32 v174, v174
v_mfma_f32_16x16x32_bf16 a[184:187], a[24:27], v[196:199], a[184:187]
buffer_load_dwordx4 v31, s[28:31], s32 offen offset:3072 sc1 lds
v_exp_f32 v190, v190
v_mfma_f32_16x16x32_bf16 a[216:219], a[24:27], v[200:203], a[216:219]
v_sub_f32 v239, 0, v23
v_exp_f32 v175, v175
v_mfma_f32_16x16x32_bf16 a[248:251], a[24:27], v[204:207], a[248:251]
v_exp_f32 v191, v191
v_mfma_f32_16x16x32_bf16 a[156:159], a[28:31], v[192:195], a[156:159]
ds_read_b128 a[12:15], v9 offset:27648
v_cvt_pk_bf16_f32 v211, v166, v167
v_cvt_pk_bf16_f32 v219, v182, v183
v_cvt_pk_bf16_f32 v214, v172, v173
v_mfma_f32_16x16x32_bf16 a[188:191], a[28:31], v[196:199], a[188:191]
v_cvt_pk_bf16_f32 v222, v188, v189
v_cvt_pk_bf16_f32 v215, v174, v175
v_cvt_pk_bf16_f32 v223, v190, v191
v_mfma_f32_16x16x32_bf16 a[220:223], a[28:31], v[200:203], a[220:223]
v_mfma_f32_16x16x32_bf16 a[252:255], a[28:31], v[204:207], a[252:255]
s_waitcnt vmcnt(4)
L_pl2:
v_readlane_b32 s74, v21, 0
s_bfe_u32 s74, s74, 524296
s_cmp_ge_u32 s74, 8
s_cbranch_scc1 L_pl2x
s_sleep 2
global_load_dword v21, v20, s[6:7] sc1
s_waitcnt vmcnt(0)
s_branch L_pl2
L_pl2x:
v_mfma_f32_16x16x32_bf16 a[96:99], a[112:115], v[208:211], a[96:99]
v_cmp_le_i32_e64 s[48:49], -16, v11
v_cmp_le_i32_e64 s[50:51], -15, v11
v_mfma_f32_16x16x32_bf16 a[100:103], a[112:115], v[212:215], a[100:103]
buffer_load_dwordx4 v[24:27], v6, s[28:31], s94 offen offset:2048 sc1
v_cmp_le_i32_e64 s[52:53], -14, v11
v_mfma_f32_16x16x32_bf16 a[104:107], a[112:115], v[216:219], a[104:107]
v_cmp_le_i32_e64 s[54:55], -13, v11
v_cmp_le_i32_e64 s[56:57], 0, v11
v_mfma_f32_16x16x32_bf16 a[108:111], a[112:115], v[220:223], a[108:111]
v_cmp_le_i32_e64 s[58:59], 1, v11
v_cmp_le_i32_e64 s[60:61], 2, v11
s_waitcnt lgkmcnt(2)
v_mfma_f32_16x16x32_bf16 a[128:131], a[0:3], v[208:211], a[128:131]
ds_read_b128 a[16:19], v9 offset:28672
buffer_load_dwordx4 v[160:163], v31, s[28:31], s94 offen offset:0 sc1
v_mfma_f32_16x16x32_bf16 a[160:163], a[0:3], v[212:215], a[160:163]
v_cmp_le_i32_e64 s[62:63], 3, v11
v_cmp_le_i32_e64 s[64:65], 16, v11
v_mfma_f32_16x16x32_bf16 a[192:195], a[0:3], v[216:219], a[192:195]
v_cmp_le_i32_e64 s[66:67], 17, v11
v_cmp_le_i32_e64 s[90:91], 18, v11
v_mfma_f32_16x16x32_bf16 a[224:227], a[0:3], v[220:223], a[224:227]
v_cmp_le_i32_e64 s[92:93], 19, v11
v_cndmask_b32_e64 v240, v16, v224, s[56:57]
v_mfma_f32_16x16x32_bf16 a[132:135], a[4:7], v[208:211], a[132:135]
ds_read_b128 a[20:23], v9 offset:29696
s_add_u32 m0, s33, 4096
s_add_u32 s32, s32, 4096
buffer_load_dwordx4 v[164:167], v31, s[28:31], s94 offen offset:1024 sc1
v_mfma_f32_16x16x32_bf16 a[164:167], a[4:7], v[212:215], a[164:167]
buffer_load_dwordx4 v31, s[28:31], s32 offen offset:0 sc1 lds
v_cndmask_b32_e64 v241, v16, v224, s[58:59]
v_cndmask_b32_e64 v242, v16, v224, s[60:61]
v_mfma_f32_16x16x32_bf16 a[196:199], a[4:7], v[216:219], a[196:199]
v_cndmask_b32_e64 v243, v16, v224, s[62:63]
v_cndmask_b32_e64 v244, v16, v228, s[48:49]
v_mfma_f32_16x16x32_bf16 a[228:231], a[4:7], v[220:223], a[228:231]
v_cndmask_b32_e64 v245, v16, v228, s[50:51]
v_cndmask_b32_e64 v246, v16, v228, s[52:53]
s_waitcnt lgkmcnt(2)
v_mfma_f32_16x16x32_bf16 a[136:139], a[8:11], v[208:211], a[136:139]
ds_read_b128 a[24:27], v9 offset:30720
s_add_u32 s94, s94, 12288
buffer_load_dwordx4 v[168:171], v31, s[28:31], s94 offen offset:0 sc1
v_cndmask_b32_e64 v247, v16, v228, s[54:55]
v_mfma_f32_16x16x32_bf16 a[168:171], a[8:11], v[212:215], a[168:171]
v_cndmask_b32_e64 v248, v16, v224, s[64:65]
v_cndmask_b32_e64 v249, v16, v224, s[66:67]
v_mfma_f32_16x16x32_bf16 a[200:203], a[8:11], v[216:219], a[200:203]
v_cndmask_b32_e64 v250, v16, v224, s[90:91]
v_cndmask_b32_e64 v251, v16, v224, s[92:93]
v_mfma_f32_16x16x32_bf16 a[232:235], a[8:11], v[220:223], a[232:235]
v_cndmask_b32_e64 v252, v16, v228, s[56:57]
v_cndmask_b32_e64 v253, v16, v228, s[58:59]
v_mfma_f32_16x16x32_bf16 a[140:143], a[12:15], v[208:211], a[140:143]
ds_read_b128 a[28:31], v9 offset:31744
buffer_load_dwordx4 v[172:175], v31, s[28:31], s94 offen offset:1024 sc1
v_cndmask_b32_e64 v254, v16, v228, s[60:61]
v_mfma_f32_16x16x32_bf16 a[172:175], a[12:15], v[212:215], a[172:175]
v_cndmask_b32_e64 v255, v16, v228, s[62:63]
v_cmp_le_i32_e64 s[48:49], -16, v18
v_mfma_f32_16x16x32_bf16 a[204:207], a[12:15], v[216:219], a[204:207]
v_cmp_le_i32_e64 s[50:51], -15, v18
v_cmp_le_i32_e64 s[52:53], -14, v18
v_mfma_f32_16x16x32_bf16 a[236:239], a[12:15], v[220:223], a[236:239]
s_add_u32 s94, s94, 12288
buffer_load_dwordx4 v[176:179], v31, s[28:31], s94 offen offset:0 sc1
v_cmp_le_i32_e64 s[54:55], -13, v18
s_waitcnt lgkmcnt(2)
v_mfma_f32_16x16x32_bf16 a[144:147], a[16:19], v[208:211], a[144:147]
ds_read_b128 a[0:3], v8 offset:0
v_cmp_le_i32_e64 s[56:57], 0, v18
v_cmp_le_i32_e64 s[58:59], 1, v18
v_mfma_f32_16x16x32_bf16 a[176:179], a[16:19], v[212:215], a[176:179]
buffer_load_dwordx4 v31, s[28:31], s32 offen offset:1024 sc1 lds
v_cmp_le_i32_e64 s[60:61], 2, v18
v_mfma_f32_16x16x32_bf16 a[208:211], a[16:19], v[216:219], a[208:211]
ds_read_b128 a[4:7], v8 offset:1024
v_cmp_le_i32_e64 s[62:63], 3, v18
v_cmp_le_i32_e64 s[64:65], 16, v18
v_mfma_f32_16x16x32_bf16 a[240:243], a[16:19], v[220:223], a[240:243]
buffer_load_dwordx4 v[180:183], v31, s[28:31], s94 offen offset:1024 sc1
v_cmp_le_i32_e64 s[66:67], 17, v18
v_cmp_le_i32_e64 s[90:91], 18, v18
v_mfma_f32_16x16x32_bf16 a[148:151], a[20:23], v[208:211], a[148:151]
ds_read_b128 a[8:11], v8 offset:2048
v_cmp_le_i32_e64 s[92:93], 19, v18
v_mfma_f32_16x16x32_bf16 a[180:183], a[20:23], v[212:215], a[180:183]
v_cndmask_b32_e64 v32, v16, v232, s[56:57]
v_cndmask_b32_e64 v33, v16, v232, s[58:59]
v_mfma_f32_16x16x32_bf16 a[212:215], a[20:23], v[216:219], a[212:215]
ds_read_b128 a[12:15], v8 offset:3072
v_cndmask_b32_e64 v34, v16, v232, s[60:61]
v_cndmask_b32_e64 v35, v16, v232, s[62:63]
v_mfma_f32_16x16x32_bf16 a[244:247], a[20:23], v[220:223], a[244:247]
s_add_u32 s94, s94, 12288
buffer_load_dwordx4 v[184:187], v31, s[28:31], s94 offen offset:0 sc1
v_cndmask_b32_e64 v36, v16, v236, s[48:49]
s_waitcnt lgkmcnt(4)
v_mfma_f32_16x16x32_bf16 a[152:155], a[24:27], v[208:211], a[152:155]
ds_read_b128 a[16:19], v8 offset:4096
v_cndmask_b32_e64 v37, v16, v236, s[50:51]
v_cndmask_b32_e64 v38, v16, v236, s[52:53]
v_mfma_f32_16x16x32_bf16 a[184:187], a[24:27], v[212:215], a[184:187]
v_cndmask_b32_e64 v39, v16, v236, s[54:55]
v_cndmask_b32_e64 v40, v16, v232, s[64:65]
v_mfma_f32_16x16x32_bf16 a[216:219], a[24:27], v[216:219], a[216:219]
v_cndmask_b32_e64 v41, v16, v232, s[66:67]
v_cndmask_b32_e64 v42, v16, v232, s[90:91]
v_mfma_f32_16x16x32_bf16 a[248:251], a[24:27], v[220:223], a[248:251]
buffer_load_dwordx4 v[188:191], v31, s[28:31], s94 offen offset:1024 sc1
v_cndmask_b32_e64 v43, v16, v232, s[92:93]
v_mfma_f32_16x16x32_bf16 a[156:159], a[28:31], v[208:211], a[156:159]
ds_read_b128 a[20:23], v8 offset:5120
v_cndmask_b32_e64 v44, v16, v236, s[56:57]
v_cndmask_b32_e64 v45, v16, v236, s[58:59]
v_mfma_f32_16x16x32_bf16 a[188:191], a[28:31], v[212:215], a[188:191]
v_cndmask_b32_e64 v46, v16, v236, s[60:61]
v_cndmask_b32_e64 v47, v16, v236, s[62:63]
v_mfma_f32_16x16x32_bf16 a[220:223], a[28:31], v[216:219], a[220:223]
s_add_u32 s94, s94, 12288
buffer_load_dwordx4 v[192:195], v31, s[28:31], s94 offen offset:0 sc1
v_subrev_u32 v11, 64, v11
v_subrev_u32 v18, 64, v18
v_mfma_f32_16x16x32_bf16 a[252:255], a[28:31], v[220:223], a[252:255]
s_waitcnt lgkmcnt(2)
v_mfma_f32_16x16x32_bf16 v[128:131], a[0:3], v[64:67], v[240:243]
ds_read_b128 a[24:27], v8 offset:6144
v_mfma_f32_16x16x32_bf16 v[128:131], a[4:7], v[80:83], v[128:131]
buffer_load_dwordx4 v31, s[28:31], s32 offen offset:2048 sc1 lds
v_mfma_f32_16x16x32_bf16 v[128:131], a[8:11], v[96:99], v[128:131]
buffer_load_dwordx4 v[196:199], v31, s[28:31], s94 offen offset:1024 sc1
v_mfma_f32_16x16x32_bf16 v[128:131], a[12:15], v[112:115], v[128:131]
v_mfma_f32_16x16x32_bf16 v[136:139], a[0:3], v[68:71], v[244:247]
ds_read_b128 a[28:31], v8 offset:7168
v_mfma_f32_16x16x32_bf16 v[136:139], a[4:7], v[84:87], v[136:139]
v_mfma_f32_16x16x32_bf16 v[136:139], a[8:11], v[100:103], v[136:139]
v_add_u32 v9, 8192, v8
s_add_u32 s94, s94, 12288
buffer_load_dwordx4 v[200:203], v31, s[28:31], s94 offen offset:0 sc1
v_mfma_f32_16x16x32_bf16 v[136:139], a[12:15], v[116:119], v[136:139]
v_mfma_f32_16x16x32_bf16 v[144:147], a[0:3], a[32:35], v[32:35]
v_mfma_f32_16x16x32_bf16 v[144:147], a[4:7], a[40:43], v[144:147]
v_mfma_f32_16x16x32_bf16 v[144:147], a[8:11], a[48:51], v[144:147]
buffer_load_dwordx4 v[204:207], v31, s[28:31], s94 offen offset:1024 sc1
v_mfma_f32_16x16x32_bf16 v[144:147], a[12:15], a[56:59], v[144:147]
v_mfma_f32_16x16x32_bf16 v[152:155], a[0:3], a[36:39], v[36:39]
v_mfma_f32_16x16x32_bf16 v[152:155], a[4:7], a[44:47], v[152:155]
s_add_u32 s94, s94, 12288
buffer_load_dwordx4 v[48:51], v31, s[28:31], s94 offen offset:0 sc1
v_mfma_f32_16x16x32_bf16 v[152:155], a[8:11], a[52:55], v[152:155]
v_mfma_f32_16x16x32_bf16 v[152:155], a[12:15], a[60:63], v[152:155]
s_waitcnt lgkmcnt(0)
v_mfma_f32_16x16x32_bf16 v[132:135], a[16:19], v[64:67], v[248:251]
v_mfma_f32_16x16x32_bf16 v[132:135], a[20:23], v[80:83], v[132:135]
buffer_load_dwordx4 v31, s[28:31], s32 offen offset:3072 sc1 lds
s_add_u32 s32, s32, 28672
s_add_u32 s33, s33, 0x8000
s_and_b32 s33, s33, 0x1ffff
buffer_load_dwordx4 v[52:55], v31, s[28:31], s94 offen offset:1024 sc1
v_mfma_f32_16x16x32_bf16 v[132:135], a[24:27], v[96:99], v[132:135]
v_mfma_f32_16x16x32_bf16 v[132:135], a[28:31], v[112:115], v[132:135]
v_mfma_f32_16x16x32_bf16 v[140:143], a[16:19], v[68:71], v[252:255]
v_mfma_f32_16x16x32_bf16 v[140:143], a[20:23], v[84:87], v[140:143]
s_add_u32 s94, s94, 12288
buffer_load_dwordx4 v[56:59], v31, s[28:31], s94 offen offset:0 sc1
v_mfma_f32_16x16x32_bf16 v[140:143], a[24:27], v[100:103], v[140:143]
v_add_u32 v8, 0x8000, v8
v_mfma_f32_16x16x32_bf16 v[140:143], a[28:31], v[116:119], v[140:143]
v_mfma_f32_16x16x32_bf16 v[148:151], a[16:19], a[32:35], v[40:43]
v_mfma_f32_16x16x32_bf16 v[148:151], a[20:23], a[40:43], v[148:151]
buffer_load_dwordx4 v[60:63], v31, s[28:31], s94 offen offset:1024 sc1
v_mfma_f32_16x16x32_bf16 v[148:151], a[24:27], a[48:51], v[148:151]
v_and_b32 v8, 0x1ffff, v8
v_mfma_f32_16x16x32_bf16 v[148:151], a[28:31], a[56:59], v[148:151]
v_mfma_f32_16x16x32_bf16 v[156:159], a[16:19], a[36:39], v[44:47]
v_mfma_f32_16x16x32_bf16 v[156:159], a[20:23], a[44:47], v[156:159]
v_mfma_f32_16x16x32_bf16 v[156:159], a[24:27], a[52:55], v[156:159]
v_mfma_f32_16x16x32_bf16 v[156:159], a[28:31], a[60:63], v[156:159]
L_fin1:
s_lshl_b32 s74, s47, 1
s_sub_u32 s32, s32, s74
s_sub_u32 s33, s33, s74
s_and_b32 s33, s33, 0x1ffff
v_accvgpr_read_b32 v20, a104
v_cmp_nlt_f32 vcc, v20, v17
s_or_b64 s[36:37], s[36:37], vcc
v_accvgpr_read_b32 v22, a108
v_cmp_nlt_f32 vcc, v22, v17
s_or_b64 s[36:37], s[36:37], vcc
v_rcp_f32 v20, v20
v_sub_f32 v21, 1.0, v30
s_add_u32 s74, s43, 1024
v_mul_f32 v20, v20, v21
v_accvgpr_read_b32 v240, a192
v_accvgpr_read_b32 v241, a193
v_accvgpr_read_b32 v242, a194
v_accvgpr_read_b32 v243, a195
v_accvgpr_read_b32 v244, a196
v_accvgpr_read_b32 v245, a197
v_accvgpr_read_b32 v246, a198
v_accvgpr_read_b32 v247, a199
v_pk_mul_f32 v[240:241], v[240:241], v[20:21] op_sel_hi:[1,0]
v_pk_mul_f32 v[242:243], v[242:243], v[20:21] op_sel_hi:[1,0]
v_pk_mul_f32 v[244:245], v[244:245], v[20:21] op_sel_hi:[1,0]
v_pk_mul_f32 v[246:247], v[246:247], v[20:21] op_sel_hi:[1,0]
v_cvt_pk_bf16_f32 v32, v240, v241
v_cvt_pk_bf16_f32 v33, v242, v243
v_cvt_pk_bf16_f32 v34, v244, v245
v_cvt_pk_bf16_f32 v35, v246, v247
buffer_store_dwordx4 v[32:35], v31, s[28:31], s74 offen offset:0 sc1
v_accvgpr_read_b32 v248, a200
v_accvgpr_read_b32 v249, a201
v_accvgpr_read_b32 v250, a202
v_accvgpr_read_b32 v251, a203
v_accvgpr_read_b32 v252, a204
v_accvgpr_read_b32 v253, a205
v_accvgpr_read_b32 v254, a206
v_accvgpr_read_b32 v255, a207
v_pk_mul_f32 v[248:249], v[248:249], v[20:21] op_sel_hi:[1,0]
v_pk_mul_f32 v[250:251], v[250:251], v[20:21] op_sel_hi:[1,0]
v_pk_mul_f32 v[252:253], v[252:253], v[20:21] op_sel_hi:[1,0]
v_pk_mul_f32 v[254:255], v[254:255], v[20:21] op_sel_hi:[1,0]
v_cvt_pk_bf16_f32 v36, v248, v249
v_cvt_pk_bf16_f32 v37, v250, v251
v_cvt_pk_bf16_f32 v38, v252, v253
v_cvt_pk_bf16_f32 v39, v254, v255
buffer_store_dwordx4 v[36:39], v31, s[28:31], s74 offen offset:1024 sc1
v_accvgpr_read_b32 v240, a208
v_accvgpr_read_b32 v241, a209
v_accvgpr_read_b32 v242, a210
v_accvgpr_read_b32 v243, a211
v_accvgpr_read_b32 v244, a212
v_accvgpr_read_b32 v245, a213
v_accvgpr_read_b32 v246, a214
v_accvgpr_read_b32 v247, a215
v_pk_mul_f32 v[240:241], v[240:241], v[20:21] op_sel_hi:[1,0]
v_pk_mul_f32 v[242:243], v[242:243], v[20:21] op_sel_hi:[1,0]
v_pk_mul_f32 v[244:245], v[244:245], v[20:21] op_sel_hi:[1,0]
v_pk_mul_f32 v[246:247], v[246:247], v[20:21] op_sel_hi:[1,0]
v_cvt_pk_bf16_f32 v32, v240, v241
v_cvt_pk_bf16_f32 v33, v242, v243
v_cvt_pk_bf16_f32 v34, v244, v245
v_cvt_pk_bf16_f32 v35, v246, v247
buffer_store_dwordx4 v[32:35], v31, s[28:31], s74 offen offset:2048 sc1
v_accvgpr_read_b32 v248, a216
v_accvgpr_read_b32 v249, a217
v_accvgpr_read_b32 v250, a218
v_accvgpr_read_b32 v251, a219
v_accvgpr_read_b32 v252, a220
v_accvgpr_read_b32 v253, a221
v_accvgpr_read_b32 v254, a222
v_accvgpr_read_b32 v255, a223
v_pk_mul_f32 v[248:249], v[248:249], v[20:21] op_sel_hi:[1,0]
v_pk_mul_f32 v[250:251], v[250:251], v[20:21] op_sel_hi:[1,0]
v_pk_mul_f32 v[252:253], v[252:253], v[20:21] op_sel_hi:[1,0]
v_pk_mul_f32 v[254:255], v[254:255], v[20:21] op_sel_hi:[1,0]
v_cvt_pk_bf16_f32 v36, v248, v249
v_cvt_pk_bf16_f32 v37, v250, v251
v_cvt_pk_bf16_f32 v38, v252, v253
v_cvt_pk_bf16_f32 v39, v254, v255
buffer_store_dwordx4 v[36:39], v31, s[28:31], s74 offen offset:3072 sc1
v_rcp_f32 v22, v22
v_sub_f32 v23, 1.0, v5
s_add_u32 s75, s43, 164864
v_mul_f32_e64 v22, v22, v23
v_accvgpr_read_b32 v240, a224
v_accvgpr_read_b32 v241, a225
v_accvgpr_read_b32 v242, a226
v_accvgpr_read_b32 v243, a227
v_accvgpr_read_b32 v244, a228
v_accvgpr_read_b32 v245, a229
v_accvgpr_read_b32 v246, a230
v_accvgpr_read_b32 v247, a231
v_pk_mul_f32 v[240:241], v[240:241], v[22:23] op_sel_hi:[1,0]
v_pk_mul_f32 v[242:243], v[242:243], v[22:23] op_sel_hi:[1,0]
v_pk_mul_f32 v[244:245], v[244:245], v[22:23] op_sel_hi:[1,0]
v_pk_mul_f32 v[246:247], v[246:247], v[22:23] op_sel_hi:[1,0]
v_cvt_pk_bf16_f32 v32, v240, v241
v_cvt_pk_bf16_f32 v33, v242, v243
v_cvt_pk_bf16_f32 v34, v244, v245
v_cvt_pk_bf16_f32 v35, v246, v247
buffer_store_dwordx4 v[32:35], v31, s[28:31], s75 offen offset:0 sc1
v_accvgpr_read_b32 v248, a232
v_accvgpr_read_b32 v249, a233
v_accvgpr_read_b32 v250, a234
v_accvgpr_read_b32 v251, a235
v_accvgpr_read_b32 v252, a236
v_accvgpr_read_b32 v253, a237
v_accvgpr_read_b32 v254, a238
v_accvgpr_read_b32 v255, a239
v_pk_mul_f32 v[248:249], v[248:249], v[22:23] op_sel_hi:[1,0]
v_pk_mul_f32 v[250:251], v[250:251], v[22:23] op_sel_hi:[1,0]
v_pk_mul_f32 v[252:253], v[252:253], v[22:23] op_sel_hi:[1,0]
v_pk_mul_f32 v[254:255], v[254:255], v[22:23] op_sel_hi:[1,0]
v_cvt_pk_bf16_f32 v36, v248, v249
v_cvt_pk_bf16_f32 v37, v250, v251
v_cvt_pk_bf16_f32 v38, v252, v253
v_cvt_pk_bf16_f32 v39, v254, v255
buffer_store_dwordx4 v[36:39], v31, s[28:31], s75 offen offset:1024 sc1
v_accvgpr_read_b32 v240, a240
v_accvgpr_read_b32 v241, a241
v_accvgpr_read_b32 v242, a242
v_accvgpr_read_b32 v243, a243
v_accvgpr_read_b32 v244, a244
v_accvgpr_read_b32 v245, a245
v_accvgpr_read_b32 v246, a246
v_accvgpr_read_b32 v247, a247
v_pk_mul_f32 v[240:241], v[240:241], v[22:23] op_sel_hi:[1,0]
v_pk_mul_f32 v[242:243], v[242:243], v[22:23] op_sel_hi:[1,0]
v_pk_mul_f32 v[244:245], v[244:245], v[22:23] op_sel_hi:[1,0]
v_pk_mul_f32 v[246:247], v[246:247], v[22:23] op_sel_hi:[1,0]
v_cvt_pk_bf16_f32 v32, v240, v241
v_cvt_pk_bf16_f32 v33, v242, v243
v_cvt_pk_bf16_f32 v34, v244, v245
v_cvt_pk_bf16_f32 v35, v246, v247
buffer_store_dwordx4 v[32:35], v31, s[28:31], s75 offen offset:2048 sc1
v_accvgpr_read_b32 v248, a248
v_accvgpr_read_b32 v249, a249
v_accvgpr_read_b32 v250, a250
v_accvgpr_read_b32 v251, a251
v_accvgpr_read_b32 v252, a252
v_accvgpr_read_b32 v253, a253
v_accvgpr_read_b32 v254, a254
v_accvgpr_read_b32 v255, a255
v_pk_mul_f32 v[248:249], v[248:249], v[22:23] op_sel_hi:[1,0]
v_pk_mul_f32 v[250:251], v[250:251], v[22:23] op_sel_hi:[1,0]
v_pk_mul_f32 v[252:253], v[252:253], v[22:23] op_sel_hi:[1,0]
v_pk_mul_f32 v[254:255], v[254:255], v[22:23] op_sel_hi:[1,0]
v_cvt_pk_bf16_f32 v36, v248, v249
v_cvt_pk_bf16_f32 v37, v250, v251
v_cvt_pk_bf16_f32 v38, v252, v253
v_cvt_pk_bf16_f32 v39, v254, v255
buffer_store_dwordx4 v[36:39], v31, s[28:31], s75 offen offset:3072 sc1
v_mov_b32 v40, 0
v_mov_b32 v41, 0
v_mov_b32 v42, 0
v_mov_b32 v43, 0
s_nop 1
v_mfma_f32_32x32x16_bf16 a[192:207], v[40:43], v[40:43], 0
v_mfma_f32_32x32x16_bf16 a[208:223], v[40:43], v[40:43], 0
v_mfma_f32_32x32x16_bf16 a[224:239], v[40:43], v[40:43], 0
v_mfma_f32_32x32x16_bf16 a[240:255], v[40:43], v[40:43], 0
v_mfma_f32_16x16x32_bf16 a[104:107], v[40:43], v[40:43], 0
v_mfma_f32_16x16x32_bf16 a[108:111], v[40:43], v[40:43], 0
s_waitcnt vmcnt(8)
v_pk_add_f32 v[160:161], v[160:161], v[168:169]
v_add_f32_dpp v24, v24, v24 row_ror:4 row_mask:0xf bank_mask:0xf
v_pk_add_f32 v[162:163], v[162:163], v[170:171]
v_add_f32_dpp v25, v25, v25 row_ror:4 row_mask:0xf bank_mask:0xf
v_pk_add_f32 v[164:165], v[164:165], v[172:173]
v_add_f32_dpp v26, v26, v26 row_ror:4 row_mask:0xf bank_mask:0xf
v_pk_add_f32 v[166:167], v[166:167], v[174:175]
v_add_f32_dpp v27, v27, v27 row_ror:4 row_mask:0xf bank_mask:0xf
v_pk_add_f32 v[160:161], v[160:161], v[176:177]
v_add_f32_dpp v24, v24, v24 row_ror:2 row_mask:0xf bank_mask:0xf
v_pk_add_f32 v[162:163], v[162:163], v[178:179]
v_add_f32_dpp v25, v25, v25 row_ror:2 row_mask:0xf bank_mask:0xf
v_pk_add_f32 v[164:165], v[164:165], v[180:181]
v_add_f32_dpp v26, v26, v26 row_ror:2 row_mask:0xf bank_mask:0xf
v_pk_add_f32 v[166:167], v[166:167], v[182:183]
v_add_f32_dpp v27, v27, v27 row_ror:2 row_mask:0xf bank_mask:0xf
v_pk_add_f32 v[160:161], v[160:161], v[184:185]
v_add_f32_dpp v24, v24, v24 row_ror:1 row_mask:0xf bank_mask:0xf
v_pk_add_f32 v[162:163], v[162:163], v[186:187]
v_add_f32_dpp v25, v25, v25 row_ror:1 row_mask:0xf bank_mask:0xf
v_pk_add_f32 v[164:165], v[164:165], v[188:189]
v_add_f32_dpp v26, v26, v26 row_ror:1 row_mask:0xf bank_mask:0xf
v_pk_add_f32 v[166:167], v[166:167], v[190:191]
v_add_f32_dpp v27, v27, v27 row_ror:1 row_mask:0xf bank_mask:0xf
v_pk_add_f32 v[160:161], v[160:161], v[192:193]
v_pk_add_f32 v[162:163], v[162:163], v[194:195]
v_pk_add_f32 v[164:165], v[164:165], v[196:197]
v_pk_add_f32 v[166:167], v[166:167], v[198:199]
v_pk_add_f32 v[160:161], v[160:161], v[200:201]
v_pk_add_f32 v[162:163], v[162:163], v[202:203]
v_pk_add_f32 v[164:165], v[164:165], v[204:205]
v_pk_add_f32 v[166:167], v[166:167], v[206:207]
v_pk_add_f32 v[160:161], v[160:161], v[48:49]
v_pk_add_f32 v[162:163], v[162:163], v[50:51]
v_pk_add_f32 v[164:165], v[164:165], v[52:53]
v_pk_add_f32 v[166:167], v[166:167], v[54:55]
v_pk_add_f32 v[160:161], v[160:161], v[56:57]
v_pk_add_f32 v[162:163], v[162:163], v[58:59]
v_pk_add_f32 v[164:165], v[164:165], v[60:61]
v_pk_add_f32 v[166:167], v[166:167], v[62:63]
s_lshr_b32 s74, s3, 1
s_mul_i32 s74, s74, 3072
s_and_b32 s73, s3, 1
s_lshl_b32 s73, s73, 3
s_add_u32 s74, s74, s73
s_add_u32 s74, s74, 131072
v_add_u32_e64 v22, s74, v31
v_add_u32 v6, 131072, v31
v_cvt_pk_bf16_f32 v208, v160, v161
v_cvt_pk_bf16_f32 v209, v162, v163
ds_write_b64 v22, v[208:209] offset:0
v_cvt_pk_bf16_f32 v210, v164, v165
v_cvt_pk_bf16_f32 v211, v166, v167
ds_write_b64 v22, v[210:211] offset:1024
v_cvt_pk_bf16_f32 v212, v24, v25
v_cvt_pk_bf16_f32 v213, v26, v27
ds_write_b64 v22, v[212:213] offset:2048
s_waitcnt lgkmcnt(0)
s_barrier
ds_read_b128 a[0:3], v8 offset:0
ds_read_b128 a[4:7], v8 offset:1024
ds_read_b128 a[8:11], v8 offset:2048
ds_read_b128 a[12:15], v8 offset:3072
s_cmp_eq_u32 s38, 0
s_cbranch_scc1 L_odo
v_cmp_le_i32_e64 s[48:49], -16, v11
v_cmp_le_i32_e64 s[50:51], -15, v11
v_cmp_le_i32_e64 s[52:53], -14, v11
v_cmp_le_i32_e64 s[54:55], -13, v11
v_cmp_le_i32_e64 s[56:57], 0, v11
v_cmp_le_i32_e64 s[58:59], 1, v11
v_cmp_le_i32_e64 s[60:61], 2, v11
v_cmp_le_i32_e64 s[62:63], 3, v11
v_cmp_le_i32_e64 s[64:65], 16, v11
v_cmp_le_i32_e64 s[66:67], 17, v11
v_cmp_le_i32_e64 s[90:91], 18, v11
v_cmp_le_i32_e64 s[92:93], 19, v11
v_cndmask_b32_e64 v240, v16, v224, s[56:57]
v_cndmask_b32_e64 v241, v16, v224, s[58:59]
v_cndmask_b32_e64 v242, v16, v224, s[60:61]
v_cndmask_b32_e64 v243, v16, v224, s[62:63]
v_cndmask_b32_e64 v244, v16, v228, s[48:49]
v_cndmask_b32_e64 v245, v16, v228, s[50:51]
v_cndmask_b32_e64 v246, v16, v228, s[52:53]
v_cndmask_b32_e64 v247, v16, v228, s[54:55]
v_cndmask_b32_e64 v248, v16, v224, s[64:65]
v_cndmask_b32_e64 v249, v16, v224, s[66:67]
v_cndmask_b32_e64 v250, v16, v224, s[90:91]
v_cndmask_b32_e64 v251, v16, v224, s[92:93]
v_cndmask_b32_e64 v252, v16, v228, s[56:57]
v_cndmask_b32_e64 v253, v16, v228, s[58:59]
v_cndmask_b32_e64 v254, v16, v228, s[60:61]
v_cndmask_b32_e64 v255, v16, v228, s[62:63]
v_cmp_le_i32_e64 s[48:49], -16, v18
v_cmp_le_i32_e64 s[50:51], -15, v18
v_cmp_le_i32_e64 s[52:53], -14, v18
v_cmp_le_i32_e64 s[54:55], -13, v18
v_cmp_le_i32_e64 s[56:57], 0, v18
v_cmp_le_i32_e64 s[58:59], 1, v18
v_cmp_le_i32_e64 s[60:61], 2, v18
v_cmp_le_i32_e64 s[62:63], 3, v18
v_cmp_le_i32_e64 s[64:65], 16, v18
v_cmp_le_i32_e64 s[66:67], 17, v18
v_cmp_le_i32_e64 s[90:91], 18, v18
v_cmp_le_i32_e64 s[92:93], 19, v18
v_cndmask_b32_e64 v32, v16, v232, s[56:57]
v_cndmask_b32_e64 v33, v16, v232, s[58:59]
v_cndmask_b32_e64 v34, v16, v232, s[60:61]
v_cndmask_b32_e64 v35, v16, v232, s[62:63]
v_cndmask_b32_e64 v36, v16, v236, s[48:49]
v_cndmask_b32_e64 v37, v16, v236, s[50:51]
v_cndmask_b32_e64 v38, v16, v236, s[52:53]
v_cndmask_b32_e64 v39, v16, v236, s[54:55]
v_cndmask_b32_e64 v40, v16, v232, s[64:65]
v_cndmask_b32_e64 v41, v16, v232, s[66:67]
v_cndmask_b32_e64 v42, v16, v232, s[90:91]
v_cndmask_b32_e64 v43, v16, v232, s[92:93]
v_cndmask_b32_e64 v44, v16, v236, s[56:57]
v_cndmask_b32_e64 v45, v16, v236, s[58:59]
v_cndmask_b32_e64 v46, v16, v236, s[60:61]
v_cndmask_b32_e64 v47, v16, v236, s[62:63]
v_subrev_u32 v11, 64, v11
v_subrev_u32 v18, 64, v18
s_waitcnt vmcnt(0) lgkmcnt(0)
s_branch L_odone
L_odo:
ds_read_b128 v[48:51], v6 offset:0
ds_read_b128 v[52:55], v6 offset:1024
ds_read_b128 v[56:59], v6 offset:2048
ds_read_b128 v[60:63], v6 offset:3072
ds_read_b128 v[20:23], v6 offset:4096
ds_read_b128 v[24:27], v6 offset:5120
v_cmp_le_i32_e64 s[48:49], -16, v11
v_cmp_le_i32_e64 s[50:51], -15, v11
v_cmp_le_i32_e64 s[52:53], -14, v11
v_cmp_le_i32_e64 s[54:55], -13, v11
v_cmp_le_i32_e64 s[56:57], 0, v11
v_cmp_le_i32_e64 s[58:59], 1, v11
v_cmp_le_i32_e64 s[60:61], 2, v11
v_cmp_le_i32_e64 s[62:63], 3, v11
v_cmp_le_i32_e64 s[64:65], 16, v11
v_cmp_le_i32_e64 s[66:67], 17, v11
v_cmp_le_i32_e64 s[90:91], 18, v11
v_cmp_le_i32_e64 s[92:93], 19, v11
s_waitcnt lgkmcnt(5)
v_mfma_f32_16x16x32_bf16 v[160:163], v[48:51], a[64:67], 0
v_cndmask_b32_e64 v240, v16, v224, s[56:57]
v_cndmask_b32_e64 v241, v16, v224, s[58:59]
s_waitcnt lgkmcnt(2)
v_mfma_f32_16x16x32_bf16 v[160:163], v[60:63], a[68:71], v[160:163]
v_cndmask_b32_e64 v242, v16, v224, s[60:61]
v_cndmask_b32_e64 v243, v16, v224, s[62:63]
v_mfma_f32_16x16x32_bf16 v[164:167], v[52:55], a[64:67], 0
v_cndmask_b32_e64 v244, v16, v228, s[48:49]
v_cndmask_b32_e64 v245, v16, v228, s[50:51]
s_waitcnt lgkmcnt(1)
v_mfma_f32_16x16x32_bf16 v[164:167], v[20:23], a[68:71], v[164:167]
v_cndmask_b32_e64 v246, v16, v228, s[52:53]
v_cndmask_b32_e64 v247, v16, v228, s[54:55]
v_mfma_f32_16x16x32_bf16 v[168:171], v[56:59], a[64:67], 0
v_cndmask_b32_e64 v248, v16, v224, s[64:65]
v_cndmask_b32_e64 v249, v16, v224, s[66:67]
s_waitcnt lgkmcnt(0)
v_mfma_f32_16x16x32_bf16 v[168:171], v[24:27], a[68:71], v[168:171]
v_cndmask_b32_e64 v250, v16, v224, s[90:91]
v_cndmask_b32_e64 v251, v16, v224, s[92:93]
v_mfma_f32_16x16x32_bf16 v[172:175], v[48:51], a[72:75], 0
v_cndmask_b32_e64 v252, v16, v228, s[56:57]
v_cndmask_b32_e64 v253, v16, v228, s[58:59]
v_mfma_f32_16x16x32_bf16 v[172:175], v[60:63], a[76:79], v[172:175]
v_cndmask_b32_e64 v254, v16, v228, s[60:61]
v_cndmask_b32_e64 v255, v16, v228, s[62:63]
v_mfma_f32_16x16x32_bf16 v[176:179], v[52:55], a[72:75], 0
v_cmp_le_i32_e64 s[48:49], -16, v18
v_cmp_le_i32_e64 s[50:51], -15, v18
v_mfma_f32_16x16x32_bf16 v[176:179], v[20:23], a[76:79], v[176:179]
v_cmp_le_i32_e64 s[52:53], -14, v18
v_cmp_le_i32_e64 s[54:55], -13, v18
v_mfma_f32_16x16x32_bf16 v[180:183], v[56:59], a[72:75], 0
v_cmp_le_i32_e64 s[56:57], 0, v18
v_cmp_le_i32_e64 s[58:59], 1, v18
v_mfma_f32_16x16x32_bf16 v[180:183], v[24:27], a[76:79], v[180:183]
v_cmp_le_i32_e64 s[60:61], 2, v18
v_cmp_le_i32_e64 s[62:63], 3, v18
v_mfma_f32_16x16x32_bf16 v[184:187], v[48:51], a[80:83], 0
v_cmp_le_i32_e64 s[64:65], 16, v18
v_cmp_le_i32_e64 s[66:67], 17, v18
v_mfma_f32_16x16x32_bf16 v[184:187], v[60:63], a[84:87], v[184:187]
v_cmp_le_i32_e64 s[90:91], 18, v18
v_cmp_le_i32_e64 s[92:93], 19, v18
v_mfma_f32_16x16x32_bf16 v[188:191], v[52:55], a[80:83], 0
v_cndmask_b32_e64 v32, v16, v232, s[56:57]
v_cndmask_b32_e64 v33, v16, v232, s[58:59]
v_mfma_f32_16x16x32_bf16 v[188:191], v[20:23], a[84:87], v[188:191]
v_cndmask_b32_e64 v34, v16, v232, s[60:61]
v_cndmask_b32_e64 v35, v16, v232, s[62:63]
v_mfma_f32_16x16x32_bf16 v[192:195], v[56:59], a[80:83], 0
v_cndmask_b32_e64 v36, v16, v236, s[48:49]
v_cndmask_b32_e64 v37, v16, v236, s[50:51]
v_mfma_f32_16x16x32_bf16 v[192:195], v[24:27], a[84:87], v[192:195]
v_cndmask_b32_e64 v38, v16, v236, s[52:53]
v_cndmask_b32_e64 v39, v16, v236, s[54:55]
v_mfma_f32_16x16x32_bf16 v[196:199], v[48:51], a[88:91], 0
v_cndmask_b32_e64 v40, v16, v232, s[64:65]
v_cndmask_b32_e64 v41, v16, v232, s[66:67]
v_mfma_f32_16x16x32_bf16 v[196:199], v[60:63], a[92:95], v[196:199]
v_cndmask_b32_e64 v42, v16, v232, s[90:91]
v_cndmask_b32_e64 v43, v16, v232, s[92:93]
v_mfma_f32_16x16x32_bf16 v[200:203], v[52:55], a[88:91], 0
v_cndmask_b32_e64 v44, v16, v236, s[56:57]
v_cndmask_b32_e64 v45, v16, v236, s[58:59]
v_mfma_f32_16x16x32_bf16 v[200:203], v[20:23], a[92:95], v[200:203]
v_cndmask_b32_e64 v46, v16, v236, s[60:61]
v_cndmask_b32_e64 v47, v16, v236, s[62:63]
v_mfma_f32_16x16x32_bf16 v[204:207], v[56:59], a[88:91], 0
v_subrev_u32 v11, 64, v11
v_subrev_u32 v18, 64, v18
v_mfma_f32_16x16x32_bf16 v[204:207], v[24:27], a[92:95], v[204:207]
v_add_f32 v168, 0x358637bd, v168
v_rcp_f32 v168, v168
s_add_u32 s74, s42, 0
v_mul_f32_e64 v168, v168, v28
v_pk_mul_f32 v[160:161], v[160:161], v[168:169] op_sel_hi:[1,0]
v_pk_mul_f32 v[162:163], v[162:163], v[168:169] op_sel_hi:[1,0]
v_pk_mul_f32 v[164:165], v[164:165], v[168:169] op_sel_hi:[1,0]
v_pk_mul_f32 v[166:167], v[166:167], v[168:169] op_sel_hi:[1,0]
v_cvt_pk_bf16_f32 v208, v160, v161
v_cvt_pk_bf16_f32 v209, v162, v163
v_cvt_pk_bf16_f32 v210, v164, v165
v_cvt_pk_bf16_f32 v211, v166, v167
buffer_store_dwordx4 v[208:211], v31, s[28:31], s74 offen sc1
v_accvgpr_write_b32 a64, v208
v_accvgpr_write_b32 a65, v209
v_accvgpr_write_b32 a66, v210
v_accvgpr_write_b32 a67, v211
v_add_f32 v180, 0x358637bd, v180
v_rcp_f32 v180, v180
s_add_u32 s74, s42, 163840
v_mul_f32 v180, v180, v29
v_pk_mul_f32 v[172:173], v[172:173], v[180:181] op_sel_hi:[1,0]
v_pk_mul_f32 v[174:175], v[174:175], v[180:181] op_sel_hi:[1,0]
v_pk_mul_f32 v[176:177], v[176:177], v[180:181] op_sel_hi:[1,0]
v_pk_mul_f32 v[178:179], v[178:179], v[180:181] op_sel_hi:[1,0]
v_cvt_pk_bf16_f32 v212, v172, v173
v_cvt_pk_bf16_f32 v213, v174, v175
v_cvt_pk_bf16_f32 v214, v176, v177
v_cvt_pk_bf16_f32 v215, v178, v179
buffer_store_dwordx4 v[212:215], v31, s[28:31], s74 offen sc1
v_accvgpr_write_b32 a68, v212
v_accvgpr_write_b32 a69, v213
v_accvgpr_write_b32 a70, v214
v_accvgpr_write_b32 a71, v215
v_add_f32 v192, 0x358637bd, v192
v_rcp_f32 v192, v192
s_add_u32 s74, s43, 0
v_mul_f32_e64 v192, v192, v30
v_pk_mul_f32 v[184:185], v[184:185], v[192:193] op_sel_hi:[1,0]
v_pk_mul_f32 v[186:187], v[186:187], v[192:193] op_sel_hi:[1,0]
v_pk_mul_f32 v[188:189], v[188:189], v[192:193] op_sel_hi:[1,0]
v_pk_mul_f32 v[190:191], v[190:191], v[192:193] op_sel_hi:[1,0]
v_cvt_pk_bf16_f32 v216, v184, v185
v_cvt_pk_bf16_f32 v217, v186, v187
v_cvt_pk_bf16_f32 v218, v188, v189
v_cvt_pk_bf16_f32 v219, v190, v191
buffer_store_dwordx4 v[216:219], v31, s[28:31], s74 offen sc1
v_accvgpr_write_b32 a72, v216
v_accvgpr_write_b32 a73, v217
v_accvgpr_write_b32 a74, v218
v_accvgpr_write_b32 a75, v219
v_add_f32 v204, 0x358637bd, v204
v_rcp_f32 v204, v204
s_add_u32 s74, s43, 163840
v_mul_f32 v204, v204, v5
v_pk_mul_f32 v[196:197], v[196:197], v[204:205] op_sel_hi:[1,0]
v_pk_mul_f32 v[198:199], v[198:199], v[204:205] op_sel_hi:[1,0]
v_pk_mul_f32 v[200:201], v[200:201], v[204:205] op_sel_hi:[1,0]
v_pk_mul_f32 v[202:203], v[202:203], v[204:205] op_sel_hi:[1,0]
v_cvt_pk_bf16_f32 v220, v196, v197
v_cvt_pk_bf16_f32 v221, v198, v199
v_cvt_pk_bf16_f32 v222, v200, v201
v_cvt_pk_bf16_f32 v223, v202, v203
buffer_store_dwordx4 v[220:223], v31, s[28:31], s74 offen sc1
v_accvgpr_write_b32 a76, v220
v_accvgpr_write_b32 a77, v221
v_accvgpr_write_b32 a78, v222
v_accvgpr_write_b32 a79, v223
L_odone:
v_mfma_f32_16x16x32_bf16 v[160:163], a[0:3], v[64:67], v[240:243]
ds_read_b128 a[16:19], v8 offset:4096
v_exp_f32 v128, v128
v_mfma_f32_16x16x32_bf16 v[160:163], a[4:7], v[80:83], v[160:163]
v_exp_f32 v144, v144
v_mfma_f32_16x16x32_bf16 v[160:163], a[8:11], v[96:99], v[160:163]
ds_read_b128 a[20:23], v8 offset:5120
v_exp_f32 v129, v129
v_mfma_f32_16x16x32_bf16 v[160:163], a[12:15], v[112:115], v[160:163]
v_exp_f32 v145, v145
v_exp_f32 v130, v130
v_mfma_f32_16x16x32_bf16 v[168:171], a[0:3], v[68:71], v[244:247]
ds_read_b128 a[24:27], v8 offset:6144
s_mov_b32 m0, s33
v_exp_f32 v146, v146
v_mfma_f32_16x16x32_bf16 v[168:171], a[4:7], v[84:87], v[168:171]
buffer_load_dwordx4 v31, s[28:31], s32 offen offset:0 sc1 lds
buffer_load_dwordx4 v31, s[28:31], s32 offen offset:1024 sc1 lds
v_exp_f32 v131, v131
v_mfma_f32_16x16x32_bf16 v[168:171], a[8:11], v[100:103], v[168:171]
ds_read_b128 a[28:31], v8 offset:7168
v_exp_f32 v147, v147
v_cvt_pk_bf16_f32 v192, v128, v129
v_mfma_f32_16x16x32_bf16 v[168:171], a[12:15], v[116:119], v[168:171]
v_exp_f32 v136, v136
v_exp_f32 v152, v152
v_mfma_f32_16x16x32_bf16 v[176:179], a[0:3], a[32:35], v[32:35]
v_exp_f32 v137, v137
v_mfma_f32_16x16x32_bf16 v[176:179], a[4:7], a[40:43], v[176:179]
buffer_load_dwordx4 v31, s[28:31], s32 offen offset:2048 sc1 lds
v_exp_f32 v153, v153
v_cvt_pk_bf16_f32 v200, v144, v145
v_mfma_f32_16x16x32_bf16 v[176:179], a[8:11], a[48:51], v[176:179]
v_exp_f32 v138, v138
v_mfma_f32_16x16x32_bf16 v[176:179], a[12:15], a[56:59], v[176:179]
v_exp_f32 v154, v154
v_exp_f32 v139, v139
v_mfma_f32_16x16x32_bf16 v[184:187], a[0:3], a[36:39], v[36:39]
v_exp_f32 v155, v155
v_mfma_f32_16x16x32_bf16 v[184:187], a[4:7], a[44:47], v[184:187]
buffer_load_dwordx4 v31, s[28:31], s32 offen offset:3072 sc1 lds
v_cvt_pk_bf16_f32 v193, v130, v131
v_cvt_pk_bf16_f32 v201, v146, v147
v_mfma_f32_16x16x32_bf16 v[184:187], a[8:11], a[52:55], v[184:187]
v_exp_f32 v132, v132
v_exp_f32 v148, v148
v_mfma_f32_16x16x32_bf16 v[184:187], a[12:15], a[60:63], v[184:187]
v_exp_f32 v133, v133
s_waitcnt lgkmcnt(0)
v_mfma_f32_16x16x32_bf16 v[164:167], a[16:19], v[64:67], v[248:251]
ds_read_b128 a[0:3], v9 offset:0
s_add_u32 m0, s33, 4096
s_add_u32 s32, s32, 4096
v_exp_f32 v149, v149
v_mfma_f32_16x16x32_bf16 v[164:167], a[20:23], v[80:83], v[164:167]
buffer_load_dwordx4 v31, s[28:31], s32 offen offset:0 sc1 lds
v_cvt_pk_bf16_f32 v196, v136, v137
v_cvt_pk_bf16_f32 v204, v152, v153
v_cvt_pk_bf16_f32 v197, v138, v139
v_mfma_f32_16x16x32_bf16 v[164:167], a[24:27], v[96:99], v[164:167]
v_exp_f32 v134, v134
v_exp_f32 v150, v150
v_mfma_f32_16x16x32_bf16 v[164:167], a[28:31], v[112:115], v[164:167]
v_exp_f32 v135, v135
v_mfma_f32_16x16x32_bf16 v[172:175], a[16:19], v[68:71], v[252:255]
ds_read_b128 a[4:7], v9 offset:1024
v_exp_f32 v151, v151
v_mfma_f32_16x16x32_bf16 v[172:175], a[20:23], v[84:87], v[172:175]
buffer_load_dwordx4 v31, s[28:31], s32 offen offset:1024 sc1 lds
v_cvt_pk_bf16_f32 v205, v154, v155
v_exp_f32 v140, v140
v_mfma_f32_16x16x32_bf16 v[172:175], a[24:27], v[100:103], v[172:175]
v_add_u32 v8, 0x8000, v8
v_exp_f32 v156, v156
v_mfma_f32_16x16x32_bf16 v[172:175], a[28:31], v[116:119], v[172:175]
v_exp_f32 v141, v141
v_exp_f32 v157, v157
v_mfma_f32_16x16x32_bf16 v[180:183], a[16:19], a[32:35], v[40:43]
ds_read_b128 a[8:11], v9 offset:2048
v_cvt_pk_bf16_f32 v194, v132, v133
v_cvt_pk_bf16_f32 v202, v148, v149
v_mfma_f32_16x16x32_bf16 v[180:183], a[20:23], a[40:43], v[180:183]
buffer_load_dwordx4 v31, s[28:31], s32 offen offset:2048 sc1 lds
v_exp_f32 v142, v142
v_mfma_f32_16x16x32_bf16 v[180:183], a[24:27], a[48:51], v[180:183]
v_and_b32 v8, 0x1ffff, v8
v_exp_f32 v158, v158
v_exp_f32 v143, v143
v_mfma_f32_16x16x32_bf16 v[180:183], a[28:31], a[56:59], v[180:183]
v_exp_f32 v159, v159
v_mfma_f32_16x16x32_bf16 v[188:191], a[16:19], a[36:39], v[44:47]
ds_read_b128 a[12:15], v9 offset:3072
v_cvt_pk_bf16_f32 v195, v134, v135
v_cvt_pk_bf16_f32 v203, v150, v151
v_mfma_f32_16x16x32_bf16 v[188:191], a[20:23], a[44:47], v[188:191]
buffer_load_dwordx4 v31, s[28:31], s32 offen offset:3072 sc1 lds
s_add_u32 s32, s32, 28672
s_add_u32 s33, s33, 0x8000
s_and_b32 s33, s33, 0x1ffff
v_cvt_pk_bf16_f32 v198, v140, v141
v_cvt_pk_bf16_f32 v206, v156, v157
v_cvt_pk_bf16_f32 v199, v142, v143
v_cvt_pk_bf16_f32 v207, v158, v159
v_mfma_f32_16x16x32_bf16 v[188:191], a[24:27], a[52:55], v[188:191]
v_mfma_f32_16x16x32_bf16 v[188:191], a[28:31], a[60:63], v[188:191]
s_cmp_eq_u32 s46, 0
s_cbranch_scc1 L_xf_x
L_xf:
s_waitcnt vmcnt(8)
s_barrier
v_mfma_f32_16x16x32_bf16 a[96:99], a[112:115], v[192:195], a[96:99]
v_exp_f32 v160, v160
v_mfma_f32_16x16x32_bf16 a[100:103], a[112:115], v[196:199], a[100:103]
v_exp_f32 v176, v176
v_mfma_f32_16x16x32_bf16 a[104:107], a[112:115], v[200:203], a[104:107]
v_mfma_f32_16x16x32_bf16 a[108:111], a[112:115], v[204:207], a[108:111]
v_exp_f32 v161, v161
s_waitcnt lgkmcnt(2)
v_mfma_f32_16x16x32_bf16 a[128:131], a[0:3], v[192:195], a[128:131]
ds_read_b128 a[16:19], v9 offset:4096
v_mfma_f32_16x16x32_bf16 a[160:163], a[0:3], v[196:199], a[160:163]
v_exp_f32 v177, v177
v_mfma_f32_16x16x32_bf16 a[192:195], a[0:3], v[200:203], a[192:195]
v_exp_f32 v162, v162
v_mfma_f32_16x16x32_bf16 a[224:227], a[0:3], v[204:207], a[224:227]
v_mfma_f32_16x16x32_bf16 a[132:135], a[4:7], v[192:195], a[132:135]
ds_read_b128 a[20:23], v9 offset:5120
s_mov_b32 m0, s33
v_mfma_f32_16x16x32_bf16 a[164:167], a[4:7], v[196:199], a[164:167]
buffer_load_dwordx4 v31, s[28:31], s32 offen offset:0 sc1 lds
v_cvt_pk_bf16_f32 v208, v160, v161
v_mfma_f32_16x16x32_bf16 a[196:199], a[4:7], v[200:203], a[196:199]
v_exp_f32 v178, v178
v_mfma_f32_16x16x32_bf16 a[228:231], a[4:7], v[204:207], a[228:231]
v_exp_f32 v163, v163
s_waitcnt lgkmcnt(2)
v_mfma_f32_16x16x32_bf16 a[136:139], a[8:11], v[192:195], a[136:139]
ds_read_b128 a[24:27], v9 offset:6144
v_cvt_pk_bf16_f32 v216, v176, v177
v_mfma_f32_16x16x32_bf16 a[168:171], a[8:11], v[196:199], a[168:171]
buffer_load_dwordx4 v31, s[28:31], s32 offen offset:1024 sc1 lds
v_mfma_f32_16x16x32_bf16 a[200:203], a[8:11], v[200:203], a[200:203]
v_exp_f32 v179, v179
v_mfma_f32_16x16x32_bf16 a[232:235], a[8:11], v[204:207], a[232:235]
v_exp_f32 v168, v168
v_mfma_f32_16x16x32_bf16 a[140:143], a[12:15], v[192:195], a[140:143]
ds_read_b128 a[28:31], v9 offset:7168
v_cvt_pk_bf16_f32 v209, v162, v163
v_mfma_f32_16x16x32_bf16 a[172:175], a[12:15], v[196:199], a[172:175]
v_exp_f32 v184, v184
v_mfma_f32_16x16x32_bf16 a[204:207], a[12:15], v[200:203], a[204:207]
v_exp_f32 v169, v169
v_mfma_f32_16x16x32_bf16 a[236:239], a[12:15], v[204:207], a[236:239]
s_waitcnt lgkmcnt(2)
v_mfma_f32_16x16x32_bf16 a[144:147], a[16:19], v[192:195], a[144:147]
ds_read_b128 a[0:3], v8 offset:0
v_cvt_pk_bf16_f32 v217, v178, v179
v_mfma_f32_16x16x32_bf16 a[176:179], a[16:19], v[196:199], a[176:179]
buffer_load_dwordx4 v31, s[28:31], s32 offen offset:2048 sc1 lds
v_mfma_f32_16x16x32_bf16 a[208:211], a[16:19], v[200:203], a[208:211]
ds_read_b128 a[4:7], v8 offset:1024
v_add_u32 v9, 0x8000, v9
v_mfma_f32_16x16x32_bf16 a[240:243], a[16:19], v[204:207], a[240:243]
v_exp_f32 v185, v185
v_mfma_f32_16x16x32_bf16 a[148:151], a[20:23], v[192:195], a[148:151]
ds_read_b128 a[8:11], v8 offset:2048
v_mfma_f32_16x16x32_bf16 a[180:183], a[20:23], v[196:199], a[180:183]
v_exp_f32 v170, v170
v_mfma_f32_16x16x32_bf16 a[212:215], a[20:23], v[200:203], a[212:215]
ds_read_b128 a[12:15], v8 offset:3072
v_and_b32 v9, 0x1ffff, v9
v_mfma_f32_16x16x32_bf16 a[244:247], a[20:23], v[204:207], a[244:247]
v_exp_f32 v186, v186
s_waitcnt lgkmcnt(4)
v_mfma_f32_16x16x32_bf16 a[152:155], a[24:27], v[192:195], a[152:155]
ds_read_b128 a[16:19], v8 offset:4096
v_cvt_pk_bf16_f32 v212, v168, v169
v_mfma_f32_16x16x32_bf16 a[184:187], a[24:27], v[196:199], a[184:187]
buffer_load_dwordx4 v31, s[28:31], s32 offen offset:3072 sc1 lds
v_cvt_pk_bf16_f32 v220, v184, v185
v_mfma_f32_16x16x32_bf16 a[216:219], a[24:27], v[200:203], a[216:219]
v_exp_f32 v171, v171
v_mfma_f32_16x16x32_bf16 a[248:251], a[24:27], v[204:207], a[248:251]
v_exp_f32 v187, v187
v_mfma_f32_16x16x32_bf16 a[156:159], a[28:31], v[192:195], a[156:159]
ds_read_b128 a[20:23], v8 offset:5120
v_mfma_f32_16x16x32_bf16 a[188:191], a[28:31], v[196:199], a[188:191]
v_exp_f32 v164, v164
v_mfma_f32_16x16x32_bf16 a[220:223], a[28:31], v[200:203], a[220:223]
v_exp_f32 v180, v180
v_mfma_f32_16x16x32_bf16 a[252:255], a[28:31], v[204:207], a[252:255]
v_exp_f32 v165, v165
s_waitcnt lgkmcnt(2)
v_mfma_f32_16x16x32_bf16 v[128:131], a[0:3], v[64:67], v[224:227]
ds_read_b128 a[24:27], v8 offset:6144
s_add_u32 m0, s33, 4096
s_add_u32 s32, s32, 4096
v_mfma_f32_16x16x32_bf16 v[128:131], a[4:7], v[80:83], v[128:131]
buffer_load_dwordx4 v31, s[28:31], s32 offen offset:0 sc1 lds
v_cvt_pk_bf16_f32 v213, v170, v171
v_mfma_f32_16x16x32_bf16 v[128:131], a[8:11], v[96:99], v[128:131]
v_exp_f32 v181, v181
v_mfma_f32_16x16x32_bf16 v[128:131], a[12:15], v[112:115], v[128:131]
v_exp_f32 v166, v166
v_mfma_f32_16x16x32_bf16 v[136:139], a[0:3], v[68:71], v[228:231]
ds_read_b128 a[28:31], v8 offset:7168
v_cvt_pk_bf16_f32 v221, v186, v187
v_mfma_f32_16x16x32_bf16 v[136:139], a[4:7], v[84:87], v[136:139]
v_exp_f32 v182, v182
v_mfma_f32_16x16x32_bf16 v[136:139], a[8:11], v[100:103], v[136:139]
v_exp_f32 v167, v167
v_mfma_f32_16x16x32_bf16 v[136:139], a[12:15], v[116:119], v[136:139]
v_mfma_f32_16x16x32_bf16 v[144:147], a[0:3], a[32:35], v[232:235]
v_exp_f32 v183, v183
v_mfma_f32_16x16x32_bf16 v[144:147], a[4:7], a[40:43], v[144:147]
buffer_load_dwordx4 v31, s[28:31], s32 offen offset:1024 sc1 lds
v_mfma_f32_16x16x32_bf16 v[144:147], a[8:11], a[48:51], v[144:147]
v_exp_f32 v172, v172
v_mfma_f32_16x16x32_bf16 v[144:147], a[12:15], a[56:59], v[144:147]
v_exp_f32 v188, v188
v_mfma_f32_16x16x32_bf16 v[152:155], a[0:3], a[36:39], v[236:239]
v_mfma_f32_16x16x32_bf16 v[152:155], a[4:7], a[44:47], v[152:155]
v_exp_f32 v173, v173
v_mfma_f32_16x16x32_bf16 v[152:155], a[8:11], a[52:55], v[152:155]
v_mfma_f32_16x16x32_bf16 v[152:155], a[12:15], a[60:63], v[152:155]
v_exp_f32 v189, v189
s_waitcnt lgkmcnt(0)
v_mfma_f32_16x16x32_bf16 v[132:135], a[16:19], v[64:67], v[224:227]
ds_read_b128 a[0:3], v9 offset:0
v_cvt_pk_bf16_f32 v210, v164, v165
v_mfma_f32_16x16x32_bf16 v[132:135], a[20:23], v[80:83], v[132:135]
buffer_load_dwordx4 v31, s[28:31], s32 offen offset:2048 sc1 lds
v_cvt_pk_bf16_f32 v218, v180, v181
v_mfma_f32_16x16x32_bf16 v[132:135], a[24:27], v[96:99], v[132:135]
v_exp_f32 v174, v174
v_mfma_f32_16x16x32_bf16 v[132:135], a[28:31], v[112:115], v[132:135]
v_mfma_f32_16x16x32_bf16 v[140:143], a[16:19], v[68:71], v[228:231]
ds_read_b128 a[4:7], v9 offset:1024
v_cvt_pk_bf16_f32 v211, v166, v167
v_mfma_f32_16x16x32_bf16 v[140:143], a[20:23], v[84:87], v[140:143]
v_exp_f32 v190, v190
v_mfma_f32_16x16x32_bf16 v[140:143], a[24:27], v[100:103], v[140:143]
v_add_u32 v8, 0x8000, v8
v_cvt_pk_bf16_f32 v219, v182, v183
v_mfma_f32_16x16x32_bf16 v[140:143], a[28:31], v[116:119], v[140:143]
v_exp_f32 v175, v175
v_mfma_f32_16x16x32_bf16 v[148:151], a[16:19], a[32:35], v[232:235]
ds_read_b128 a[8:11], v9 offset:2048
v_mfma_f32_16x16x32_bf16 v[148:151], a[20:23], a[40:43], v[148:151]
buffer_load_dwordx4 v31, s[28:31], s32 offen offset:3072 sc1 lds
s_add_u32 s32, s32, 28672
s_add_u32 s33, s33, 0x8000
s_and_b32 s33, s33, 0x1ffff
v_mfma_f32_16x16x32_bf16 v[148:151], a[24:27], a[48:51], v[148:151]
v_and_b32 v8, 0x1ffff, v8
v_cvt_pk_bf16_f32 v214, v172, v173
v_mfma_f32_16x16x32_bf16 v[148:151], a[28:31], a[56:59], v[148:151]
v_exp_f32 v191, v191
v_mfma_f32_16x16x32_bf16 v[156:159], a[16:19], a[36:39], v[236:239]
ds_read_b128 a[12:15], v9 offset:3072
v_cvt_pk_bf16_f32 v222, v188, v189
v_mfma_f32_16x16x32_bf16 v[156:159], a[20:23], a[44:47], v[156:159]
v_cvt_pk_bf16_f32 v215, v174, v175
v_cvt_pk_bf16_f32 v223, v190, v191
v_mfma_f32_16x16x32_bf16 v[156:159], a[24:27], a[52:55], v[156:159]
v_mfma_f32_16x16x32_bf16 v[156:159], a[28:31], a[60:63], v[156:159]
s_waitcnt vmcnt(8)
s_barrier
v_mfma_f32_16x16x32_bf16 a[96:99], a[112:115], v[208:211], a[96:99]
v_exp_f32 v128, v128
v_mfma_f32_16x16x32_bf16 a[100:103], a[112:115], v[212:215], a[100:103]
v_exp_f32 v144, v144
v_mfma_f32_16x16x32_bf16 a[104:107], a[112:115], v[216:219], a[104:107]
v_mfma_f32_16x16x32_bf16 a[108:111], a[112:115], v[220:223], a[108:111]
v_exp_f32 v129, v129
s_waitcnt lgkmcnt(2)
v_mfma_f32_16x16x32_bf16 a[128:131], a[0:3], v[208:211], a[128:131]
ds_read_b128 a[16:19], v9 offset:4096
v_mfma_f32_16x16x32_bf16 a[160:163], a[0:3], v[212:215], a[160:163]
v_exp_f32 v145, v145
v_mfma_f32_16x16x32_bf16 a[192:195], a[0:3], v[216:219], a[192:195]
v_exp_f32 v130, v130
v_mfma_f32_16x16x32_bf16 a[224:227], a[0:3], v[220:223], a[224:227]
v_mfma_f32_16x16x32_bf16 a[132:135], a[4:7], v[208:211], a[132:135]
ds_read_b128 a[20:23], v9 offset:5120
s_mov_b32 m0, s33
v_mfma_f32_16x16x32_bf16 a[164:167], a[4:7], v[212:215], a[164:167]
buffer_load_dwordx4 v31, s[28:31], s32 offen offset:0 sc1 lds
v_cvt_pk_bf16_f32 v192, v128, v129
v_mfma_f32_16x16x32_bf16 a[196:199], a[4:7], v[216:219], a[196:199]
v_exp_f32 v146, v146
v_mfma_f32_16x16x32_bf16 a[228:231], a[4:7], v[220:223], a[228:231]
v_exp_f32 v131, v131
s_waitcnt lgkmcnt(2)
v_mfma_f32_16x16x32_bf16 a[136:139], a[8:11], v[208:211], a[136:139]
ds_read_b128 a[24:27], v9 offset:6144
v_cvt_pk_bf16_f32 v200, v144, v145
v_mfma_f32_16x16x32_bf16 a[168:171], a[8:11], v[212:215], a[168:171]
buffer_load_dwordx4 v31, s[28:31], s32 offen offset:1024 sc1 lds
v_mfma_f32_16x16x32_bf16 a[200:203], a[8:11], v[216:219], a[200:203]
v_exp_f32 v147, v147
v_mfma_f32_16x16x32_bf16 a[232:235], a[8:11], v[220:223], a[232:235]
v_exp_f32 v136, v136
v_mfma_f32_16x16x32_bf16 a[140:143], a[12:15], v[208:211], a[140:143]
ds_read_b128 a[28:31], v9 offset:7168
v_cvt_pk_bf16_f32 v193, v130, v131
v_mfma_f32_16x16x32_bf16 a[172:175], a[12:15], v[212:215], a[172:175]
v_exp_f32 v152, v152
v_mfma_f32_16x16x32_bf16 a[204:207], a[12:15], v[216:219], a[204:207]
v_exp_f32 v137, v137
v_mfma_f32_16x16x32_bf16 a[236:239], a[12:15], v[220:223], a[236:239]
s_waitcnt lgkmcnt(2)
v_mfma_f32_16x16x32_bf16 a[144:147], a[16:19], v[208:211], a[144:147]
ds_read_b128 a[0:3], v8 offset:0
v_cvt_pk_bf16_f32 v201, v146, v147
v_mfma_f32_16x16x32_bf16 a[176:179], a[16:19], v[212:215], a[176:179]
buffer_load_dwordx4 v31, s[28:31], s32 offen offset:2048 sc1 lds
v_mfma_f32_16x16x32_bf16 a[208:211], a[16:19], v[216:219], a[208:211]
ds_read_b128 a[4:7], v8 offset:1024
v_add_u32 v9, 0x8000, v9
v_mfma_f32_16x16x32_bf16 a[240:243], a[16:19], v[220:223], a[240:243]
v_exp_f32 v153, v153
v_mfma_f32_16x16x32_bf16 a[148:151], a[20:23], v[208:211], a[148:151]
ds_read_b128 a[8:11], v8 offset:2048
v_mfma_f32_16x16x32_bf16 a[180:183], a[20:23], v[212:215], a[180:183]
v_exp_f32 v138, v138
v_mfma_f32_16x16x32_bf16 a[212:215], a[20:23], v[216:219], a[212:215]
ds_read_b128 a[12:15], v8 offset:3072
v_and_b32 v9, 0x1ffff, v9
v_mfma_f32_16x16x32_bf16 a[244:247], a[20:23], v[220:223], a[244:247]
v_exp_f32 v154, v154
s_waitcnt lgkmcnt(4)
v_mfma_f32_16x16x32_bf16 a[152:155], a[24:27], v[208:211], a[152:155]
ds_read_b128 a[16:19], v8 offset:4096
v_cvt_pk_bf16_f32 v196, v136, v137
v_mfma_f32_16x16x32_bf16 a[184:187], a[24:27], v[212:215], a[184:187]
buffer_load_dwordx4 v31, s[28:31], s32 offen offset:3072 sc1 lds
v_cvt_pk_bf16_f32 v204, v152, v153
v_mfma_f32_16x16x32_bf16 a[216:219], a[24:27], v[216:219], a[216:219]
v_exp_f32 v139, v139
v_mfma_f32_16x16x32_bf16 a[248:251], a[24:27], v[220:223], a[248:251]
v_exp_f32 v155, v155
v_mfma_f32_16x16x32_bf16 a[156:159], a[28:31], v[208:211], a[156:159]
ds_read_b128 a[20:23], v8 offset:5120
v_mfma_f32_16x16x32_bf16 a[188:191], a[28:31], v[212:215], a[188:191]
v_exp_f32 v132, v132
v_mfma_f32_16x16x32_bf16 a[220:223], a[28:31], v[216:219], a[220:223]
v_exp_f32 v148, v148
v_mfma_f32_16x16x32_bf16 a[252:255], a[28:31], v[220:223], a[252:255]
v_exp_f32 v133, v133
s_waitcnt lgkmcnt(2)
v_mfma_f32_16x16x32_bf16 v[160:163], a[0:3], v[64:67], v[224:227]
ds_read_b128 a[24:27], v8 offset:6144
s_add_u32 m0, s33, 4096
s_add_u32 s32, s32, 4096
v_mfma_f32_16x16x32_bf16 v[160:163], a[4:7], v[80:83], v[160:163]
buffer_load_dwordx4 v31, s[28:31], s32 offen offset:0 sc1 lds
v_cvt_pk_bf16_f32 v197, v138, v139
v_mfma_f32_16x16x32_bf16 v[160:163], a[8:11], v[96:99], v[160:163]
v_exp_f32 v149, v149
v_mfma_f32_16x16x32_bf16 v[160:163], a[12:15], v[112:115], v[160:163]
v_exp_f32 v134, v134
v_mfma_f32_16x16x32_bf16 v[168:171], a[0:3], v[68:71], v[228:231]
ds_read_b128 a[28:31], v8 offset:7168
v_cvt_pk_bf16_f32 v205, v154, v155
v_mfma_f32_16x16x32_bf16 v[168:171], a[4:7], v[84:87], v[168:171]
v_exp_f32 v150, v150
v_mfma_f32_16x16x32_bf16 v[168:171], a[8:11], v[100:103], v[168:171]
v_exp_f32 v135, v135
v_mfma_f32_16x16x32_bf16 v[168:171], a[12:15], v[116:119], v[168:171]
v_mfma_f32_16x16x32_bf16 v[176:179], a[0:3], a[32:35], v[232:235]
v_exp_f32 v151, v151
v_mfma_f32_16x16x32_bf16 v[176:179], a[4:7], a[40:43], v[176:179]
buffer_load_dwordx4 v31, s[28:31], s32 offen offset:1024 sc1 lds
v_mfma_f32_16x16x32_bf16 v[176:179], a[8:11], a[48:51], v[176:179]
v_exp_f32 v140, v140
v_mfma_f32_16x16x32_bf16 v[176:179], a[12:15], a[56:59], v[176:179]
v_exp_f32 v156, v156
v_mfma_f32_16x16x32_bf16 v[184:187], a[0:3], a[36:39], v[236:239]
v_mfma_f32_16x16x32_bf16 v[184:187], a[4:7], a[44:47], v[184:187]
v_exp_f32 v141, v141
v_mfma_f32_16x16x32_bf16 v[184:187], a[8:11], a[52:55], v[184:187]
v_mfma_f32_16x16x32_bf16 v[184:187], a[12:15], a[60:63], v[184:187]
v_exp_f32 v157, v157
s_waitcnt lgkmcnt(0)
v_mfma_f32_16x16x32_bf16 v[164:167], a[16:19], v[64:67], v[224:227]
ds_read_b128 a[0:3], v9 offset:0
v_cvt_pk_bf16_f32 v194, v132, v133
v_mfma_f32_16x16x32_bf16 v[164:167], a[20:23], v[80:83], v[164:167]
buffer_load_dwordx4 v31, s[28:31], s32 offen offset:2048 sc1 lds
v_cvt_pk_bf16_f32 v202, v148, v149
v_mfma_f32_16x16x32_bf16 v[164:167], a[24:27], v[96:99], v[164:167]
v_exp_f32 v142, v142
v_mfma_f32_16x16x32_bf16 v[164:167], a[28:31], v[112:115], v[164:167]
v_mfma_f32_16x16x32_bf16 v[172:175], a[16:19], v[68:71], v[228:231]
ds_read_b128 a[4:7], v9 offset:1024
v_cvt_pk_bf16_f32 v195, v134, v135
v_mfma_f32_16x16x32_bf16 v[172:175], a[20:23], v[84:87], v[172:175]
v_exp_f32 v158, v158
v_mfma_f32_16x16x32_bf16 v[172:175], a[24:27], v[100:103], v[172:175]
v_add_u32 v8, 0x8000, v8
v_cvt_pk_bf16_f32 v203, v150, v151
v_mfma_f32_16x16x32_bf16 v[172:175], a[28:31], v[116:119], v[172:175]
v_exp_f32 v143, v143
v_mfma_f32_16x16x32_bf16 v[180:183], a[16:19], a[32:35], v[232:235]
ds_read_b128 a[8:11], v9 offset:2048
v_mfma_f32_16x16x32_bf16 v[180:183], a[20:23], a[40:43], v[180:183]
buffer_load_dwordx4 v31, s[28:31], s32 offen offset:3072 sc1 lds
s_add_u32 s32, s32, 28672
s_add_u32 s33, s33, 0x8000
s_and_b32 s33, s33, 0x1ffff
v_mfma_f32_16x16x32_bf16 v[180:183], a[24:27], a[48:51], v[180:183]
v_and_b32 v8, 0x1ffff, v8
v_cvt_pk_bf16_f32 v198, v140, v141
v_mfma_f32_16x16x32_bf16 v[180:183], a[28:31], a[56:59], v[180:183]
v_exp_f32 v159, v159
v_mfma_f32_16x16x32_bf16 v[188:191], a[16:19], a[36:39], v[236:239]
ds_read_b128 a[12:15], v9 offset:3072
v_cvt_pk_bf16_f32 v206, v156, v157
v_mfma_f32_16x16x32_bf16 v[188:191], a[20:23], a[44:47], v[188:191]
v_cvt_pk_bf16_f32 v199, v142, v143
v_cvt_pk_bf16_f32 v207, v158, v159
v_mfma_f32_16x16x32_bf16 v[188:191], a[24:27], a[52:55], v[188:191]
s_sub_u32 s46, s46, 1
s_cmp_lg_u32 s46, 0
v_mfma_f32_16x16x32_bf16 v[188:191], a[28:31], a[60:63], v[188:191]
s_cbranch_scc1 L_xf
L_xf_x:
s_cmp_eq_u32 s5, 7
s_cbranch_scc1 L_xt
s_and_b32 s75, s40, 96
s_lshr_b32 s74, s47, 9
s_sub_u32 s73, s75, s74
v_sub_u32 v11, s73, v10
s_xor_b32 s75, s75, 32
s_sub_u32 s73, s75, s74
v_sub_u32 v18, s73, v10
s_waitcnt vmcnt(8)
s_barrier
v_mfma_f32_16x16x32_bf16 a[96:99], a[112:115], v[192:195], a[96:99]
v_cmp_le_i32_e64 s[48:49], -16, v11
v_cmp_le_i32_e64 s[50:51], -15, v11
v_mfma_f32_16x16x32_bf16 a[100:103], a[112:115], v[196:199], a[100:103]
v_cmp_le_i32_e64 s[52:53], -14, v11
v_cmp_le_i32_e64 s[54:55], -13, v11
v_mfma_f32_16x16x32_bf16 a[104:107], a[112:115], v[200:203], a[104:107]
v_cmp_le_i32_e64 s[56:57], 0, v11
v_exp_f32 v160, v160
v_mfma_f32_16x16x32_bf16 a[108:111], a[112:115], v[204:207], a[108:111]
v_cmp_le_i32_e64 s[58:59], 1, v11
v_cmp_le_i32_e64 s[60:61], 2, v11
s_waitcnt lgkmcnt(2)
v_mfma_f32_16x16x32_bf16 a[128:131], a[0:3], v[192:195], a[128:131]
ds_read_b128 a[16:19], v9 offset:4096
v_cmp_le_i32_e64 s[62:63], 3, v11
v_exp_f32 v176, v176
v_mfma_f32_16x16x32_bf16 a[160:163], a[0:3], v[196:199], a[160:163]
v_cmp_le_i32_e64 s[64:65], 16, v11
v_cmp_le_i32_e64 s[66:67], 17, v11
v_mfma_f32_16x16x32_bf16 a[192:195], a[0:3], v[200:203], a[192:195]
v_cmp_le_i32_e64 s[90:91], 18, v11
v_cmp_le_i32_e64 s[92:93], 19, v11
v_exp_f32 v161, v161
v_mfma_f32_16x16x32_bf16 a[224:227], a[0:3], v[204:207], a[224:227]
v_cndmask_b32_e64 v240, v16, v224, s[56:57]
v_cndmask_b32_e64 v241, v16, v224, s[58:59]
v_exp_f32 v177, v177
v_mfma_f32_16x16x32_bf16 a[132:135], a[4:7], v[192:195], a[132:135]
ds_read_b128 a[20:23], v9 offset:5120
s_mov_b32 m0, s33
v_exp_f32 v162, v162
v_mfma_f32_16x16x32_bf16 a[164:167], a[4:7], v[196:199], a[164:167]
buffer_load_dwordx4 v31, s[28:31], s32 offen offset:0 sc1 lds
v_cndmask_b32_e64 v242, v16, v224, s[60:61]
v_cndmask_b32_e64 v243, v16, v224, s[62:63]
v_mfma_f32_16x16x32_bf16 a[196:199], a[4:7], v[200:203], a[196:199]
v_cndmask_b32_e64 v244, v16, v228, s[48:49]
v_cndmask_b32_e64 v245, v16, v228, s[50:51]
v_cvt_pk_bf16_f32 v208, v160, v161
v_mfma_f32_16x16x32_bf16 a[228:231], a[4:7], v[204:207], a[228:231]
v_cndmask_b32_e64 v246, v16, v228, s[52:53]
v_cndmask_b32_e64 v247, v16, v228, s[54:55]
v_exp_f32 v178, v178
s_waitcnt lgkmcnt(2)
v_mfma_f32_16x16x32_bf16 a[136:139], a[8:11], v[192:195], a[136:139]
ds_read_b128 a[24:27], v9 offset:6144
v_cndmask_b32_e64 v248, v16, v224, s[64:65]
v_cvt_pk_bf16_f32 v216, v176, v177
v_mfma_f32_16x16x32_bf16 a[168:171], a[8:11], v[196:199], a[168:171]
buffer_load_dwordx4 v31, s[28:31], s32 offen offset:1024 sc1 lds
v_cndmask_b32_e64 v249, v16, v224, s[66:67]
v_mfma_f32_16x16x32_bf16 a[200:203], a[8:11], v[200:203], a[200:203]
v_cndmask_b32_e64 v250, v16, v224, s[90:91]
v_cndmask_b32_e64 v251, v16, v224, s[92:93]
v_exp_f32 v163, v163
v_mfma_f32_16x16x32_bf16 a[232:235], a[8:11], v[204:207], a[232:235]
v_cndmask_b32_e64 v252, v16, v228, s[56:57]
v_cndmask_b32_e64 v253, v16, v228, s[58:59]
v_mfma_f32_16x16x32_bf16 a[140:143], a[12:15], v[192:195], a[140:143]
ds_read_b128 a[28:31], v9 offset:7168
v_cndmask_b32_e64 v254, v16, v228, s[60:61]
v_exp_f32 v179, v179
v_mfma_f32_16x16x32_bf16 a[172:175], a[12:15], v[196:199], a[172:175]
v_cndmask_b32_e64 v255, v16, v228, s[62:63]
v_cmp_le_i32_e64 s[48:49], -16, v18
v_exp_f32 v168, v168
v_mfma_f32_16x16x32_bf16 a[204:207], a[12:15], v[200:203], a[204:207]
v_cmp_le_i32_e64 s[50:51], -15, v18
v_cmp_le_i32_e64 s[52:53], -14, v18
v_cvt_pk_bf16_f32 v209, v162, v163
v_mfma_f32_16x16x32_bf16 a[236:239], a[12:15], v[204:207], a[236:239]
v_cmp_le_i32_e64 s[54:55], -13, v18
v_cmp_le_i32_e64 s[56:57], 0, v18
v_cvt_pk_bf16_f32 v217, v178, v179
s_waitcnt lgkmcnt(2)
v_mfma_f32_16x16x32_bf16 a[144:147], a[16:19], v[192:195], a[144:147]
ds_read_b128 a[0:3], v8 offset:0
v_cmp_le_i32_e64 s[58:59], 1, v18
v_mfma_f32_16x16x32_bf16 a[176:179], a[16:19], v[196:199], a[176:179]
buffer_load_dwordx4 v31, s[28:31], s32 offen offset:2048 sc1 lds
v_cmp_le_i32_e64 s[60:61], 2, v18
v_exp_f32 v184, v184
v_mfma_f32_16x16x32_bf16 a[208:211], a[16:19], v[200:203], a[208:211]
ds_read_b128 a[4:7], v8 offset:1024
v_add_u32 v9, 0x8000, v9
v_cmp_le_i32_e64 s[62:63], 3, v18
v_exp_f32 v169, v169
v_mfma_f32_16x16x32_bf16 a[240:243], a[16:19], v[204:207], a[240:243]
v_cmp_le_i32_e64 s[64:65], 16, v18
v_cmp_le_i32_e64 s[66:67], 17, v18
v_cmp_le_i32_e64 s[90:91], 18, v18
v_mfma_f32_16x16x32_bf16 a[148:151], a[20:23], v[192:195], a[148:151]
ds_read_b128 a[8:11], v8 offset:2048
v_cmp_le_i32_e64 s[92:93], 19, v18
v_exp_f32 v185, v185
v_mfma_f32_16x16x32_bf16 a[180:183], a[20:23], v[196:199], a[180:183]
v_cndmask_b32_e64 v32, v16, v232, s[56:57]
v_cndmask_b32_e64 v33, v16, v232, s[58:59]
v_exp_f32 v170, v170
v_mfma_f32_16x16x32_bf16 a[212:215], a[20:23], v[200:203], a[212:215]
ds_read_b128 a[12:15], v8 offset:3072
v_and_b32 v9, 0x1ffff, v9
v_cndmask_b32_e64 v34, v16, v232, s[60:61]
v_cvt_pk_bf16_f32 v212, v168, v169
v_mfma_f32_16x16x32_bf16 a[244:247], a[20:23], v[204:207], a[244:247]
v_cndmask_b32_e64 v35, v16, v232, s[62:63]
v_cndmask_b32_e64 v36, v16, v236, s[48:49]
v_cvt_pk_bf16_f32 v220, v184, v185
s_waitcnt lgkmcnt(4)
v_mfma_f32_16x16x32_bf16 a[152:155], a[24:27], v[192:195], a[152:155]
ds_read_b128 a[16:19], v8 offset:4096
v_cndmask_b32_e64 v37, v16, v236, s[50:51]
v_cndmask_b32_e64 v38, v16, v236, s[52:53]
v_mfma_f32_16x16x32_bf16 a[184:187], a[24:27], v[196:199], a[184:187]
buffer_load_dwordx4 v31, s[28:31], s32 offen offset:3072 sc1 lds
v_cndmask_b32_e64 v39, v16, v236, s[54:55]
v_cndmask_b32_e64 v40, v16, v232, s[64:65]
v_mfma_f32_16x16x32_bf16 a[216:219], a[24:27], v[200:203], a[216:219]
v_cndmask_b32_e64 v41, v16, v232, s[66:67]
v_cndmask_b32_e64 v42, v16, v232, s[90:91]
v_exp_f32 v186, v186
v_mfma_f32_16x16x32_bf16 a[248:251], a[24:27], v[204:207], a[248:251]
v_cndmask_b32_e64 v43, v16, v232, s[92:93]
v_cndmask_b32_e64 v44, v16, v236, s[56:57]
v_exp_f32 v171, v171
v_mfma_f32_16x16x32_bf16 a[156:159], a[28:31], v[192:195], a[156:159]
ds_read_b128 a[20:23], v8 offset:5120
v_cndmask_b32_e64 v45, v16, v236, s[58:59]
v_exp_f32 v187, v187
v_mfma_f32_16x16x32_bf16 a[188:191], a[28:31], v[196:199], a[188:191]
v_cndmask_b32_e64 v46, v16, v236, s[60:61]
v_cndmask_b32_e64 v47, v16, v236, s[62:63]
v_mfma_f32_16x16x32_bf16 a[220:223], a[28:31], v[200:203], a[220:223]
v_subrev_u32 v11, 64, v11
v_subrev_u32 v18, 64, v18
v_exp_f32 v164, v164
v_mfma_f32_16x16x32_bf16 a[252:255], a[28:31], v[204:207], a[252:255]
v_exp_f32 v180, v180
v_cvt_pk_bf16_f32 v213, v170, v171
s_waitcnt lgkmcnt(2)
v_mfma_f32_16x16x32_bf16 v[128:131], a[0:3], v[64:67], v[240:243]
ds_read_b128 a[24:27], v8 offset:6144
s_add_u32 m0, s33, 4096
s_add_u32 s32, s32, 4096
v_cvt_pk_bf16_f32 v221, v186, v187
v_mfma_f32_16x16x32_bf16 v[128:131], a[4:7], v[80:83], v[128:131]
buffer_load_dwordx4 v31, s[28:31], s32 offen offset:0 sc1 lds
v_exp_f32 v165, v165
v_mfma_f32_16x16x32_bf16 v[128:131], a[8:11], v[96:99], v[128:131]
v_exp_f32 v181, v181
v_mfma_f32_16x16x32_bf16 v[128:131], a[12:15], v[112:115], v[128:131]
v_exp_f32 v166, v166
v_mfma_f32_16x16x32_bf16 v[136:139], a[0:3], v[68:71], v[244:247]
ds_read_b128 a[28:31], v8 offset:7168
v_mfma_f32_16x16x32_bf16 v[136:139], a[4:7], v[84:87], v[136:139]
v_exp_f32 v182, v182
v_mfma_f32_16x16x32_bf16 v[136:139], a[8:11], v[100:103], v[136:139]
v_exp_f32 v167, v167
v_mfma_f32_16x16x32_bf16 v[136:139], a[12:15], v[116:119], v[136:139]
v_mfma_f32_16x16x32_bf16 v[144:147], a[0:3], a[32:35], v[32:35]
v_exp_f32 v183, v183
v_mfma_f32_16x16x32_bf16 v[144:147], a[4:7], a[40:43], v[144:147]
buffer_load_dwordx4 v31, s[28:31], s32 offen offset:1024 sc1 lds
v_mfma_f32_16x16x32_bf16 v[144:147], a[8:11], a[48:51], v[144:147]
v_exp_f32 v172, v172
v_mfma_f32_16x16x32_bf16 v[144:147], a[12:15], a[56:59], v[144:147]
v_exp_f32 v188, v188
v_mfma_f32_16x16x32_bf16 v[152:155], a[0:3], a[36:39], v[36:39]
v_mfma_f32_16x16x32_bf16 v[152:155], a[4:7], a[44:47], v[152:155]
v_exp_f32 v173, v173
v_mfma_f32_16x16x32_bf16 v[152:155], a[8:11], a[52:55], v[152:155]
v_mfma_f32_16x16x32_bf16 v[152:155], a[12:15], a[60:63], v[152:155]
v_exp_f32 v189, v189
s_waitcnt lgkmcnt(0)
v_mfma_f32_16x16x32_bf16 v[132:135], a[16:19], v[64:67], v[248:251]
ds_read_b128 a[0:3], v9 offset:0
v_cvt_pk_bf16_f32 v210, v164, v165
v_mfma_f32_16x16x32_bf16 v[132:135], a[20:23], v[80:83], v[132:135]
buffer_load_dwordx4 v31, s[28:31], s32 offen offset:2048 sc1 lds
v_cvt_pk_bf16_f32 v218, v180, v181
v_mfma_f32_16x16x32_bf16 v[132:135], a[24:27], v[96:99], v[132:135]
v_exp_f32 v174, v174
v_mfma_f32_16x16x32_bf16 v[132:135], a[28:31], v[112:115], v[132:135]
v_mfma_f32_16x16x32_bf16 v[140:143], a[16:19], v[68:71], v[252:255]
ds_read_b128 a[4:7], v9 offset:1024
v_cvt_pk_bf16_f32 v211, v166, v167
v_mfma_f32_16x16x32_bf16 v[140:143], a[20:23], v[84:87], v[140:143]
v_exp_f32 v190, v190
v_mfma_f32_16x16x32_bf16 v[140:143], a[24:27], v[100:103], v[140:143]
v_add_u32 v8, 0x8000, v8
v_cvt_pk_bf16_f32 v219, v182, v183
v_mfma_f32_16x16x32_bf16 v[140:143], a[28:31], v[116:119], v[140:143]
v_exp_f32 v175, v175
v_mfma_f32_16x16x32_bf16 v[148:151], a[16:19], a[32:35], v[40:43]
ds_read_b128 a[8:11], v9 offset:2048
v_mfma_f32_16x16x32_bf16 v[148:151], a[20:23], a[40:43], v[148:151]
buffer_load_dwordx4 v31, s[28:31], s32 offen offset:3072 sc1 lds
s_add_u32 s32, s32, 28672
s_add_u32 s33, s33, 0x8000
s_and_b32 s33, s33, 0x1ffff
v_mfma_f32_16x16x32_bf16 v[148:151], a[24:27], a[48:51], v[148:151]
v_and_b32 v8, 0x1ffff, v8
v_exp_f32 v191, v191
v_mfma_f32_16x16x32_bf16 v[148:151], a[28:31], a[56:59], v[148:151]
v_cvt_pk_bf16_f32 v214, v172, v173
v_cvt_pk_bf16_f32 v222, v188, v189
v_mfma_f32_16x16x32_bf16 v[156:159], a[16:19], a[36:39], v[44:47]
ds_read_b128 a[12:15], v9 offset:3072
v_cvt_pk_bf16_f32 v215, v174, v175
v_mfma_f32_16x16x32_bf16 v[156:159], a[20:23], a[44:47], v[156:159]
v_cvt_pk_bf16_f32 v223, v190, v191
v_mfma_f32_16x16x32_bf16 v[156:159], a[24:27], a[52:55], v[156:159]
v_mfma_f32_16x16x32_bf16 v[156:159], a[28:31], a[60:63], v[156:159]
s_waitcnt vmcnt(8)
s_barrier
v_mfma_f32_16x16x32_bf16 a[96:99], a[112:115], v[208:211], a[96:99]
v_cmp_le_i32_e64 s[48:49], -16, v11
v_cmp_le_i32_e64 s[50:51], -15, v11
v_mfma_f32_16x16x32_bf16 a[100:103], a[112:115], v[212:215], a[100:103]
v_cmp_le_i32_e64 s[52:53], -14, v11
v_cmp_le_i32_e64 s[54:55], -13, v11
v_mfma_f32_16x16x32_bf16 a[104:107], a[112:115], v[216:219], a[104:107]
v_cmp_le_i32_e64 s[56:57], 0, v11
v_cmp_le_i32_e64 s[58:59], 1, v11
v_exp_f32 v128, v128
v_mfma_f32_16x16x32_bf16 a[108:111], a[112:115], v[220:223], a[108:111]
v_cmp_le_i32_e64 s[60:61], 2, v11
v_cmp_le_i32_e64 s[62:63], 3, v11
s_waitcnt lgkmcnt(2)
v_mfma_f32_16x16x32_bf16 a[128:131], a[0:3], v[208:211], a[128:131]
ds_read_b128 a[16:19], v9 offset:4096
v_cmp_le_i32_e64 s[64:65], 16, v11
v_exp_f32 v144, v144
v_mfma_f32_16x16x32_bf16 a[160:163], a[0:3], v[212:215], a[160:163]
v_cmp_le_i32_e64 s[66:67], 17, v11
v_cmp_le_i32_e64 s[90:91], 18, v11
v_mfma_f32_16x16x32_bf16 a[192:195], a[0:3], v[216:219], a[192:195]
v_cmp_le_i32_e64 s[92:93], 19, v11
v_cndmask_b32_e64 v240, v16, v224, s[56:57]
v_exp_f32 v129, v129
v_mfma_f32_16x16x32_bf16 a[224:227], a[0:3], v[220:223], a[224:227]
v_cndmask_b32_e64 v241, v16, v224, s[58:59]
v_cndmask_b32_e64 v242, v16, v224, s[60:61]
v_exp_f32 v145, v145
v_mfma_f32_16x16x32_bf16 a[132:135], a[4:7], v[208:211], a[132:135]
ds_read_b128 a[20:23], v9 offset:5120
v_cndmask_b32_e64 v243, v16, v224, s[62:63]
v_mfma_f32_16x16x32_bf16 a[164:167], a[4:7], v[212:215], a[164:167]
v_cndmask_b32_e64 v244, v16, v228, s[48:49]
v_cndmask_b32_e64 v245, v16, v228, s[50:51]
v_exp_f32 v130, v130
v_mfma_f32_16x16x32_bf16 a[196:199], a[4:7], v[216:219], a[196:199]
v_cndmask_b32_e64 v246, v16, v228, s[52:53]
v_cndmask_b32_e64 v247, v16, v228, s[54:55]
v_cvt_pk_bf16_f32 v192, v128, v129
v_mfma_f32_16x16x32_bf16 a[228:231], a[4:7], v[220:223], a[228:231]
v_cndmask_b32_e64 v248, v16, v224, s[64:65]
v_cndmask_b32_e64 v249, v16, v224, s[66:67]
v_exp_f32 v146, v146
s_waitcnt lgkmcnt(2)
v_mfma_f32_16x16x32_bf16 a[136:139], a[8:11], v[208:211], a[136:139]
ds_read_b128 a[24:27], v9 offset:6144
v_cndmask_b32_e64 v250, v16, v224, s[90:91]
v_cvt_pk_bf16_f32 v200, v144, v145
v_mfma_f32_16x16x32_bf16 a[168:171], a[8:11], v[212:215], a[168:171]
v_cndmask_b32_e64 v251, v16, v224, s[92:93]
v_cndmask_b32_e64 v252, v16, v228, s[56:57]
v_mfma_f32_16x16x32_bf16 a[200:203], a[8:11], v[216:219], a[200:203]
v_cndmask_b32_e64 v253, v16, v228, s[58:59]
v_cndmask_b32_e64 v254, v16, v228, s[60:61]
v_exp_f32 v131, v131
v_mfma_f32_16x16x32_bf16 a[232:235], a[8:11], v[220:223], a[232:235]
v_cndmask_b32_e64 v255, v16, v228, s[62:63]
v_cmp_le_i32_e64 s[48:49], -16, v18
v_mfma_f32_16x16x32_bf16 a[140:143], a[12:15], v[208:211], a[140:143]
ds_read_b128 a[28:31], v9 offset:7168
v_cmp_le_i32_e64 s[50:51], -15, v18
v_exp_f32 v147, v147
v_mfma_f32_16x16x32_bf16 a[172:175], a[12:15], v[212:215], a[172:175]
v_cmp_le_i32_e64 s[52:53], -14, v18
v_cmp_le_i32_e64 s[54:55], -13, v18
v_exp_f32 v136, v136
v_mfma_f32_16x16x32_bf16 a[204:207], a[12:15], v[216:219], a[204:207]
v_cmp_le_i32_e64 s[56:57], 0, v18
v_cmp_le_i32_e64 s[58:59], 1, v18
v_cvt_pk_bf16_f32 v193, v130, v131
v_mfma_f32_16x16x32_bf16 a[236:239], a[12:15], v[220:223], a[236:239]
v_cmp_le_i32_e64 s[60:61], 2, v18
v_cmp_le_i32_e64 s[62:63], 3, v18
v_cvt_pk_bf16_f32 v201, v146, v147
s_waitcnt lgkmcnt(2)
v_mfma_f32_16x16x32_bf16 a[144:147], a[16:19], v[208:211], a[144:147]
ds_read_b128 a[0:3], v8 offset:0
v_cmp_le_i32_e64 s[64:65], 16, v18
v_mfma_f32_16x16x32_bf16 a[176:179], a[16:19], v[212:215], a[176:179]
v_cmp_le_i32_e64 s[66:67], 17, v18
v_cmp_le_i32_e64 s[90:91], 18, v18
v_exp_f32 v152, v152
v_mfma_f32_16x16x32_bf16 a[208:211], a[16:19], v[216:219], a[208:211]
ds_read_b128 a[4:7], v8 offset:1024
v_add_u32 v9, 0x8000, v9
v_exp_f32 v137, v137
v_mfma_f32_16x16x32_bf16 a[240:243], a[16:19], v[220:223], a[240:243]
v_cmp_le_i32_e64 s[92:93], 19, v18
v_cndmask_b32_e64 v32, v16, v232, s[56:57]
v_mfma_f32_16x16x32_bf16 a[148:151], a[20:23], v[208:211], a[148:151]
ds_read_b128 a[8:11], v8 offset:2048
v_cndmask_b32_e64 v33, v16, v232, s[58:59]
v_exp_f32 v153, v153
v_mfma_f32_16x16x32_bf16 a[180:183], a[20:23], v[212:215], a[180:183]
v_cndmask_b32_e64 v34, v16, v232, s[60:61]
v_cndmask_b32_e64 v35, v16, v232, s[62:63]
v_exp_f32 v138, v138
v_mfma_f32_16x16x32_bf16 a[212:215], a[20:23], v[216:219], a[212:215]
ds_read_b128 a[12:15], v8 offset:3072
v_and_b32 v9, 0x1ffff, v9
v_exp_f32 v154, v154
v_mfma_f32_16x16x32_bf16 a[244:247], a[20:23], v[220:223], a[244:247]
v_cndmask_b32_e64 v36, v16, v236, s[48:49]
v_cndmask_b32_e64 v37, v16, v236, s[50:51]
v_cvt_pk_bf16_f32 v196, v136, v137
s_waitcnt lgkmcnt(4)
v_mfma_f32_16x16x32_bf16 a[152:155], a[24:27], v[208:211], a[152:155]
ds_read_b128 a[16:19], v8 offset:4096
v_cndmask_b32_e64 v38, v16, v236, s[52:53]
v_cvt_pk_bf16_f32 v204, v152, v153
v_mfma_f32_16x16x32_bf16 a[184:187], a[24:27], v[212:215], a[184:187]
v_cndmask_b32_e64 v39, v16, v236, s[54:55]
v_cndmask_b32_e64 v40, v16, v232, s[64:65]
v_mfma_f32_16x16x32_bf16 a[216:219], a[24:27], v[216:219], a[216:219]
v_cndmask_b32_e64 v41, v16, v232, s[66:67]
v_cndmask_b32_e64 v42, v16, v232, s[90:91]
v_exp_f32 v139, v139
v_mfma_f32_16x16x32_bf16 a[248:251], a[24:27], v[220:223], a[248:251]
v_cndmask_b32_e64 v43, v16, v232, s[92:93]
v_cndmask_b32_e64 v44, v16, v236, s[56:57]
v_mfma_f32_16x16x32_bf16 a[156:159], a[28:31], v[208:211], a[156:159]
ds_read_b128 a[20:23], v8 offset:5120
v_cndmask_b32_e64 v45, v16, v236, s[58:59]
v_exp_f32 v155, v155
v_mfma_f32_16x16x32_bf16 a[188:191], a[28:31], v[212:215], a[188:191]
v_cndmask_b32_e64 v46, v16, v236, s[60:61]
v_cndmask_b32_e64 v47, v16, v236, s[62:63]
v_mfma_f32_16x16x32_bf16 a[220:223], a[28:31], v[216:219], a[220:223]
v_subrev_u32 v11, 64, v11
v_subrev_u32 v18, 64, v18
v_exp_f32 v132, v132
v_mfma_f32_16x16x32_bf16 a[252:255], a[28:31], v[220:223], a[252:255]
v_exp_f32 v148, v148
v_cvt_pk_bf16_f32 v197, v138, v139
s_waitcnt lgkmcnt(2)
v_mfma_f32_16x16x32_bf16 v[160:163], a[0:3], v[64:67], v[240:243]
ds_read_b128 a[24:27], v8 offset:6144
v_exp_f32 v133, v133
v_mfma_f32_16x16x32_bf16 v[160:163], a[4:7], v[80:83], v[160:163]
v_exp_f32 v149, v149
v_mfma_f32_16x16x32_bf16 v[160:163], a[8:11], v[96:99], v[160:163]
v_exp_f32 v134, v134
v_mfma_f32_16x16x32_bf16 v[160:163], a[12:15], v[112:115], v[160:163]
v_mfma_f32_16x16x32_bf16 v[168:171], a[0:3], v[68:71], v[244:247]
ds_read_b128 a[28:31], v8 offset:7168
v_cvt_pk_bf16_f32 v205, v154, v155
v_mfma_f32_16x16x32_bf16 v[168:171], a[4:7], v[84:87], v[168:171]
v_exp_f32 v150, v150
v_mfma_f32_16x16x32_bf16 v[168:171], a[8:11], v[100:103], v[168:171]
v_exp_f32 v135, v135
v_mfma_f32_16x16x32_bf16 v[168:171], a[12:15], v[116:119], v[168:171]
v_mfma_f32_16x16x32_bf16 v[176:179], a[0:3], a[32:35], v[32:35]
v_exp_f32 v151, v151
v_mfma_f32_16x16x32_bf16 v[176:179], a[4:7], a[40:43], v[176:179]
v_mfma_f32_16x16x32_bf16 v[176:179], a[8:11], a[48:51], v[176:179]
v_exp_f32 v140, v140
v_mfma_f32_16x16x32_bf16 v[176:179], a[12:15], a[56:59], v[176:179]
v_exp_f32 v156, v156
v_mfma_f32_16x16x32_bf16 v[184:187], a[0:3], a[36:39], v[36:39]
v_mfma_f32_16x16x32_bf16 v[184:187], a[4:7], a[44:47], v[184:187]
v_exp_f32 v141, v141
v_mfma_f32_16x16x32_bf16 v[184:187], a[8:11], a[52:55], v[184:187]
v_mfma_f32_16x16x32_bf16 v[184:187], a[12:15], a[60:63], v[184:187]
v_exp_f32 v157, v157
s_waitcnt lgkmcnt(0)
v_mfma_f32_16x16x32_bf16 v[164:167], a[16:19], v[64:67], v[248:251]
ds_read_b128 a[0:3], v9 offset:0
v_cvt_pk_bf16_f32 v194, v132, v133
v_mfma_f32_16x16x32_bf16 v[164:167], a[20:23], v[80:83], v[164:167]
v_cvt_pk_bf16_f32 v202, v148, v149
v_mfma_f32_16x16x32_bf16 v[164:167], a[24:27], v[96:99], v[164:167]
v_exp_f32 v142, v142
v_mfma_f32_16x16x32_bf16 v[164:167], a[28:31], v[112:115], v[164:167]
v_mfma_f32_16x16x32_bf16 v[172:175], a[16:19], v[68:71], v[252:255]
ds_read_b128 a[4:7], v9 offset:1024
v_cvt_pk_bf16_f32 v195, v134, v135
v_mfma_f32_16x16x32_bf16 v[172:175], a[20:23], v[84:87], v[172:175]
v_exp_f32 v158, v158
v_mfma_f32_16x16x32_bf16 v[172:175], a[24:27], v[100:103], v[172:175]
v_add_u32 v8, 0x8000, v8
v_cvt_pk_bf16_f32 v203, v150, v151
v_mfma_f32_16x16x32_bf16 v[172:175], a[28:31], v[116:119], v[172:175]
v_exp_f32 v143, v143
v_mfma_f32_16x16x32_bf16 v[180:183], a[16:19], a[32:35], v[40:43]
ds_read_b128 a[8:11], v9 offset:2048
v_mfma_f32_16x16x32_bf16 v[180:183], a[20:23], a[40:43], v[180:183]
v_exp_f32 v159, v159
v_mfma_f32_16x16x32_bf16 v[180:183], a[24:27], a[48:51], v[180:183]
v_and_b32 v8, 0x1ffff, v8
v_cvt_pk_bf16_f32 v198, v140, v141
v_mfma_f32_16x16x32_bf16 v[180:183], a[28:31], a[56:59], v[180:183]
v_cvt_pk_bf16_f32 v206, v156, v157
v_mfma_f32_16x16x32_bf16 v[188:191], a[16:19], a[36:39], v[44:47]
ds_read_b128 a[12:15], v9 offset:3072
v_cvt_pk_bf16_f32 v199, v142, v143
v_mfma_f32_16x16x32_bf16 v[188:191], a[20:23], a[44:47], v[188:191]
v_cvt_pk_bf16_f32 v207, v158, v159
v_mfma_f32_16x16x32_bf16 v[188:191], a[24:27], a[52:55], v[188:191]
v_mfma_f32_16x16x32_bf16 v[188:191], a[28:31], a[60:63], v[188:191]
L_xt:
s_waitcnt vmcnt(0)
s_barrier
v_mfma_f32_16x16x32_bf16 a[96:99], a[112:115], v[192:195], a[96:99]
v_exp_f32 v160, v160
v_mfma_f32_16x16x32_bf16 a[100:103], a[112:115], v[196:199], a[100:103]
s_add_u32 s73, s43, 1024
buffer_load_dwordx4 a[32:35], v31, s[28:31], s73 offen offset:0 sc1
v_exp_f32 v176, v176
v_mfma_f32_16x16x32_bf16 a[104:107], a[112:115], v[200:203], a[104:107]
v_exp_f32 v161, v161
v_mfma_f32_16x16x32_bf16 a[108:111], a[112:115], v[204:207], a[108:111]
v_exp_f32 v177, v177
s_waitcnt lgkmcnt(2)
v_mfma_f32_16x16x32_bf16 a[128:131], a[0:3], v[192:195], a[128:131]
ds_read_b128 a[16:19], v9 offset:4096
v_exp_f32 v162, v162
v_cvt_pk_bf16_f32 v208, v160, v161
v_mfma_f32_16x16x32_bf16 a[160:163], a[0:3], v[196:199], a[160:163]
buffer_load_dwordx4 a[48:51], v31, s[28:31], s73 offen offset:1024 sc1
v_exp_f32 v178, v178
v_mfma_f32_16x16x32_bf16 a[192:195], a[0:3], v[200:203], a[192:195]
v_exp_f32 v163, v163
v_mfma_f32_16x16x32_bf16 a[224:227], a[0:3], v[204:207], a[224:227]
v_exp_f32 v179, v179
v_exp_f32 v168, v168
v_mfma_f32_16x16x32_bf16 a[132:135], a[4:7], v[192:195], a[132:135]
ds_read_b128 a[20:23], v9 offset:5120
v_exp_f32 v184, v184
v_mfma_f32_16x16x32_bf16 a[164:167], a[4:7], v[196:199], a[164:167]
buffer_load_dwordx4 a[80:83], v31, s[28:31], s73 offen offset:2048 sc1
v_exp_f32 v169, v169
v_mfma_f32_16x16x32_bf16 a[196:199], a[4:7], v[200:203], a[196:199]
v_exp_f32 v185, v185
v_mfma_f32_16x16x32_bf16 a[228:231], a[4:7], v[204:207], a[228:231]
v_cvt_pk_bf16_f32 v216, v176, v177
v_exp_f32 v170, v170
s_waitcnt lgkmcnt(2)
v_mfma_f32_16x16x32_bf16 a[136:139], a[8:11], v[192:195], a[136:139]
ds_read_b128 a[24:27], v9 offset:6144
v_exp_f32 v186, v186
v_mfma_f32_16x16x32_bf16 a[168:171], a[8:11], v[196:199], a[168:171]
buffer_load_dwordx4 a[88:91], v31, s[28:31], s73 offen offset:3072 sc1
v_exp_f32 v171, v171
v_mfma_f32_16x16x32_bf16 a[200:203], a[8:11], v[200:203], a[200:203]
v_exp_f32 v187, v187
v_mfma_f32_16x16x32_bf16 a[232:235], a[8:11], v[204:207], a[232:235]
v_cvt_pk_bf16_f32 v209, v162, v163
v_cvt_pk_bf16_f32 v217, v178, v179
v_exp_f32 v164, v164
v_mfma_f32_16x16x32_bf16 a[140:143], a[12:15], v[192:195], a[140:143]
ds_read_b128 a[28:31], v9 offset:7168
v_exp_f32 v180, v180
v_mfma_f32_16x16x32_bf16 a[172:175], a[12:15], v[196:199], a[172:175]
v_add_u32 v9, 0x8000, v9
s_add_u32 s73, s43, 164864
buffer_load_dwordx4 a[36:39], v31, s[28:31], s73 offen offset:0 sc1
v_exp_f32 v165, v165
v_mfma_f32_16x16x32_bf16 a[204:207], a[12:15], v[200:203], a[204:207]
v_and_b32 v9, 0x1ffff, v9
v_exp_f32 v181, v181
v_mfma_f32_16x16x32_bf16 a[236:239], a[12:15], v[204:207], a[236:239]
v_cvt_pk_bf16_f32 v212, v168, v169
v_cvt_pk_bf16_f32 v220, v184, v185
s_waitcnt lgkmcnt(2)
v_mfma_f32_16x16x32_bf16 a[144:147], a[16:19], v[192:195], a[144:147]
ds_read_b128 a[0:3], v9 offset:0
v_exp_f32 v166, v166
v_mfma_f32_16x16x32_bf16 a[176:179], a[16:19], v[196:199], a[176:179]
buffer_load_dwordx4 a[52:55], v31, s[28:31], s73 offen offset:1024 sc1
v_exp_f32 v182, v182
v_cvt_pk_bf16_f32 v213, v170, v171
v_mfma_f32_16x16x32_bf16 a[208:211], a[16:19], v[200:203], a[208:211]
v_exp_f32 v167, v167
v_mfma_f32_16x16x32_bf16 a[240:243], a[16:19], v[204:207], a[240:243]
v_exp_f32 v183, v183
v_mfma_f32_16x16x32_bf16 a[148:151], a[20:23], v[192:195], a[148:151]
ds_read_b128 a[4:7], v9 offset:1024
v_cvt_pk_bf16_f32 v221, v186, v187
v_exp_f32 v172, v172
v_mfma_f32_16x16x32_bf16 a[180:183], a[20:23], v[196:199], a[180:183]
buffer_load_dwordx4 a[84:87], v31, s[28:31], s73 offen offset:2048 sc1
v_exp_f32 v188, v188
v_mfma_f32_16x16x32_bf16 a[212:215], a[20:23], v[200:203], a[212:215]
v_exp_f32 v173, v173
v_exp_f32 v189, v189
v_mfma_f32_16x16x32_bf16 a[244:247], a[20:23], v[204:207], a[244:247]
v_cvt_pk_bf16_f32 v210, v164, v165
v_cvt_pk_bf16_f32 v218, v180, v181
s_waitcnt lgkmcnt(2)
v_mfma_f32_16x16x32_bf16 a[152:155], a[24:27], v[192:195], a[152:155]
ds_read_b128 a[8:11], v9 offset:2048
v_exp_f32 v174, v174
v_mfma_f32_16x16x32_bf16 a[184:187], a[24:27], v[196:199], a[184:187]
buffer_load_dwordx4 a[92:95], v31, s[28:31], s73 offen offset:3072 sc1
v_exp_f32 v190, v190
v_mfma_f32_16x16x32_bf16 a[216:219], a[24:27], v[200:203], a[216:219]
v_exp_f32 v175, v175
v_mfma_f32_16x16x32_bf16 a[248:251], a[24:27], v[204:207], a[248:251]
v_exp_f32 v191, v191
v_mfma_f32_16x16x32_bf16 a[156:159], a[28:31], v[192:195], a[156:159]
ds_read_b128 a[12:15], v9 offset:3072
v_cvt_pk_bf16_f32 v211, v166, v167
v_cvt_pk_bf16_f32 v219, v182, v183
v_cvt_pk_bf16_f32 v214, v172, v173
v_mfma_f32_16x16x32_bf16 a[188:191], a[28:31], v[196:199], a[188:191]
v_cvt_pk_bf16_f32 v222, v188, v189
v_cvt_pk_bf16_f32 v215, v174, v175
v_cvt_pk_bf16_f32 v223, v190, v191
v_mfma_f32_16x16x32_bf16 a[220:223], a[28:31], v[200:203], a[220:223]
v_mfma_f32_16x16x32_bf16 a[252:255], a[28:31], v[204:207], a[252:255]
v_mfma_f32_16x16x32_bf16 a[96:99], a[112:115], v[208:211], a[96:99]
s_and_b32 s74, s5, 1
s_lshl_b32 s74, s74, 16
v_add_u32 v62, s74, v31
v_lshl_add_u32 v62, s3, 14, v62
v_mfma_f32_16x16x32_bf16 a[100:103], a[112:115], v[212:215], a[100:103]
v_xor_b32 v63, 0x4000, v62
s_lshl_b32 s74, s3, 9
s_add_u32 s74, s74, 147456
v_mfma_f32_16x16x32_bf16 a[104:107], a[112:115], v[216:219], a[104:107]
v_lshl_add_u32 v20, v1, 3, s74
v_xor_b32 v23, 0x200, v20
s_mov_b32 s8, s88
v_mfma_f32_16x16x32_bf16 a[108:111], a[112:115], v[220:223], a[108:111]
s_and_b32 s9, s89, 0xffff
s_mov_b32 s10, 2097152
s_mov_b32 s11, 0x20000
s_waitcnt lgkmcnt(2)
v_mfma_f32_16x16x32_bf16 a[128:131], a[0:3], v[208:211], a[128:131]
ds_read_b128 a[16:19], v9 offset:4096
s_mov_b32 s12, s84
s_and_b32 s13, s85, 0xffff
s_mov_b32 s14, 8388608
v_mfma_f32_16x16x32_bf16 a[160:163], a[0:3], v[212:215], a[160:163]
s_mov_b32 s15, 0x20000
s_lshr_b32 s45, s4, 3
s_and_b32 s75, s45, 1
v_mfma_f32_16x16x32_bf16 a[192:195], a[0:3], v[216:219], a[192:195]
s_lshl_b32 s75, s75, 2
s_and_b32 s62, s4, 7
s_xor_b32 s62, s62, s75
v_mfma_f32_16x16x32_bf16 a[224:227], a[0:3], v[220:223], a[224:227]
s_lshl_b32 s75, s62, 8
s_and_b32 s51, s5, 1
s_lshl_b32 s51, s51, 1
v_mfma_f32_16x16x32_bf16 a[132:135], a[4:7], v[208:211], a[132:135]
ds_read_b128 a[20:23], v9 offset:5120
s_xor_b32 s51, s51, 2
s_mul_i32 s21, s51, 40960
s_lshl_b32 s46, s3, 11
v_mfma_f32_16x16x32_bf16 a[164:167], a[4:7], v[212:215], a[164:167]
s_lshl_b32 s47, s3, 13
s_add_u32 s47, s47, 8192
v_add_u32 v6, 0, v2
v_mfma_f32_16x16x32_bf16 a[196:199], a[4:7], v[216:219], a[196:199]
v_lshlrev_b32 v7, 1, v6
v_xor_b32 v7, v3, v7
v_lshlrev_b32 v7, 4, v7
v_mfma_f32_16x16x32_bf16 a[228:231], a[4:7], v[220:223], a[228:231]
v_lshlrev_b32 v6, 11, v6
v_add3_u32 v18, v6, v7, s75
v_add_u32 v6, 4, v2
s_waitcnt lgkmcnt(2)
v_mfma_f32_16x16x32_bf16 a[136:139], a[8:11], v[208:211], a[136:139]
ds_read_b128 a[24:27], v9 offset:6144
v_lshlrev_b32 v7, 1, v6
v_xor_b32 v7, v3, v7
v_lshlrev_b32 v7, 4, v7
v_mfma_f32_16x16x32_bf16 a[168:171], a[8:11], v[212:215], a[168:171]
v_lshlrev_b32 v6, 11, v6
v_add3_u32 v19, v6, v7, s75
v_subrev_u32 v19, 1024, v19
ds_write_b128 v62, a[192:195] offset:0
v_mfma_f32_16x16x32_bf16 a[200:203], a[8:11], v[216:219], a[200:203]
v_lshrrev_b32 v6, 2, v3
v_lshl_add_u32 v6, v2, 2, v6
v_and_b32 v7, 7, v6
v_mfma_f32_16x16x32_bf16 a[232:235], a[8:11], v[220:223], a[232:235]
v_lshlrev_b32 v7, 5, v7
v_lshl_add_u32 v7, v6, 8, v7
v_and_b32 v6, 3, v3
ds_write_b128 v62, a[224:227] offset:8192
v_mfma_f32_16x16x32_bf16 a[140:143], a[12:15], v[208:211], a[140:143]
ds_read_b128 a[28:31], v9 offset:7168
v_lshl_add_u32 v7, v6, 3, v7
s_lshl_b32 s75, s45, 6
v_xor_b32 v7, s75, v7
v_mfma_f32_16x16x32_bf16 a[172:175], a[12:15], v[212:215], a[172:175]
s_mov_b32 s63, s21
s_and_b32 s75, s4, 28
s_add_u32 s20, s4, 1
ds_write_b128 v62, a[196:199] offset:1024
v_add_u32 v9, 0x8000, v9
v_mfma_f32_16x16x32_bf16 a[204:207], a[12:15], v[216:219], a[204:207]
s_and_b32 s20, s20, 3
s_or_b32 s20, s20, s75
s_add_u32 s44, s4, 2
v_and_b32 v9, 0x1ffff, v9
v_mfma_f32_16x16x32_bf16 a[236:239], a[12:15], v[220:223], a[236:239]
s_and_b32 s44, s44, 3
s_or_b32 s44, s44, s75
s_mov_b32 s52, s45
ds_write_b128 v62, a[228:231] offset:9216
s_waitcnt lgkmcnt(6)
v_mfma_f32_16x16x32_bf16 a[144:147], a[16:19], v[208:211], a[144:147]
v_mfma_f32_16x16x32_bf16 a[176:179], a[16:19], v[212:215], a[176:179]
ds_write_b128 v62, a[200:203] offset:2048
v_mfma_f32_16x16x32_bf16 a[208:211], a[16:19], v[216:219], a[208:211]
v_mfma_f32_16x16x32_bf16 a[240:243], a[16:19], v[220:223], a[240:243]
ds_write_b128 v62, a[232:235] offset:10240
v_mfma_f32_16x16x32_bf16 a[148:151], a[20:23], v[208:211], a[148:151]
v_mfma_f32_16x16x32_bf16 a[180:183], a[20:23], v[212:215], a[180:183]
ds_write_b128 v62, a[204:207] offset:3072
v_mfma_f32_16x16x32_bf16 a[212:215], a[20:23], v[216:219], a[212:215]
v_mfma_f32_16x16x32_bf16 a[244:247], a[20:23], v[220:223], a[244:247]
ds_write_b128 v62, a[236:239] offset:11264
s_waitcnt lgkmcnt(6)
v_mfma_f32_16x16x32_bf16 a[152:155], a[24:27], v[208:211], a[152:155]
v_mfma_f32_16x16x32_bf16 a[184:187], a[24:27], v[212:215], a[184:187]
ds_write_b128 v62, a[208:211] offset:4096
v_mfma_f32_16x16x32_bf16 a[216:219], a[24:27], v[216:219], a[216:219]
v_mfma_f32_16x16x32_bf16 a[248:251], a[24:27], v[220:223], a[248:251]
ds_write_b128 v62, a[240:243] offset:12288
v_mfma_f32_16x16x32_bf16 a[156:159], a[28:31], v[208:211], a[156:159]
v_mfma_f32_16x16x32_bf16 a[188:191], a[28:31], v[212:215], a[188:191]
ds_write_b128 v62, a[212:215] offset:5120
v_mfma_f32_16x16x32_bf16 a[220:223], a[28:31], v[216:219], a[220:223]
v_mfma_f32_16x16x32_bf16 a[252:255], a[28:31], v[220:223], a[252:255]
ds_write_b128 v62, a[244:247] offset:13312
v_accvgpr_read_b32 v52, a104
v_cmp_nlt_f32 vcc, v52, v17
s_or_b64 s[36:37], s[36:37], vcc
v_accvgpr_read_b32 v54, a108
v_cmp_nlt_f32 vcc, v54, v17
s_or_b64 s[36:37], s[36:37], vcc
v_accvgpr_read_b32 v56, a96
v_cmp_nlt_f32 vcc, v56, v17
s_or_b64 s[36:37], s[36:37], vcc
v_accvgpr_read_b32 v58, a100
v_cmp_nlt_f32 vcc, v58, v17
s_or_b64 s[36:37], s[36:37], vcc
v_mov_b32 v53, v54
ds_write_b64 v20, v[52:53]
ds_write_b128 v62, a[216:219] offset:6144
ds_write_b128 v62, a[248:251] offset:14336
ds_write_b128 v62, a[220:223] offset:7168
ds_write_b128 v62, a[252:255] offset:15360
s_cmp_lg_u64 s[36:37], 0
s_cselect_b32 s74, 1, 0
v_mov_b32 v21, s74
s_lshl_b32 s75, s3, 2
s_add_u32 s75, s75, 139264
v_mov_b32 v22, s75
ds_write_b32 v22, v21
v_mov_b32 v22, 139264
s_waitcnt lgkmcnt(0)
s_barrier
ds_read_b128 v[24:27], v22
ds_read_b64 v[60:61], v23
ds_read_b128 v[128:131], v63 offset:0
ds_read_b128 v[132:135], v63 offset:1024
ds_read_b128 v[136:139], v63 offset:2048
ds_read_b128 v[140:143], v63 offset:3072
ds_read_b128 v[144:147], v63 offset:4096
ds_read_b128 v[148:151], v63 offset:5120
ds_read_b128 v[152:155], v63 offset:6144
ds_read_b128 v[156:159], v63 offset:7168
ds_read_b128 v[160:163], v63 offset:8192
ds_read_b128 v[164:167], v63 offset:9216
ds_read_b128 v[168:171], v63 offset:10240
ds_read_b128 v[172:175], v63 offset:11264
ds_read_b128 v[176:179], v63 offset:12288
ds_read_b128 v[180:183], v63 offset:13312
ds_read_b128 v[184:187], v63 offset:14336
ds_read_b128 v[188:191], v63 offset:15360
s_and_b32 s23, s4, 31
s_lshl_b32 s23, s23, 2
s_add_u32 s23, s23, s3
s_lshl_b32 s22, s23, 14
s_lshl_b32 s23, s23, 16
s_add_u32 m0, s21, s46
s_nop 0
buffer_load_dwordx4 v18, s[8:11], s22 offen offset:0 lds
buffer_load_dwordx4 v19, s[8:11], s22 offen offset:1024 lds
s_waitcnt lgkmcnt(15)
v_or3_b32 v24, v24, v25, v26
v_or_b32 v24, v24, v27
s_nop 0
v_readfirstlane_b32 s75, v24
v_add_f32 v56, v56, v60
v_add_f32 v58, v58, v61
s_andn2_b32 s75, s75, s38
s_cmp_lg_u32 s75, 0
s_cbranch_scc1 L_slow
s_waitcnt lgkmcnt(0)
s_lshl_b32 s56, s5, 12
s_add_u32 s56, s56, 63995904
v_mov_b32 v24, 1
s_lshl_b32 s74, s4, 7
v_mov_b32 v25, s74
s_cmp_lg_u32 s3, 0
s_cbranch_scc1 L_sigA
buffer_store_dword v24, v25, s[28:31], s56 offen offset:4 sc1
L_sigA:
v_xor_b32 v8, 0, v7
v_add_u32 v8, s63, v8
v_xor_b32 v9, 32, v7
v_add_u32 v9, s63, v9
v_xor_b32 v10, 64, v7
v_add_u32 v10, s63, v10
v_xor_b32 v11, 96, v7
v_add_u32 v11, s63, v11
v_xor_b32 v12, 128, v7
v_add_u32 v12, s63, v12
v_xor_b32 v13, 160, v7
v_add_u32 v13, s63, v13
v_xor_b32 v14, 192, v7
v_add_u32 v14, s63, v14
v_xor_b32 v15, 224, v7
v_add_u32 v15, s63, v15
v_add_u32 v22, 163840, v31
s_mov_b32 s16, s86
s_and_b32 s17, s87, 0xffff
s_mov_b32 s18, 4194304
s_mov_b32 s19, 0x20000
s_mov_b32 s54, 4294885376
s_mov_b32 s55, 40960
s_mul_i32 s75, s4, 5120
s_sub_u32 s48, s42, s75
s_sub_u32 s49, s43, s75
s_add_u32 m0, s21, s47
s_nop 0
buffer_load_dwordx4 v18, s[12:15], s23 offen offset:0 lds
v_rcp_f32 v56, v56
v_sub_f32 v57, 1.0, v28
s_add_u32 s74, s42, 1024
v_mul_f32 v56, v56, v57
v_accvgpr_read_b32 v112, a128
v_accvgpr_read_b32 v113, a129
v_accvgpr_read_b32 v114, a130
v_accvgpr_read_b32 v115, a131
v_accvgpr_read_b32 v116, a132
v_accvgpr_read_b32 v117, a133
v_accvgpr_read_b32 v118, a134
buffer_load_dwordx4 v19, s[12:15], s23 offen offset:1024 lds
v_accvgpr_read_b32 v119, a135
v_pk_add_f32 v[112:113], v[112:113], v[128:129]
v_pk_add_f32 v[114:115], v[114:115], v[130:131]
v_pk_add_f32 v[116:117], v[116:117], v[132:133]
v_pk_add_f32 v[118:119], v[118:119], v[134:135]
v_pk_mul_f32 v[112:113], v[112:113], v[56:57] op_sel_hi:[1,0]
v_pk_mul_f32 v[114:115], v[114:115], v[56:57] op_sel_hi:[1,0]
v_pk_mul_f32 v[116:117], v[116:117], v[56:57] op_sel_hi:[1,0]
v_pk_mul_f32 v[118:119], v[118:119], v[56:57] op_sel_hi:[1,0]
v_cvt_pk_bf16_f32 v64, v112, v113
v_cvt_pk_bf16_f32 v65, v114, v115
v_cvt_pk_bf16_f32 v66, v116, v117
s_add_u32 s24, s23, 14336
buffer_load_dwordx4 v18, s[12:15], s24 offen offset:2048 lds
v_cvt_pk_bf16_f32 v67, v118, v119
v_accvgpr_read_b32 v120, a136
v_accvgpr_read_b32 v121, a137
v_accvgpr_read_b32 v122, a138
v_accvgpr_read_b32 v123, a139
v_accvgpr_read_b32 v124, a140
v_accvgpr_read_b32 v125, a141
v_accvgpr_read_b32 v126, a142
v_accvgpr_read_b32 v127, a143
v_pk_add_f32 v[120:121], v[120:121], v[136:137]
v_pk_add_f32 v[122:123], v[122:123], v[138:139]
buffer_load_dwordx4 v19, s[12:15], s24 offen offset:3072 lds
v_pk_add_f32 v[124:125], v[124:125], v[140:141]
v_pk_add_f32 v[126:127], v[126:127], v[142:143]
v_pk_mul_f32 v[120:121], v[120:121], v[56:57] op_sel_hi:[1,0]
v_pk_mul_f32 v[122:123], v[122:123], v[56:57] op_sel_hi:[1,0]
v_pk_mul_f32 v[124:125], v[124:125], v[56:57] op_sel_hi:[1,0]
v_pk_mul_f32 v[126:127], v[126:127], v[56:57] op_sel_hi:[1,0]
v_cvt_pk_bf16_f32 v68, v120, v121
v_cvt_pk_bf16_f32 v69, v122, v123
v_cvt_pk_bf16_f32 v70, v124, v125
v_cvt_pk_bf16_f32 v71, v126, v127
v_accvgpr_read_b32 v112, a144
v_accvgpr_read_b32 v113, a145
s_add_u32 m0, m0, 4096
s_nop 0
s_nop 0
s_add_u32 s23, s23, 32768
buffer_load_dwordx4 v18, s[12:15], s23 offen offset:0 lds
v_accvgpr_read_b32 v114, a146
v_accvgpr_read_b32 v115, a147
v_accvgpr_read_b32 v116, a148
v_accvgpr_read_b32 v117, a149
v_accvgpr_read_b32 v118, a150
v_accvgpr_read_b32 v119, a151
v_pk_add_f32 v[112:113], v[112:113], v[144:145]
v_pk_add_f32 v[114:115], v[114:115], v[146:147]
v_pk_add_f32 v[116:117], v[116:117], v[148:149]
v_pk_add_f32 v[118:119], v[118:119], v[150:151]
v_pk_mul_f32 v[112:113], v[112:113], v[56:57] op_sel_hi:[1,0]
buffer_load_dwordx4 v19, s[12:15], s23 offen offset:1024 lds
v_pk_mul_f32 v[114:115], v[114:115], v[56:57] op_sel_hi:[1,0]
v_pk_mul_f32 v[116:117], v[116:117], v[56:57] op_sel_hi:[1,0]
v_pk_mul_f32 v[118:119], v[118:119], v[56:57] op_sel_hi:[1,0]
v_cvt_pk_bf16_f32 v72, v112, v113
v_cvt_pk_bf16_f32 v73, v114, v115
v_cvt_pk_bf16_f32 v74, v116, v117
v_cvt_pk_bf16_f32 v75, v118, v119
v_accvgpr_read_b32 v120, a152
v_accvgpr_read_b32 v121, a153
v_accvgpr_read_b32 v122, a154
v_accvgpr_read_b32 v123, a155
v_accvgpr_read_b32 v124, a156
s_add_u32 s24, s24, 32768
buffer_load_dwordx4 v18, s[12:15], s24 offen offset:2048 lds
v_accvgpr_read_b32 v125, a157
v_accvgpr_read_b32 v126, a158
v_accvgpr_read_b32 v127, a159
v_pk_add_f32 v[120:121], v[120:121], v[152:153]
v_pk_add_f32 v[122:123], v[122:123], v[154:155]
v_pk_add_f32 v[124:125], v[124:125], v[156:157]
v_pk_add_f32 v[126:127], v[126:127], v[158:159]
v_pk_mul_f32 v[120:121], v[120:121], v[56:57] op_sel_hi:[1,0]
v_pk_mul_f32 v[122:123], v[122:123], v[56:57] op_sel_hi:[1,0]
v_pk_mul_f32 v[124:125], v[124:125], v[56:57] op_sel_hi:[1,0]
v_pk_mul_f32 v[126:127], v[126:127], v[56:57] op_sel_hi:[1,0]
buffer_load_dwordx4 v19, s[12:15], s24 offen offset:3072 lds
v_cvt_pk_bf16_f32 v76, v120, v121
v_cvt_pk_bf16_f32 v77, v122, v123
v_cvt_pk_bf16_f32 v78, v124, v125
v_cvt_pk_bf16_f32 v79, v126, v127
v_rcp_f32 v58, v58
v_sub_f32 v59, 1.0, v29
s_add_u32 s75, s42, 164864
v_mul_f32_e64 v58, v58, v59
v_accvgpr_read_b32 v112, a160
v_accvgpr_read_b32 v113, a161
v_accvgpr_read_b32 v114, a162
v_accvgpr_read_b32 v115, a163
s_add_u32 s21, s21, 40960
s_cmp_eq_u32 s21, 122880
s_cselect_b32 s21, 0, s21
s_nop 0
buffer_store_dwordx4 v[64:67], v31, s[28:31], s74 offen offset:0 sc1
v_accvgpr_read_b32 v116, a164
v_accvgpr_read_b32 v117, a165
v_accvgpr_read_b32 v118, a166
v_accvgpr_read_b32 v119, a167
v_pk_add_f32 v[112:113], v[112:113], v[160:161]
v_pk_add_f32 v[114:115], v[114:115], v[162:163]
v_pk_add_f32 v[116:117], v[116:117], v[164:165]
v_pk_add_f32 v[118:119], v[118:119], v[166:167]
v_pk_mul_f32 v[112:113], v[112:113], v[58:59] op_sel_hi:[1,0]
buffer_store_dwordx4 v[68:71], v31, s[28:31], s74 offen offset:1024 sc1
v_pk_mul_f32 v[114:115], v[114:115], v[58:59] op_sel_hi:[1,0]
v_pk_mul_f32 v[116:117], v[116:117], v[58:59] op_sel_hi:[1,0]
v_pk_mul_f32 v[118:119], v[118:119], v[58:59] op_sel_hi:[1,0]
v_cvt_pk_bf16_f32 v80, v112, v113
v_cvt_pk_bf16_f32 v81, v114, v115
v_cvt_pk_bf16_f32 v82, v116, v117
v_cvt_pk_bf16_f32 v83, v118, v119
buffer_store_dwordx4 v[80:83], v31, s[28:31], s75 offen offset:0 sc1
v_accvgpr_read_b32 v120, a168
buffer_store_dwordx4 v[72:75], v31, s[28:31], s74 offen offset:2048 sc1
v_accvgpr_read_b32 v121, a169
v_accvgpr_read_b32 v122, a170
v_accvgpr_read_b32 v123, a171
v_accvgpr_read_b32 v124, a172
v_accvgpr_read_b32 v125, a173
v_accvgpr_read_b32 v126, a174
v_accvgpr_read_b32 v127, a175
v_pk_add_f32 v[120:121], v[120:121], v[168:169]
v_pk_add_f32 v[122:123], v[122:123], v[170:171]
buffer_store_dwordx4 v[76:79], v31, s[28:31], s74 offen offset:3072 sc1
v_pk_add_f32 v[124:125], v[124:125], v[172:173]
v_pk_add_f32 v[126:127], v[126:127], v[174:175]
v_pk_mul_f32 v[120:121], v[120:121], v[58:59] op_sel_hi:[1,0]
v_pk_mul_f32 v[122:123], v[122:123], v[58:59] op_sel_hi:[1,0]
v_pk_mul_f32 v[124:125], v[124:125], v[58:59] op_sel_hi:[1,0]
v_pk_mul_f32 v[126:127], v[126:127], v[58:59] op_sel_hi:[1,0]
v_cvt_pk_bf16_f32 v84, v120, v121
v_cvt_pk_bf16_f32 v85, v122, v123
v_cvt_pk_bf16_f32 v86, v124, v125
v_cvt_pk_bf16_f32 v87, v126, v127
buffer_store_dwordx4 v[84:87], v31, s[28:31], s75 offen offset:1024 sc1
v_accvgpr_read_b32 v112, a176
v_accvgpr_read_b32 v113, a177
v_accvgpr_read_b32 v114, a178
v_accvgpr_read_b32 v115, a179
v_accvgpr_read_b32 v116, a180
v_accvgpr_read_b32 v117, a181
v_accvgpr_read_b32 v118, a182
v_accvgpr_read_b32 v119, a183
v_pk_add_f32 v[112:113], v[112:113], v[176:177]
v_pk_add_f32 v[114:115], v[114:115], v[178:179]
v_pk_add_f32 v[116:117], v[116:117], v[180:181]
v_pk_add_f32 v[118:119], v[118:119], v[182:183]
v_pk_mul_f32 v[112:113], v[112:113], v[58:59] op_sel_hi:[1,0]
v_pk_mul_f32 v[114:115], v[114:115], v[58:59] op_sel_hi:[1,0]
v_pk_mul_f32 v[116:117], v[116:117], v[58:59] op_sel_hi:[1,0]
v_pk_mul_f32 v[118:119], v[118:119], v[58:59] op_sel_hi:[1,0]
v_cvt_pk_bf16_f32 v88, v112, v113
v_cvt_pk_bf16_f32 v89, v114, v115
v_cvt_pk_bf16_f32 v90, v116, v117
v_cvt_pk_bf16_f32 v91, v118, v119
buffer_store_dwordx4 v[88:91], v31, s[28:31], s75 offen offset:2048 sc1
v_accvgpr_read_b32 v120, a184
v_accvgpr_read_b32 v121, a185
v_accvgpr_read_b32 v122, a186
v_accvgpr_read_b32 v123, a187
v_accvgpr_read_b32 v124, a188
v_accvgpr_read_b32 v125, a189
v_accvgpr_read_b32 v126, a190
v_accvgpr_read_b32 v127, a191
v_pk_add_f32 v[120:121], v[120:121], v[184:185]
v_pk_add_f32 v[122:123], v[122:123], v[186:187]
v_pk_add_f32 v[124:125], v[124:125], v[188:189]
v_pk_add_f32 v[126:127], v[126:127], v[190:191]
v_pk_mul_f32 v[120:121], v[120:121], v[58:59] op_sel_hi:[1,0]
v_pk_mul_f32 v[122:123], v[122:123], v[58:59] op_sel_hi:[1,0]
v_pk_mul_f32 v[124:125], v[124:125], v[58:59] op_sel_hi:[1,0]
v_pk_mul_f32 v[126:127], v[126:127], v[58:59] op_sel_hi:[1,0]
v_cvt_pk_bf16_f32 v92, v120, v121
v_cvt_pk_bf16_f32 v93, v122, v123
v_cvt_pk_bf16_f32 v94, v124, v125
v_cvt_pk_bf16_f32 v95, v126, v127
buffer_store_dwordx4 v[92:95], v31, s[28:31], s75 offen offset:3072 sc1
s_waitcnt vmcnt(8)
s_barrier
ds_read_b64_tr_b16 v[32:33], v8 offset:0
ds_read_b64_tr_b16 v[34:35], v8 offset:4096
ds_read_b64_tr_b16 v[36:37], v9 offset:0
ds_read_b64_tr_b16 v[38:39], v9 offset:4096
ds_read_b64_tr_b16 v[40:41], v10 offset:0
ds_read_b64_tr_b16 v[42:43], v10 offset:4096
ds_read_b64_tr_b16 v[44:45], v11 offset:0
ds_read_b64_tr_b16 v[46:47], v11 offset:4096
s_lshl_b32 s58, s5, 3
s_add_u32 s58, s58, s62
s_lshl_b32 s58, s58, 7
s_add_u32 s58, s58, 64028672
v_mov_b32 v27, 0
s_lshl_b32 s74, s3, 2
s_add_u32 s74, s74, 122880
v_mov_b32 v23, s74
v_mov_b32 v116, 122880
s_lshl_b32 s76, s52, 3
s_lshl_b32 s77, 1, s76
v_mov_b32 v26, s77
s_lshr_b32 s59, s52, 2
s_or_b32 s59, s59, s3
s_lshl_b32 s74, s20, 7
s_add_u32 s74, s74, 4
v_mov_b32 v20, s74
buffer_load_dword v21, v20, s[28:31], s56 offen sc1
s_waitcnt lgkmcnt(4)
v_mfma_f32_16x16x32_bf16 v[128:131], v[32:35], a[64:67], 0
ds_read_b64_tr_b16 v[48:49], v12 offset:0
ds_read_b64_tr_b16 v[50:51], v12 offset:4096
s_and_b32 s23, s20, 31
v_mfma_f32_16x16x32_bf16 v[160:163], v[32:35], a[68:71], 0
s_lshl_b32 s23, s23, 2
s_add_u32 s23, s23, s3
v_mfma_f32_16x16x32_bf16 v[192:195], v[32:35], a[72:75], 0
s_lshl_b32 s22, s23, 14
s_lshl_b32 s23, s23, 16
s_add_u32 m0, s21, s46
v_mfma_f32_16x16x32_bf16 v[224:227], v[32:35], a[76:79], 0
buffer_load_dwordx4 v18, s[8:11], s22 offen offset:0 lds
buffer_load_dwordx4 v19, s[8:11], s22 offen offset:1024 lds
s_cmp_lg_u32 s59, 0
s_cbranch_scc1 L_cl0
s_mov_b64 exec, 1
buffer_atomic_add v26, v27, s[28:31], s58 offen sc0 sc1
s_mov_b64 exec, -1
L_cl0:
buffer_load_dword v0, v25, s[8:11], 0 offen
v_mfma_f32_16x16x32_bf16 v[132:135], v[36:39], a[64:67], 0
ds_read_b64_tr_b16 v[52:53], v13 offset:0
v_mfma_f32_16x16x32_bf16 v[164:167], v[36:39], a[68:71], 0
ds_read_b64_tr_b16 v[54:55], v13 offset:4096
v_mfma_f32_16x16x32_bf16 v[196:199], v[36:39], a[72:75], 0
s_add_u32 m0, s21, s47
v_mfma_f32_16x16x32_bf16 v[228:231], v[36:39], a[76:79], 0
buffer_load_dwordx4 v18, s[12:15], s23 offen offset:0 lds
s_waitcnt lgkmcnt(4)
v_mfma_f32_16x16x32_bf16 v[136:139], v[40:43], a[64:67], 0
ds_read_b64_tr_b16 v[56:57], v14 offset:0
v_mfma_f32_16x16x32_bf16 v[168:171], v[40:43], a[68:71], 0
ds_read_b64_tr_b16 v[58:59], v14 offset:4096
v_mfma_f32_16x16x32_bf16 v[200:203], v[40:43], a[72:75], 0
buffer_load_dwordx4 v19, s[12:15], s23 offen offset:1024 lds
v_mfma_f32_16x16x32_bf16 v[232:235], v[40:43], a[76:79], 0
v_mfma_f32_16x16x32_bf16 v[140:143], v[44:47], a[64:67], 0
ds_read_b64_tr_b16 v[60:61], v15 offset:0
v_mfma_f32_16x16x32_bf16 v[172:175], v[44:47], a[68:71], 0
ds_read_b64_tr_b16 v[62:63], v15 offset:4096
v_mfma_f32_16x16x32_bf16 v[204:207], v[44:47], a[72:75], 0
s_add_u32 s24, s23, 14336
v_mfma_f32_16x16x32_bf16 v[236:239], v[44:47], a[76:79], 0
buffer_load_dwordx4 v18, s[12:15], s24 offen offset:2048 lds
s_waitcnt lgkmcnt(4)
v_mfma_f32_16x16x32_bf16 v[144:147], v[48:51], a[64:67], 0
ds_read_b64_tr_b16 v[32:33], v8 offset:8192
v_mfma_f32_16x16x32_bf16 v[176:179], v[48:51], a[68:71], 0
ds_read_b64_tr_b16 v[34:35], v8 offset:12288
v_mfma_f32_16x16x32_bf16 v[208:211], v[48:51], a[72:75], 0
buffer_load_dwordx4 v19, s[12:15], s24 offen offset:3072 lds
v_mfma_f32_16x16x32_bf16 v[240:243], v[48:51], a[76:79], 0
v_mfma_f32_16x16x32_bf16 v[148:151], v[52:55], a[64:67], 0
ds_read_b64_tr_b16 v[36:37], v9 offset:8192
ds_read_b64_tr_b16 v[38:39], v9 offset:12288
v_mfma_f32_16x16x32_bf16 v[180:183], v[52:55], a[68:71], 0
s_add_u32 m0, m0, 4096
v_mfma_f32_16x16x32_bf16 v[212:215], v[52:55], a[72:75], 0
s_add_u32 s23, s23, 32768
v_mfma_f32_16x16x32_bf16 v[244:247], v[52:55], a[76:79], 0
buffer_load_dwordx4 v18, s[12:15], s23 offen offset:0 lds
s_waitcnt lgkmcnt(4)
v_mfma_f32_16x16x32_bf16 v[152:155], v[56:59], a[64:67], 0
ds_read_b64_tr_b16 v[40:41], v10 offset:8192
v_mfma_f32_16x16x32_bf16 v[184:187], v[56:59], a[68:71], 0
ds_read_b64_tr_b16 v[42:43], v10 offset:12288
v_mfma_f32_16x16x32_bf16 v[216:219], v[56:59], a[72:75], 0
buffer_load_dwordx4 v19, s[12:15], s23 offen offset:1024 lds
v_mfma_f32_16x16x32_bf16 v[248:251], v[56:59], a[76:79], 0
v_mfma_f32_16x16x32_bf16 v[156:159], v[60:63], a[64:67], 0
ds_read_b64_tr_b16 v[44:45], v11 offset:8192
v_mfma_f32_16x16x32_bf16 v[188:191], v[60:63], a[68:71], 0
ds_read_b64_tr_b16 v[46:47], v11 offset:12288
v_mfma_f32_16x16x32_bf16 v[220:223], v[60:63], a[72:75], 0
s_add_u32 s24, s24, 32768
v_mfma_f32_16x16x32_bf16 v[252:255], v[60:63], a[76:79], 0
buffer_load_dwordx4 v18, s[12:15], s24 offen offset:2048 lds
s_waitcnt vmcnt(11)
s_barrier
s_cmp_lg_u32 s3, 0
s_cbranch_scc1 L_sig3
s_mov_b64 exec, 1
buffer_store_dword v24, v25, s[28:31], s56 offen sc1
s_mov_b64 exec, -1
L_sig3:
s_waitcnt lgkmcnt(4)
v_mfma_f32_16x16x32_bf16 v[128:131], v[32:35], v[64:67], v[128:131]
ds_read_b64_tr_b16 v[48:49], v12 offset:8192
ds_read_b64_tr_b16 v[50:51], v12 offset:12288
v_mfma_f32_16x16x32_bf16 v[160:163], v[32:35], v[80:83], v[160:163]
buffer_load_dwordx4 v19, s[12:15], s24 offen offset:3072 lds
v_mfma_f32_16x16x32_bf16 v[192:195], v[32:35], a[32:35], v[192:195]
s_add_u32 s21, s21, 40960
v_mfma_f32_16x16x32_bf16 v[224:227], v[32:35], a[36:39], v[224:227]
s_cmp_eq_u32 s21, 122880
s_cselect_b32 s21, 0, s21
s_waitcnt vmcnt(11)
L_pl3:
v_readfirstlane_b32 s74, v21
s_cmp_eq_u32 s74, 1
s_cbranch_scc1 L_pl3x
s_sleep 4
buffer_load_dword v21, v20, s[28:31], s56 offen sc1
s_waitcnt vmcnt(0)
s_branch L_pl3
L_pl3x:
v_mfma_f32_16x16x32_bf16 v[132:135], v[36:39], v[64:67], v[132:135]
ds_read_b64_tr_b16 v[52:53], v13 offset:8192
ds_read_b64_tr_b16 v[54:55], v13 offset:12288
v_mfma_f32_16x16x32_bf16 v[164:167], v[36:39], v[80:83], v[164:167]
s_mul_i32 s75, s20, 5120
s_add_u32 s26, s48, s75
v_mfma_f32_16x16x32_bf16 v[196:199], v[36:39], a[32:35], v[196:199]
s_add_u32 s27, s49, s75
s_add_u32 s64, s26, 4096
v_mfma_f32_16x16x32_bf16 v[228:231], v[36:39], a[36:39], v[228:231]
s_add_u32 s65, s27, 4096
buffer_load_dwordx4 a[8:11], v31, s[28:31], s27 offen offset:0 sc1
s_waitcnt lgkmcnt(4)
v_mfma_f32_16x16x32_bf16 v[136:139], v[40:43], v[64:67], v[136:139]
ds_read_b64_tr_b16 v[56:57], v14 offset:8192
ds_read_b64_tr_b16 v[58:59], v14 offset:12288
s_and_b32 s23, s44, 31
v_mfma_f32_16x16x32_bf16 v[168:171], v[40:43], v[80:83], v[168:171]
s_lshl_b32 s23, s23, 2
s_add_u32 s23, s23, s3
v_mfma_f32_16x16x32_bf16 v[200:203], v[40:43], a[32:35], v[200:203]
s_lshl_b32 s22, s23, 14
s_lshl_b32 s23, s23, 16
v_mfma_f32_16x16x32_bf16 v[232:235], v[40:43], a[36:39], v[232:235]
s_add_u32 m0, s21, s46
s_nop 0
buffer_load_dwordx4 v18, s[8:11], s22 offen offset:0 lds
v_mfma_f32_16x16x32_bf16 v[140:143], v[44:47], v[64:67], v[140:143]
ds_read_b64_tr_b16 v[60:61], v15 offset:8192
v_mfma_f32_16x16x32_bf16 v[172:175], v[44:47], v[80:83], v[172:175]
ds_read_b64_tr_b16 v[62:63], v15 offset:12288
v_mfma_f32_16x16x32_bf16 v[204:207], v[44:47], a[32:35], v[204:207]
buffer_load_dwordx4 a[24:27], v31, s[28:31], s27 offen offset:1024 sc1
v_mfma_f32_16x16x32_bf16 v[236:239], v[44:47], a[36:39], v[236:239]
s_waitcnt lgkmcnt(4)
v_mfma_f32_16x16x32_bf16 v[144:147], v[48:51], v[64:67], v[144:147]
ds_read_b64_tr_b16 v[32:33], v8 offset:16384
v_mfma_f32_16x16x32_bf16 v[176:179], v[48:51], v[80:83], v[176:179]
v_mfma_f32_16x16x32_bf16 v[208:211], v[48:51], a[32:35], v[208:211]
ds_read_b64_tr_b16 v[34:35], v8 offset:20480
v_mfma_f32_16x16x32_bf16 v[240:243], v[48:51], a[36:39], v[240:243]
v_mfma_f32_16x16x32_bf16 v[148:151], v[52:55], v[64:67], v[148:151]
ds_read_b64_tr_b16 v[36:37], v9 offset:16384
v_mfma_f32_16x16x32_bf16 v[180:183], v[52:55], v[80:83], v[180:183]
ds_read_b64_tr_b16 v[38:39], v9 offset:20480
v_mfma_f32_16x16x32_bf16 v[212:215], v[52:55], a[32:35], v[212:215]
buffer_load_dwordx4 v19, s[8:11], s22 offen offset:1024 lds
v_mfma_f32_16x16x32_bf16 v[244:247], v[52:55], a[36:39], v[244:247]
s_waitcnt lgkmcnt(4)
v_mfma_f32_16x16x32_bf16 v[152:155], v[56:59], v[64:67], v[152:155]
ds_read_b64_tr_b16 v[40:41], v10 offset:16384
v_mfma_f32_16x16x32_bf16 v[184:187], v[56:59], v[80:83], v[184:187]
ds_read_b64_tr_b16 v[42:43], v10 offset:20480
v_mfma_f32_16x16x32_bf16 v[216:219], v[56:59], a[32:35], v[216:219]
buffer_load_dwordx4 a[40:43], v31, s[28:31], s27 offen offset:2048 sc1
v_mfma_f32_16x16x32_bf16 v[248:251], v[56:59], a[36:39], v[248:251]
v_mfma_f32_16x16x32_bf16 v[156:159], v[60:63], v[64:67], v[156:159]
ds_read_b64_tr_b16 v[44:45], v11 offset:16384
v_mfma_f32_16x16x32_bf16 v[188:191], v[60:63], v[80:83], v[188:191]
ds_read_b64_tr_b16 v[46:47], v11 offset:20480
v_mfma_f32_16x16x32_bf16 v[220:223], v[60:63], a[32:35], v[220:223]
s_add_u32 m0, s21, s47
v_mfma_f32_16x16x32_bf16 v[252:255], v[60:63], a[36:39], v[252:255]
buffer_load_dwordx4 v18, s[12:15], s23 offen offset:0 lds
s_waitcnt lgkmcnt(4)
v_mfma_f32_16x16x32_bf16 v[128:131], v[32:35], v[68:71], v[128:131]
ds_read_b64_tr_b16 v[48:49], v12 offset:16384
v_mfma_f32_16x16x32_bf16 v[160:163], v[32:35], v[84:87], v[160:163]
v_mfma_f32_16x16x32_bf16 v[192:195], v[32:35], a[48:51], v[192:195]
ds_read_b64_tr_b16 v[50:51], v12 offset:20480
v_mfma_f32_16x16x32_bf16 v[224:227], v[32:35], a[52:55], v[224:227]
v_mfma_f32_16x16x32_bf16 v[132:135], v[36:39], v[68:71], v[132:135]
ds_read_b64_tr_b16 v[52:53], v13 offset:16384
v_mfma_f32_16x16x32_bf16 v[164:167], v[36:39], v[84:87], v[164:167]
ds_read_b64_tr_b16 v[54:55], v13 offset:20480
v_mfma_f32_16x16x32_bf16 v[196:199], v[36:39], a[48:51], v[196:199]
buffer_load_dwordx4 a[56:59], v31, s[28:31], s27 offen offset:3072 sc1
v_mfma_f32_16x16x32_bf16 v[228:231], v[36:39], a[52:55], v[228:231]
s_waitcnt lgkmcnt(4)
v_mfma_f32_16x16x32_bf16 v[136:139], v[40:43], v[68:71], v[136:139]
ds_read_b64_tr_b16 v[56:57], v14 offset:16384
v_mfma_f32_16x16x32_bf16 v[168:171], v[40:43], v[84:87], v[168:171]
ds_read_b64_tr_b16 v[58:59], v14 offset:20480
v_mfma_f32_16x16x32_bf16 v[200:203], v[40:43], a[48:51], v[200:203]
buffer_load_dwordx4 v19, s[12:15], s23 offen offset:1024 lds
v_mfma_f32_16x16x32_bf16 v[232:235], v[40:43], a[52:55], v[232:235]
v_mfma_f32_16x16x32_bf16 v[140:143], v[44:47], v[68:71], v[140:143]
ds_read_b64_tr_b16 v[60:61], v15 offset:16384
v_mfma_f32_16x16x32_bf16 v[172:175], v[44:47], v[84:87], v[172:175]
ds_read_b64_tr_b16 v[62:63], v15 offset:20480
v_mfma_f32_16x16x32_bf16 v[204:207], v[44:47], a[48:51], v[204:207]
buffer_load_dwordx4 a[72:75], v31, s[28:31], s65 offen offset:0 sc1
v_mfma_f32_16x16x32_bf16 v[236:239], v[44:47], a[52:55], v[236:239]
s_waitcnt vmcnt(17)
s_waitcnt lgkmcnt(4)
v_mfma_f32_16x16x32_bf16 v[144:147], v[48:51], v[68:71], v[144:147]
ds_read_b64_tr_b16 v[32:33], v8 offset:24576
ds_read_b64_tr_b16 v[34:35], v8 offset:28672
v_mfma_f32_16x16x32_bf16 v[176:179], v[48:51], v[84:87], v[176:179]
s_cmp_eq_u32 s51, 2
s_cselect_b32 s25, s54, s55
s_cselect_b32 s51, -1, s51
s_add_u32 s51, s51, 1
v_mfma_f32_16x16x32_bf16 v[208:211], v[48:51], a[48:51], v[208:211]
v_readfirstlane_b32 s78, v26
s_lshr_b32 s79, s78, s76
v_mfma_f32_16x16x32_bf16 v[240:243], v[48:51], a[52:55], v[240:243]
s_and_b32 s79, s79, 255
v_mfma_f32_16x16x32_bf16 v[148:151], v[52:55], v[68:71], v[148:151]
ds_read_b64_tr_b16 v[36:37], v9 offset:24576
ds_read_b64_tr_b16 v[38:39], v9 offset:28672
v_mfma_f32_16x16x32_bf16 v[180:183], v[52:55], v[84:87], v[180:183]
s_add_u32 s78, s78, s77
v_mfma_f32_16x16x32_bf16 v[212:215], v[52:55], a[48:51], v[212:215]
s_cmp_eq_u32 s52, 4
s_cselect_b32 s79, 99, s79
s_add_u32 s24, s23, 14336
v_mfma_f32_16x16x32_bf16 v[244:247], v[52:55], a[52:55], v[244:247]
buffer_load_dwordx4 v18, s[12:15], s24 offen offset:2048 lds
s_waitcnt lgkmcnt(4)
v_mfma_f32_16x16x32_bf16 v[152:155], v[56:59], v[68:71], v[152:155]
ds_read_b64_tr_b16 v[40:41], v10 offset:24576
ds_read_b64_tr_b16 v[42:43], v10 offset:28672
v_mfma_f32_16x16x32_bf16 v[184:187], v[56:59], v[84:87], v[184:187]
s_and_b32 s80, s52, 1
v_mfma_f32_16x16x32_bf16 v[216:219], v[56:59], a[48:51], v[216:219]
s_lshl_b32 s80, s80, 2
s_xor_b32 s80, s80, s62
v_mfma_f32_16x16x32_bf16 v[248:251], v[56:59], a[52:55], v[248:251]
buffer_load_dwordx4 a[12:15], v22, s[28:31], s27 offen offset:0 sc1
v_mfma_f32_16x16x32_bf16 v[156:159], v[60:63], v[68:71], v[156:159]
ds_read_b64_tr_b16 v[44:45], v11 offset:24576
v_mfma_f32_16x16x32_bf16 v[188:191], v[60:63], v[84:87], v[188:191]
ds_read_b64_tr_b16 v[46:47], v11 offset:28672
v_mfma_f32_16x16x32_bf16 v[220:223], v[60:63], a[48:51], v[220:223]
s_add_u32 s81, s79, 3
v_mfma_f32_16x16x32_bf16 v[252:255], v[60:63], a[52:55], v[252:255]
s_add_u32 s82, s80, s81
s_waitcnt lgkmcnt(4)
v_mfma_f32_16x16x32_bf16 v[128:131], v[32:35], v[72:75], v[128:131]
ds_read_b64_tr_b16 v[48:49], v12 offset:24576
ds_read_b64_tr_b16 v[50:51], v12 offset:28672
v_mfma_f32_16x16x32_bf16 v[160:163], v[32:35], v[88:91], v[160:163]
s_and_b32 s82, s82, 3
v_mfma_f32_16x16x32_bf16 v[192:195], v[32:35], a[80:83], v[192:195]
s_xor_b32 s80, s80, s81
s_and_b32 s80, s80, 4
v_mfma_f32_16x16x32_bf16 v[224:227], v[32:35], a[84:87], v[224:227]
buffer_load_dwordx4 v19, s[12:15], s24 offen offset:3072 lds
v_mfma_f32_16x16x32_bf16 v[132:135], v[36:39], v[72:75], v[132:135]
ds_read_b64_tr_b16 v[52:53], v13 offset:24576
ds_read_b64_tr_b16 v[54:55], v13 offset:28672
v_mfma_f32_16x16x32_bf16 v[164:167], v[36:39], v[88:91], v[164:167]
s_or_b32 s82, s82, s80
v_mfma_f32_16x16x32_bf16 v[196:199], v[36:39], a[80:83], v[196:199]
s_lshl_b32 s80, s52, 3
v_mfma_f32_16x16x32_bf16 v[228:231], v[36:39], a[84:87], v[228:231]
buffer_load_dwordx4 a[28:31], v22, s[28:31], s27 offen offset:1024 sc1
s_waitcnt lgkmcnt(4)
v_mfma_f32_16x16x32_bf16 v[136:139], v[40:43], v[72:75], v[136:139]
ds_read_b64_tr_b16 v[56:57], v14 offset:24576
ds_read_b64_tr_b16 v[58:59], v14 offset:28672
v_mfma_f32_16x16x32_bf16 v[168:171], v[40:43], v[88:91], v[168:171]
s_or_b32 s82, s82, s80
s_cmp_lt_u32 s79, 5
s_cselect_b32 s82, s82, 64
v_mfma_f32_16x16x32_bf16 v[200:203], v[40:43], a[80:83], v[200:203]
v_mov_b32 v118, s82
s_add_u32 m0, m0, 4096
v_mfma_f32_16x16x32_bf16 v[232:235], v[40:43], a[84:87], v[232:235]
s_add_u32 s23, s23, 32768
buffer_load_dwordx4 v18, s[12:15], s23 offen offset:0 lds
v_mfma_f32_16x16x32_bf16 v[140:143], v[44:47], v[72:75], v[140:143]
ds_read_b64_tr_b16 v[60:61], v15 offset:24576
v_mfma_f32_16x16x32_bf16 v[172:175], v[44:47], v[88:91], v[172:175]
ds_read_b64_tr_b16 v[62:63], v15 offset:28672
v_mfma_f32_16x16x32_bf16 v[204:207], v[44:47], a[80:83], v[204:207]
ds_write_b32 v23, v118
v_mfma_f32_16x16x32_bf16 v[236:239], v[44:47], a[84:87], v[236:239]
s_and_b32 s80, s78, 255
s_waitcnt lgkmcnt(5)
v_mfma_f32_16x16x32_bf16 v[144:147], v[48:51], v[72:75], v[144:147]
ds_read_b64_tr_b16 v[32:33], v8 offset:32768
ds_read_b64_tr_b16 v[34:35], v8 offset:36864
v_mfma_f32_16x16x32_bf16 v[176:179], v[48:51], v[88:91], v[176:179]
v_add_u32 v8, s25, v8
s_bfe_u32 s81, s78, 0x80008
v_mfma_f32_16x16x32_bf16 v[208:211], v[48:51], a[80:83], v[208:211]
s_cmp_lt_u32 s81, s80
s_cselect_b32 s83, 1, 0
s_min_u32 s80, s80, s81
v_mfma_f32_16x16x32_bf16 v[240:243], v[48:51], a[84:87], v[240:243]
buffer_load_dwordx4 a[44:47], v22, s[28:31], s27 offen offset:2048 sc1
v_mfma_f32_16x16x32_bf16 v[148:151], v[52:55], v[72:75], v[148:151]
ds_read_b64_tr_b16 v[36:37], v9 offset:32768
ds_read_b64_tr_b16 v[38:39], v9 offset:36864
v_mfma_f32_16x16x32_bf16 v[180:183], v[52:55], v[88:91], v[180:183]
v_add_u32 v9, s25, v9
v_mfma_f32_16x16x32_bf16 v[212:215], v[52:55], a[80:83], v[212:215]
s_bfe_u32 s81, s78, 0x80010
s_cmp_lt_u32 s81, s80
s_cselect_b32 s83, 2, s83
v_mfma_f32_16x16x32_bf16 v[244:247], v[52:55], a[84:87], v[244:247]
buffer_load_dwordx4 v19, s[12:15], s23 offen offset:1024 lds
s_waitcnt lgkmcnt(5)
v_mfma_f32_16x16x32_bf16 v[152:155], v[56:59], v[72:75], v[152:155]
ds_read_b64_tr_b16 v[40:41], v10 offset:32768
ds_read_b64_tr_b16 v[42:43], v10 offset:36864
v_mfma_f32_16x16x32_bf16 v[184:187], v[56:59], v[88:91], v[184:187]
v_add_u32 v10, s25, v10
s_min_u32 s80, s80, s81
v_mfma_f32_16x16x32_bf16 v[216:219], v[56:59], a[80:83], v[216:219]
s_lshr_b32 s81, s78, 24
s_cmp_lt_u32 s81, s80
s_cselect_b32 s83, 3, s83
v_mfma_f32_16x16x32_bf16 v[248:251], v[56:59], a[84:87], v[248:251]
buffer_load_dwordx4 a[60:63], v22, s[28:31], s27 offen offset:3072 sc1
v_mfma_f32_16x16x32_bf16 v[156:159], v[60:63], v[72:75], v[156:159]
ds_read_b64_tr_b16 v[44:45], v11 offset:32768
ds_read_b64_tr_b16 v[46:47], v11 offset:36864
v_mfma_f32_16x16x32_bf16 v[188:191], v[60:63], v[88:91], v[188:191]
v_add_u32 v11, s25, v11
ds_read_b64_tr_b16 v[48:49], v12 offset:32768
v_mfma_f32_16x16x32_bf16 v[220:223], v[60:63], a[80:83], v[220:223]
ds_read_b64_tr_b16 v[50:51], v12 offset:36864
v_add_u32 v12, s25, v12
v_mfma_f32_16x16x32_bf16 v[252:255], v[60:63], a[84:87], v[252:255]
s_min_u32 s80, s80, s81
s_cmp_lt_u32 s80, 5
s_cselect_b32 s83, s83, 4
s_waitcnt lgkmcnt(6)
v_mfma_f32_16x16x32_bf16 v[128:131], v[32:35], v[76:79], v[128:131]
ds_read_b64_tr_b16 v[52:53], v13 offset:32768
ds_read_b64_tr_b16 v[54:55], v13 offset:36864
v_add_u32 v13, s25, v13
v_mfma_f32_16x16x32_bf16 v[160:163], v[32:35], v[92:95], v[160:163]
ds_read_b64_tr_b16 v[56:57], v14 offset:32768
ds_read_b64_tr_b16 v[58:59], v14 offset:36864
v_add_u32 v14, s25, v14
v_mfma_f32_16x16x32_bf16 v[192:195], v[32:35], a[88:91], v[192:195]
s_lshl_b32 s80, s45, 3
s_lshr_b32 s80, s78, s80
s_and_b32 s80, s80, 255
v_mfma_f32_16x16x32_bf16 v[224:227], v[32:35], a[92:95], v[224:227]
s_add_u32 s24, s24, 32768
buffer_load_dwordx4 v18, s[12:15], s24 offen offset:2048 lds
v_mfma_f32_16x16x32_bf16 v[132:135], v[36:39], v[76:79], v[132:135]
ds_read_b64_tr_b16 v[60:61], v15 offset:32768
ds_read_b64_tr_b16 v[62:63], v15 offset:36864
v_mfma_f32_16x16x32_bf16 v[164:167], v[36:39], v[92:95], v[164:167]
v_add_u32 v15, s25, v15
v_mfma_f32_16x16x32_bf16 v[196:199], v[36:39], a[88:91], v[196:199]
s_cmp_lt_u32 s80, 5
s_cselect_b32 s83, s45, s83
s_cmp_lt_u32 s79, 5
s_cselect_b32 s52, s83, 4
v_mfma_f32_16x16x32_bf16 v[228:231], v[36:39], a[92:95], v[228:231]
buffer_load_dwordx4 a[76:79], v22, s[28:31], s65 offen offset:0 sc1
s_lshl_b32 s74, s20, 7
v_mov_b32 v20, s74
s_lshl_b32 s74, s44, 7
v_writelane_b32 v20, s74, 1
buffer_load_dword v21, v20, s[28:31], s56 offen sc1
s_waitcnt lgkmcnt(8)
v_mfma_f32_16x16x32_bf16 v[136:139], v[40:43], v[76:79], v[136:139]
s_lshl_b32 s76, s52, 3
v_mfma_f32_16x16x32_bf16 v[168:171], v[40:43], v[92:95], v[168:171]
s_lshl_b32 s77, 1, s76
v_mfma_f32_16x16x32_bf16 v[200:203], v[40:43], a[88:91], v[200:203]
v_mov_b32 v26, s77
v_mfma_f32_16x16x32_bf16 v[232:235], v[40:43], a[92:95], v[232:235]
buffer_load_dwordx4 v19, s[12:15], s24 offen offset:3072 lds
v_mfma_f32_16x16x32_bf16 v[140:143], v[44:47], v[76:79], v[140:143]
s_lshr_b32 s59, s52, 2
v_mfma_f32_16x16x32_bf16 v[172:175], v[44:47], v[92:95], v[172:175]
v_mfma_f32_16x16x32_bf16 v[204:207], v[44:47], a[88:91], v[204:207]
s_or_b32 s59, s59, s3
v_mfma_f32_16x16x32_bf16 v[236:239], v[44:47], a[92:95], v[236:239]
s_waitcnt vmcnt(21)
s_waitcnt lgkmcnt(0)
s_barrier
v_mfma_f32_16x16x32_bf16 v[144:147], v[48:51], v[76:79], v[144:147]
ds_read_b32 v117, v116
ds_read_b64_tr_b16 v[32:33], v10 offset:0
v_mfma_f32_16x16x32_bf16 v[176:179], v[48:51], v[92:95], v[176:179]
ds_read_b64_tr_b16 v[34:35], v10 offset:4096
ds_read_b64_tr_b16 v[36:37], v10 offset:8192
v_mfma_f32_16x16x32_bf16 v[208:211], v[48:51], a[88:91], v[208:211]
ds_read_b64_tr_b16 v[38:39], v10 offset:12288
s_add_u32 s21, s21, 40960
v_mfma_f32_16x16x32_bf16 v[240:243], v[48:51], a[92:95], v[240:243]
s_cmp_eq_u32 s21, 122880
s_cselect_b32 s21, 0, s21
buffer_load_dwordx4 a[0:3], v31, s[28:31], s26 offen offset:0 sc1
v_mfma_f32_16x16x32_bf16 v[148:151], v[52:55], v[76:79], v[148:151]
ds_read_b64_tr_b16 v[40:41], v10 offset:16384
v_mfma_f32_16x16x32_bf16 v[180:183], v[52:55], v[92:95], v[180:183]
ds_read_b64_tr_b16 v[42:43], v10 offset:20480
v_mfma_f32_16x16x32_bf16 v[212:215], v[52:55], a[88:91], v[212:215]
ds_read_b64_tr_b16 v[44:45], v10 offset:24576
v_mfma_f32_16x16x32_bf16 v[244:247], v[52:55], a[92:95], v[244:247]
buffer_load_dwordx4 a[4:7], v22, s[28:31], s26 offen offset:0 sc1
v_mfma_f32_16x16x32_bf16 v[152:155], v[56:59], v[76:79], v[152:155]
ds_read_b64_tr_b16 v[46:47], v10 offset:28672
v_mfma_f32_16x16x32_bf16 v[184:187], v[56:59], v[92:95], v[184:187]
ds_read_b64_tr_b16 v[120:121], v10 offset:32768
v_mfma_f32_16x16x32_bf16 v[216:219], v[56:59], a[88:91], v[216:219]
ds_read_b64_tr_b16 v[122:123], v10 offset:36864
v_mfma_f32_16x16x32_bf16 v[248:251], v[56:59], a[92:95], v[248:251]
v_mfma_f32_16x16x32_bf16 v[156:159], v[60:63], v[76:79], v[156:159]
s_cmp_eq_u32 s51, 2
s_cselect_b32 s25, s54, s55
s_cselect_b32 s51, -1, s51
s_add_u32 s51, s51, 1
v_mfma_f32_16x16x32_bf16 v[188:191], v[60:63], v[92:95], v[188:191]
v_add_u32 v10, s25, v10
s_waitcnt lgkmcnt(10)
v_mfma_f32_16x16x32_bf16 v[220:223], v[60:63], a[88:91], v[220:223]
s_mov_b32 s20, s44
v_readfirstlane_b32 s44, v117
v_mfma_f32_16x16x32_bf16 v[252:255], v[60:63], a[92:95], v[252:255]
s_cmp_ge_u32 s20, 64
s_cmp_lg_u32 s59, 0
s_cbranch_scc1 L_cl1
s_mov_b64 exec, 1
buffer_atomic_add v26, v27, s[28:31], s58 offen sc0 sc1
s_mov_b64 exec, -1
L_cl1:
buffer_load_dword v0, v25, s[8:11], 0 offen
s_waitcnt vmcnt(15)
s_waitcnt lgkmcnt(6)
v_mfma_f32_16x16x32_bf16 v[200:203], v[32:35], a[8:11], v[200:203]
v_subrev_u32 v119, s25, v10
ds_read_b64_tr_b16 v[48:49], v11 offset:0
ds_read_b64_tr_b16 v[50:51], v11 offset:4096
v_mfma_f32_16x16x32_bf16 v[200:203], v[36:39], a[24:27], v[200:203]
ds_read_b64_tr_b16 v[52:53], v11 offset:8192
ds_read_b64_tr_b16 v[54:55], v11 offset:12288
s_waitcnt lgkmcnt(4)
v_mfma_f32_16x16x32_bf16 v[200:203], v[40:43], a[40:43], v[200:203]
ds_read_b64_tr_b16 v[56:57], v11 offset:16384
ds_read_b64_tr_b16 v[58:59], v11 offset:20480
v_mfma_f32_16x16x32_bf16 v[200:203], v[44:47], a[56:59], v[200:203]
ds_read_b64_tr_b16 v[60:61], v11 offset:24576
ds_read_b64_tr_b16 v[62:63], v11 offset:28672
v_mfma_f32_16x16x32_bf16 v[200:203], v[120:123], a[72:75], v[200:203]
ds_read_b64_tr_b16 v[124:125], v11 offset:32768
ds_read_b64_tr_b16 v[126:127], v11 offset:36864
s_waitcnt vmcnt(5)
v_mfma_f32_16x16x32_bf16 v[232:235], v[32:35], a[12:15], v[232:235]
ds_read_b64_tr_b16 v[64:65], v12 offset:0
ds_read_b64_tr_b16 v[66:67], v12 offset:4096
v_mfma_f32_16x16x32_bf16 v[232:235], v[36:39], a[28:31], v[232:235]
ds_read_b64_tr_b16 v[68:69], v12 offset:8192
ds_read_b64_tr_b16 v[70:71], v12 offset:12288
v_mfma_f32_16x16x32_bf16 v[232:235], v[40:43], a[44:47], v[232:235]
ds_read_b64_tr_b16 v[72:73], v12 offset:16384
ds_read_b64_tr_b16 v[74:75], v12 offset:20480
v_mfma_f32_16x16x32_bf16 v[232:235], v[44:47], a[60:63], v[232:235]
ds_read_b64_tr_b16 v[76:77], v12 offset:24576
ds_read_b64_tr_b16 v[78:79], v12 offset:28672
v_mfma_f32_16x16x32_bf16 v[232:235], v[120:123], a[76:79], v[232:235]
ds_read_b64_tr_b16 v[80:81], v12 offset:32768
ds_read_b64_tr_b16 v[82:83], v12 offset:36864
s_waitcnt lgkmcnt(15)
v_mfma_f32_16x16x32_bf16 v[204:207], v[48:51], a[8:11], v[204:207]
ds_read_b64_tr_b16 v[84:85], v13 offset:0
v_mfma_f32_16x16x32_bf16 v[204:207], v[52:55], a[24:27], v[204:207]
ds_read_b64_tr_b16 v[86:87], v13 offset:4096
s_waitcnt lgkmcnt(12)
v_mfma_f32_16x16x32_bf16 v[204:207], v[56:59], a[40:43], v[204:207]
ds_read_b64_tr_b16 v[88:89], v13 offset:8192
v_mfma_f32_16x16x32_bf16 v[204:207], v[60:63], a[56:59], v[204:207]
ds_read_b64_tr_b16 v[90:91], v13 offset:12288
v_mfma_f32_16x16x32_bf16 v[204:207], v[124:127], a[72:75], v[204:207]
ds_read_b64_tr_b16 v[92:93], v13 offset:16384
v_mfma_f32_16x16x32_bf16 v[236:239], v[48:51], a[12:15], v[236:239]
ds_read_b64_tr_b16 v[94:95], v13 offset:20480
v_mfma_f32_16x16x32_bf16 v[236:239], v[52:55], a[28:31], v[236:239]
ds_read_b64_tr_b16 v[96:97], v13 offset:24576
v_mfma_f32_16x16x32_bf16 v[236:239], v[56:59], a[44:47], v[236:239]
ds_read_b64_tr_b16 v[98:99], v13 offset:28672
v_mfma_f32_16x16x32_bf16 v[236:239], v[60:63], a[60:63], v[236:239]
ds_read_b64_tr_b16 v[100:101], v13 offset:32768
v_mfma_f32_16x16x32_bf16 v[236:239], v[124:127], a[76:79], v[236:239]
ds_read_b64_tr_b16 v[102:103], v13 offset:36864
s_waitcnt lgkmcnt(15)
v_mfma_f32_16x16x32_bf16 v[208:211], v[64:67], a[8:11], v[208:211]
ds_read_b64_tr_b16 v[32:33], v14 offset:0
v_mfma_f32_16x16x32_bf16 v[208:211], v[68:71], a[24:27], v[208:211]
ds_read_b64_tr_b16 v[34:35], v14 offset:4096
s_waitcnt lgkmcnt(12)
v_mfma_f32_16x16x32_bf16 v[208:211], v[72:75], a[40:43], v[208:211]
ds_read_b64_tr_b16 v[36:37], v14 offset:8192
v_mfma_f32_16x16x32_bf16 v[208:211], v[76:79], a[56:59], v[208:211]
ds_read_b64_tr_b16 v[38:39], v14 offset:12288
v_mfma_f32_16x16x32_bf16 v[208:211], v[80:83], a[72:75], v[208:211]
ds_read_b64_tr_b16 v[40:41], v14 offset:16384
s_waitcnt vmcnt(4)
L_pc1:
v_readlane_b32 s74, v21, 0
v_readlane_b32 s75, v21, 1
s_and_b32 s74, s74, s75
s_cmp_eq_u32 s74, 1
s_cbranch_scc1 L_pc1x
s_sleep 4
buffer_load_dword v21, v20, s[28:31], s56 offen sc1
s_waitcnt vmcnt(0)
s_branch L_pc1
L_pc1x:
v_mfma_f32_16x16x32_bf16 v[240:243], v[64:67], a[12:15], v[240:243]
ds_read_b64_tr_b16 v[42:43], v14 offset:20480
ds_read_b64_tr_b16 v[44:45], v14 offset:24576
v_mfma_f32_16x16x32_bf16 v[240:243], v[68:71], a[28:31], v[240:243]
ds_read_b64_tr_b16 v[46:47], v14 offset:28672
v_mfma_f32_16x16x32_bf16 v[240:243], v[72:75], a[44:47], v[240:243]
ds_read_b64_tr_b16 v[120:121], v14 offset:32768
ds_read_b64_tr_b16 v[122:123], v14 offset:36864
v_mfma_f32_16x16x32_bf16 v[240:243], v[76:79], a[60:63], v[240:243]
buffer_load_dwordx4 a[16:19], v31, s[28:31], s26 offen offset:1024 sc1
v_mfma_f32_16x16x32_bf16 v[240:243], v[80:83], a[76:79], v[240:243]
buffer_load_dwordx4 a[32:35], v31, s[28:31], s26 offen offset:2048 sc1
s_waitcnt lgkmcnt(15)
v_mfma_f32_16x16x32_bf16 v[212:215], v[84:87], a[8:11], v[212:215]
ds_read_b64_tr_b16 v[48:49], v15 offset:0
ds_read_b64_tr_b16 v[50:51], v15 offset:4096
v_mfma_f32_16x16x32_bf16 v[212:215], v[88:91], a[24:27], v[212:215]
ds_read_b64_tr_b16 v[52:53], v15 offset:8192
s_waitcnt lgkmcnt(13)
v_mfma_f32_16x16x32_bf16 v[212:215], v[92:95], a[40:43], v[212:215]
ds_read_b64_tr_b16 v[54:55], v15 offset:12288
ds_read_b64_tr_b16 v[56:57], v15 offset:16384
v_mfma_f32_16x16x32_bf16 v[212:215], v[96:99], a[56:59], v[212:215]
buffer_load_dwordx4 a[48:51], v31, s[28:31], s26 offen offset:3072 sc1
v_mfma_f32_16x16x32_bf16 v[212:215], v[100:103], a[72:75], v[212:215]
buffer_load_dwordx4 a[64:67], v31, s[28:31], s64 offen offset:0 sc1
v_mfma_f32_16x16x32_bf16 v[244:247], v[84:87], a[12:15], v[244:247]
ds_read_b64_tr_b16 v[58:59], v15 offset:20480
ds_read_b64_tr_b16 v[60:61], v15 offset:24576
v_mfma_f32_16x16x32_bf16 v[244:247], v[88:91], a[28:31], v[244:247]
ds_read_b64_tr_b16 v[62:63], v15 offset:28672
v_mfma_f32_16x16x32_bf16 v[244:247], v[92:95], a[44:47], v[244:247]
ds_read_b64_tr_b16 v[124:125], v15 offset:32768
v_mfma_f32_16x16x32_bf16 v[244:247], v[96:99], a[60:63], v[244:247]
ds_read_b64_tr_b16 v[126:127], v15 offset:36864
v_mfma_f32_16x16x32_bf16 v[244:247], v[100:103], a[76:79], v[244:247]
buffer_load_dwordx4 a[20:23], v22, s[28:31], s26 offen offset:1024 sc1
s_waitcnt lgkmcnt(15)
v_mfma_f32_16x16x32_bf16 v[216:219], v[32:35], a[8:11], v[216:219]
ds_read_b64_tr_b16 v[64:65], v8 offset:0
ds_read_b64_tr_b16 v[66:67], v8 offset:4096
v_mfma_f32_16x16x32_bf16 v[216:219], v[36:39], a[24:27], v[216:219]
ds_read_b64_tr_b16 v[68:69], v8 offset:8192
s_waitcnt lgkmcnt(13)
v_mfma_f32_16x16x32_bf16 v[216:219], v[40:43], a[40:43], v[216:219]
ds_read_b64_tr_b16 v[70:71], v8 offset:12288
ds_read_b64_tr_b16 v[72:73], v8 offset:16384
v_mfma_f32_16x16x32_bf16 v[216:219], v[44:47], a[56:59], v[216:219]
buffer_load_dwordx4 a[36:39], v22, s[28:31], s26 offen offset:2048 sc1
v_mfma_f32_16x16x32_bf16 v[216:219], v[120:123], a[72:75], v[216:219]
buffer_load_dwordx4 a[52:55], v22, s[28:31], s26 offen offset:3072 sc1
v_mfma_f32_16x16x32_bf16 v[248:251], v[32:35], a[12:15], v[248:251]
ds_read_b64_tr_b16 v[74:75], v8 offset:20480
ds_read_b64_tr_b16 v[76:77], v8 offset:24576
v_mfma_f32_16x16x32_bf16 v[248:251], v[36:39], a[28:31], v[248:251]
ds_read_b64_tr_b16 v[78:79], v8 offset:28672
v_mfma_f32_16x16x32_bf16 v[248:251], v[40:43], a[44:47], v[248:251]
ds_read_b64_tr_b16 v[80:81], v8 offset:32768
v_mfma_f32_16x16x32_bf16 v[248:251], v[44:47], a[60:63], v[248:251]
ds_read_b64_tr_b16 v[82:83], v8 offset:36864
v_mfma_f32_16x16x32_bf16 v[248:251], v[120:123], a[76:79], v[248:251]
buffer_load_dwordx4 a[68:71], v22, s[28:31], s64 offen offset:0 sc1
s_waitcnt lgkmcnt(15)
v_mfma_f32_16x16x32_bf16 v[220:223], v[48:51], a[8:11], v[220:223]
ds_read_b64_tr_b16 v[84:85], v9 offset:0
ds_read_b64_tr_b16 v[86:87], v9 offset:4096
ds_read_b64_tr_b16 v[88:89], v9 offset:8192
v_mfma_f32_16x16x32_bf16 v[220:223], v[52:55], a[24:27], v[220:223]
ds_read_b64_tr_b16 v[90:91], v9 offset:12288
ds_read_b64_tr_b16 v[92:93], v9 offset:16384
s_waitcnt lgkmcnt(15)
v_mfma_f32_16x16x32_bf16 v[220:223], v[56:59], a[40:43], v[220:223]
s_mul_i32 s75, s20, 5120
s_add_u32 s26, s48, s75
s_add_u32 s27, s49, s75
v_mfma_f32_16x16x32_bf16 v[220:223], v[60:63], a[56:59], v[220:223]
s_add_u32 s64, s26, 4096
s_add_u32 s65, s27, 4096
v_mfma_f32_16x16x32_bf16 v[220:223], v[124:127], a[72:75], v[220:223]
buffer_load_dwordx4 a[176:179], v31, s[28:31], s26 offen offset:0 sc1
buffer_load_dwordx4 a[192:195], v31, s[28:31], s26 offen offset:1024 sc1
v_mfma_f32_16x16x32_bf16 v[252:255], v[48:51], a[12:15], v[252:255]
ds_read_b64_tr_b16 v[94:95], v9 offset:20480
ds_read_b64_tr_b16 v[96:97], v9 offset:24576
v_mfma_f32_16x16x32_bf16 v[252:255], v[52:55], a[28:31], v[252:255]
ds_read_b64_tr_b16 v[98:99], v9 offset:28672
v_mfma_f32_16x16x32_bf16 v[252:255], v[56:59], a[44:47], v[252:255]
ds_read_b64_tr_b16 v[100:101], v9 offset:32768
v_mfma_f32_16x16x32_bf16 v[252:255], v[60:63], a[60:63], v[252:255]
ds_read_b64_tr_b16 v[102:103], v9 offset:36864
v_mfma_f32_16x16x32_bf16 v[252:255], v[124:127], a[76:79], v[252:255]
buffer_load_dwordx4 a[208:211], v31, s[28:31], s26 offen offset:2048 sc1
s_waitcnt vmcnt(11)
s_waitcnt lgkmcnt(15)
v_mfma_f32_16x16x32_bf16 v[192:195], v[64:67], a[8:11], v[192:195]
ds_read_b64_tr_b16 v[32:33], v119 offset:0
ds_read_b64_tr_b16 v[34:35], v119 offset:4096
ds_read_b64_tr_b16 v[36:37], v119 offset:8192
ds_read_b64_tr_b16 v[38:39], v119 offset:12288
v_mfma_f32_16x16x32_bf16 v[192:195], v[68:71], a[24:27], v[192:195]
ds_read_b64_tr_b16 v[40:41], v119 offset:16384
v_readfirstlane_b32 s78, v26
s_lshr_b32 s79, s78, s76
s_waitcnt lgkmcnt(15)
v_mfma_f32_16x16x32_bf16 v[192:195], v[72:75], a[40:43], v[192:195]
s_and_b32 s79, s79, 255
buffer_load_dwordx4 a[224:227], v31, s[28:31], s26 offen offset:3072 sc1
s_and_b32 s23, s44, 31
v_mfma_f32_16x16x32_bf16 v[192:195], v[76:79], a[56:59], v[192:195]
s_lshl_b32 s23, s23, 2
s_add_u32 s23, s23, s3
s_lshl_b32 s22, s23, 14
v_mfma_f32_16x16x32_bf16 v[192:195], v[80:83], a[72:75], v[192:195]
s_lshl_b32 s23, s23, 16
s_add_u32 m0, s21, s46
s_nop 0
buffer_load_dwordx4 v18, s[8:11], s22 offen offset:0 lds
v_mfma_f32_16x16x32_bf16 v[224:227], v[64:67], a[12:15], v[224:227]
ds_read_b64_tr_b16 v[42:43], v119 offset:20480
ds_read_b64_tr_b16 v[44:45], v119 offset:24576
v_mfma_f32_16x16x32_bf16 v[224:227], v[68:71], a[28:31], v[224:227]
ds_read_b64_tr_b16 v[46:47], v119 offset:28672
ds_read_b64_tr_b16 v[120:121], v119 offset:32768
v_mfma_f32_16x16x32_bf16 v[224:227], v[72:75], a[44:47], v[224:227]
ds_read_b64_tr_b16 v[122:123], v119 offset:36864
v_mfma_f32_16x16x32_bf16 v[224:227], v[76:79], a[60:63], v[224:227]
s_add_u32 s78, s78, s77
s_cmp_eq_u32 s52, 4
s_cselect_b32 s79, 99, s79
v_mfma_f32_16x16x32_bf16 v[224:227], v[80:83], a[76:79], v[224:227]
buffer_load_dwordx4 a[240:243], v31, s[28:31], s64 offen offset:0 sc1
s_waitcnt lgkmcnt(15)
v_mfma_f32_16x16x32_bf16 v[196:199], v[84:87], a[8:11], v[196:199]
ds_read_b64_tr_b16 v[48:49], v11 offset:0
ds_read_b64_tr_b16 v[50:51], v11 offset:4096
v_mfma_f32_16x16x32_bf16 v[196:199], v[88:91], a[24:27], v[196:199]
ds_read_b64_tr_b16 v[52:53], v11 offset:8192
ds_read_b64_tr_b16 v[54:55], v11 offset:12288
s_waitcnt lgkmcnt(14)
v_mfma_f32_16x16x32_bf16 v[196:199], v[92:95], a[40:43], v[196:199]
ds_read_b64_tr_b16 v[56:57], v11 offset:16384
s_and_b32 s80, s52, 1
v_mfma_f32_16x16x32_bf16 v[196:199], v[96:99], a[56:59], v[196:199]
s_lshl_b32 s80, s80, 2
s_xor_b32 s80, s80, s62
v_mfma_f32_16x16x32_bf16 v[196:199], v[100:103], a[72:75], v[196:199]
buffer_load_dwordx4 a[180:183], v22, s[28:31], s26 offen offset:0 sc1
buffer_load_dwordx4 a[196:199], v22, s[28:31], s26 offen offset:1024 sc1
v_mfma_f32_16x16x32_bf16 v[228:231], v[84:87], a[12:15], v[228:231]
ds_read_b64_tr_b16 v[58:59], v11 offset:20480
ds_read_b64_tr_b16 v[60:61], v11 offset:24576
v_mfma_f32_16x16x32_bf16 v[228:231], v[88:91], a[28:31], v[228:231]
ds_read_b64_tr_b16 v[62:63], v11 offset:28672
ds_read_b64_tr_b16 v[124:125], v11 offset:32768
v_mfma_f32_16x16x32_bf16 v[228:231], v[92:95], a[44:47], v[228:231]
ds_read_b64_tr_b16 v[126:127], v11 offset:36864
v_add_u32 v11, s25, v11
v_mfma_f32_16x16x32_bf16 v[228:231], v[96:99], a[60:63], v[228:231]
s_add_u32 s81, s79, 3
s_add_u32 s82, s80, s81
v_mfma_f32_16x16x32_bf16 v[228:231], v[100:103], a[76:79], v[228:231]
buffer_load_dwordx4 a[212:215], v22, s[28:31], s26 offen offset:2048 sc1
s_and_b32 s74, s44, 31
s_lshl_b32 s74, s74, 7
v_mov_b32 v20, s74
buffer_load_dword v21, v20, s[28:31], s56 offen sc1
s_waitcnt vmcnt(14)
s_waitcnt lgkmcnt(15)
v_mfma_f32_16x16x32_bf16 v[136:139], v[32:35], a[0:3], v[136:139]
ds_read_b64_tr_b16 v[64:65], v12 offset:0
ds_read_b64_tr_b16 v[66:67], v12 offset:4096
v_mfma_f32_16x16x32_bf16 v[136:139], v[36:39], a[16:19], v[136:139]
ds_read_b64_tr_b16 v[68:69], v12 offset:8192
ds_read_b64_tr_b16 v[70:71], v12 offset:12288
s_waitcnt lgkmcnt(14)
v_mfma_f32_16x16x32_bf16 v[136:139], v[40:43], a[32:35], v[136:139]
ds_read_b64_tr_b16 v[72:73], v12 offset:16384
s_and_b32 s82, s82, 3
v_mfma_f32_16x16x32_bf16 v[136:139], v[44:47], a[48:51], v[136:139]
s_xor_b32 s80, s80, s81
s_and_b32 s80, s80, 4
v_mfma_f32_16x16x32_bf16 v[136:139], v[120:123], a[64:67], v[136:139]
buffer_load_dwordx4 v19, s[8:11], s22 offen offset:1024 lds
buffer_load_dwordx4 a[228:231], v22, s[28:31], s26 offen offset:3072 sc1
s_waitcnt vmcnt(12)
v_mfma_f32_16x16x32_bf16 v[168:171], v[32:35], a[4:7], v[168:171]
ds_read_b64_tr_b16 v[74:75], v12 offset:20480
ds_read_b64_tr_b16 v[76:77], v12 offset:24576
v_mfma_f32_16x16x32_bf16 v[168:171], v[36:39], a[20:23], v[168:171]
ds_read_b64_tr_b16 v[78:79], v12 offset:28672
ds_read_b64_tr_b16 v[80:81], v12 offset:32768
v_mfma_f32_16x16x32_bf16 v[168:171], v[40:43], a[36:39], v[168:171]
ds_read_b64_tr_b16 v[82:83], v12 offset:36864
v_add_u32 v12, s25, v12
v_mfma_f32_16x16x32_bf16 v[168:171], v[44:47], a[52:55], v[168:171]
s_or_b32 s82, s82, s80
s_lshl_b32 s80, s52, 3
v_mfma_f32_16x16x32_bf16 v[168:171], v[120:123], a[68:71], v[168:171]
buffer_load_dwordx4 a[244:247], v22, s[28:31], s64 offen offset:0 sc1
s_waitcnt lgkmcnt(15)
v_mfma_f32_16x16x32_bf16 v[140:143], v[48:51], a[0:3], v[140:143]
ds_read_b64_tr_b16 v[84:85], v13 offset:0
ds_read_b64_tr_b16 v[86:87], v13 offset:4096
v_mfma_f32_16x16x32_bf16 v[140:143], v[52:55], a[16:19], v[140:143]
ds_read_b64_tr_b16 v[88:89], v13 offset:8192
ds_read_b64_tr_b16 v[90:91], v13 offset:12288
s_waitcnt lgkmcnt(14)
v_mfma_f32_16x16x32_bf16 v[140:143], v[56:59], a[32:35], v[140:143]
ds_read_b64_tr_b16 v[92:93], v13 offset:16384
s_or_b32 s82, s82, s80
v_mfma_f32_16x16x32_bf16 v[140:143], v[60:63], a[48:51], v[140:143]
s_cmp_lt_u32 s79, 5
s_cselect_b32 s82, s82, 64
v_mov_b32 v118, s82
v_mfma_f32_16x16x32_bf16 v[140:143], v[124:127], a[64:67], v[140:143]
buffer_load_dwordx4 a[184:187], v31, s[28:31], s27 offen offset:0 sc1
buffer_load_dwordx4 a[200:203], v31, s[28:31], s27 offen offset:1024 sc1
v_mfma_f32_16x16x32_bf16 v[172:175], v[48:51], a[4:7], v[172:175]
ds_read_b64_tr_b16 v[94:95], v13 offset:20480
ds_read_b64_tr_b16 v[96:97], v13 offset:24576
v_mfma_f32_16x16x32_bf16 v[172:175], v[52:55], a[20:23], v[172:175]
ds_read_b64_tr_b16 v[98:99], v13 offset:28672
ds_read_b64_tr_b16 v[100:101], v13 offset:32768
v_mfma_f32_16x16x32_bf16 v[172:175], v[56:59], a[36:39], v[172:175]
ds_read_b64_tr_b16 v[102:103], v13 offset:36864
v_add_u32 v13, s25, v13
v_mfma_f32_16x16x32_bf16 v[172:175], v[60:63], a[52:55], v[172:175]
ds_write_b32 v23, v118
s_and_b32 s80, s78, 255
v_mfma_f32_16x16x32_bf16 v[172:175], v[124:127], a[68:71], v[172:175]
s_add_u32 m0, s21, s47
s_nop 0
buffer_load_dwordx4 v18, s[12:15], s23 offen offset:0 lds
s_waitcnt lgkmcnt(15)
v_mfma_f32_16x16x32_bf16 v[144:147], v[64:67], a[0:3], v[144:147]
ds_read_b64_tr_b16 v[32:33], v14 offset:0
ds_read_b64_tr_b16 v[34:35], v14 offset:4096
v_mfma_f32_16x16x32_bf16 v[144:147], v[68:71], a[16:19], v[144:147]
ds_read_b64_tr_b16 v[36:37], v14 offset:8192
ds_read_b64_tr_b16 v[38:39], v14 offset:12288
s_waitcnt lgkmcnt(15)
v_mfma_f32_16x16x32_bf16 v[144:147], v[72:75], a[32:35], v[144:147]
ds_read_b64_tr_b16 v[40:41], v14 offset:16384
s_bfe_u32 s81, s78, 0x80008
v_mfma_f32_16x16x32_bf16 v[144:147], v[76:79], a[48:51], v[144:147]
s_cmp_lt_u32 s81, s80
s_cselect_b32 s83, 1, 0
s_min_u32 s80, s80, s81
v_mfma_f32_16x16x32_bf16 v[144:147], v[80:83], a[64:67], v[144:147]
buffer_load_dwordx4 a[216:219], v31, s[28:31], s27 offen offset:2048 sc1
buffer_load_dwordx4 a[232:235], v31, s[28:31], s27 offen offset:3072 sc1
v_mfma_f32_16x16x32_bf16 v[176:179], v[64:67], a[4:7], v[176:179]
ds_read_b64_tr_b16 v[42:43], v14 offset:20480
ds_read_b64_tr_b16 v[44:45], v14 offset:24576
ds_read_b64_tr_b16 v[46:47], v14 offset:28672
v_mfma_f32_16x16x32_bf16 v[176:179], v[68:71], a[20:23], v[176:179]
ds_read_b64_tr_b16 v[120:121], v14 offset:32768
ds_read_b64_tr_b16 v[122:123], v14 offset:36864
v_add_u32 v14, s25, v14
v_mfma_f32_16x16x32_bf16 v[176:179], v[72:75], a[36:39], v[176:179]
ds_read_b64_tr_b16 v[48:49], v15 offset:0
ds_read_b64_tr_b16 v[50:51], v15 offset:4096
ds_read_b64_tr_b16 v[52:53], v15 offset:8192
v_mfma_f32_16x16x32_bf16 v[176:179], v[76:79], a[52:55], v[176:179]
ds_read_b64_tr_b16 v[54:55], v15 offset:12288
ds_read_b64_tr_b16 v[56:57], v15 offset:16384
s_bfe_u32 s81, s78, 0x80010
v_mfma_f32_16x16x32_bf16 v[176:179], v[80:83], a[68:71], v[176:179]
s_cmp_lt_u32 s81, s80
s_cselect_b32 s83, 2, s83
buffer_load_dwordx4 a[248:251], v31, s[28:31], s65 offen offset:0 sc1
s_waitcnt lgkmcnt(15)
v_mfma_f32_16x16x32_bf16 v[148:151], v[84:87], a[0:3], v[148:151]
ds_read_b64_tr_b16 v[58:59], v15 offset:20480
ds_read_b64_tr_b16 v[60:61], v15 offset:24576
ds_read_b64_tr_b16 v[62:63], v15 offset:28672
ds_read_b64_tr_b16 v[124:125], v15 offset:32768
v_mfma_f32_16x16x32_bf16 v[148:151], v[88:91], a[16:19], v[148:151]
ds_read_b64_tr_b16 v[126:127], v15 offset:36864
v_add_u32 v15, s25, v15
ds_read_b64_tr_b16 v[64:65], v8 offset:0
v_mfma_f32_16x16x32_bf16 v[148:151], v[92:95], a[32:35], v[148:151]
ds_read_b64_tr_b16 v[66:67], v8 offset:4096
ds_read_b64_tr_b16 v[68:69], v8 offset:8192
ds_read_b64_tr_b16 v[70:71], v8 offset:12288
v_mfma_f32_16x16x32_bf16 v[148:151], v[96:99], a[48:51], v[148:151]
ds_read_b64_tr_b16 v[72:73], v8 offset:16384
s_min_u32 s80, s80, s81
s_lshr_b32 s81, s78, 24
v_mfma_f32_16x16x32_bf16 v[148:151], v[100:103], a[64:67], v[148:151]
s_cmp_lt_u32 s81, s80
s_cselect_b32 s83, 3, s83
buffer_load_dwordx4 a[188:191], v22, s[28:31], s27 offen offset:0 sc1
buffer_load_dwordx4 v19, s[12:15], s23 offen offset:1024 lds
v_mfma_f32_16x16x32_bf16 v[180:183], v[84:87], a[4:7], v[180:183]
ds_read_b64_tr_b16 v[74:75], v8 offset:20480
ds_read_b64_tr_b16 v[76:77], v8 offset:24576
v_mfma_f32_16x16x32_bf16 v[180:183], v[88:91], a[20:23], v[180:183]
ds_read_b64_tr_b16 v[78:79], v8 offset:28672
ds_read_b64_tr_b16 v[80:81], v8 offset:32768
v_mfma_f32_16x16x32_bf16 v[180:183], v[92:95], a[36:39], v[180:183]
ds_read_b64_tr_b16 v[82:83], v8 offset:36864
v_add_u32 v8, s25, v8
v_mfma_f32_16x16x32_bf16 v[180:183], v[96:99], a[52:55], v[180:183]
s_min_u32 s80, s80, s81
s_cmp_lt_u32 s80, 5
s_cselect_b32 s83, s83, 4
v_mfma_f32_16x16x32_bf16 v[180:183], v[100:103], a[68:71], v[180:183]
buffer_load_dwordx4 a[204:207], v22, s[28:31], s27 offen offset:1024 sc1
s_waitcnt lgkmcnt(15)
v_mfma_f32_16x16x32_bf16 v[152:155], v[32:35], a[0:3], v[152:155]
ds_read_b64_tr_b16 v[84:85], v9 offset:0
ds_read_b64_tr_b16 v[86:87], v9 offset:4096
v_mfma_f32_16x16x32_bf16 v[152:155], v[36:39], a[16:19], v[152:155]
ds_read_b64_tr_b16 v[88:89], v9 offset:8192
ds_read_b64_tr_b16 v[90:91], v9 offset:12288
v_mfma_f32_16x16x32_bf16 v[152:155], v[40:43], a[32:35], v[152:155]
ds_read_b64_tr_b16 v[92:93], v9 offset:16384
s_lshl_b32 s80, s45, 3
v_mfma_f32_16x16x32_bf16 v[152:155], v[44:47], a[48:51], v[152:155]
s_lshr_b32 s80, s78, s80
s_and_b32 s80, s80, 255
v_mfma_f32_16x16x32_bf16 v[152:155], v[120:123], a[64:67], v[152:155]
buffer_load_dwordx4 a[220:223], v22, s[28:31], s27 offen offset:2048 sc1
buffer_load_dwordx4 a[236:239], v22, s[28:31], s27 offen offset:3072 sc1
v_mfma_f32_16x16x32_bf16 v[184:187], v[32:35], a[4:7], v[184:187]
ds_read_b64_tr_b16 v[94:95], v9 offset:20480
ds_read_b64_tr_b16 v[96:97], v9 offset:24576
v_mfma_f32_16x16x32_bf16 v[184:187], v[36:39], a[20:23], v[184:187]
ds_read_b64_tr_b16 v[98:99], v9 offset:28672
ds_read_b64_tr_b16 v[100:101], v9 offset:32768
v_mfma_f32_16x16x32_bf16 v[184:187], v[40:43], a[36:39], v[184:187]
ds_read_b64_tr_b16 v[102:103], v9 offset:36864
v_add_u32 v9, s25, v9
v_mfma_f32_16x16x32_bf16 v[184:187], v[44:47], a[52:55], v[184:187]
s_cmp_lt_u32 s80, 5
s_cselect_b32 s83, s45, s83
s_cmp_lt_u32 s79, 5
s_cselect_b32 s52, s83, 4
v_mfma_f32_16x16x32_bf16 v[184:187], v[120:123], a[68:71], v[184:187]
buffer_load_dwordx4 a[252:255], v22, s[28:31], s65 offen offset:0 sc1
v_mfma_f32_16x16x32_bf16 v[156:159], v[48:51], a[0:3], v[156:159]
s_lshl_b32 s76, s52, 3
s_lshl_b32 s77, 1, s76
v_mfma_f32_16x16x32_bf16 v[156:159], v[52:55], a[16:19], v[156:159]
v_mov_b32 v26, s77
s_waitcnt lgkmcnt(15)
v_mfma_f32_16x16x32_bf16 v[156:159], v[56:59], a[32:35], v[156:159]
s_add_u32 s24, s23, 14336
v_mfma_f32_16x16x32_bf16 v[156:159], v[60:63], a[48:51], v[156:159]
buffer_load_dwordx4 v18, s[12:15], s24 offen offset:2048 lds
v_mfma_f32_16x16x32_bf16 v[156:159], v[124:127], a[64:67], v[156:159]
buffer_load_dwordx4 v19, s[12:15], s24 offen offset:3072 lds
v_mfma_f32_16x16x32_bf16 v[188:191], v[48:51], a[4:7], v[188:191]
s_lshr_b32 s59, s52, 2
v_mfma_f32_16x16x32_bf16 v[188:191], v[52:55], a[20:23], v[188:191]
s_or_b32 s59, s59, s3
v_mfma_f32_16x16x32_bf16 v[188:191], v[56:59], a[36:39], v[188:191]
s_add_u32 m0, m0, 4096
v_mfma_f32_16x16x32_bf16 v[188:191], v[60:63], a[52:55], v[188:191]
s_add_u32 s23, s23, 32768
v_mfma_f32_16x16x32_bf16 v[188:191], v[124:127], a[68:71], v[188:191]
buffer_load_dwordx4 v18, s[12:15], s23 offen offset:0 lds
s_waitcnt lgkmcnt(0)
s_barrier
v_mfma_f32_16x16x32_bf16 v[128:131], v[64:67], a[0:3], v[128:131]
ds_read_b32 v117, v116
ds_read_b64_tr_b16 v[32:33], v10 offset:0
v_mfma_f32_16x16x32_bf16 v[128:131], v[68:71], a[16:19], v[128:131]
ds_read_b64_tr_b16 v[34:35], v10 offset:4096
ds_read_b64_tr_b16 v[36:37], v10 offset:8192
v_mfma_f32_16x16x32_bf16 v[128:131], v[72:75], a[32:35], v[128:131]
ds_read_b64_tr_b16 v[38:39], v10 offset:12288
v_mfma_f32_16x16x32_bf16 v[128:131], v[76:79], a[48:51], v[128:131]
buffer_load_dwordx4 v19, s[12:15], s23 offen offset:1024 lds
s_add_u32 s24, s24, 32768
v_mfma_f32_16x16x32_bf16 v[128:131], v[80:83], a[64:67], v[128:131]
buffer_load_dwordx4 v18, s[12:15], s24 offen offset:2048 lds
v_mfma_f32_16x16x32_bf16 v[160:163], v[64:67], a[4:7], v[160:163]
ds_read_b64_tr_b16 v[40:41], v10 offset:16384
ds_read_b64_tr_b16 v[42:43], v10 offset:20480
v_mfma_f32_16x16x32_bf16 v[160:163], v[68:71], a[20:23], v[160:163]
ds_read_b64_tr_b16 v[44:45], v10 offset:24576
v_mfma_f32_16x16x32_bf16 v[160:163], v[72:75], a[36:39], v[160:163]
buffer_load_dwordx4 v19, s[12:15], s24 offen offset:3072 lds
v_mfma_f32_16x16x32_bf16 v[160:163], v[76:79], a[52:55], v[160:163]
s_add_u32 s21, s21, 40960
v_mfma_f32_16x16x32_bf16 v[160:163], v[80:83], a[68:71], v[160:163]
s_cmp_eq_u32 s21, 122880
s_cselect_b32 s21, 0, s21
v_mfma_f32_16x16x32_bf16 v[132:135], v[84:87], a[0:3], v[132:135]
ds_read_b64_tr_b16 v[46:47], v10 offset:28672
v_mfma_f32_16x16x32_bf16 v[132:135], v[88:91], a[16:19], v[132:135]
ds_read_b64_tr_b16 v[120:121], v10 offset:32768
v_mfma_f32_16x16x32_bf16 v[132:135], v[92:95], a[32:35], v[132:135]
v_mfma_f32_16x16x32_bf16 v[132:135], v[96:99], a[48:51], v[132:135]
ds_read_b64_tr_b16 v[122:123], v10 offset:36864
v_mfma_f32_16x16x32_bf16 v[132:135], v[100:103], a[64:67], v[132:135]
v_mfma_f32_16x16x32_bf16 v[164:167], v[84:87], a[4:7], v[164:167]
s_cmp_eq_u32 s51, 2
s_cselect_b32 s25, s54, s55
s_cselect_b32 s51, -1, s51
s_add_u32 s51, s51, 1
v_mfma_f32_16x16x32_bf16 v[164:167], v[88:91], a[20:23], v[164:167]
v_add_u32 v10, s25, v10
v_mfma_f32_16x16x32_bf16 v[164:167], v[92:95], a[36:39], v[164:167]
s_waitcnt lgkmcnt(10)
s_mov_b32 s20, s44
v_mfma_f32_16x16x32_bf16 v[164:167], v[96:99], a[52:55], v[164:167]
v_readfirstlane_b32 s44, v117
v_mfma_f32_16x16x32_bf16 v[164:167], v[100:103], a[68:71], v[164:167]
s_cmp_ge_u32 s20, 64
s_cbranch_scc0 L_p4e
s_waitcnt vmcnt(0)
s_branch L_last0
L_p4e:
L_p4:
s_cmp_lg_u32 s59, 0
s_cbranch_scc1 L_cl2
s_mov_b64 exec, 1
buffer_atomic_add v26, v27, s[28:31], s58 offen sc0 sc1
s_mov_b64 exec, -1
L_cl2:
buffer_load_dword v0, v25, s[8:11], 0 offen
s_waitcnt vmcnt(18)
L_pc2:
v_readfirstlane_b32 s74, v21
s_cmp_eq_u32 s74, 1
s_cbranch_scc1 L_pc2x
s_sleep 4
buffer_load_dword v21, v20, s[28:31], s56 offen sc1
s_waitcnt vmcnt(0)
s_branch L_pc2
L_pc2x:
s_waitcnt lgkmcnt(6)
v_mfma_f32_16x16x32_bf16 v[136:139], v[32:35], a[176:179], v[136:139]
ds_read_b64_tr_b16 v[48:49], v11 offset:0
ds_read_b64_tr_b16 v[50:51], v11 offset:4096
v_mfma_f32_16x16x32_bf16 v[136:139], v[36:39], a[192:195], v[136:139]
ds_read_b64_tr_b16 v[52:53], v11 offset:8192
ds_read_b64_tr_b16 v[54:55], v11 offset:12288
s_waitcnt lgkmcnt(4)
v_mfma_f32_16x16x32_bf16 v[136:139], v[40:43], a[208:211], v[136:139]
s_mul_i32 s75, s20, 5120
s_add_u32 s26, s48, s75
v_mfma_f32_16x16x32_bf16 v[136:139], v[44:47], a[224:227], v[136:139]
s_add_u32 s27, s49, s75
s_add_u32 s64, s26, 4096
v_mfma_f32_16x16x32_bf16 v[136:139], v[120:123], a[240:243], v[136:139]
s_add_u32 s65, s27, 4096
buffer_load_dwordx4 a[0:3], v31, s[28:31], s26 offen offset:0 sc1
s_waitcnt vmcnt(20)
v_mfma_f32_16x16x32_bf16 v[168:171], v[32:35], a[180:183], v[168:171]
ds_read_b64_tr_b16 v[56:57], v11 offset:16384
v_mfma_f32_16x16x32_bf16 v[168:171], v[36:39], a[196:199], v[168:171]
ds_read_b64_tr_b16 v[58:59], v11 offset:20480
v_mfma_f32_16x16x32_bf16 v[168:171], v[40:43], a[212:215], v[168:171]
ds_read_b64_tr_b16 v[60:61], v11 offset:24576
v_mfma_f32_16x16x32_bf16 v[168:171], v[44:47], a[228:231], v[168:171]
buffer_load_dwordx4 a[16:19], v31, s[28:31], s26 offen offset:1024 sc1
v_mfma_f32_16x16x32_bf16 v[168:171], v[120:123], a[244:247], v[168:171]
s_waitcnt vmcnt(15)
v_mfma_f32_16x16x32_bf16 v[200:203], v[32:35], a[184:187], v[200:203]
ds_read_b64_tr_b16 v[62:63], v11 offset:28672
v_mfma_f32_16x16x32_bf16 v[200:203], v[36:39], a[200:203], v[200:203]
ds_read_b64_tr_b16 v[124:125], v11 offset:32768
v_mfma_f32_16x16x32_bf16 v[200:203], v[40:43], a[216:219], v[200:203]
ds_read_b64_tr_b16 v[126:127], v11 offset:36864
v_mfma_f32_16x16x32_bf16 v[200:203], v[44:47], a[232:235], v[200:203]
buffer_load_dwordx4 a[32:35], v31, s[28:31], s26 offen offset:2048 sc1
v_mfma_f32_16x16x32_bf16 v[200:203], v[120:123], a[248:251], v[200:203]
s_waitcnt vmcnt(10)
v_mfma_f32_16x16x32_bf16 v[232:235], v[32:35], a[188:191], v[232:235]
v_add_u32 v11, s25, v11
v_mfma_f32_16x16x32_bf16 v[232:235], v[36:39], a[204:207], v[232:235]
v_mfma_f32_16x16x32_bf16 v[232:235], v[40:43], a[220:223], v[232:235]
buffer_load_dwordx4 a[48:51], v31, s[28:31], s26 offen offset:3072 sc1
v_mfma_f32_16x16x32_bf16 v[232:235], v[44:47], a[236:239], v[232:235]
v_mfma_f32_16x16x32_bf16 v[232:235], v[120:123], a[252:255], v[232:235]
s_waitcnt lgkmcnt(6)
v_mfma_f32_16x16x32_bf16 v[140:143], v[48:51], a[176:179], v[140:143]
ds_read_b64_tr_b16 v[32:33], v12 offset:0
ds_read_b64_tr_b16 v[34:35], v12 offset:4096
ds_read_b64_tr_b16 v[36:37], v12 offset:8192
v_mfma_f32_16x16x32_bf16 v[140:143], v[52:55], a[192:195], v[140:143]
ds_read_b64_tr_b16 v[38:39], v12 offset:12288
s_and_b32 s23, s44, 31
s_waitcnt lgkmcnt(4)
v_mfma_f32_16x16x32_bf16 v[140:143], v[56:59], a[208:211], v[140:143]
s_lshl_b32 s23, s23, 2
s_add_u32 s23, s23, s3
v_mfma_f32_16x16x32_bf16 v[140:143], v[60:63], a[224:227], v[140:143]
s_lshl_b32 s22, s23, 14
s_lshl_b32 s23, s23, 16
v_mfma_f32_16x16x32_bf16 v[140:143], v[124:127], a[240:243], v[140:143]
s_add_u32 m0, s21, s46
s_nop 0
buffer_load_dwordx4 v18, s[8:11], s22 offen offset:0 lds
v_mfma_f32_16x16x32_bf16 v[172:175], v[48:51], a[180:183], v[172:175]
ds_read_b64_tr_b16 v[40:41], v12 offset:16384
v_mfma_f32_16x16x32_bf16 v[172:175], v[52:55], a[196:199], v[172:175]
ds_read_b64_tr_b16 v[42:43], v12 offset:20480
v_mfma_f32_16x16x32_bf16 v[172:175], v[56:59], a[212:215], v[172:175]
ds_read_b64_tr_b16 v[44:45], v12 offset:24576
v_mfma_f32_16x16x32_bf16 v[172:175], v[60:63], a[228:231], v[172:175]
buffer_load_dwordx4 a[64:67], v31, s[28:31], s64 offen offset:0 sc1
v_mfma_f32_16x16x32_bf16 v[172:175], v[124:127], a[244:247], v[172:175]
v_mfma_f32_16x16x32_bf16 v[204:207], v[48:51], a[184:187], v[204:207]
ds_read_b64_tr_b16 v[46:47], v12 offset:28672
v_mfma_f32_16x16x32_bf16 v[204:207], v[52:55], a[200:203], v[204:207]
ds_read_b64_tr_b16 v[120:121], v12 offset:32768
v_mfma_f32_16x16x32_bf16 v[204:207], v[56:59], a[216:219], v[204:207]
ds_read_b64_tr_b16 v[122:123], v12 offset:36864
v_mfma_f32_16x16x32_bf16 v[204:207], v[60:63], a[232:235], v[204:207]
buffer_load_dwordx4 a[4:7], v22, s[28:31], s26 offen offset:0 sc1
v_mfma_f32_16x16x32_bf16 v[204:207], v[124:127], a[248:251], v[204:207]
v_mfma_f32_16x16x32_bf16 v[236:239], v[48:51], a[188:191], v[236:239]
v_add_u32 v12, s25, v12
v_mfma_f32_16x16x32_bf16 v[236:239], v[52:55], a[204:207], v[236:239]
v_mfma_f32_16x16x32_bf16 v[236:239], v[56:59], a[220:223], v[236:239]
buffer_load_dwordx4 a[20:23], v22, s[28:31], s26 offen offset:1024 sc1
v_mfma_f32_16x16x32_bf16 v[236:239], v[60:63], a[236:239], v[236:239]
v_mfma_f32_16x16x32_bf16 v[236:239], v[124:127], a[252:255], v[236:239]
s_waitcnt lgkmcnt(6)
v_mfma_f32_16x16x32_bf16 v[144:147], v[32:35], a[176:179], v[144:147]
ds_read_b64_tr_b16 v[48:49], v13 offset:0
v_mfma_f32_16x16x32_bf16 v[144:147], v[36:39], a[192:195], v[144:147]
ds_read_b64_tr_b16 v[50:51], v13 offset:4096
s_waitcnt lgkmcnt(2)
v_mfma_f32_16x16x32_bf16 v[144:147], v[40:43], a[208:211], v[144:147]
ds_read_b64_tr_b16 v[52:53], v13 offset:8192
v_mfma_f32_16x16x32_bf16 v[144:147], v[44:47], a[224:227], v[144:147]
ds_read_b64_tr_b16 v[54:55], v13 offset:12288
v_mfma_f32_16x16x32_bf16 v[144:147], v[120:123], a[240:243], v[144:147]
buffer_load_dwordx4 a[36:39], v22, s[28:31], s26 offen offset:2048 sc1
v_mfma_f32_16x16x32_bf16 v[176:179], v[32:35], a[180:183], v[176:179]
ds_read_b64_tr_b16 v[56:57], v13 offset:16384
v_mfma_f32_16x16x32_bf16 v[176:179], v[36:39], a[196:199], v[176:179]
ds_read_b64_tr_b16 v[58:59], v13 offset:20480
v_mfma_f32_16x16x32_bf16 v[176:179], v[40:43], a[212:215], v[176:179]
ds_read_b64_tr_b16 v[60:61], v13 offset:24576
v_mfma_f32_16x16x32_bf16 v[176:179], v[44:47], a[228:231], v[176:179]
buffer_load_dwordx4 v19, s[8:11], s22 offen offset:1024 lds
v_mfma_f32_16x16x32_bf16 v[176:179], v[120:123], a[244:247], v[176:179]
s_waitcnt vmcnt(10)
v_mfma_f32_16x16x32_bf16 v[208:211], v[32:35], a[184:187], v[208:211]
ds_read_b64_tr_b16 v[62:63], v13 offset:28672
ds_read_b64_tr_b16 v[124:125], v13 offset:32768
v_mfma_f32_16x16x32_bf16 v[208:211], v[36:39], a[200:203], v[208:211]
ds_read_b64_tr_b16 v[126:127], v13 offset:36864
v_mfma_f32_16x16x32_bf16 v[208:211], v[40:43], a[216:219], v[208:211]
v_readfirstlane_b32 s78, v26
s_lshr_b32 s79, s78, s76
v_mfma_f32_16x16x32_bf16 v[208:211], v[44:47], a[232:235], v[208:211]
s_and_b32 s79, s79, 255
v_mfma_f32_16x16x32_bf16 v[208:211], v[120:123], a[248:251], v[208:211]
buffer_load_dwordx4 a[52:55], v22, s[28:31], s26 offen offset:3072 sc1
v_mfma_f32_16x16x32_bf16 v[240:243], v[32:35], a[188:191], v[240:243]
v_add_u32 v13, s25, v13
v_mfma_f32_16x16x32_bf16 v[240:243], v[36:39], a[204:207], v[240:243]
s_add_u32 s78, s78, s77
v_mfma_f32_16x16x32_bf16 v[240:243], v[40:43], a[220:223], v[240:243]
s_cmp_eq_u32 s52, 4
s_cselect_b32 s79, 99, s79
v_mfma_f32_16x16x32_bf16 v[240:243], v[44:47], a[236:239], v[240:243]
buffer_load_dwordx4 a[68:71], v22, s[28:31], s64 offen offset:0 sc1
v_mfma_f32_16x16x32_bf16 v[240:243], v[120:123], a[252:255], v[240:243]
s_waitcnt lgkmcnt(6)
v_mfma_f32_16x16x32_bf16 v[148:151], v[48:51], a[176:179], v[148:151]
ds_read_b64_tr_b16 v[32:33], v14 offset:0
ds_read_b64_tr_b16 v[34:35], v14 offset:4096
v_mfma_f32_16x16x32_bf16 v[148:151], v[52:55], a[192:195], v[148:151]
ds_read_b64_tr_b16 v[36:37], v14 offset:8192
s_waitcnt lgkmcnt(3)
v_mfma_f32_16x16x32_bf16 v[148:151], v[56:59], a[208:211], v[148:151]
ds_read_b64_tr_b16 v[38:39], v14 offset:12288
s_and_b32 s80, s52, 1
v_mfma_f32_16x16x32_bf16 v[148:151], v[60:63], a[224:227], v[148:151]
s_lshl_b32 s80, s80, 2
v_mfma_f32_16x16x32_bf16 v[148:151], v[124:127], a[240:243], v[148:151]
buffer_load_dwordx4 a[8:11], v31, s[28:31], s27 offen offset:0 sc1
s_and_b32 s74, s44, 31
s_lshl_b32 s74, s74, 7
v_mov_b32 v20, s74
buffer_load_dword v21, v20, s[28:31], s56 offen sc1
v_mfma_f32_16x16x32_bf16 v[180:183], v[48:51], a[180:183], v[180:183]
ds_read_b64_tr_b16 v[40:41], v14 offset:16384
ds_read_b64_tr_b16 v[42:43], v14 offset:20480
v_mfma_f32_16x16x32_bf16 v[180:183], v[52:55], a[196:199], v[180:183]
ds_read_b64_tr_b16 v[44:45], v14 offset:24576
v_mfma_f32_16x16x32_bf16 v[180:183], v[56:59], a[212:215], v[180:183]
s_xor_b32 s80, s80, s62
v_mfma_f32_16x16x32_bf16 v[180:183], v[60:63], a[228:231], v[180:183]
s_add_u32 s81, s79, 3
v_mfma_f32_16x16x32_bf16 v[180:183], v[124:127], a[244:247], v[180:183]
buffer_load_dwordx4 a[24:27], v31, s[28:31], s27 offen offset:1024 sc1
v_mfma_f32_16x16x32_bf16 v[212:215], v[48:51], a[184:187], v[212:215]
ds_read_b64_tr_b16 v[46:47], v14 offset:28672
ds_read_b64_tr_b16 v[120:121], v14 offset:32768
v_mfma_f32_16x16x32_bf16 v[212:215], v[52:55], a[200:203], v[212:215]
ds_read_b64_tr_b16 v[122:123], v14 offset:36864
s_add_u32 s82, s80, s81
v_mfma_f32_16x16x32_bf16 v[212:215], v[56:59], a[216:219], v[212:215]
s_and_b32 s82, s82, 3
v_mfma_f32_16x16x32_bf16 v[212:215], v[60:63], a[232:235], v[212:215]
s_xor_b32 s80, s80, s81
s_add_u32 m0, s21, s47
v_mfma_f32_16x16x32_bf16 v[212:215], v[124:127], a[248:251], v[212:215]
buffer_load_dwordx4 v18, s[12:15], s23 offen offset:0 lds
v_mfma_f32_16x16x32_bf16 v[244:247], v[48:51], a[188:191], v[244:247]
v_add_u32 v14, s25, v14
v_mfma_f32_16x16x32_bf16 v[244:247], v[52:55], a[204:207], v[244:247]
s_and_b32 s80, s80, 4
v_mfma_f32_16x16x32_bf16 v[244:247], v[56:59], a[220:223], v[244:247]
s_or_b32 s82, s82, s80
v_mfma_f32_16x16x32_bf16 v[244:247], v[60:63], a[236:239], v[244:247]
buffer_load_dwordx4 a[40:43], v31, s[28:31], s27 offen offset:2048 sc1
v_mfma_f32_16x16x32_bf16 v[244:247], v[124:127], a[252:255], v[244:247]
s_waitcnt lgkmcnt(6)
v_mfma_f32_16x16x32_bf16 v[152:155], v[32:35], a[176:179], v[152:155]
ds_read_b64_tr_b16 v[48:49], v15 offset:0
ds_read_b64_tr_b16 v[50:51], v15 offset:4096
v_mfma_f32_16x16x32_bf16 v[152:155], v[36:39], a[192:195], v[152:155]
ds_read_b64_tr_b16 v[52:53], v15 offset:8192
s_waitcnt lgkmcnt(3)
v_mfma_f32_16x16x32_bf16 v[152:155], v[40:43], a[208:211], v[152:155]
ds_read_b64_tr_b16 v[54:55], v15 offset:12288
s_lshl_b32 s80, s52, 3
v_mfma_f32_16x16x32_bf16 v[152:155], v[44:47], a[224:227], v[152:155]
s_or_b32 s82, s82, s80
v_mfma_f32_16x16x32_bf16 v[152:155], v[120:123], a[240:243], v[152:155]
buffer_load_dwordx4 a[56:59], v31, s[28:31], s27 offen offset:3072 sc1
v_mfma_f32_16x16x32_bf16 v[184:187], v[32:35], a[180:183], v[184:187]
ds_read_b64_tr_b16 v[56:57], v15 offset:16384
ds_read_b64_tr_b16 v[58:59], v15 offset:20480
v_mfma_f32_16x16x32_bf16 v[184:187], v[36:39], a[196:199], v[184:187]
ds_read_b64_tr_b16 v[60:61], v15 offset:24576
v_mfma_f32_16x16x32_bf16 v[184:187], v[40:43], a[212:215], v[184:187]
s_cmp_lt_u32 s79, 5
s_cselect_b32 s82, s82, 64
v_mfma_f32_16x16x32_bf16 v[184:187], v[44:47], a[228:231], v[184:187]
v_mov_b32 v118, s82
v_mfma_f32_16x16x32_bf16 v[184:187], v[120:123], a[244:247], v[184:187]
buffer_load_dwordx4 a[72:75], v31, s[28:31], s65 offen offset:0 sc1
v_mfma_f32_16x16x32_bf16 v[216:219], v[32:35], a[184:187], v[216:219]
ds_read_b64_tr_b16 v[62:63], v15 offset:28672
ds_read_b64_tr_b16 v[124:125], v15 offset:32768
v_mfma_f32_16x16x32_bf16 v[216:219], v[36:39], a[200:203], v[216:219]
ds_read_b64_tr_b16 v[126:127], v15 offset:36864
v_mfma_f32_16x16x32_bf16 v[216:219], v[40:43], a[216:219], v[216:219]
ds_write_b32 v23, v118
v_mfma_f32_16x16x32_bf16 v[216:219], v[44:47], a[232:235], v[216:219]
s_and_b32 s80, s78, 255
v_mfma_f32_16x16x32_bf16 v[216:219], v[120:123], a[248:251], v[216:219]
buffer_load_dwordx4 a[12:15], v22, s[28:31], s27 offen offset:0 sc1
v_mfma_f32_16x16x32_bf16 v[248:251], v[32:35], a[188:191], v[248:251]
v_add_u32 v15, s25, v15
v_mfma_f32_16x16x32_bf16 v[248:251], v[36:39], a[204:207], v[248:251]
s_bfe_u32 s81, s78, 0x80008
v_mfma_f32_16x16x32_bf16 v[248:251], v[40:43], a[220:223], v[248:251]
s_cmp_lt_u32 s81, s80
s_cselect_b32 s83, 1, 0
v_mfma_f32_16x16x32_bf16 v[248:251], v[44:47], a[236:239], v[248:251]
s_min_u32 s80, s80, s81
v_mfma_f32_16x16x32_bf16 v[248:251], v[120:123], a[252:255], v[248:251]
buffer_load_dwordx4 v19, s[12:15], s23 offen offset:1024 lds
s_waitcnt lgkmcnt(7)
v_mfma_f32_16x16x32_bf16 v[156:159], v[48:51], a[176:179], v[156:159]
ds_read_b64_tr_b16 v[32:33], v8 offset:0
ds_read_b64_tr_b16 v[34:35], v8 offset:4096
v_mfma_f32_16x16x32_bf16 v[156:159], v[52:55], a[192:195], v[156:159]
ds_read_b64_tr_b16 v[36:37], v8 offset:8192
s_waitcnt lgkmcnt(4)
v_mfma_f32_16x16x32_bf16 v[156:159], v[56:59], a[208:211], v[156:159]
ds_read_b64_tr_b16 v[38:39], v8 offset:12288
s_bfe_u32 s81, s78, 0x80010
v_mfma_f32_16x16x32_bf16 v[156:159], v[60:63], a[224:227], v[156:159]
s_cmp_lt_u32 s81, s80
s_cselect_b32 s83, 2, s83
v_mfma_f32_16x16x32_bf16 v[156:159], v[124:127], a[240:243], v[156:159]
buffer_load_dwordx4 a[28:31], v22, s[28:31], s27 offen offset:1024 sc1
v_mfma_f32_16x16x32_bf16 v[188:191], v[48:51], a[180:183], v[188:191]
ds_read_b64_tr_b16 v[40:41], v8 offset:16384
ds_read_b64_tr_b16 v[42:43], v8 offset:20480
v_mfma_f32_16x16x32_bf16 v[188:191], v[52:55], a[196:199], v[188:191]
ds_read_b64_tr_b16 v[44:45], v8 offset:24576
v_mfma_f32_16x16x32_bf16 v[188:191], v[56:59], a[212:215], v[188:191]
s_min_u32 s80, s80, s81
v_mfma_f32_16x16x32_bf16 v[188:191], v[60:63], a[228:231], v[188:191]
s_lshr_b32 s81, s78, 24
v_mfma_f32_16x16x32_bf16 v[188:191], v[124:127], a[244:247], v[188:191]
buffer_load_dwordx4 a[44:47], v22, s[28:31], s27 offen offset:2048 sc1
v_mfma_f32_16x16x32_bf16 v[220:223], v[48:51], a[184:187], v[220:223]
ds_read_b64_tr_b16 v[46:47], v8 offset:28672
ds_read_b64_tr_b16 v[120:121], v8 offset:32768
v_mfma_f32_16x16x32_bf16 v[220:223], v[52:55], a[200:203], v[220:223]
ds_read_b64_tr_b16 v[122:123], v8 offset:36864
v_mfma_f32_16x16x32_bf16 v[220:223], v[56:59], a[216:219], v[220:223]
s_cmp_lt_u32 s81, s80
s_cselect_b32 s83, 3, s83
v_mfma_f32_16x16x32_bf16 v[220:223], v[60:63], a[232:235], v[220:223]
s_min_u32 s80, s80, s81
v_mfma_f32_16x16x32_bf16 v[220:223], v[124:127], a[248:251], v[220:223]
buffer_load_dwordx4 a[60:63], v22, s[28:31], s27 offen offset:3072 sc1
v_mfma_f32_16x16x32_bf16 v[252:255], v[48:51], a[188:191], v[252:255]
v_add_u32 v8, s25, v8
v_mfma_f32_16x16x32_bf16 v[252:255], v[52:55], a[204:207], v[252:255]
s_cmp_lt_u32 s80, 5
s_cselect_b32 s83, s83, 4
v_mfma_f32_16x16x32_bf16 v[252:255], v[56:59], a[220:223], v[252:255]
s_lshl_b32 s80, s45, 3
v_mfma_f32_16x16x32_bf16 v[252:255], v[60:63], a[236:239], v[252:255]
s_lshr_b32 s80, s78, s80
v_mfma_f32_16x16x32_bf16 v[252:255], v[124:127], a[252:255], v[252:255]
buffer_load_dwordx4 a[76:79], v22, s[28:31], s65 offen offset:0 sc1
s_waitcnt lgkmcnt(6)
v_mfma_f32_16x16x32_bf16 v[128:131], v[32:35], a[176:179], v[128:131]
ds_read_b64_tr_b16 v[48:49], v9 offset:0
ds_read_b64_tr_b16 v[50:51], v9 offset:4096
v_mfma_f32_16x16x32_bf16 v[128:131], v[36:39], a[192:195], v[128:131]
ds_read_b64_tr_b16 v[52:53], v9 offset:8192
ds_read_b64_tr_b16 v[54:55], v9 offset:12288
s_waitcnt lgkmcnt(4)
v_mfma_f32_16x16x32_bf16 v[128:131], v[40:43], a[208:211], v[128:131]
s_and_b32 s80, s80, 255
v_mfma_f32_16x16x32_bf16 v[128:131], v[44:47], a[224:227], v[128:131]
s_cmp_lt_u32 s80, 5
s_cselect_b32 s83, s45, s83
s_add_u32 s24, s23, 14336
v_mfma_f32_16x16x32_bf16 v[128:131], v[120:123], a[240:243], v[128:131]
buffer_load_dwordx4 v18, s[12:15], s24 offen offset:2048 lds
v_mfma_f32_16x16x32_bf16 v[160:163], v[32:35], a[180:183], v[160:163]
ds_read_b64_tr_b16 v[56:57], v9 offset:16384
ds_read_b64_tr_b16 v[58:59], v9 offset:20480
v_mfma_f32_16x16x32_bf16 v[160:163], v[36:39], a[196:199], v[160:163]
ds_read_b64_tr_b16 v[60:61], v9 offset:24576
v_mfma_f32_16x16x32_bf16 v[160:163], v[40:43], a[212:215], v[160:163]
s_cmp_lt_u32 s79, 5
s_cselect_b32 s52, s83, 4
v_mfma_f32_16x16x32_bf16 v[160:163], v[44:47], a[228:231], v[160:163]
s_lshl_b32 s76, s52, 3
v_mfma_f32_16x16x32_bf16 v[160:163], v[120:123], a[244:247], v[160:163]
buffer_load_dwordx4 v19, s[12:15], s24 offen offset:3072 lds
v_mfma_f32_16x16x32_bf16 v[192:195], v[32:35], a[184:187], v[192:195]
ds_read_b64_tr_b16 v[62:63], v9 offset:28672
ds_read_b64_tr_b16 v[124:125], v9 offset:32768
v_mfma_f32_16x16x32_bf16 v[192:195], v[36:39], a[200:203], v[192:195]
ds_read_b64_tr_b16 v[126:127], v9 offset:36864
s_lshl_b32 s77, 1, s76
v_mfma_f32_16x16x32_bf16 v[192:195], v[40:43], a[216:219], v[192:195]
v_mov_b32 v26, s77
v_mfma_f32_16x16x32_bf16 v[192:195], v[44:47], a[232:235], v[192:195]
s_add_u32 m0, m0, 4096
s_add_u32 s23, s23, 32768
v_mfma_f32_16x16x32_bf16 v[192:195], v[120:123], a[248:251], v[192:195]
buffer_load_dwordx4 v18, s[12:15], s23 offen offset:0 lds
v_mfma_f32_16x16x32_bf16 v[224:227], v[32:35], a[188:191], v[224:227]
v_add_u32 v9, s25, v9
v_mfma_f32_16x16x32_bf16 v[224:227], v[36:39], a[204:207], v[224:227]
s_lshr_b32 s59, s52, 2
v_mfma_f32_16x16x32_bf16 v[224:227], v[40:43], a[220:223], v[224:227]
s_or_b32 s59, s59, s3
v_mfma_f32_16x16x32_bf16 v[224:227], v[44:47], a[236:239], v[224:227]
buffer_load_dwordx4 v19, s[12:15], s23 offen offset:1024 lds
v_mfma_f32_16x16x32_bf16 v[224:227], v[120:123], a[252:255], v[224:227]
s_waitcnt lgkmcnt(0)
s_barrier
v_mfma_f32_16x16x32_bf16 v[132:135], v[48:51], a[176:179], v[132:135]
ds_read_b32 v117, v116
ds_read_b64_tr_b16 v[32:33], v10 offset:0
v_mfma_f32_16x16x32_bf16 v[132:135], v[52:55], a[192:195], v[132:135]
ds_read_b64_tr_b16 v[34:35], v10 offset:4096
v_mfma_f32_16x16x32_bf16 v[132:135], v[56:59], a[208:211], v[132:135]
ds_read_b64_tr_b16 v[36:37], v10 offset:8192
ds_read_b64_tr_b16 v[38:39], v10 offset:12288
v_mfma_f32_16x16x32_bf16 v[132:135], v[60:63], a[224:227], v[132:135]
s_add_u32 s24, s24, 32768
v_mfma_f32_16x16x32_bf16 v[132:135], v[124:127], a[240:243], v[132:135]
buffer_load_dwordx4 v18, s[12:15], s24 offen offset:2048 lds
v_mfma_f32_16x16x32_bf16 v[164:167], v[48:51], a[180:183], v[164:167]
ds_read_b64_tr_b16 v[40:41], v10 offset:16384
ds_read_b64_tr_b16 v[42:43], v10 offset:20480
v_mfma_f32_16x16x32_bf16 v[164:167], v[52:55], a[196:199], v[164:167]
ds_read_b64_tr_b16 v[44:45], v10 offset:24576
v_mfma_f32_16x16x32_bf16 v[164:167], v[56:59], a[212:215], v[164:167]
buffer_load_dwordx4 v19, s[12:15], s24 offen offset:3072 lds
v_mfma_f32_16x16x32_bf16 v[164:167], v[60:63], a[228:231], v[164:167]
s_add_u32 s21, s21, 40960
v_mfma_f32_16x16x32_bf16 v[164:167], v[124:127], a[244:247], v[164:167]
s_cmp_eq_u32 s21, 122880
s_cselect_b32 s21, 0, s21
v_mfma_f32_16x16x32_bf16 v[196:199], v[48:51], a[184:187], v[196:199]
ds_read_b64_tr_b16 v[46:47], v10 offset:28672
v_mfma_f32_16x16x32_bf16 v[196:199], v[52:55], a[200:203], v[196:199]
ds_read_b64_tr_b16 v[120:121], v10 offset:32768
v_mfma_f32_16x16x32_bf16 v[196:199], v[56:59], a[216:219], v[196:199]
v_mfma_f32_16x16x32_bf16 v[196:199], v[60:63], a[232:235], v[196:199]
ds_read_b64_tr_b16 v[122:123], v10 offset:36864
v_mfma_f32_16x16x32_bf16 v[196:199], v[124:127], a[248:251], v[196:199]
v_mfma_f32_16x16x32_bf16 v[228:231], v[48:51], a[188:191], v[228:231]
s_cmp_eq_u32 s51, 2
s_cselect_b32 s25, s54, s55
s_cselect_b32 s51, -1, s51
s_add_u32 s51, s51, 1
v_mfma_f32_16x16x32_bf16 v[228:231], v[52:55], a[204:207], v[228:231]
v_add_u32 v10, s25, v10
v_mfma_f32_16x16x32_bf16 v[228:231], v[56:59], a[220:223], v[228:231]
s_waitcnt lgkmcnt(10)
s_mov_b32 s20, s44
v_mfma_f32_16x16x32_bf16 v[228:231], v[60:63], a[236:239], v[228:231]
v_readfirstlane_b32 s44, v117
v_mfma_f32_16x16x32_bf16 v[228:231], v[124:127], a[252:255], v[228:231]
s_cmp_ge_u32 s20, 64
s_cbranch_scc1 L_last1
s_cmp_lg_u32 s59, 0
s_cbranch_scc1 L_cl3
s_mov_b64 exec, 1
buffer_atomic_add v26, v27, s[28:31], s58 offen sc0 sc1
s_mov_b64 exec, -1
L_cl3:
buffer_load_dword v0, v25, s[8:11], 0 offen
s_waitcnt vmcnt(18)
L_pc3:
v_readfirstlane_b32 s74, v21
s_cmp_eq_u32 s74, 1
s_cbranch_scc1 L_pc3x
s_sleep 4
buffer_load_dword v21, v20, s[28:31], s56 offen sc1
s_waitcnt vmcnt(0)
s_branch L_pc3
L_pc3x:
s_waitcnt lgkmcnt(6)
v_mfma_f32_16x16x32_bf16 v[136:139], v[32:35], a[0:3], v[136:139]
ds_read_b64_tr_b16 v[48:49], v11 offset:0
ds_read_b64_tr_b16 v[50:51], v11 offset:4096
v_mfma_f32_16x16x32_bf16 v[136:139], v[36:39], a[16:19], v[136:139]
ds_read_b64_tr_b16 v[52:53], v11 offset:8192
ds_read_b64_tr_b16 v[54:55], v11 offset:12288
s_waitcnt lgkmcnt(4)
v_mfma_f32_16x16x32_bf16 v[136:139], v[40:43], a[32:35], v[136:139]
s_mul_i32 s75, s20, 5120
s_add_u32 s26, s48, s75
v_mfma_f32_16x16x32_bf16 v[136:139], v[44:47], a[48:51], v[136:139]
s_add_u32 s27, s49, s75
s_add_u32 s64, s26, 4096
v_mfma_f32_16x16x32_bf16 v[136:139], v[120:123], a[64:67], v[136:139]
s_add_u32 s65, s27, 4096
buffer_load_dwordx4 a[176:179], v31, s[28:31], s26 offen offset:0 sc1
v_mfma_f32_16x16x32_bf16 v[168:171], v[32:35], a[4:7], v[168:171]
ds_read_b64_tr_b16 v[56:57], v11 offset:16384
v_mfma_f32_16x16x32_bf16 v[168:171], v[36:39], a[20:23], v[168:171]
ds_read_b64_tr_b16 v[58:59], v11 offset:20480
v_mfma_f32_16x16x32_bf16 v[168:171], v[40:43], a[36:39], v[168:171]
ds_read_b64_tr_b16 v[60:61], v11 offset:24576
v_mfma_f32_16x16x32_bf16 v[168:171], v[44:47], a[52:55], v[168:171]
buffer_load_dwordx4 a[192:195], v31, s[28:31], s26 offen offset:1024 sc1
v_mfma_f32_16x16x32_bf16 v[168:171], v[120:123], a[68:71], v[168:171]
s_waitcnt vmcnt(15)
v_mfma_f32_16x16x32_bf16 v[200:203], v[32:35], a[8:11], v[200:203]
ds_read_b64_tr_b16 v[62:63], v11 offset:28672
v_mfma_f32_16x16x32_bf16 v[200:203], v[36:39], a[24:27], v[200:203]
ds_read_b64_tr_b16 v[124:125], v11 offset:32768
v_mfma_f32_16x16x32_bf16 v[200:203], v[40:43], a[40:43], v[200:203]
ds_read_b64_tr_b16 v[126:127], v11 offset:36864
v_mfma_f32_16x16x32_bf16 v[200:203], v[44:47], a[56:59], v[200:203]
buffer_load_dwordx4 a[208:211], v31, s[28:31], s26 offen offset:2048 sc1
v_mfma_f32_16x16x32_bf16 v[200:203], v[120:123], a[72:75], v[200:203]
s_waitcnt vmcnt(10)
v_mfma_f32_16x16x32_bf16 v[232:235], v[32:35], a[12:15], v[232:235]
v_add_u32 v11, s25, v11
v_mfma_f32_16x16x32_bf16 v[232:235], v[36:39], a[28:31], v[232:235]
v_mfma_f32_16x16x32_bf16 v[232:235], v[40:43], a[44:47], v[232:235]
buffer_load_dwordx4 a[224:227], v31, s[28:31], s26 offen offset:3072 sc1
v_mfma_f32_16x16x32_bf16 v[232:235], v[44:47], a[60:63], v[232:235]
v_mfma_f32_16x16x32_bf16 v[232:235], v[120:123], a[76:79], v[232:235]
s_waitcnt lgkmcnt(6)
v_mfma_f32_16x16x32_bf16 v[140:143], v[48:51], a[0:3], v[140:143]
ds_read_b64_tr_b16 v[32:33], v12 offset:0
ds_read_b64_tr_b16 v[34:35], v12 offset:4096
ds_read_b64_tr_b16 v[36:37], v12 offset:8192
v_mfma_f32_16x16x32_bf16 v[140:143], v[52:55], a[16:19], v[140:143]
ds_read_b64_tr_b16 v[38:39], v12 offset:12288
s_and_b32 s23, s44, 31
s_waitcnt lgkmcnt(4)
v_mfma_f32_16x16x32_bf16 v[140:143], v[56:59], a[32:35], v[140:143]
s_lshl_b32 s23, s23, 2
s_add_u32 s23, s23, s3
v_mfma_f32_16x16x32_bf16 v[140:143], v[60:63], a[48:51], v[140:143]
s_lshl_b32 s22, s23, 14
s_lshl_b32 s23, s23, 16
v_mfma_f32_16x16x32_bf16 v[140:143], v[124:127], a[64:67], v[140:143]
s_add_u32 m0, s21, s46
s_nop 0
buffer_load_dwordx4 v18, s[8:11], s22 offen offset:0 lds
v_mfma_f32_16x16x32_bf16 v[172:175], v[48:51], a[4:7], v[172:175]
ds_read_b64_tr_b16 v[40:41], v12 offset:16384
v_mfma_f32_16x16x32_bf16 v[172:175], v[52:55], a[20:23], v[172:175]
ds_read_b64_tr_b16 v[42:43], v12 offset:20480
v_mfma_f32_16x16x32_bf16 v[172:175], v[56:59], a[36:39], v[172:175]
ds_read_b64_tr_b16 v[44:45], v12 offset:24576
v_mfma_f32_16x16x32_bf16 v[172:175], v[60:63], a[52:55], v[172:175]
buffer_load_dwordx4 a[240:243], v31, s[28:31], s64 offen offset:0 sc1
v_mfma_f32_16x16x32_bf16 v[172:175], v[124:127], a[68:71], v[172:175]
v_mfma_f32_16x16x32_bf16 v[204:207], v[48:51], a[8:11], v[204:207]
ds_read_b64_tr_b16 v[46:47], v12 offset:28672
v_mfma_f32_16x16x32_bf16 v[204:207], v[52:55], a[24:27], v[204:207]
ds_read_b64_tr_b16 v[120:121], v12 offset:32768
v_mfma_f32_16x16x32_bf16 v[204:207], v[56:59], a[40:43], v[204:207]
ds_read_b64_tr_b16 v[122:123], v12 offset:36864
v_mfma_f32_16x16x32_bf16 v[204:207], v[60:63], a[56:59], v[204:207]
buffer_load_dwordx4 a[180:183], v22, s[28:31], s26 offen offset:0 sc1
v_mfma_f32_16x16x32_bf16 v[204:207], v[124:127], a[72:75], v[204:207]
v_mfma_f32_16x16x32_bf16 v[236:239], v[48:51], a[12:15], v[236:239]
v_add_u32 v12, s25, v12
v_mfma_f32_16x16x32_bf16 v[236:239], v[52:55], a[28:31], v[236:239]
v_mfma_f32_16x16x32_bf16 v[236:239], v[56:59], a[44:47], v[236:239]
buffer_load_dwordx4 a[196:199], v22, s[28:31], s26 offen offset:1024 sc1
v_mfma_f32_16x16x32_bf16 v[236:239], v[60:63], a[60:63], v[236:239]
v_mfma_f32_16x16x32_bf16 v[236:239], v[124:127], a[76:79], v[236:239]
s_waitcnt lgkmcnt(6)
v_mfma_f32_16x16x32_bf16 v[144:147], v[32:35], a[0:3], v[144:147]
ds_read_b64_tr_b16 v[48:49], v13 offset:0
v_mfma_f32_16x16x32_bf16 v[144:147], v[36:39], a[16:19], v[144:147]
ds_read_b64_tr_b16 v[50:51], v13 offset:4096
s_waitcnt lgkmcnt(2)
v_mfma_f32_16x16x32_bf16 v[144:147], v[40:43], a[32:35], v[144:147]
ds_read_b64_tr_b16 v[52:53], v13 offset:8192
v_mfma_f32_16x16x32_bf16 v[144:147], v[44:47], a[48:51], v[144:147]
ds_read_b64_tr_b16 v[54:55], v13 offset:12288
v_mfma_f32_16x16x32_bf16 v[144:147], v[120:123], a[64:67], v[144:147]
buffer_load_dwordx4 a[212:215], v22, s[28:31], s26 offen offset:2048 sc1
v_mfma_f32_16x16x32_bf16 v[176:179], v[32:35], a[4:7], v[176:179]
ds_read_b64_tr_b16 v[56:57], v13 offset:16384
v_mfma_f32_16x16x32_bf16 v[176:179], v[36:39], a[20:23], v[176:179]
ds_read_b64_tr_b16 v[58:59], v13 offset:20480
v_mfma_f32_16x16x32_bf16 v[176:179], v[40:43], a[36:39], v[176:179]
ds_read_b64_tr_b16 v[60:61], v13 offset:24576
v_mfma_f32_16x16x32_bf16 v[176:179], v[44:47], a[52:55], v[176:179]
buffer_load_dwordx4 v19, s[8:11], s22 offen offset:1024 lds
v_mfma_f32_16x16x32_bf16 v[176:179], v[120:123], a[68:71], v[176:179]
s_waitcnt vmcnt(10)
v_mfma_f32_16x16x32_bf16 v[208:211], v[32:35], a[8:11], v[208:211]
ds_read_b64_tr_b16 v[62:63], v13 offset:28672
ds_read_b64_tr_b16 v[124:125], v13 offset:32768
v_mfma_f32_16x16x32_bf16 v[208:211], v[36:39], a[24:27], v[208:211]
ds_read_b64_tr_b16 v[126:127], v13 offset:36864
v_mfma_f32_16x16x32_bf16 v[208:211], v[40:43], a[40:43], v[208:211]
v_readfirstlane_b32 s78, v26
s_lshr_b32 s79, s78, s76
v_mfma_f32_16x16x32_bf16 v[208:211], v[44:47], a[56:59], v[208:211]
s_and_b32 s79, s79, 255
v_mfma_f32_16x16x32_bf16 v[208:211], v[120:123], a[72:75], v[208:211]
buffer_load_dwordx4 a[228:231], v22, s[28:31], s26 offen offset:3072 sc1
v_mfma_f32_16x16x32_bf16 v[240:243], v[32:35], a[12:15], v[240:243]
v_add_u32 v13, s25, v13
v_mfma_f32_16x16x32_bf16 v[240:243], v[36:39], a[28:31], v[240:243]
s_add_u32 s78, s78, s77
v_mfma_f32_16x16x32_bf16 v[240:243], v[40:43], a[44:47], v[240:243]
s_cmp_eq_u32 s52, 4
s_cselect_b32 s79, 99, s79
v_mfma_f32_16x16x32_bf16 v[240:243], v[44:47], a[60:63], v[240:243]
buffer_load_dwordx4 a[244:247], v22, s[28:31], s64 offen offset:0 sc1
v_mfma_f32_16x16x32_bf16 v[240:243], v[120:123], a[76:79], v[240:243]
s_waitcnt lgkmcnt(6)
v_mfma_f32_16x16x32_bf16 v[148:151], v[48:51], a[0:3], v[148:151]
ds_read_b64_tr_b16 v[32:33], v14 offset:0
ds_read_b64_tr_b16 v[34:35], v14 offset:4096
v_mfma_f32_16x16x32_bf16 v[148:151], v[52:55], a[16:19], v[148:151]
ds_read_b64_tr_b16 v[36:37], v14 offset:8192
s_waitcnt lgkmcnt(3)
v_mfma_f32_16x16x32_bf16 v[148:151], v[56:59], a[32:35], v[148:151]
ds_read_b64_tr_b16 v[38:39], v14 offset:12288
s_and_b32 s80, s52, 1
v_mfma_f32_16x16x32_bf16 v[148:151], v[60:63], a[48:51], v[148:151]
s_lshl_b32 s80, s80, 2
v_mfma_f32_16x16x32_bf16 v[148:151], v[124:127], a[64:67], v[148:151]
buffer_load_dwordx4 a[184:187], v31, s[28:31], s27 offen offset:0 sc1
s_and_b32 s74, s44, 31
s_lshl_b32 s74, s74, 7
v_mov_b32 v20, s74
buffer_load_dword v21, v20, s[28:31], s56 offen sc1
v_mfma_f32_16x16x32_bf16 v[180:183], v[48:51], a[4:7], v[180:183]
ds_read_b64_tr_b16 v[40:41], v14 offset:16384
ds_read_b64_tr_b16 v[42:43], v14 offset:20480
v_mfma_f32_16x16x32_bf16 v[180:183], v[52:55], a[20:23], v[180:183]
ds_read_b64_tr_b16 v[44:45], v14 offset:24576
v_mfma_f32_16x16x32_bf16 v[180:183], v[56:59], a[36:39], v[180:183]
s_xor_b32 s80, s80, s62
v_mfma_f32_16x16x32_bf16 v[180:183], v[60:63], a[52:55], v[180:183]
s_add_u32 s81, s79, 3
v_mfma_f32_16x16x32_bf16 v[180:183], v[124:127], a[68:71], v[180:183]
buffer_load_dwordx4 a[200:203], v31, s[28:31], s27 offen offset:1024 sc1
v_mfma_f32_16x16x32_bf16 v[212:215], v[48:51], a[8:11], v[212:215]
ds_read_b64_tr_b16 v[46:47], v14 offset:28672
ds_read_b64_tr_b16 v[120:121], v14 offset:32768
v_mfma_f32_16x16x32_bf16 v[212:215], v[52:55], a[24:27], v[212:215]
ds_read_b64_tr_b16 v[122:123], v14 offset:36864
s_add_u32 s82, s80, s81
v_mfma_f32_16x16x32_bf16 v[212:215], v[56:59], a[40:43], v[212:215]
s_and_b32 s82, s82, 3
v_mfma_f32_16x16x32_bf16 v[212:215], v[60:63], a[56:59], v[212:215]
s_xor_b32 s80, s80, s81
s_add_u32 m0, s21, s47
v_mfma_f32_16x16x32_bf16 v[212:215], v[124:127], a[72:75], v[212:215]
buffer_load_dwordx4 v18, s[12:15], s23 offen offset:0 lds
v_mfma_f32_16x16x32_bf16 v[244:247], v[48:51], a[12:15], v[244:247]
v_add_u32 v14, s25, v14
v_mfma_f32_16x16x32_bf16 v[244:247], v[52:55], a[28:31], v[244:247]
s_and_b32 s80, s80, 4
v_mfma_f32_16x16x32_bf16 v[244:247], v[56:59], a[44:47], v[244:247]
s_or_b32 s82, s82, s80
v_mfma_f32_16x16x32_bf16 v[244:247], v[60:63], a[60:63], v[244:247]
buffer_load_dwordx4 a[216:219], v31, s[28:31], s27 offen offset:2048 sc1
v_mfma_f32_16x16x32_bf16 v[244:247], v[124:127], a[76:79], v[244:247]
s_waitcnt lgkmcnt(6)
v_mfma_f32_16x16x32_bf16 v[152:155], v[32:35], a[0:3], v[152:155]
ds_read_b64_tr_b16 v[48:49], v15 offset:0
ds_read_b64_tr_b16 v[50:51], v15 offset:4096
v_mfma_f32_16x16x32_bf16 v[152:155], v[36:39], a[16:19], v[152:155]
ds_read_b64_tr_b16 v[52:53], v15 offset:8192
s_waitcnt lgkmcnt(3)
v_mfma_f32_16x16x32_bf16 v[152:155], v[40:43], a[32:35], v[152:155]
ds_read_b64_tr_b16 v[54:55], v15 offset:12288
s_lshl_b32 s80, s52, 3
v_mfma_f32_16x16x32_bf16 v[152:155], v[44:47], a[48:51], v[152:155]
s_or_b32 s82, s82, s80
v_mfma_f32_16x16x32_bf16 v[152:155], v[120:123], a[64:67], v[152:155]
buffer_load_dwordx4 a[232:235], v31, s[28:31], s27 offen offset:3072 sc1
v_mfma_f32_16x16x32_bf16 v[184:187], v[32:35], a[4:7], v[184:187]
ds_read_b64_tr_b16 v[56:57], v15 offset:16384
ds_read_b64_tr_b16 v[58:59], v15 offset:20480
v_mfma_f32_16x16x32_bf16 v[184:187], v[36:39], a[20:23], v[184:187]
ds_read_b64_tr_b16 v[60:61], v15 offset:24576
v_mfma_f32_16x16x32_bf16 v[184:187], v[40:43], a[36:39], v[184:187]
s_cmp_lt_u32 s79, 5
s_cselect_b32 s82, s82, 64
v_mfma_f32_16x16x32_bf16 v[184:187], v[44:47], a[52:55], v[184:187]
v_mov_b32 v118, s82
v_mfma_f32_16x16x32_bf16 v[184:187], v[120:123], a[68:71], v[184:187]
buffer_load_dwordx4 a[248:251], v31, s[28:31], s65 offen offset:0 sc1
v_mfma_f32_16x16x32_bf16 v[216:219], v[32:35], a[8:11], v[216:219]
ds_read_b64_tr_b16 v[62:63], v15 offset:28672
ds_read_b64_tr_b16 v[124:125], v15 offset:32768
v_mfma_f32_16x16x32_bf16 v[216:219], v[36:39], a[24:27], v[216:219]
ds_read_b64_tr_b16 v[126:127], v15 offset:36864
v_mfma_f32_16x16x32_bf16 v[216:219], v[40:43], a[40:43], v[216:219]
ds_write_b32 v23, v118
v_mfma_f32_16x16x32_bf16 v[216:219], v[44:47], a[56:59], v[216:219]
s_and_b32 s80, s78, 255
v_mfma_f32_16x16x32_bf16 v[216:219], v[120:123], a[72:75], v[216:219]
buffer_load_dwordx4 a[188:191], v22, s[28:31], s27 offen offset:0 sc1
v_mfma_f32_16x16x32_bf16 v[248:251], v[32:35], a[12:15], v[248:251]
v_add_u32 v15, s25, v15
v_mfma_f32_16x16x32_bf16 v[248:251], v[36:39], a[28:31], v[248:251]
s_bfe_u32 s81, s78, 0x80008
v_mfma_f32_16x16x32_bf16 v[248:251], v[40:43], a[44:47], v[248:251]
s_cmp_lt_u32 s81, s80
s_cselect_b32 s83, 1, 0
v_mfma_f32_16x16x32_bf16 v[248:251], v[44:47], a[60:63], v[248:251]
s_min_u32 s80, s80, s81
v_mfma_f32_16x16x32_bf16 v[248:251], v[120:123], a[76:79], v[248:251]
buffer_load_dwordx4 v19, s[12:15], s23 offen offset:1024 lds
s_waitcnt lgkmcnt(7)
v_mfma_f32_16x16x32_bf16 v[156:159], v[48:51], a[0:3], v[156:159]
ds_read_b64_tr_b16 v[32:33], v8 offset:0
ds_read_b64_tr_b16 v[34:35], v8 offset:4096
v_mfma_f32_16x16x32_bf16 v[156:159], v[52:55], a[16:19], v[156:159]
ds_read_b64_tr_b16 v[36:37], v8 offset:8192
s_waitcnt lgkmcnt(4)
v_mfma_f32_16x16x32_bf16 v[156:159], v[56:59], a[32:35], v[156:159]
ds_read_b64_tr_b16 v[38:39], v8 offset:12288
s_bfe_u32 s81, s78, 0x80010
v_mfma_f32_16x16x32_bf16 v[156:159], v[60:63], a[48:51], v[156:159]
s_cmp_lt_u32 s81, s80
s_cselect_b32 s83, 2, s83
v_mfma_f32_16x16x32_bf16 v[156:159], v[124:127], a[64:67], v[156:159]
buffer_load_dwordx4 a[204:207], v22, s[28:31], s27 offen offset:1024 sc1
v_mfma_f32_16x16x32_bf16 v[188:191], v[48:51], a[4:7], v[188:191]
ds_read_b64_tr_b16 v[40:41], v8 offset:16384
ds_read_b64_tr_b16 v[42:43], v8 offset:20480
v_mfma_f32_16x16x32_bf16 v[188:191], v[52:55], a[20:23], v[188:191]
ds_read_b64_tr_b16 v[44:45], v8 offset:24576
v_mfma_f32_16x16x32_bf16 v[188:191], v[56:59], a[36:39], v[188:191]
s_min_u32 s80, s80, s81
v_mfma_f32_16x16x32_bf16 v[188:191], v[60:63], a[52:55], v[188:191]
s_lshr_b32 s81, s78, 24
v_mfma_f32_16x16x32_bf16 v[188:191], v[124:127], a[68:71], v[188:191]
buffer_load_dwordx4 a[220:223], v22, s[28:31], s27 offen offset:2048 sc1
v_mfma_f32_16x16x32_bf16 v[220:223], v[48:51], a[8:11], v[220:223]
ds_read_b64_tr_b16 v[46:47], v8 offset:28672
ds_read_b64_tr_b16 v[120:121], v8 offset:32768
v_mfma_f32_16x16x32_bf16 v[220:223], v[52:55], a[24:27], v[220:223]
ds_read_b64_tr_b16 v[122:123], v8 offset:36864
v_mfma_f32_16x16x32_bf16 v[220:223], v[56:59], a[40:43], v[220:223]
s_cmp_lt_u32 s81, s80
s_cselect_b32 s83, 3, s83
v_mfma_f32_16x16x32_bf16 v[220:223], v[60:63], a[56:59], v[220:223]
s_min_u32 s80, s80, s81
v_mfma_f32_16x16x32_bf16 v[220:223], v[124:127], a[72:75], v[220:223]
buffer_load_dwordx4 a[236:239], v22, s[28:31], s27 offen offset:3072 sc1
v_mfma_f32_16x16x32_bf16 v[252:255], v[48:51], a[12:15], v[252:255]
v_add_u32 v8, s25, v8
v_mfma_f32_16x16x32_bf16 v[252:255], v[52:55], a[28:31], v[252:255]
s_cmp_lt_u32 s80, 5
s_cselect_b32 s83, s83, 4
v_mfma_f32_16x16x32_bf16 v[252:255], v[56:59], a[44:47], v[252:255]
s_lshl_b32 s80, s45, 3
v_mfma_f32_16x16x32_bf16 v[252:255], v[60:63], a[60:63], v[252:255]
s_lshr_b32 s80, s78, s80
v_mfma_f32_16x16x32_bf16 v[252:255], v[124:127], a[76:79], v[252:255]
buffer_load_dwordx4 a[252:255], v22, s[28:31], s65 offen offset:0 sc1
s_waitcnt lgkmcnt(6)
v_mfma_f32_16x16x32_bf16 v[128:131], v[32:35], a[0:3], v[128:131]
ds_read_b64_tr_b16 v[48:49], v9 offset:0
ds_read_b64_tr_b16 v[50:51], v9 offset:4096
v_mfma_f32_16x16x32_bf16 v[128:131], v[36:39], a[16:19], v[128:131]
ds_read_b64_tr_b16 v[52:53], v9 offset:8192
ds_read_b64_tr_b16 v[54:55], v9 offset:12288
s_waitcnt lgkmcnt(4)
v_mfma_f32_16x16x32_bf16 v[128:131], v[40:43], a[32:35], v[128:131]
s_and_b32 s80, s80, 255
v_mfma_f32_16x16x32_bf16 v[128:131], v[44:47], a[48:51], v[128:131]
s_cmp_lt_u32 s80, 5
s_cselect_b32 s83, s45, s83
s_add_u32 s24, s23, 14336
v_mfma_f32_16x16x32_bf16 v[128:131], v[120:123], a[64:67], v[128:131]
buffer_load_dwordx4 v18, s[12:15], s24 offen offset:2048 lds
v_mfma_f32_16x16x32_bf16 v[160:163], v[32:35], a[4:7], v[160:163]
ds_read_b64_tr_b16 v[56:57], v9 offset:16384
ds_read_b64_tr_b16 v[58:59], v9 offset:20480
v_mfma_f32_16x16x32_bf16 v[160:163], v[36:39], a[20:23], v[160:163]
ds_read_b64_tr_b16 v[60:61], v9 offset:24576
v_mfma_f32_16x16x32_bf16 v[160:163], v[40:43], a[36:39], v[160:163]
s_cmp_lt_u32 s79, 5
s_cselect_b32 s52, s83, 4
v_mfma_f32_16x16x32_bf16 v[160:163], v[44:47], a[52:55], v[160:163]
s_lshl_b32 s76, s52, 3
v_mfma_f32_16x16x32_bf16 v[160:163], v[120:123], a[68:71], v[160:163]
buffer_load_dwordx4 v19, s[12:15], s24 offen offset:3072 lds
v_mfma_f32_16x16x32_bf16 v[192:195], v[32:35], a[8:11], v[192:195]
ds_read_b64_tr_b16 v[62:63], v9 offset:28672
ds_read_b64_tr_b16 v[124:125], v9 offset:32768
v_mfma_f32_16x16x32_bf16 v[192:195], v[36:39], a[24:27], v[192:195]
ds_read_b64_tr_b16 v[126:127], v9 offset:36864
s_lshl_b32 s77, 1, s76
v_mfma_f32_16x16x32_bf16 v[192:195], v[40:43], a[40:43], v[192:195]
v_mov_b32 v26, s77
v_mfma_f32_16x16x32_bf16 v[192:195], v[44:47], a[56:59], v[192:195]
s_add_u32 m0, m0, 4096
s_add_u32 s23, s23, 32768
v_mfma_f32_16x16x32_bf16 v[192:195], v[120:123], a[72:75], v[192:195]
buffer_load_dwordx4 v18, s[12:15], s23 offen offset:0 lds
v_mfma_f32_16x16x32_bf16 v[224:227], v[32:35], a[12:15], v[224:227]
v_add_u32 v9, s25, v9
v_mfma_f32_16x16x32_bf16 v[224:227], v[36:39], a[28:31], v[224:227]
s_lshr_b32 s59, s52, 2
v_mfma_f32_16x16x32_bf16 v[224:227], v[40:43], a[44:47], v[224:227]
s_or_b32 s59, s59, s3
v_mfma_f32_16x16x32_bf16 v[224:227], v[44:47], a[60:63], v[224:227]
buffer_load_dwordx4 v19, s[12:15], s23 offen offset:1024 lds
v_mfma_f32_16x16x32_bf16 v[224:227], v[120:123], a[76:79], v[224:227]
s_waitcnt lgkmcnt(0)
s_barrier
v_mfma_f32_16x16x32_bf16 v[132:135], v[48:51], a[0:3], v[132:135]
ds_read_b32 v117, v116
ds_read_b64_tr_b16 v[32:33], v10 offset:0
v_mfma_f32_16x16x32_bf16 v[132:135], v[52:55], a[16:19], v[132:135]
ds_read_b64_tr_b16 v[34:35], v10 offset:4096
v_mfma_f32_16x16x32_bf16 v[132:135], v[56:59], a[32:35], v[132:135]
ds_read_b64_tr_b16 v[36:37], v10 offset:8192
ds_read_b64_tr_b16 v[38:39], v10 offset:12288
v_mfma_f32_16x16x32_bf16 v[132:135], v[60:63], a[48:51], v[132:135]
s_add_u32 s24, s24, 32768
v_mfma_f32_16x16x32_bf16 v[132:135], v[124:127], a[64:67], v[132:135]
buffer_load_dwordx4 v18, s[12:15], s24 offen offset:2048 lds
v_mfma_f32_16x16x32_bf16 v[164:167], v[48:51], a[4:7], v[164:167]
ds_read_b64_tr_b16 v[40:41], v10 offset:16384
ds_read_b64_tr_b16 v[42:43], v10 offset:20480
v_mfma_f32_16x16x32_bf16 v[164:167], v[52:55], a[20:23], v[164:167]
ds_read_b64_tr_b16 v[44:45], v10 offset:24576
v_mfma_f32_16x16x32_bf16 v[164:167], v[56:59], a[36:39], v[164:167]
buffer_load_dwordx4 v19, s[12:15], s24 offen offset:3072 lds
v_mfma_f32_16x16x32_bf16 v[164:167], v[60:63], a[52:55], v[164:167]
s_add_u32 s21, s21, 40960
v_mfma_f32_16x16x32_bf16 v[164:167], v[124:127], a[68:71], v[164:167]
s_cmp_eq_u32 s21, 122880
s_cselect_b32 s21, 0, s21
v_mfma_f32_16x16x32_bf16 v[196:199], v[48:51], a[8:11], v[196:199]
ds_read_b64_tr_b16 v[46:47], v10 offset:28672
v_mfma_f32_16x16x32_bf16 v[196:199], v[52:55], a[24:27], v[196:199]
ds_read_b64_tr_b16 v[120:121], v10 offset:32768
v_mfma_f32_16x16x32_bf16 v[196:199], v[56:59], a[40:43], v[196:199]
v_mfma_f32_16x16x32_bf16 v[196:199], v[60:63], a[56:59], v[196:199]
ds_read_b64_tr_b16 v[122:123], v10 offset:36864
v_mfma_f32_16x16x32_bf16 v[196:199], v[124:127], a[72:75], v[196:199]
v_mfma_f32_16x16x32_bf16 v[228:231], v[48:51], a[12:15], v[228:231]
s_cmp_eq_u32 s51, 2
s_cselect_b32 s25, s54, s55
s_cselect_b32 s51, -1, s51
s_add_u32 s51, s51, 1
v_mfma_f32_16x16x32_bf16 v[228:231], v[52:55], a[28:31], v[228:231]
v_add_u32 v10, s25, v10
v_mfma_f32_16x16x32_bf16 v[228:231], v[56:59], a[44:47], v[228:231]
s_waitcnt lgkmcnt(10)
s_mov_b32 s20, s44
v_mfma_f32_16x16x32_bf16 v[228:231], v[60:63], a[60:63], v[228:231]
v_readfirstlane_b32 s44, v117
v_mfma_f32_16x16x32_bf16 v[228:231], v[124:127], a[76:79], v[228:231]
s_cmp_ge_u32 s20, 64
s_cbranch_scc1 L_last0
s_branch L_p4
L_last0:
s_waitcnt vmcnt(25)
s_waitcnt lgkmcnt(6)
v_mfma_f32_16x16x32_bf16 v[136:139], v[32:35], a[176:179], v[136:139]
ds_read_b64_tr_b16 v[48:49], v11 offset:0
ds_read_b64_tr_b16 v[50:51], v11 offset:4096
v_mfma_f32_16x16x32_bf16 v[136:139], v[36:39], a[192:195], v[136:139]
ds_read_b64_tr_b16 v[52:53], v11 offset:8192
ds_read_b64_tr_b16 v[54:55], v11 offset:12288
s_waitcnt lgkmcnt(4)
v_mfma_f32_16x16x32_bf16 v[136:139], v[40:43], a[208:211], v[136:139]
s_lshl_b32 s57, s2, 2
s_add_u32 s57, s57, s3
v_mfma_f32_16x16x32_bf16 v[136:139], v[44:47], a[224:227], v[136:139]
s_mul_i32 s57, s57, 12288
s_add_u32 s57, s57, 67108864
v_mfma_f32_16x16x32_bf16 v[136:139], v[120:123], a[240:243], v[136:139]
s_lshl_b32 s74, s3, 2
s_waitcnt vmcnt(19)
v_mfma_f32_16x16x32_bf16 v[168:171], v[32:35], a[180:183], v[168:171]
ds_read_b64_tr_b16 v[56:57], v11 offset:16384
ds_read_b64_tr_b16 v[58:59], v11 offset:20480
v_mfma_f32_16x16x32_bf16 v[168:171], v[36:39], a[196:199], v[168:171]
ds_read_b64_tr_b16 v[60:61], v11 offset:24576
v_mov_b32 v26, s74
v_mfma_f32_16x16x32_bf16 v[168:171], v[40:43], a[212:215], v[168:171]
v_and_b32 v18, 3, v1
v_mfma_f32_16x16x32_bf16 v[168:171], v[44:47], a[228:231], v[168:171]
v_lshl_add_u32 v18, v18, 4, s74
s_lshl_b32 s56, s2, 7
v_mfma_f32_16x16x32_bf16 v[168:171], v[120:123], a[244:247], v[168:171]
s_add_u32 s56, s56, 63963136
s_waitcnt vmcnt(12)
v_mfma_f32_16x16x32_bf16 v[200:203], v[32:35], a[184:187], v[200:203]
ds_read_b64_tr_b16 v[62:63], v11 offset:28672
ds_read_b64_tr_b16 v[124:125], v11 offset:32768
v_mfma_f32_16x16x32_bf16 v[200:203], v[36:39], a[200:203], v[200:203]
ds_read_b64_tr_b16 v[126:127], v11 offset:36864
v_mov_b32 v16, 0x3f80
v_mfma_f32_16x16x32_bf16 v[200:203], v[40:43], a[216:219], v[200:203]
v_mov_b32 v17, 0x3f800000
v_mfma_f32_16x16x32_bf16 v[200:203], v[44:47], a[232:235], v[200:203]
v_lshlrev_b32 v20, 11, v3
v_and_b32 v21, 1, v2
v_mfma_f32_16x16x32_bf16 v[200:203], v[120:123], a[248:251], v[200:203]
v_lshl_add_u32 v20, v21, 5, v20
s_waitcnt vmcnt(6)
v_mfma_f32_16x16x32_bf16 v[232:235], v[32:35], a[188:191], v[232:235]
v_lshrrev_b32 v21, 1, v2
v_mfma_f32_16x16x32_bf16 v[232:235], v[36:39], a[204:207], v[232:235]
v_lshl_add_u32 v20, v21, 4, v20
v_mfma_f32_16x16x32_bf16 v[232:235], v[40:43], a[220:223], v[232:235]
s_lshl_b32 s58, s62, 8
v_mfma_f32_16x16x32_bf16 v[232:235], v[44:47], a[236:239], v[232:235]
s_lshl_b32 s59, s45, 6
v_mfma_f32_16x16x32_bf16 v[232:235], v[120:123], a[252:255], v[232:235]
s_add_u32 s58, s58, s59
s_waitcnt lgkmcnt(6)
v_mfma_f32_16x16x32_bf16 v[140:143], v[48:51], a[176:179], v[140:143]
ds_read_b64_tr_b16 v[32:33], v12 offset:0
ds_read_b64_tr_b16 v[34:35], v12 offset:4096
v_mfma_f32_16x16x32_bf16 v[140:143], v[52:55], a[192:195], v[140:143]
ds_read_b64_tr_b16 v[36:37], v12 offset:8192
ds_read_b64_tr_b16 v[38:39], v12 offset:12288
s_waitcnt lgkmcnt(4)
v_mfma_f32_16x16x32_bf16 v[140:143], v[56:59], a[208:211], v[140:143]
s_lshl_b32 s60, s40, 11
s_add_u32 s60, s60, s58
v_mfma_f32_16x16x32_bf16 v[140:143], v[60:63], a[224:227], v[140:143]
s_lshl_b32 s61, s41, 11
s_add_u32 s61, s61, s58
v_mfma_f32_16x16x32_bf16 v[140:143], v[124:127], a[240:243], v[140:143]
v_add_u32 v21, 32768, v20
v_mfma_f32_16x16x32_bf16 v[172:175], v[48:51], a[180:183], v[172:175]
ds_read_b64_tr_b16 v[40:41], v12 offset:16384
ds_read_b64_tr_b16 v[42:43], v12 offset:20480
v_mfma_f32_16x16x32_bf16 v[172:175], v[52:55], a[196:199], v[172:175]
ds_read_b64_tr_b16 v[44:45], v12 offset:24576
s_xor_b32 s74, s2, 3
v_mfma_f32_16x16x32_bf16 v[172:175], v[56:59], a[212:215], v[172:175]
s_lshl_b32 s74, s74, 2
v_mfma_f32_16x16x32_bf16 v[172:175], v[60:63], a[228:231], v[172:175]
s_add_u32 s74, s74, s3
s_mul_i32 s74, s74, 12288
v_mfma_f32_16x16x32_bf16 v[172:175], v[124:127], a[244:247], v[172:175]
s_add_u32 s76, s74, 67108864
v_mfma_f32_16x16x32_bf16 v[204:207], v[48:51], a[184:187], v[204:207]
ds_read_b64_tr_b16 v[46:47], v12 offset:28672
ds_read_b64_tr_b16 v[120:121], v12 offset:32768
v_mfma_f32_16x16x32_bf16 v[204:207], v[52:55], a[200:203], v[204:207]
ds_read_b64_tr_b16 v[122:123], v12 offset:36864
s_xor_b32 s74, s2, 4
v_mfma_f32_16x16x32_bf16 v[204:207], v[56:59], a[216:219], v[204:207]
s_lshl_b32 s74, s74, 2
v_mfma_f32_16x16x32_bf16 v[204:207], v[60:63], a[232:235], v[204:207]
s_add_u32 s74, s74, s3
s_mul_i32 s74, s74, 12288
v_mfma_f32_16x16x32_bf16 v[204:207], v[124:127], a[248:251], v[204:207]
s_add_u32 s77, s74, 67112960
v_mfma_f32_16x16x32_bf16 v[236:239], v[48:51], a[188:191], v[236:239]
s_xor_b32 s74, s2, 7
v_mfma_f32_16x16x32_bf16 v[236:239], v[52:55], a[204:207], v[236:239]
s_lshl_b32 s74, s74, 2
v_mfma_f32_16x16x32_bf16 v[236:239], v[56:59], a[220:223], v[236:239]
s_add_u32 s74, s74, s3
v_mfma_f32_16x16x32_bf16 v[236:239], v[60:63], a[236:239], v[236:239]
s_mul_i32 s74, s74, 12288
v_mfma_f32_16x16x32_bf16 v[236:239], v[124:127], a[252:255], v[236:239]
s_add_u32 s78, s74, 67117056
s_waitcnt lgkmcnt(6)
v_mfma_f32_16x16x32_bf16 v[144:147], v[32:35], a[176:179], v[144:147]
ds_read_b64_tr_b16 v[48:49], v13 offset:0
v_mfma_f32_16x16x32_bf16 v[144:147], v[36:39], a[192:195], v[144:147]
ds_read_b64_tr_b16 v[50:51], v13 offset:4096
s_waitcnt lgkmcnt(2)
v_mfma_f32_16x16x32_bf16 v[144:147], v[40:43], a[208:211], v[144:147]
ds_read_b64_tr_b16 v[52:53], v13 offset:8192
v_mfma_f32_16x16x32_bf16 v[144:147], v[44:47], a[224:227], v[144:147]
ds_read_b64_tr_b16 v[54:55], v13 offset:12288
v_mfma_f32_16x16x32_bf16 v[144:147], v[120:123], a[240:243], v[144:147]
v_mfma_f32_16x16x32_bf16 v[176:179], v[32:35], a[180:183], v[176:179]
ds_read_b64_tr_b16 v[56:57], v13 offset:16384
ds_read_b64_tr_b16 v[58:59], v13 offset:20480
v_mfma_f32_16x16x32_bf16 v[176:179], v[36:39], a[196:199], v[176:179]
ds_read_b64_tr_b16 v[60:61], v13 offset:24576
v_cvt_pk_bf16_f32 v64, v136, v137
v_mfma_f32_16x16x32_bf16 v[176:179], v[40:43], a[212:215], v[176:179]
v_cvt_pk_bf16_f32 v65, v138, v139
v_mfma_f32_16x16x32_bf16 v[176:179], v[44:47], a[228:231], v[176:179]
v_cvt_pk_bf16_f32 v66, v140, v141
v_cvt_pk_bf16_f32 v67, v142, v143
v_mfma_f32_16x16x32_bf16 v[176:179], v[120:123], a[244:247], v[176:179]
buffer_store_dwordx4 v[64:67], v31, s[28:31], s57 offen offset:0 sc1
v_mfma_f32_16x16x32_bf16 v[208:211], v[32:35], a[184:187], v[208:211]
ds_read_b64_tr_b16 v[62:63], v13 offset:28672
ds_read_b64_tr_b16 v[124:125], v13 offset:32768
v_mfma_f32_16x16x32_bf16 v[208:211], v[36:39], a[200:203], v[208:211]
ds_read_b64_tr_b16 v[126:127], v13 offset:36864
v_cvt_pk_bf16_f32 v68, v168, v169
v_mfma_f32_16x16x32_bf16 v[208:211], v[40:43], a[216:219], v[208:211]
v_cvt_pk_bf16_f32 v69, v170, v171
v_mfma_f32_16x16x32_bf16 v[208:211], v[44:47], a[232:235], v[208:211]
v_cvt_pk_bf16_f32 v70, v172, v173
v_cvt_pk_bf16_f32 v71, v174, v175
v_mfma_f32_16x16x32_bf16 v[208:211], v[120:123], a[248:251], v[208:211]
buffer_store_dwordx4 v[68:71], v31, s[28:31], s57 offen offset:1024 sc1
v_mfma_f32_16x16x32_bf16 v[240:243], v[32:35], a[188:191], v[240:243]
v_mfma_f32_16x16x32_bf16 v[240:243], v[36:39], a[204:207], v[240:243]
v_mfma_f32_16x16x32_bf16 v[240:243], v[40:43], a[220:223], v[240:243]
v_mfma_f32_16x16x32_bf16 v[240:243], v[44:47], a[236:239], v[240:243]
v_mfma_f32_16x16x32_bf16 v[240:243], v[120:123], a[252:255], v[240:243]
s_waitcnt lgkmcnt(6)
v_mfma_f32_16x16x32_bf16 v[148:151], v[48:51], a[176:179], v[148:151]
ds_read_b64_tr_b16 v[32:33], v14 offset:0
ds_read_b64_tr_b16 v[34:35], v14 offset:4096
v_mfma_f32_16x16x32_bf16 v[148:151], v[52:55], a[192:195], v[148:151]
ds_read_b64_tr_b16 v[36:37], v14 offset:8192
ds_read_b64_tr_b16 v[38:39], v14 offset:12288
s_waitcnt lgkmcnt(4)
v_mfma_f32_16x16x32_bf16 v[148:151], v[56:59], a[208:211], v[148:151]
v_cvt_pk_bf16_f32 v72, v200, v201
v_cvt_pk_bf16_f32 v73, v202, v203
v_mfma_f32_16x16x32_bf16 v[148:151], v[60:63], a[224:227], v[148:151]
v_cvt_pk_bf16_f32 v74, v204, v205
v_cvt_pk_bf16_f32 v75, v206, v207
v_mfma_f32_16x16x32_bf16 v[148:151], v[124:127], a[240:243], v[148:151]
buffer_store_dwordx4 v[72:75], v31, s[28:31], s57 offen offset:2048 sc1
v_mfma_f32_16x16x32_bf16 v[180:183], v[48:51], a[180:183], v[180:183]
ds_read_b64_tr_b16 v[40:41], v14 offset:16384
v_mfma_f32_16x16x32_bf16 v[180:183], v[52:55], a[196:199], v[180:183]
ds_read_b64_tr_b16 v[42:43], v14 offset:20480
v_mfma_f32_16x16x32_bf16 v[180:183], v[56:59], a[212:215], v[180:183]
v_mfma_f32_16x16x32_bf16 v[180:183], v[60:63], a[228:231], v[180:183]
ds_read_b64_tr_b16 v[44:45], v14 offset:24576
v_mfma_f32_16x16x32_bf16 v[180:183], v[124:127], a[244:247], v[180:183]
v_mfma_f32_16x16x32_bf16 v[212:215], v[48:51], a[184:187], v[212:215]
ds_read_b64_tr_b16 v[46:47], v14 offset:28672
ds_read_b64_tr_b16 v[120:121], v14 offset:32768
v_mfma_f32_16x16x32_bf16 v[212:215], v[52:55], a[200:203], v[212:215]
ds_read_b64_tr_b16 v[122:123], v14 offset:36864
v_cvt_pk_bf16_f32 v76, v232, v233
v_mfma_f32_16x16x32_bf16 v[212:215], v[56:59], a[216:219], v[212:215]
v_cvt_pk_bf16_f32 v77, v234, v235
v_cvt_pk_bf16_f32 v78, v236, v237
v_mfma_f32_16x16x32_bf16 v[212:215], v[60:63], a[232:235], v[212:215]
v_cvt_pk_bf16_f32 v79, v238, v239
buffer_store_dwordx4 v[76:79], v31, s[28:31], s57 offen offset:3072 sc1
v_mfma_f32_16x16x32_bf16 v[212:215], v[124:127], a[248:251], v[212:215]
s_add_u32 s57, s57, 4096
v_mfma_f32_16x16x32_bf16 v[244:247], v[48:51], a[188:191], v[244:247]
v_mfma_f32_16x16x32_bf16 v[244:247], v[52:55], a[204:207], v[244:247]
v_mfma_f32_16x16x32_bf16 v[244:247], v[56:59], a[220:223], v[244:247]
v_mfma_f32_16x16x32_bf16 v[244:247], v[60:63], a[236:239], v[244:247]
v_mfma_f32_16x16x32_bf16 v[244:247], v[124:127], a[252:255], v[244:247]
s_waitcnt lgkmcnt(6)
v_mfma_f32_16x16x32_bf16 v[152:155], v[32:35], a[176:179], v[152:155]
ds_read_b64_tr_b16 v[48:49], v15 offset:0
v_mfma_f32_16x16x32_bf16 v[152:155], v[36:39], a[192:195], v[152:155]
ds_read_b64_tr_b16 v[50:51], v15 offset:4096
s_waitcnt lgkmcnt(2)
v_mfma_f32_16x16x32_bf16 v[152:155], v[40:43], a[208:211], v[152:155]
ds_read_b64_tr_b16 v[52:53], v15 offset:8192
v_mfma_f32_16x16x32_bf16 v[152:155], v[44:47], a[224:227], v[152:155]
ds_read_b64_tr_b16 v[54:55], v15 offset:12288
v_mfma_f32_16x16x32_bf16 v[152:155], v[120:123], a[240:243], v[152:155]
v_mfma_f32_16x16x32_bf16 v[184:187], v[32:35], a[180:183], v[184:187]
ds_read_b64_tr_b16 v[56:57], v15 offset:16384
ds_read_b64_tr_b16 v[58:59], v15 offset:20480
v_mfma_f32_16x16x32_bf16 v[184:187], v[36:39], a[196:199], v[184:187]
ds_read_b64_tr_b16 v[60:61], v15 offset:24576
v_cvt_pk_bf16_f32 v80, v144, v145
v_mfma_f32_16x16x32_bf16 v[184:187], v[40:43], a[212:215], v[184:187]
v_cvt_pk_bf16_f32 v81, v146, v147
v_mfma_f32_16x16x32_bf16 v[184:187], v[44:47], a[228:231], v[184:187]
v_cvt_pk_bf16_f32 v82, v148, v149
v_cvt_pk_bf16_f32 v83, v150, v151
v_mfma_f32_16x16x32_bf16 v[184:187], v[120:123], a[244:247], v[184:187]
buffer_store_dwordx4 v[80:83], v31, s[28:31], s57 offen offset:0 sc1
v_mfma_f32_16x16x32_bf16 v[216:219], v[32:35], a[184:187], v[216:219]
ds_read_b64_tr_b16 v[62:63], v15 offset:28672
ds_read_b64_tr_b16 v[124:125], v15 offset:32768
v_mfma_f32_16x16x32_bf16 v[216:219], v[36:39], a[200:203], v[216:219]
ds_read_b64_tr_b16 v[126:127], v15 offset:36864
v_cvt_pk_bf16_f32 v84, v176, v177
v_mfma_f32_16x16x32_bf16 v[216:219], v[40:43], a[216:219], v[216:219]
v_cvt_pk_bf16_f32 v85, v178, v179
v_mfma_f32_16x16x32_bf16 v[216:219], v[44:47], a[232:235], v[216:219]
v_cvt_pk_bf16_f32 v86, v180, v181
v_cvt_pk_bf16_f32 v87, v182, v183
v_mfma_f32_16x16x32_bf16 v[216:219], v[120:123], a[248:251], v[216:219]
buffer_store_dwordx4 v[84:87], v31, s[28:31], s57 offen offset:1024 sc1
v_mfma_f32_16x16x32_bf16 v[248:251], v[32:35], a[188:191], v[248:251]
v_mfma_f32_16x16x32_bf16 v[248:251], v[36:39], a[204:207], v[248:251]
v_mfma_f32_16x16x32_bf16 v[248:251], v[40:43], a[220:223], v[248:251]
v_mfma_f32_16x16x32_bf16 v[248:251], v[44:47], a[236:239], v[248:251]
v_mfma_f32_16x16x32_bf16 v[248:251], v[120:123], a[252:255], v[248:251]
s_waitcnt lgkmcnt(6)
v_mfma_f32_16x16x32_bf16 v[156:159], v[48:51], a[176:179], v[156:159]
ds_read_b64_tr_b16 v[32:33], v8 offset:0
ds_read_b64_tr_b16 v[34:35], v8 offset:4096
v_mfma_f32_16x16x32_bf16 v[156:159], v[52:55], a[192:195], v[156:159]
ds_read_b64_tr_b16 v[36:37], v8 offset:8192
ds_read_b64_tr_b16 v[38:39], v8 offset:12288
s_waitcnt lgkmcnt(4)
v_mfma_f32_16x16x32_bf16 v[156:159], v[56:59], a[208:211], v[156:159]
v_cvt_pk_bf16_f32 v88, v208, v209
v_cvt_pk_bf16_f32 v89, v210, v211
v_mfma_f32_16x16x32_bf16 v[156:159], v[60:63], a[224:227], v[156:159]
v_cvt_pk_bf16_f32 v90, v212, v213
v_cvt_pk_bf16_f32 v91, v214, v215
v_mfma_f32_16x16x32_bf16 v[156:159], v[124:127], a[240:243], v[156:159]
buffer_store_dwordx4 v[88:91], v31, s[28:31], s57 offen offset:2048 sc1
s_waitcnt vmcnt(3)
s_xor_b32 s74, s2, 3
s_lshl_b32 s74, s74, 7
s_add_u32 s74, s74, 63963136
buffer_store_dword v24, v26, s[28:31], s74 offen sc1
v_mfma_f32_16x16x32_bf16 v[188:191], v[48:51], a[180:183], v[188:191]
ds_read_b64_tr_b16 v[40:41], v8 offset:16384
v_mfma_f32_16x16x32_bf16 v[188:191], v[52:55], a[196:199], v[188:191]
ds_read_b64_tr_b16 v[42:43], v8 offset:20480
v_mfma_f32_16x16x32_bf16 v[188:191], v[56:59], a[212:215], v[188:191]
v_mfma_f32_16x16x32_bf16 v[188:191], v[60:63], a[228:231], v[188:191]
ds_read_b64_tr_b16 v[44:45], v8 offset:24576
v_mfma_f32_16x16x32_bf16 v[188:191], v[124:127], a[244:247], v[188:191]
v_mfma_f32_16x16x32_bf16 v[220:223], v[48:51], a[184:187], v[220:223]
ds_read_b64_tr_b16 v[46:47], v8 offset:28672
ds_read_b64_tr_b16 v[120:121], v8 offset:32768
v_mfma_f32_16x16x32_bf16 v[220:223], v[52:55], a[200:203], v[220:223]
ds_read_b64_tr_b16 v[122:123], v8 offset:36864
v_cvt_pk_bf16_f32 v92, v240, v241
v_mfma_f32_16x16x32_bf16 v[220:223], v[56:59], a[216:219], v[220:223]
v_cvt_pk_bf16_f32 v93, v242, v243
v_cvt_pk_bf16_f32 v94, v244, v245
v_mfma_f32_16x16x32_bf16 v[220:223], v[60:63], a[232:235], v[220:223]
v_cvt_pk_bf16_f32 v95, v246, v247
buffer_store_dwordx4 v[92:95], v31, s[28:31], s57 offen offset:3072 sc1
v_mfma_f32_16x16x32_bf16 v[220:223], v[124:127], a[248:251], v[220:223]
s_add_u32 s57, s57, 4096
v_mfma_f32_16x16x32_bf16 v[252:255], v[48:51], a[188:191], v[252:255]
v_mfma_f32_16x16x32_bf16 v[252:255], v[52:55], a[204:207], v[252:255]
v_mfma_f32_16x16x32_bf16 v[252:255], v[56:59], a[220:223], v[252:255]
v_mfma_f32_16x16x32_bf16 v[252:255], v[60:63], a[236:239], v[252:255]
v_mfma_f32_16x16x32_bf16 v[252:255], v[124:127], a[252:255], v[252:255]
s_waitcnt lgkmcnt(6)
v_mfma_f32_16x16x32_bf16 v[128:131], v[32:35], a[176:179], v[128:131]
ds_read_b64_tr_b16 v[48:49], v9 offset:0
v_mfma_f32_16x16x32_bf16 v[128:131], v[36:39], a[192:195], v[128:131]
ds_read_b64_tr_b16 v[50:51], v9 offset:4096
s_waitcnt lgkmcnt(2)
v_mfma_f32_16x16x32_bf16 v[128:131], v[40:43], a[208:211], v[128:131]
ds_read_b64_tr_b16 v[52:53], v9 offset:8192
v_mfma_f32_16x16x32_bf16 v[128:131], v[44:47], a[224:227], v[128:131]
ds_read_b64_tr_b16 v[54:55], v9 offset:12288
v_mfma_f32_16x16x32_bf16 v[128:131], v[120:123], a[240:243], v[128:131]
v_mfma_f32_16x16x32_bf16 v[160:163], v[32:35], a[180:183], v[160:163]
ds_read_b64_tr_b16 v[56:57], v9 offset:16384
ds_read_b64_tr_b16 v[58:59], v9 offset:20480
v_mfma_f32_16x16x32_bf16 v[160:163], v[36:39], a[196:199], v[160:163]
ds_read_b64_tr_b16 v[60:61], v9 offset:24576
v_cvt_pk_bf16_f32 v96, v152, v153
v_mfma_f32_16x16x32_bf16 v[160:163], v[40:43], a[212:215], v[160:163]
v_cvt_pk_bf16_f32 v97, v154, v155
v_mfma_f32_16x16x32_bf16 v[160:163], v[44:47], a[228:231], v[160:163]
v_cvt_pk_bf16_f32 v98, v156, v157
v_cvt_pk_bf16_f32 v99, v158, v159
v_mfma_f32_16x16x32_bf16 v[160:163], v[120:123], a[244:247], v[160:163]
buffer_store_dwordx4 v[96:99], v31, s[28:31], s57 offen offset:0 sc1
v_mfma_f32_16x16x32_bf16 v[192:195], v[32:35], a[184:187], v[192:195]
ds_read_b64_tr_b16 v[62:63], v9 offset:28672
ds_read_b64_tr_b16 v[124:125], v9 offset:32768
v_mfma_f32_16x16x32_bf16 v[192:195], v[36:39], a[200:203], v[192:195]
ds_read_b64_tr_b16 v[126:127], v9 offset:36864
v_cvt_pk_bf16_f32 v100, v184, v185
v_mfma_f32_16x16x32_bf16 v[192:195], v[40:43], a[216:219], v[192:195]
v_cvt_pk_bf16_f32 v101, v186, v187
v_mfma_f32_16x16x32_bf16 v[192:195], v[44:47], a[232:235], v[192:195]
v_cvt_pk_bf16_f32 v102, v188, v189
v_cvt_pk_bf16_f32 v103, v190, v191
v_mfma_f32_16x16x32_bf16 v[192:195], v[120:123], a[248:251], v[192:195]
buffer_store_dwordx4 v[100:103], v31, s[28:31], s57 offen offset:1024 sc1
v_mfma_f32_16x16x32_bf16 v[224:227], v[32:35], a[188:191], v[224:227]
v_mfma_f32_16x16x32_bf16 v[224:227], v[36:39], a[204:207], v[224:227]
v_mfma_f32_16x16x32_bf16 v[224:227], v[40:43], a[220:223], v[224:227]
v_mfma_f32_16x16x32_bf16 v[224:227], v[44:47], a[236:239], v[224:227]
v_mfma_f32_16x16x32_bf16 v[224:227], v[120:123], a[252:255], v[224:227]
s_waitcnt lgkmcnt(6)
v_mfma_f32_16x16x32_bf16 v[132:135], v[48:51], a[176:179], v[132:135]
v_cvt_pk_bf16_f32 v104, v216, v217
v_mfma_f32_16x16x32_bf16 v[132:135], v[52:55], a[192:195], v[132:135]
v_cvt_pk_bf16_f32 v105, v218, v219
s_waitcnt lgkmcnt(0)
v_mfma_f32_16x16x32_bf16 v[132:135], v[56:59], a[208:211], v[132:135]
v_cvt_pk_bf16_f32 v106, v220, v221
v_mfma_f32_16x16x32_bf16 v[132:135], v[60:63], a[224:227], v[132:135]
v_cvt_pk_bf16_f32 v107, v222, v223
v_mfma_f32_16x16x32_bf16 v[132:135], v[124:127], a[240:243], v[132:135]
buffer_store_dwordx4 v[104:107], v31, s[28:31], s57 offen offset:2048 sc1
s_waitcnt vmcnt(3)
s_xor_b32 s74, s2, 4
s_lshl_b32 s74, s74, 7
s_add_u32 s74, s74, 63963152
buffer_store_dword v24, v26, s[28:31], s74 offen sc1
buffer_load_dword v19, v18, s[28:31], s56 offen sc1
v_mfma_f32_16x16x32_bf16 v[164:167], v[48:51], a[180:183], v[164:167]
v_mfma_f32_16x16x32_bf16 v[164:167], v[52:55], a[196:199], v[164:167]
v_mfma_f32_16x16x32_bf16 v[164:167], v[56:59], a[212:215], v[164:167]
v_mfma_f32_16x16x32_bf16 v[164:167], v[60:63], a[228:231], v[164:167]
v_mfma_f32_16x16x32_bf16 v[164:167], v[124:127], a[244:247], v[164:167]
v_mfma_f32_16x16x32_bf16 v[196:199], v[48:51], a[184:187], v[196:199]
v_cvt_pk_bf16_f32 v108, v248, v249
v_cvt_pk_bf16_f32 v109, v250, v251
v_mfma_f32_16x16x32_bf16 v[196:199], v[52:55], a[200:203], v[196:199]
v_cvt_pk_bf16_f32 v110, v252, v253
v_mfma_f32_16x16x32_bf16 v[196:199], v[56:59], a[216:219], v[196:199]
v_cvt_pk_bf16_f32 v111, v254, v255
v_mfma_f32_16x16x32_bf16 v[196:199], v[60:63], a[232:235], v[196:199]
buffer_store_dwordx4 v[108:111], v31, s[28:31], s57 offen offset:3072 sc1
v_mfma_f32_16x16x32_bf16 v[196:199], v[124:127], a[248:251], v[196:199]
s_add_u32 s57, s57, 4096
v_mfma_f32_16x16x32_bf16 v[228:231], v[48:51], a[188:191], v[228:231]
v_mfma_f32_16x16x32_bf16 v[228:231], v[52:55], a[204:207], v[228:231]
v_mfma_f32_16x16x32_bf16 v[228:231], v[56:59], a[220:223], v[228:231]
v_mfma_f32_16x16x32_bf16 v[228:231], v[60:63], a[236:239], v[228:231]
v_mfma_f32_16x16x32_bf16 v[228:231], v[124:127], a[252:255], v[228:231]
s_branch L_tail
L_last1:
s_waitcnt vmcnt(25)
s_waitcnt lgkmcnt(6)
v_mfma_f32_16x16x32_bf16 v[136:139], v[32:35], a[0:3], v[136:139]
ds_read_b64_tr_b16 v[48:49], v11 offset:0
ds_read_b64_tr_b16 v[50:51], v11 offset:4096
v_mfma_f32_16x16x32_bf16 v[136:139], v[36:39], a[16:19], v[136:139]
ds_read_b64_tr_b16 v[52:53], v11 offset:8192
ds_read_b64_tr_b16 v[54:55], v11 offset:12288
s_waitcnt lgkmcnt(4)
v_mfma_f32_16x16x32_bf16 v[136:139], v[40:43], a[32:35], v[136:139]
s_lshl_b32 s57, s2, 2
s_add_u32 s57, s57, s3
v_mfma_f32_16x16x32_bf16 v[136:139], v[44:47], a[48:51], v[136:139]
s_mul_i32 s57, s57, 12288
s_add_u32 s57, s57, 67108864
v_mfma_f32_16x16x32_bf16 v[136:139], v[120:123], a[64:67], v[136:139]
s_lshl_b32 s74, s3, 2
s_waitcnt vmcnt(19)
v_mfma_f32_16x16x32_bf16 v[168:171], v[32:35], a[4:7], v[168:171]
ds_read_b64_tr_b16 v[56:57], v11 offset:16384
ds_read_b64_tr_b16 v[58:59], v11 offset:20480
v_mfma_f32_16x16x32_bf16 v[168:171], v[36:39], a[20:23], v[168:171]
ds_read_b64_tr_b16 v[60:61], v11 offset:24576
v_mov_b32 v26, s74
v_mfma_f32_16x16x32_bf16 v[168:171], v[40:43], a[36:39], v[168:171]
v_and_b32 v18, 3, v1
v_mfma_f32_16x16x32_bf16 v[168:171], v[44:47], a[52:55], v[168:171]
v_lshl_add_u32 v18, v18, 4, s74
s_lshl_b32 s56, s2, 7
v_mfma_f32_16x16x32_bf16 v[168:171], v[120:123], a[68:71], v[168:171]
s_add_u32 s56, s56, 63963136
s_waitcnt vmcnt(12)
v_mfma_f32_16x16x32_bf16 v[200:203], v[32:35], a[8:11], v[200:203]
ds_read_b64_tr_b16 v[62:63], v11 offset:28672
ds_read_b64_tr_b16 v[124:125], v11 offset:32768
v_mfma_f32_16x16x32_bf16 v[200:203], v[36:39], a[24:27], v[200:203]
ds_read_b64_tr_b16 v[126:127], v11 offset:36864
v_mov_b32 v16, 0x3f80
v_mfma_f32_16x16x32_bf16 v[200:203], v[40:43], a[40:43], v[200:203]
v_mov_b32 v17, 0x3f800000
v_mfma_f32_16x16x32_bf16 v[200:203], v[44:47], a[56:59], v[200:203]
v_lshlrev_b32 v20, 11, v3
v_and_b32 v21, 1, v2
v_mfma_f32_16x16x32_bf16 v[200:203], v[120:123], a[72:75], v[200:203]
v_lshl_add_u32 v20, v21, 5, v20
s_waitcnt vmcnt(6)
v_mfma_f32_16x16x32_bf16 v[232:235], v[32:35], a[12:15], v[232:235]
v_lshrrev_b32 v21, 1, v2
v_mfma_f32_16x16x32_bf16 v[232:235], v[36:39], a[28:31], v[232:235]
v_lshl_add_u32 v20, v21, 4, v20
v_mfma_f32_16x16x32_bf16 v[232:235], v[40:43], a[44:47], v[232:235]
s_lshl_b32 s58, s62, 8
v_mfma_f32_16x16x32_bf16 v[232:235], v[44:47], a[60:63], v[232:235]
s_lshl_b32 s59, s45, 6
v_mfma_f32_16x16x32_bf16 v[232:235], v[120:123], a[76:79], v[232:235]
s_add_u32 s58, s58, s59
s_waitcnt lgkmcnt(6)
v_mfma_f32_16x16x32_bf16 v[140:143], v[48:51], a[0:3], v[140:143]
ds_read_b64_tr_b16 v[32:33], v12 offset:0
ds_read_b64_tr_b16 v[34:35], v12 offset:4096
v_mfma_f32_16x16x32_bf16 v[140:143], v[52:55], a[16:19], v[140:143]
ds_read_b64_tr_b16 v[36:37], v12 offset:8192
ds_read_b64_tr_b16 v[38:39], v12 offset:12288
s_waitcnt lgkmcnt(4)
v_mfma_f32_16x16x32_bf16 v[140:143], v[56:59], a[32:35], v[140:143]
s_lshl_b32 s60, s40, 11
s_add_u32 s60, s60, s58
v_mfma_f32_16x16x32_bf16 v[140:143], v[60:63], a[48:51], v[140:143]
s_lshl_b32 s61, s41, 11
s_add_u32 s61, s61, s58
v_mfma_f32_16x16x32_bf16 v[140:143], v[124:127], a[64:67], v[140:143]
v_add_u32 v21, 32768, v20
v_mfma_f32_16x16x32_bf16 v[172:175], v[48:51], a[4:7], v[172:175]
ds_read_b64_tr_b16 v[40:41], v12 offset:16384
ds_read_b64_tr_b16 v[42:43], v12 offset:20480
v_mfma_f32_16x16x32_bf16 v[172:175], v[52:55], a[20:23], v[172:175]
ds_read_b64_tr_b16 v[44:45], v12 offset:24576
s_xor_b32 s74, s2, 3
v_mfma_f32_16x16x32_bf16 v[172:175], v[56:59], a[36:39], v[172:175]
s_lshl_b32 s74, s74, 2
v_mfma_f32_16x16x32_bf16 v[172:175], v[60:63], a[52:55], v[172:175]
s_add_u32 s74, s74, s3
s_mul_i32 s74, s74, 12288
v_mfma_f32_16x16x32_bf16 v[172:175], v[124:127], a[68:71], v[172:175]
s_add_u32 s76, s74, 67108864
v_mfma_f32_16x16x32_bf16 v[204:207], v[48:51], a[8:11], v[204:207]
ds_read_b64_tr_b16 v[46:47], v12 offset:28672
ds_read_b64_tr_b16 v[120:121], v12 offset:32768
v_mfma_f32_16x16x32_bf16 v[204:207], v[52:55], a[24:27], v[204:207]
ds_read_b64_tr_b16 v[122:123], v12 offset:36864
s_xor_b32 s74, s2, 4
v_mfma_f32_16x16x32_bf16 v[204:207], v[56:59], a[40:43], v[204:207]
s_lshl_b32 s74, s74, 2
v_mfma_f32_16x16x32_bf16 v[204:207], v[60:63], a[56:59], v[204:207]
s_add_u32 s74, s74, s3
s_mul_i32 s74, s74, 12288
v_mfma_f32_16x16x32_bf16 v[204:207], v[124:127], a[72:75], v[204:207]
s_add_u32 s77, s74, 67112960
v_mfma_f32_16x16x32_bf16 v[236:239], v[48:51], a[12:15], v[236:239]
s_xor_b32 s74, s2, 7
v_mfma_f32_16x16x32_bf16 v[236:239], v[52:55], a[28:31], v[236:239]
s_lshl_b32 s74, s74, 2
v_mfma_f32_16x16x32_bf16 v[236:239], v[56:59], a[44:47], v[236:239]
s_add_u32 s74, s74, s3
v_mfma_f32_16x16x32_bf16 v[236:239], v[60:63], a[60:63], v[236:239]
s_mul_i32 s74, s74, 12288
v_mfma_f32_16x16x32_bf16 v[236:239], v[124:127], a[76:79], v[236:239]
s_add_u32 s78, s74, 67117056
s_waitcnt lgkmcnt(6)
v_mfma_f32_16x16x32_bf16 v[144:147], v[32:35], a[0:3], v[144:147]
ds_read_b64_tr_b16 v[48:49], v13 offset:0
v_mfma_f32_16x16x32_bf16 v[144:147], v[36:39], a[16:19], v[144:147]
ds_read_b64_tr_b16 v[50:51], v13 offset:4096
s_waitcnt lgkmcnt(2)
v_mfma_f32_16x16x32_bf16 v[144:147], v[40:43], a[32:35], v[144:147]
ds_read_b64_tr_b16 v[52:53], v13 offset:8192
v_mfma_f32_16x16x32_bf16 v[144:147], v[44:47], a[48:51], v[144:147]
ds_read_b64_tr_b16 v[54:55], v13 offset:12288
v_mfma_f32_16x16x32_bf16 v[144:147], v[120:123], a[64:67], v[144:147]
v_mfma_f32_16x16x32_bf16 v[176:179], v[32:35], a[4:7], v[176:179]
ds_read_b64_tr_b16 v[56:57], v13 offset:16384
ds_read_b64_tr_b16 v[58:59], v13 offset:20480
v_mfma_f32_16x16x32_bf16 v[176:179], v[36:39], a[20:23], v[176:179]
ds_read_b64_tr_b16 v[60:61], v13 offset:24576
v_cvt_pk_bf16_f32 v64, v136, v137
v_mfma_f32_16x16x32_bf16 v[176:179], v[40:43], a[36:39], v[176:179]
v_cvt_pk_bf16_f32 v65, v138, v139
v_mfma_f32_16x16x32_bf16 v[176:179], v[44:47], a[52:55], v[176:179]
v_cvt_pk_bf16_f32 v66, v140, v141
v_cvt_pk_bf16_f32 v67, v142, v143
v_mfma_f32_16x16x32_bf16 v[176:179], v[120:123], a[68:71], v[176:179]
buffer_store_dwordx4 v[64:67], v31, s[28:31], s57 offen offset:0 sc1
v_mfma_f32_16x16x32_bf16 v[208:211], v[32:35], a[8:11], v[208:211]
ds_read_b64_tr_b16 v[62:63], v13 offset:28672
ds_read_b64_tr_b16 v[124:125], v13 offset:32768
v_mfma_f32_16x16x32_bf16 v[208:211], v[36:39], a[24:27], v[208:211]
ds_read_b64_tr_b16 v[126:127], v13 offset:36864
v_cvt_pk_bf16_f32 v68, v168, v169
v_mfma_f32_16x16x32_bf16 v[208:211], v[40:43], a[40:43], v[208:211]
v_cvt_pk_bf16_f32 v69, v170, v171
v_mfma_f32_16x16x32_bf16 v[208:211], v[44:47], a[56:59], v[208:211]
v_cvt_pk_bf16_f32 v70, v172, v173
v_cvt_pk_bf16_f32 v71, v174, v175
v_mfma_f32_16x16x32_bf16 v[208:211], v[120:123], a[72:75], v[208:211]
buffer_store_dwordx4 v[68:71], v31, s[28:31], s57 offen offset:1024 sc1
v_mfma_f32_16x16x32_bf16 v[240:243], v[32:35], a[12:15], v[240:243]
v_mfma_f32_16x16x32_bf16 v[240:243], v[36:39], a[28:31], v[240:243]
v_mfma_f32_16x16x32_bf16 v[240:243], v[40:43], a[44:47], v[240:243]
v_mfma_f32_16x16x32_bf16 v[240:243], v[44:47], a[60:63], v[240:243]
v_mfma_f32_16x16x32_bf16 v[240:243], v[120:123], a[76:79], v[240:243]
s_waitcnt lgkmcnt(6)
v_mfma_f32_16x16x32_bf16 v[148:151], v[48:51], a[0:3], v[148:151]
ds_read_b64_tr_b16 v[32:33], v14 offset:0
ds_read_b64_tr_b16 v[34:35], v14 offset:4096
v_mfma_f32_16x16x32_bf16 v[148:151], v[52:55], a[16:19], v[148:151]
ds_read_b64_tr_b16 v[36:37], v14 offset:8192
ds_read_b64_tr_b16 v[38:39], v14 offset:12288
s_waitcnt lgkmcnt(4)
v_mfma_f32_16x16x32_bf16 v[148:151], v[56:59], a[32:35], v[148:151]
v_cvt_pk_bf16_f32 v72, v200, v201
v_cvt_pk_bf16_f32 v73, v202, v203
v_mfma_f32_16x16x32_bf16 v[148:151], v[60:63], a[48:51], v[148:151]
v_cvt_pk_bf16_f32 v74, v204, v205
v_cvt_pk_bf16_f32 v75, v206, v207
v_mfma_f32_16x16x32_bf16 v[148:151], v[124:127], a[64:67], v[148:151]
buffer_store_dwordx4 v[72:75], v31, s[28:31], s57 offen offset:2048 sc1
v_mfma_f32_16x16x32_bf16 v[180:183], v[48:51], a[4:7], v[180:183]
ds_read_b64_tr_b16 v[40:41], v14 offset:16384
v_mfma_f32_16x16x32_bf16 v[180:183], v[52:55], a[20:23], v[180:183]
ds_read_b64_tr_b16 v[42:43], v14 offset:20480
v_mfma_f32_16x16x32_bf16 v[180:183], v[56:59], a[36:39], v[180:183]
v_mfma_f32_16x16x32_bf16 v[180:183], v[60:63], a[52:55], v[180:183]
ds_read_b64_tr_b16 v[44:45], v14 offset:24576
v_mfma_f32_16x16x32_bf16 v[180:183], v[124:127], a[68:71], v[180:183]
v_mfma_f32_16x16x32_bf16 v[212:215], v[48:51], a[8:11], v[212:215]
ds_read_b64_tr_b16 v[46:47], v14 offset:28672
ds_read_b64_tr_b16 v[120:121], v14 offset:32768
v_mfma_f32_16x16x32_bf16 v[212:215], v[52:55], a[24:27], v[212:215]
ds_read_b64_tr_b16 v[122:123], v14 offset:36864
v_cvt_pk_bf16_f32 v76, v232, v233
v_mfma_f32_16x16x32_bf16 v[212:215], v[56:59], a[40:43], v[212:215]
v_cvt_pk_bf16_f32 v77, v234, v235
v_cvt_pk_bf16_f32 v78, v236, v237
v_mfma_f32_16x16x32_bf16 v[212:215], v[60:63], a[56:59], v[212:215]
v_cvt_pk_bf16_f32 v79, v238, v239
buffer_store_dwordx4 v[76:79], v31, s[28:31], s57 offen offset:3072 sc1
v_mfma_f32_16x16x32_bf16 v[212:215], v[124:127], a[72:75], v[212:215]
s_add_u32 s57, s57, 4096
v_mfma_f32_16x16x32_bf16 v[244:247], v[48:51], a[12:15], v[244:247]
v_mfma_f32_16x16x32_bf16 v[244:247], v[52:55], a[28:31], v[244:247]
v_mfma_f32_16x16x32_bf16 v[244:247], v[56:59], a[44:47], v[244:247]
v_mfma_f32_16x16x32_bf16 v[244:247], v[60:63], a[60:63], v[244:247]
v_mfma_f32_16x16x32_bf16 v[244:247], v[124:127], a[76:79], v[244:247]
s_waitcnt lgkmcnt(6)
v_mfma_f32_16x16x32_bf16 v[152:155], v[32:35], a[0:3], v[152:155]
ds_read_b64_tr_b16 v[48:49], v15 offset:0
v_mfma_f32_16x16x32_bf16 v[152:155], v[36:39], a[16:19], v[152:155]
ds_read_b64_tr_b16 v[50:51], v15 offset:4096
s_waitcnt lgkmcnt(2)
v_mfma_f32_16x16x32_bf16 v[152:155], v[40:43], a[32:35], v[152:155]
ds_read_b64_tr_b16 v[52:53], v15 offset:8192
v_mfma_f32_16x16x32_bf16 v[152:155], v[44:47], a[48:51], v[152:155]
ds_read_b64_tr_b16 v[54:55], v15 offset:12288
v_mfma_f32_16x16x32_bf16 v[152:155], v[120:123], a[64:67], v[152:155]
v_mfma_f32_16x16x32_bf16 v[184:187], v[32:35], a[4:7], v[184:187]
ds_read_b64_tr_b16 v[56:57], v15 offset:16384
ds_read_b64_tr_b16 v[58:59], v15 offset:20480
v_mfma_f32_16x16x32_bf16 v[184:187], v[36:39], a[20:23], v[184:187]
ds_read_b64_tr_b16 v[60:61], v15 offset:24576
v_cvt_pk_bf16_f32 v80, v144, v145
v_mfma_f32_16x16x32_bf16 v[184:187], v[40:43], a[36:39], v[184:187]
v_cvt_pk_bf16_f32 v81, v146, v147
v_mfma_f32_16x16x32_bf16 v[184:187], v[44:47], a[52:55], v[184:187]
v_cvt_pk_bf16_f32 v82, v148, v149
v_cvt_pk_bf16_f32 v83, v150, v151
v_mfma_f32_16x16x32_bf16 v[184:187], v[120:123], a[68:71], v[184:187]
buffer_store_dwordx4 v[80:83], v31, s[28:31], s57 offen offset:0 sc1
v_mfma_f32_16x16x32_bf16 v[216:219], v[32:35], a[8:11], v[216:219]
ds_read_b64_tr_b16 v[62:63], v15 offset:28672
ds_read_b64_tr_b16 v[124:125], v15 offset:32768
v_mfma_f32_16x16x32_bf16 v[216:219], v[36:39], a[24:27], v[216:219]
ds_read_b64_tr_b16 v[126:127], v15 offset:36864
v_cvt_pk_bf16_f32 v84, v176, v177
v_mfma_f32_16x16x32_bf16 v[216:219], v[40:43], a[40:43], v[216:219]
v_cvt_pk_bf16_f32 v85, v178, v179
v_mfma_f32_16x16x32_bf16 v[216:219], v[44:47], a[56:59], v[216:219]
v_cvt_pk_bf16_f32 v86, v180, v181
v_cvt_pk_bf16_f32 v87, v182, v183
v_mfma_f32_16x16x32_bf16 v[216:219], v[120:123], a[72:75], v[216:219]
buffer_store_dwordx4 v[84:87], v31, s[28:31], s57 offen offset:1024 sc1
v_mfma_f32_16x16x32_bf16 v[248:251], v[32:35], a[12:15], v[248:251]
v_mfma_f32_16x16x32_bf16 v[248:251], v[36:39], a[28:31], v[248:251]
v_mfma_f32_16x16x32_bf16 v[248:251], v[40:43], a[44:47], v[248:251]
v_mfma_f32_16x16x32_bf16 v[248:251], v[44:47], a[60:63], v[248:251]
v_mfma_f32_16x16x32_bf16 v[248:251], v[120:123], a[76:79], v[248:251]
s_waitcnt lgkmcnt(6)
v_mfma_f32_16x16x32_bf16 v[156:159], v[48:51], a[0:3], v[156:159]
ds_read_b64_tr_b16 v[32:33], v8 offset:0
ds_read_b64_tr_b16 v[34:35], v8 offset:4096
v_mfma_f32_16x16x32_bf16 v[156:159], v[52:55], a[16:19], v[156:159]
ds_read_b64_tr_b16 v[36:37], v8 offset:8192
ds_read_b64_tr_b16 v[38:39], v8 offset:12288
s_waitcnt lgkmcnt(4)
v_mfma_f32_16x16x32_bf16 v[156:159], v[56:59], a[32:35], v[156:159]
v_cvt_pk_bf16_f32 v88, v208, v209
v_cvt_pk_bf16_f32 v89, v210, v211
v_mfma_f32_16x16x32_bf16 v[156:159], v[60:63], a[48:51], v[156:159]
v_cvt_pk_bf16_f32 v90, v212, v213
v_cvt_pk_bf16_f32 v91, v214, v215
v_mfma_f32_16x16x32_bf16 v[156:159], v[124:127], a[64:67], v[156:159]
buffer_store_dwordx4 v[88:91], v31, s[28:31], s57 offen offset:2048 sc1
s_waitcnt vmcnt(3)
s_xor_b32 s74, s2, 3
s_lshl_b32 s74, s74, 7
s_add_u32 s74, s74, 63963136
buffer_store_dword v24, v26, s[28:31], s74 offen sc1
v_mfma_f32_16x16x32_bf16 v[188:191], v[48:51], a[4:7], v[188:191]
ds_read_b64_tr_b16 v[40:41], v8 offset:16384
v_mfma_f32_16x16x32_bf16 v[188:191], v[52:55], a[20:23], v[188:191]
ds_read_b64_tr_b16 v[42:43], v8 offset:20480
v_mfma_f32_16x16x32_bf16 v[188:191], v[56:59], a[36:39], v[188:191]
v_mfma_f32_16x16x32_bf16 v[188:191], v[60:63], a[52:55], v[188:191]
ds_read_b64_tr_b16 v[44:45], v8 offset:24576
v_mfma_f32_16x16x32_bf16 v[188:191], v[124:127], a[68:71], v[188:191]
v_mfma_f32_16x16x32_bf16 v[220:223], v[48:51], a[8:11], v[220:223]
ds_read_b64_tr_b16 v[46:47], v8 offset:28672
ds_read_b64_tr_b16 v[120:121], v8 offset:32768
v_mfma_f32_16x16x32_bf16 v[220:223], v[52:55], a[24:27], v[220:223]
ds_read_b64_tr_b16 v[122:123], v8 offset:36864
v_cvt_pk_bf16_f32 v92, v240, v241
v_mfma_f32_16x16x32_bf16 v[220:223], v[56:59], a[40:43], v[220:223]
v_cvt_pk_bf16_f32 v93, v242, v243
v_cvt_pk_bf16_f32 v94, v244, v245
v_mfma_f32_16x16x32_bf16 v[220:223], v[60:63], a[56:59], v[220:223]
v_cvt_pk_bf16_f32 v95, v246, v247
buffer_store_dwordx4 v[92:95], v31, s[28:31], s57 offen offset:3072 sc1
v_mfma_f32_16x16x32_bf16 v[220:223], v[124:127], a[72:75], v[220:223]
s_add_u32 s57, s57, 4096
v_mfma_f32_16x16x32_bf16 v[252:255], v[48:51], a[12:15], v[252:255]
v_mfma_f32_16x16x32_bf16 v[252:255], v[52:55], a[28:31], v[252:255]
v_mfma_f32_16x16x32_bf16 v[252:255], v[56:59], a[44:47], v[252:255]
v_mfma_f32_16x16x32_bf16 v[252:255], v[60:63], a[60:63], v[252:255]
v_mfma_f32_16x16x32_bf16 v[252:255], v[124:127], a[76:79], v[252:255]
s_waitcnt lgkmcnt(6)
v_mfma_f32_16x16x32_bf16 v[128:131], v[32:35], a[0:3], v[128:131]
ds_read_b64_tr_b16 v[48:49], v9 offset:0
v_mfma_f32_16x16x32_bf16 v[128:131], v[36:39], a[16:19], v[128:131]
ds_read_b64_tr_b16 v[50:51], v9 offset:4096
s_waitcnt lgkmcnt(2)
v_mfma_f32_16x16x32_bf16 v[128:131], v[40:43], a[32:35], v[128:131]
ds_read_b64_tr_b16 v[52:53], v9 offset:8192
v_mfma_f32_16x16x32_bf16 v[128:131], v[44:47], a[48:51], v[128:131]
ds_read_b64_tr_b16 v[54:55], v9 offset:12288
v_mfma_f32_16x16x32_bf16 v[128:131], v[120:123], a[64:67], v[128:131]
v_mfma_f32_16x16x32_bf16 v[160:163], v[32:35], a[4:7], v[160:163]
ds_read_b64_tr_b16 v[56:57], v9 offset:16384
ds_read_b64_tr_b16 v[58:59], v9 offset:20480
v_mfma_f32_16x16x32_bf16 v[160:163], v[36:39], a[20:23], v[160:163]
ds_read_b64_tr_b16 v[60:61], v9 offset:24576
v_cvt_pk_bf16_f32 v96, v152, v153
v_mfma_f32_16x16x32_bf16 v[160:163], v[40:43], a[36:39], v[160:163]
v_cvt_pk_bf16_f32 v97, v154, v155
v_mfma_f32_16x16x32_bf16 v[160:163], v[44:47], a[52:55], v[160:163]
v_cvt_pk_bf16_f32 v98, v156, v157
v_cvt_pk_bf16_f32 v99, v158, v159
v_mfma_f32_16x16x32_bf16 v[160:163], v[120:123], a[68:71], v[160:163]
buffer_store_dwordx4 v[96:99], v31, s[28:31], s57 offen offset:0 sc1
v_mfma_f32_16x16x32_bf16 v[192:195], v[32:35], a[8:11], v[192:195]
ds_read_b64_tr_b16 v[62:63], v9 offset:28672
ds_read_b64_tr_b16 v[124:125], v9 offset:32768
v_mfma_f32_16x16x32_bf16 v[192:195], v[36:39], a[24:27], v[192:195]
ds_read_b64_tr_b16 v[126:127], v9 offset:36864
v_cvt_pk_bf16_f32 v100, v184, v185
v_mfma_f32_16x16x32_bf16 v[192:195], v[40:43], a[40:43], v[192:195]
v_cvt_pk_bf16_f32 v101, v186, v187
v_mfma_f32_16x16x32_bf16 v[192:195], v[44:47], a[56:59], v[192:195]
v_cvt_pk_bf16_f32 v102, v188, v189
v_cvt_pk_bf16_f32 v103, v190, v191
v_mfma_f32_16x16x32_bf16 v[192:195], v[120:123], a[72:75], v[192:195]
buffer_store_dwordx4 v[100:103], v31, s[28:31], s57 offen offset:1024 sc1
v_mfma_f32_16x16x32_bf16 v[224:227], v[32:35], a[12:15], v[224:227]
v_mfma_f32_16x16x32_bf16 v[224:227], v[36:39], a[28:31], v[224:227]
v_mfma_f32_16x16x32_bf16 v[224:227], v[40:43], a[44:47], v[224:227]
v_mfma_f32_16x16x32_bf16 v[224:227], v[44:47], a[60:63], v[224:227]
v_mfma_f32_16x16x32_bf16 v[224:227], v[120:123], a[76:79], v[224:227]
s_waitcnt lgkmcnt(6)
v_mfma_f32_16x16x32_bf16 v[132:135], v[48:51], a[0:3], v[132:135]
v_cvt_pk_bf16_f32 v104, v216, v217
v_mfma_f32_16x16x32_bf16 v[132:135], v[52:55], a[16:19], v[132:135]
v_cvt_pk_bf16_f32 v105, v218, v219
s_waitcnt lgkmcnt(0)
v_mfma_f32_16x16x32_bf16 v[132:135], v[56:59], a[32:35], v[132:135]
v_cvt_pk_bf16_f32 v106, v220, v221
v_mfma_f32_16x16x32_bf16 v[132:135], v[60:63], a[48:51], v[132:135]
v_cvt_pk_bf16_f32 v107, v222, v223
v_mfma_f32_16x16x32_bf16 v[132:135], v[124:127], a[64:67], v[132:135]
buffer_store_dwordx4 v[104:107], v31, s[28:31], s57 offen offset:2048 sc1
s_waitcnt vmcnt(3)
s_xor_b32 s74, s2, 4
s_lshl_b32 s74, s74, 7
s_add_u32 s74, s74, 63963152
buffer_store_dword v24, v26, s[28:31], s74 offen sc1
buffer_load_dword v19, v18, s[28:31], s56 offen sc1
v_mfma_f32_16x16x32_bf16 v[164:167], v[48:51], a[4:7], v[164:167]
v_mfma_f32_16x16x32_bf16 v[164:167], v[52:55], a[20:23], v[164:167]
v_mfma_f32_16x16x32_bf16 v[164:167], v[56:59], a[36:39], v[164:167]
v_mfma_f32_16x16x32_bf16 v[164:167], v[60:63], a[52:55], v[164:167]
v_mfma_f32_16x16x32_bf16 v[164:167], v[124:127], a[68:71], v[164:167]
v_mfma_f32_16x16x32_bf16 v[196:199], v[48:51], a[8:11], v[196:199]
v_cvt_pk_bf16_f32 v108, v248, v249
v_cvt_pk_bf16_f32 v109, v250, v251
v_mfma_f32_16x16x32_bf16 v[196:199], v[52:55], a[24:27], v[196:199]
v_cvt_pk_bf16_f32 v110, v252, v253
v_mfma_f32_16x16x32_bf16 v[196:199], v[56:59], a[40:43], v[196:199]
v_cvt_pk_bf16_f32 v111, v254, v255
v_mfma_f32_16x16x32_bf16 v[196:199], v[60:63], a[56:59], v[196:199]
buffer_store_dwordx4 v[108:111], v31, s[28:31], s57 offen offset:3072 sc1
v_mfma_f32_16x16x32_bf16 v[196:199], v[124:127], a[72:75], v[196:199]
s_add_u32 s57, s57, 4096
v_mfma_f32_16x16x32_bf16 v[228:231], v[48:51], a[12:15], v[228:231]
v_mfma_f32_16x16x32_bf16 v[228:231], v[52:55], a[28:31], v[228:231]
v_mfma_f32_16x16x32_bf16 v[228:231], v[56:59], a[44:47], v[228:231]
v_mfma_f32_16x16x32_bf16 v[228:231], v[60:63], a[60:63], v[228:231]
v_mfma_f32_16x16x32_bf16 v[228:231], v[124:127], a[76:79], v[228:231]
L_tail:
s_waitcnt vmcnt(0)
s_xor_b32 s74, s2, 7
s_lshl_b32 s74, s74, 7
s_add_u32 s74, s74, 63963168
buffer_store_dword v24, v26, s[28:31], s74 offen sc1
L_pq1:
v_readlane_b32 s74, v19, 0
s_cmp_eq_u32 s74, 1
s_cbranch_scc1 L_pq1x
s_sleep 2
buffer_load_dword v19, v18, s[28:31], s56 offen sc1
s_waitcnt vmcnt(0)
s_branch L_pq1
L_pq1x:
buffer_load_dwordx4 v[64:67], v31, s[28:31], s76 offen offset:0 sc1
buffer_load_dwordx4 v[68:71], v31, s[28:31], s76 offen offset:1024 sc1
buffer_load_dwordx4 v[72:75], v31, s[28:31], s76 offen offset:2048 sc1
buffer_load_dwordx4 v[76:79], v31, s[28:31], s76 offen offset:3072 sc1
L_pq2:
v_readlane_b32 s74, v19, 1
s_cmp_eq_u32 s74, 1
s_cbranch_scc1 L_pq2x
s_sleep 2
buffer_load_dword v19, v18, s[28:31], s56 offen sc1
s_waitcnt vmcnt(0)
s_branch L_pq2
L_pq2x:
buffer_load_dwordx4 v[80:83], v31, s[28:31], s77 offen offset:0 sc1
buffer_load_dwordx4 v[84:87], v31, s[28:31], s77 offen offset:1024 sc1
buffer_load_dwordx4 v[88:91], v31, s[28:31], s77 offen offset:2048 sc1
buffer_load_dwordx4 v[92:95], v31, s[28:31], s77 offen offset:3072 sc1
L_pq3:
v_readlane_b32 s74, v19, 2
s_cmp_eq_u32 s74, 1
s_cbranch_scc1 L_pq3x
s_sleep 2
buffer_load_dword v19, v18, s[28:31], s56 offen sc1
s_waitcnt vmcnt(0)
s_branch L_pq3
L_pq3x:
buffer_load_dwordx4 v[96:99], v31, s[28:31], s78 offen offset:0 sc1
buffer_load_dwordx4 v[100:103], v31, s[28:31], s78 offen offset:1024 sc1
buffer_load_dwordx4 v[104:107], v31, s[28:31], s78 offen offset:2048 sc1
buffer_load_dwordx4 v[108:111], v31, s[28:31], s78 offen offset:3072 sc1
s_waitcnt vmcnt(11)
v_dot2c_f32_bf16 v128, v64, v16
v_dot2c_f32_bf16 v129, v64, v17
v_dot2c_f32_bf16 v130, v65, v16
v_dot2c_f32_bf16 v131, v65, v17
v_dot2c_f32_bf16 v132, v66, v16
v_dot2c_f32_bf16 v133, v66, v17
v_dot2c_f32_bf16 v134, v67, v16
v_dot2c_f32_bf16 v135, v67, v17
s_waitcnt vmcnt(10)
v_dot2c_f32_bf16 v160, v68, v16
v_dot2c_f32_bf16 v161, v68, v17
v_dot2c_f32_bf16 v162, v69, v16
v_dot2c_f32_bf16 v163, v69, v17
v_dot2c_f32_bf16 v164, v70, v16
v_dot2c_f32_bf16 v165, v70, v17
v_dot2c_f32_bf16 v166, v71, v16
v_dot2c_f32_bf16 v167, v71, v17
s_waitcnt vmcnt(9)
v_dot2c_f32_bf16 v192, v72, v16
v_dot2c_f32_bf16 v193, v72, v17
v_dot2c_f32_bf16 v194, v73, v16
v_dot2c_f32_bf16 v195, v73, v17
v_dot2c_f32_bf16 v196, v74, v16
v_dot2c_f32_bf16 v197, v74, v17
v_dot2c_f32_bf16 v198, v75, v16
v_dot2c_f32_bf16 v199, v75, v17
s_waitcnt vmcnt(8)
v_dot2c_f32_bf16 v224, v76, v16
v_dot2c_f32_bf16 v225, v76, v17
v_dot2c_f32_bf16 v226, v77, v16
v_dot2c_f32_bf16 v227, v77, v17
v_dot2c_f32_bf16 v228, v78, v16
v_dot2c_f32_bf16 v229, v78, v17
v_dot2c_f32_bf16 v230, v79, v16
v_dot2c_f32_bf16 v231, v79, v17
s_waitcnt vmcnt(7)
v_dot2c_f32_bf16 v128, v80, v16
v_dot2c_f32_bf16 v129, v80, v17
v_dot2c_f32_bf16 v130, v81, v16
v_dot2c_f32_bf16 v131, v81, v17
v_dot2c_f32_bf16 v132, v82, v16
v_dot2c_f32_bf16 v133, v82, v17
v_dot2c_f32_bf16 v134, v83, v16
v_dot2c_f32_bf16 v135, v83, v17
s_waitcnt vmcnt(6)
v_dot2c_f32_bf16 v160, v84, v16
v_dot2c_f32_bf16 v161, v84, v17
v_dot2c_f32_bf16 v162, v85, v16
v_dot2c_f32_bf16 v163, v85, v17
v_dot2c_f32_bf16 v164, v86, v16
v_dot2c_f32_bf16 v165, v86, v17
v_dot2c_f32_bf16 v166, v87, v16
v_dot2c_f32_bf16 v167, v87, v17
s_waitcnt vmcnt(5)
v_dot2c_f32_bf16 v192, v88, v16
v_dot2c_f32_bf16 v193, v88, v17
v_dot2c_f32_bf16 v194, v89, v16
v_dot2c_f32_bf16 v195, v89, v17
v_dot2c_f32_bf16 v196, v90, v16
v_dot2c_f32_bf16 v197, v90, v17
v_dot2c_f32_bf16 v198, v91, v16
v_dot2c_f32_bf16 v199, v91, v17
s_waitcnt vmcnt(4)
v_dot2c_f32_bf16 v224, v92, v16
v_dot2c_f32_bf16 v225, v92, v17
v_dot2c_f32_bf16 v226, v93, v16
v_dot2c_f32_bf16 v227, v93, v17
v_dot2c_f32_bf16 v228, v94, v16
v_dot2c_f32_bf16 v229, v94, v17
v_dot2c_f32_bf16 v230, v95, v16
v_dot2c_f32_bf16 v231, v95, v17
s_waitcnt vmcnt(3)
v_dot2c_f32_bf16 v128, v96, v16
v_dot2c_f32_bf16 v129, v96, v17
v_dot2c_f32_bf16 v130, v97, v16
v_dot2c_f32_bf16 v131, v97, v17
v_dot2c_f32_bf16 v132, v98, v16
v_dot2c_f32_bf16 v133, v98, v17
v_dot2c_f32_bf16 v134, v99, v16
v_dot2c_f32_bf16 v135, v99, v17
v_cvt_pk_bf16_f32 v32, v128, v129
v_cvt_pk_bf16_f32 v33, v130, v131
v_cvt_pk_bf16_f32 v34, v132, v133
v_cvt_pk_bf16_f32 v35, v134, v135
s_nop 0
v_permlane16_swap_b32 v32, v34
v_permlane16_swap_b32 v33, v35
buffer_store_dwordx4 v[32:35], v20, s[16:19], s60 offen
s_waitcnt vmcnt(3)
v_dot2c_f32_bf16 v160, v100, v16
v_dot2c_f32_bf16 v161, v100, v17
v_dot2c_f32_bf16 v162, v101, v16
v_dot2c_f32_bf16 v163, v101, v17
v_dot2c_f32_bf16 v164, v102, v16
v_dot2c_f32_bf16 v165, v102, v17
v_dot2c_f32_bf16 v166, v103, v16
v_dot2c_f32_bf16 v167, v103, v17
v_cvt_pk_bf16_f32 v36, v160, v161
v_cvt_pk_bf16_f32 v37, v162, v163
v_cvt_pk_bf16_f32 v38, v164, v165
v_cvt_pk_bf16_f32 v39, v166, v167
s_nop 0
v_permlane16_swap_b32 v36, v38
v_permlane16_swap_b32 v37, v39
buffer_store_dwordx4 v[36:39], v21, s[16:19], s60 offen
s_waitcnt vmcnt(3)
v_dot2c_f32_bf16 v192, v104, v16
v_dot2c_f32_bf16 v193, v104, v17
v_dot2c_f32_bf16 v194, v105, v16
v_dot2c_f32_bf16 v195, v105, v17
v_dot2c_f32_bf16 v196, v106, v16
v_dot2c_f32_bf16 v197, v106, v17
v_dot2c_f32_bf16 v198, v107, v16
v_dot2c_f32_bf16 v199, v107, v17
v_cvt_pk_bf16_f32 v40, v192, v193
v_cvt_pk_bf16_f32 v41, v194, v195
v_cvt_pk_bf16_f32 v42, v196, v197
v_cvt_pk_bf16_f32 v43, v198, v199
s_nop 0
v_permlane16_swap_b32 v40, v42
v_permlane16_swap_b32 v41, v43
buffer_store_dwordx4 v[40:43], v20, s[16:19], s61 offen
s_waitcnt vmcnt(3)
v_dot2c_f32_bf16 v224, v108, v16
v_dot2c_f32_bf16 v225, v108, v17
v_dot2c_f32_bf16 v226, v109, v16
v_dot2c_f32_bf16 v227, v109, v17
v_dot2c_f32_bf16 v228, v110, v16
v_dot2c_f32_bf16 v229, v110, v17
v_dot2c_f32_bf16 v230, v111, v16
v_dot2c_f32_bf16 v231, v111, v17
v_cvt_pk_bf16_f32 v44, v224, v225
v_cvt_pk_bf16_f32 v45, v226, v227
v_cvt_pk_bf16_f32 v46, v228, v229
v_cvt_pk_bf16_f32 v47, v230, v231
s_nop 0
v_permlane16_swap_b32 v44, v46
v_permlane16_swap_b32 v45, v47
buffer_store_dwordx4 v[44:47], v21, s[16:19], s61 offen
s_endpgm
L_slow:
s_mov_b32 s38, 1
s_mul_i32 s32, s4, 0x110000
s_lshl_b32 s33, s3, 13
s_add_u32 s32, s32, s33
s_lshl_b32 s44, s5, 1
s_sub_u32 s44, 32, s44
s_mov_b32 s34, 0
v_mov_b32 v8, v31
s_mov_b32 s45, s33
L_mx:
s_waitcnt vmcnt(0) lgkmcnt(0)
s_barrier
s_mov_b32 s33, s45
s_mov_b32 m0, s33
s_nop 0
buffer_load_dwordx4 v31, s[28:31], s32 offen offset:0 sc1 lds
buffer_load_dwordx4 v31, s[28:31], s32 offen offset:1024 sc1 lds
buffer_load_dwordx4 v31, s[28:31], s32 offen offset:2048 sc1 lds
buffer_load_dwordx4 v31, s[28:31], s32 offen offset:3072 sc1 lds
s_add_u32 m0, s33, 4096
s_nop 0
s_add_u32 s32, s32, 4096
buffer_load_dwordx4 v31, s[28:31], s32 offen offset:0 sc1 lds
buffer_load_dwordx4 v31, s[28:31], s32 offen offset:1024 sc1 lds
buffer_load_dwordx4 v31, s[28:31], s32 offen offset:2048 sc1 lds
buffer_load_dwordx4 v31, s[28:31], s32 offen offset:3072 sc1 lds
s_add_u32 s32, s32, 28672
s_add_u32 s33, s33, 0x8000
s_and_b32 s33, s33, 0x1ffff
s_waitcnt vmcnt(0)
s_barrier
s_lshl_b32 s74, s34, 5
s_sub_u32 s74, s40, s74
v_sub_u32_e64 v11, s74, v10
v_cmp_le_i32_e64 s[48:49], -16, v11
v_cmp_le_i32_e64 s[50:51], -15, v11
v_cmp_le_i32_e64 s[52:53], -14, v11
v_cmp_le_i32_e64 s[54:55], -13, v11
v_cmp_le_i32_e64 s[56:57], 0, v11
v_cmp_le_i32_e64 s[58:59], 1, v11
v_cmp_le_i32_e64 s[60:61], 2, v11
v_cmp_le_i32_e64 s[62:63], 3, v11
v_cmp_le_i32_e64 s[64:65], 16, v11
v_cmp_le_i32_e64 s[66:67], 17, v11
v_cmp_le_i32_e64 s[90:91], 18, v11
v_cmp_le_i32_e64 s[92:93], 19, v11
v_cndmask_b32_e64 v240, v16, 0, s[56:57]
v_cndmask_b32_e64 v241, v16, 0, s[58:59]
v_cndmask_b32_e64 v242, v16, 0, s[60:61]
v_cndmask_b32_e64 v243, v16, 0, s[62:63]
v_cndmask_b32_e64 v244, v16, 0, s[48:49]
v_cndmask_b32_e64 v245, v16, 0, s[50:51]
v_cndmask_b32_e64 v246, v16, 0, s[52:53]
v_cndmask_b32_e64 v247, v16, 0, s[54:55]
v_cndmask_b32_e64 v248, v16, 0, s[64:65]
v_cndmask_b32_e64 v249, v16, 0, s[66:67]
v_cndmask_b32_e64 v250, v16, 0, s[90:91]
v_cndmask_b32_e64 v251, v16, 0, s[92:93]
v_cndmask_b32_e64 v252, v16, 0, s[56:57]
v_cndmask_b32_e64 v253, v16, 0, s[58:59]
v_cndmask_b32_e64 v254, v16, 0, s[60:61]
v_cndmask_b32_e64 v255, v16, 0, s[62:63]
ds_read_b128 a[0:3], v8 offset:0
ds_read_b128 a[4:7], v8 offset:1024
ds_read_b128 a[8:11], v8 offset:2048
ds_read_b128 a[12:15], v8 offset:3072
ds_read_b128 a[16:19], v8 offset:4096
ds_read_b128 a[20:23], v8 offset:5120
ds_read_b128 a[24:27], v8 offset:6144
ds_read_b128 a[28:31], v8 offset:7168
s_waitcnt lgkmcnt(7)
v_mfma_f32_16x16x32_bf16 v[128:131], a[0:3], v[64:67], v[240:243]
v_mfma_f32_16x16x32_bf16 v[136:139], a[0:3], v[68:71], v[244:247]
s_waitcnt lgkmcnt(6)
v_mfma_f32_16x16x32_bf16 v[128:131], a[4:7], v[80:83], v[128:131]
v_mfma_f32_16x16x32_bf16 v[136:139], a[4:7], v[84:87], v[136:139]
s_waitcnt lgkmcnt(5)
v_mfma_f32_16x16x32_bf16 v[128:131], a[8:11], v[96:99], v[128:131]
v_mfma_f32_16x16x32_bf16 v[136:139], a[8:11], v[100:103], v[136:139]
s_waitcnt lgkmcnt(4)
v_mfma_f32_16x16x32_bf16 v[128:131], a[12:15], v[112:115], v[128:131]
v_mfma_f32_16x16x32_bf16 v[136:139], a[12:15], v[116:119], v[136:139]
s_waitcnt lgkmcnt(3)
v_mfma_f32_16x16x32_bf16 v[132:135], a[16:19], v[64:67], v[248:251]
v_mfma_f32_16x16x32_bf16 v[140:143], a[16:19], v[68:71], v[252:255]
s_waitcnt lgkmcnt(2)
v_mfma_f32_16x16x32_bf16 v[132:135], a[20:23], v[80:83], v[132:135]
v_mfma_f32_16x16x32_bf16 v[140:143], a[20:23], v[84:87], v[140:143]
s_waitcnt lgkmcnt(1)
v_mfma_f32_16x16x32_bf16 v[132:135], a[24:27], v[96:99], v[132:135]
v_mfma_f32_16x16x32_bf16 v[140:143], a[24:27], v[100:103], v[140:143]
s_waitcnt lgkmcnt(0)
v_mfma_f32_16x16x32_bf16 v[132:135], a[28:31], v[112:115], v[132:135]
v_mfma_f32_16x16x32_bf16 v[140:143], a[28:31], v[116:119], v[140:143]
s_nop 7
s_nop 0
v_max3_f32 v12, v12, v128, v129
v_max3_f32 v12, v12, v130, v131
v_max3_f32 v12, v12, v132, v133
v_max3_f32 v12, v12, v134, v135
v_max3_f32 v13, v13, v136, v137
v_max3_f32 v13, v13, v138, v139
v_max3_f32 v13, v13, v140, v141
v_max3_f32 v13, v13, v142, v143
s_lshl_b32 s74, s34, 5
s_sub_u32 s74, s41, s74
v_sub_u32_e64 v11, s74, v10
v_cmp_le_i32_e64 s[48:49], -16, v11
v_cmp_le_i32_e64 s[50:51], -15, v11
v_cmp_le_i32_e64 s[52:53], -14, v11
v_cmp_le_i32_e64 s[54:55], -13, v11
v_cmp_le_i32_e64 s[56:57], 0, v11
v_cmp_le_i32_e64 s[58:59], 1, v11
v_cmp_le_i32_e64 s[60:61], 2, v11
v_cmp_le_i32_e64 s[62:63], 3, v11
v_cmp_le_i32_e64 s[64:65], 16, v11
v_cmp_le_i32_e64 s[66:67], 17, v11
v_cmp_le_i32_e64 s[90:91], 18, v11
v_cmp_le_i32_e64 s[92:93], 19, v11
v_cndmask_b32_e64 v240, v16, 0, s[56:57]
v_cndmask_b32_e64 v241, v16, 0, s[58:59]
v_cndmask_b32_e64 v242, v16, 0, s[60:61]
v_cndmask_b32_e64 v243, v16, 0, s[62:63]
v_cndmask_b32_e64 v244, v16, 0, s[48:49]
v_cndmask_b32_e64 v245, v16, 0, s[50:51]
v_cndmask_b32_e64 v246, v16, 0, s[52:53]
v_cndmask_b32_e64 v247, v16, 0, s[54:55]
v_cndmask_b32_e64 v248, v16, 0, s[64:65]
v_cndmask_b32_e64 v249, v16, 0, s[66:67]
v_cndmask_b32_e64 v250, v16, 0, s[90:91]
v_cndmask_b32_e64 v251, v16, 0, s[92:93]
v_cndmask_b32_e64 v252, v16, 0, s[56:57]
v_cndmask_b32_e64 v253, v16, 0, s[58:59]
v_cndmask_b32_e64 v254, v16, 0, s[60:61]
v_cndmask_b32_e64 v255, v16, 0, s[62:63]
ds_read_b128 a[0:3], v8 offset:0
ds_read_b128 a[4:7], v8 offset:1024
ds_read_b128 a[8:11], v8 offset:2048
ds_read_b128 a[12:15], v8 offset:3072
ds_read_b128 a[16:19], v8 offset:4096
ds_read_b128 a[20:23], v8 offset:5120
ds_read_b128 a[24:27], v8 offset:6144
ds_read_b128 a[28:31], v8 offset:7168
s_waitcnt lgkmcnt(7)
v_mfma_f32_16x16x32_bf16 v[128:131], a[0:3], v[72:75], v[240:243]
v_mfma_f32_16x16x32_bf16 v[136:139], a[0:3], v[76:79], v[244:247]
s_waitcnt lgkmcnt(6)
v_mfma_f32_16x16x32_bf16 v[128:131], a[4:7], v[88:91], v[128:131]
v_mfma_f32_16x16x32_bf16 v[136:139], a[4:7], v[92:95], v[136:139]
s_waitcnt lgkmcnt(5)
v_mfma_f32_16x16x32_bf16 v[128:131], a[8:11], v[104:107], v[128:131]
v_mfma_f32_16x16x32_bf16 v[136:139], a[8:11], v[108:111], v[136:139]
s_waitcnt lgkmcnt(4)
v_mfma_f32_16x16x32_bf16 v[128:131], a[12:15], v[120:123], v[128:131]
v_mfma_f32_16x16x32_bf16 v[136:139], a[12:15], v[124:127], v[136:139]
s_waitcnt lgkmcnt(3)
v_mfma_f32_16x16x32_bf16 v[132:135], a[16:19], v[72:75], v[248:251]
v_mfma_f32_16x16x32_bf16 v[140:143], a[16:19], v[76:79], v[252:255]
s_waitcnt lgkmcnt(2)
v_mfma_f32_16x16x32_bf16 v[132:135], a[20:23], v[88:91], v[132:135]
v_mfma_f32_16x16x32_bf16 v[140:143], a[20:23], v[92:95], v[140:143]
s_waitcnt lgkmcnt(1)
v_mfma_f32_16x16x32_bf16 v[132:135], a[24:27], v[104:107], v[132:135]
v_mfma_f32_16x16x32_bf16 v[140:143], a[24:27], v[108:111], v[140:143]
s_waitcnt lgkmcnt(0)
v_mfma_f32_16x16x32_bf16 v[132:135], a[28:31], v[120:123], v[132:135]
v_mfma_f32_16x16x32_bf16 v[140:143], a[28:31], v[124:127], v[140:143]
s_nop 7
s_nop 0
v_max3_f32 v14, v14, v128, v129
v_max3_f32 v14, v14, v130, v131
v_max3_f32 v14, v14, v132, v133
v_max3_f32 v14, v14, v134, v135
v_max3_f32 v15, v15, v136, v137
v_max3_f32 v15, v15, v138, v139
v_max3_f32 v15, v15, v140, v141
v_max3_f32 v15, v15, v142, v143
s_add_u32 s34, s34, 1
s_lshl_b32 s74, s34, 5
s_sub_u32 s74, s40, s74
v_sub_u32 v11, s74, v10
v_cmp_le_i32_e64 s[48:49], -16, v11
v_cmp_le_i32_e64 s[50:51], -15, v11
v_cmp_le_i32_e64 s[52:53], -14, v11
v_cmp_le_i32_e64 s[54:55], -13, v11
v_cmp_le_i32_e64 s[56:57], 0, v11
v_cmp_le_i32_e64 s[58:59], 1, v11
v_cmp_le_i32_e64 s[60:61], 2, v11
v_cmp_le_i32_e64 s[62:63], 3, v11
v_cmp_le_i32_e64 s[64:65], 16, v11
v_cmp_le_i32_e64 s[66:67], 17, v11
v_cmp_le_i32_e64 s[90:91], 18, v11
v_cmp_le_i32_e64 s[92:93], 19, v11
v_cndmask_b32_e64 v240, v16, 0, s[56:57]
v_cndmask_b32_e64 v241, v16, 0, s[58:59]
v_cndmask_b32_e64 v242, v16, 0, s[60:61]
v_cndmask_b32_e64 v243, v16, 0, s[62:63]
v_cndmask_b32_e64 v244, v16, 0, s[48:49]
v_cndmask_b32_e64 v245, v16, 0, s[50:51]
v_cndmask_b32_e64 v246, v16, 0, s[52:53]
v_cndmask_b32_e64 v247, v16, 0, s[54:55]
v_cndmask_b32_e64 v248, v16, 0, s[64:65]
v_cndmask_b32_e64 v249, v16, 0, s[66:67]
v_cndmask_b32_e64 v250, v16, 0, s[90:91]
v_cndmask_b32_e64 v251, v16, 0, s[92:93]
v_cndmask_b32_e64 v252, v16, 0, s[56:57]
v_cndmask_b32_e64 v253, v16, 0, s[58:59]
v_cndmask_b32_e64 v254, v16, 0, s[60:61]
v_cndmask_b32_e64 v255, v16, 0, s[62:63]
ds_read_b128 a[0:3], v8 offset:16384
ds_read_b128 a[4:7], v8 offset:17408
ds_read_b128 a[8:11], v8 offset:18432
ds_read_b128 a[12:15], v8 offset:19456
ds_read_b128 a[16:19], v8 offset:20480
ds_read_b128 a[20:23], v8 offset:21504
ds_read_b128 a[24:27], v8 offset:22528
ds_read_b128 a[28:31], v8 offset:23552
s_waitcnt lgkmcnt(7)
v_mfma_f32_16x16x32_bf16 v[128:131], a[0:3], v[64:67], v[240:243]
v_mfma_f32_16x16x32_bf16 v[136:139], a[0:3], v[68:71], v[244:247]
s_waitcnt lgkmcnt(6)
v_mfma_f32_16x16x32_bf16 v[128:131], a[4:7], v[80:83], v[128:131]
v_mfma_f32_16x16x32_bf16 v[136:139], a[4:7], v[84:87], v[136:139]
s_waitcnt lgkmcnt(5)
v_mfma_f32_16x16x32_bf16 v[128:131], a[8:11], v[96:99], v[128:131]
v_mfma_f32_16x16x32_bf16 v[136:139], a[8:11], v[100:103], v[136:139]
s_waitcnt lgkmcnt(4)
v_mfma_f32_16x16x32_bf16 v[128:131], a[12:15], v[112:115], v[128:131]
v_mfma_f32_16x16x32_bf16 v[136:139], a[12:15], v[116:119], v[136:139]
s_waitcnt lgkmcnt(3)
v_mfma_f32_16x16x32_bf16 v[132:135], a[16:19], v[64:67], v[248:251]
v_mfma_f32_16x16x32_bf16 v[140:143], a[16:19], v[68:71], v[252:255]
s_waitcnt lgkmcnt(2)
v_mfma_f32_16x16x32_bf16 v[132:135], a[20:23], v[80:83], v[132:135]
v_mfma_f32_16x16x32_bf16 v[140:143], a[20:23], v[84:87], v[140:143]
s_waitcnt lgkmcnt(1)
v_mfma_f32_16x16x32_bf16 v[132:135], a[24:27], v[96:99], v[132:135]
v_mfma_f32_16x16x32_bf16 v[140:143], a[24:27], v[100:103], v[140:143]
s_waitcnt lgkmcnt(0)
v_mfma_f32_16x16x32_bf16 v[132:135], a[28:31], v[112:115], v[132:135]
v_mfma_f32_16x16x32_bf16 v[140:143], a[28:31], v[116:119], v[140:143]
s_nop 7
s_nop 0
v_max3_f32 v12, v12, v128, v129
v_max3_f32 v12, v12, v130, v131
v_max3_f32 v12, v12, v132, v133
v_max3_f32 v12, v12, v134, v135
v_max3_f32 v13, v13, v136, v137
v_max3_f32 v13, v13, v138, v139
v_max3_f32 v13, v13, v140, v141
v_max3_f32 v13, v13, v142, v143
s_lshl_b32 s74, s34, 5
s_sub_u32 s74, s41, s74
v_sub_u32_e64 v11, s74, v10
v_cmp_le_i32_e64 s[48:49], -16, v11
v_cmp_le_i32_e64 s[50:51], -15, v11
v_cmp_le_i32_e64 s[52:53], -14, v11
v_cmp_le_i32_e64 s[54:55], -13, v11
v_cmp_le_i32_e64 s[56:57], 0, v11
v_cmp_le_i32_e64 s[58:59], 1, v11
v_cmp_le_i32_e64 s[60:61], 2, v11
v_cmp_le_i32_e64 s[62:63], 3, v11
v_cmp_le_i32_e64 s[64:65], 16, v11
v_cmp_le_i32_e64 s[66:67], 17, v11
v_cmp_le_i32_e64 s[90:91], 18, v11
v_cmp_le_i32_e64 s[92:93], 19, v11
v_cndmask_b32_e64 v240, v16, 0, s[56:57]
v_cndmask_b32_e64 v241, v16, 0, s[58:59]
v_cndmask_b32_e64 v242, v16, 0, s[60:61]
v_cndmask_b32_e64 v243, v16, 0, s[62:63]
v_cndmask_b32_e64 v244, v16, 0, s[48:49]
v_cndmask_b32_e64 v245, v16, 0, s[50:51]
v_cndmask_b32_e64 v246, v16, 0, s[52:53]
v_cndmask_b32_e64 v247, v16, 0, s[54:55]
v_cndmask_b32_e64 v248, v16, 0, s[64:65]
v_cndmask_b32_e64 v249, v16, 0, s[66:67]
v_cndmask_b32_e64 v250, v16, 0, s[90:91]
v_cndmask_b32_e64 v251, v16, 0, s[92:93]
v_cndmask_b32_e64 v252, v16, 0, s[56:57]
v_cndmask_b32_e64 v253, v16, 0, s[58:59]
v_cndmask_b32_e64 v254, v16, 0, s[60:61]
v_cndmask_b32_e64 v255, v16, 0, s[62:63]
ds_read_b128 a[0:3], v8 offset:16384
ds_read_b128 a[4:7], v8 offset:17408
ds_read_b128 a[8:11], v8 offset:18432
ds_read_b128 a[12:15], v8 offset:19456
ds_read_b128 a[16:19], v8 offset:20480
ds_read_b128 a[20:23], v8 offset:21504
ds_read_b128 a[24:27], v8 offset:22528
ds_read_b128 a[28:31], v8 offset:23552
s_waitcnt lgkmcnt(7)
v_mfma_f32_16x16x32_bf16 v[128:131], a[0:3], v[72:75], v[240:243]
v_mfma_f32_16x16x32_bf16 v[136:139], a[0:3], v[76:79], v[244:247]
s_waitcnt lgkmcnt(6)
v_mfma_f32_16x16x32_bf16 v[128:131], a[4:7], v[88:91], v[128:131]
v_mfma_f32_16x16x32_bf16 v[136:139], a[4:7], v[92:95], v[136:139]
s_waitcnt lgkmcnt(5)
v_mfma_f32_16x16x32_bf16 v[128:131], a[8:11], v[104:107], v[128:131]
v_mfma_f32_16x16x32_bf16 v[136:139], a[8:11], v[108:111], v[136:139]
s_waitcnt lgkmcnt(4)
v_mfma_f32_16x16x32_bf16 v[128:131], a[12:15], v[120:123], v[128:131]
v_mfma_f32_16x16x32_bf16 v[136:139], a[12:15], v[124:127], v[136:139]
s_waitcnt lgkmcnt(3)
v_mfma_f32_16x16x32_bf16 v[132:135], a[16:19], v[72:75], v[248:251]
v_mfma_f32_16x16x32_bf16 v[140:143], a[16:19], v[76:79], v[252:255]
s_waitcnt lgkmcnt(2)
v_mfma_f32_16x16x32_bf16 v[132:135], a[20:23], v[88:91], v[132:135]
v_mfma_f32_16x16x32_bf16 v[140:143], a[20:23], v[92:95], v[140:143]
s_waitcnt lgkmcnt(1)
v_mfma_f32_16x16x32_bf16 v[132:135], a[24:27], v[104:107], v[132:135]
v_mfma_f32_16x16x32_bf16 v[140:143], a[24:27], v[108:111], v[140:143]
s_waitcnt lgkmcnt(0)
v_mfma_f32_16x16x32_bf16 v[132:135], a[28:31], v[120:123], v[132:135]
v_mfma_f32_16x16x32_bf16 v[140:143], a[28:31], v[124:127], v[140:143]
s_nop 7
s_nop 0
v_max3_f32 v14, v14, v128, v129
v_max3_f32 v14, v14, v130, v131
v_max3_f32 v14, v14, v132, v133
v_max3_f32 v14, v14, v134, v135
v_max3_f32 v15, v15, v136, v137
v_max3_f32 v15, v15, v138, v139
v_max3_f32 v15, v15, v140, v141
v_max3_f32 v15, v15, v142, v143
s_add_u32 s34, s34, 1
s_sub_u32 s44, s44, 1
s_cmp_lg_u32 s44, 0
s_cbranch_scc1 L_mx
s_lshl_b32 s74, s3, 13
s_add_u32 s74, s74, 131072
v_add_u32 v21, s74, v31
ds_write_b128 v21, v[64:67] offset:0
ds_write_b128 v21, v[68:71] offset:1024
ds_write_b128 v21, v[80:83] offset:2048
ds_write_b128 v21, v[84:87] offset:3072
ds_write_b128 v21, v[96:99] offset:4096
ds_write_b128 v21, v[100:103] offset:5120
ds_write_b128 v21, v[112:115] offset:6144
ds_write_b128 v21, v[116:119] offset:7168
v_xor_b32 v21, 0x2000, v21
s_waitcnt lgkmcnt(0)
s_barrier
s_mul_i32 s32, s4, 0x110000
s_lshl_b32 s33, s3, 13
s_add_u32 s32, s32, s33
ds_read_b128 a[32:35], v21 offset:0
ds_read_b128 a[36:39], v21 offset:1024
ds_read_b128 a[40:43], v21 offset:2048
ds_read_b128 a[44:47], v21 offset:3072
ds_read_b128 a[48:51], v21 offset:4096
ds_read_b128 a[52:55], v21 offset:5120
ds_read_b128 a[56:59], v21 offset:6144
ds_read_b128 a[60:63], v21 offset:7168
s_waitcnt lgkmcnt(0)
s_mov_b32 m0, s33
s_nop 0
buffer_load_dwordx4 v31, s[28:31], s32 offen offset:0 sc1 lds
buffer_load_dwordx4 v31, s[28:31], s32 offen offset:1024 sc1 lds
buffer_load_dwordx4 v31, s[28:31], s32 offen offset:2048 sc1 lds
buffer_load_dwordx4 v31, s[28:31], s32 offen offset:3072 sc1 lds
s_add_u32 m0, s33, 4096
s_nop 0
s_add_u32 s32, s32, 4096
buffer_load_dwordx4 v31, s[28:31], s32 offen offset:0 sc1 lds
buffer_load_dwordx4 v31, s[28:31], s32 offen offset:1024 sc1 lds
buffer_load_dwordx4 v31, s[28:31], s32 offen offset:2048 sc1 lds
buffer_load_dwordx4 v31, s[28:31], s32 offen offset:3072 sc1 lds
s_add_u32 s32, s32, 28672
s_add_u32 s33, s33, 0x8000
s_and_b32 s33, s33, 0x1ffff
s_mov_b32 m0, s33
s_nop 0
buffer_load_dwordx4 v31, s[28:31], s32 offen offset:0 sc1 lds
buffer_load_dwordx4 v31, s[28:31], s32 offen offset:1024 sc1 lds
buffer_load_dwordx4 v31, s[28:31], s32 offen offset:2048 sc1 lds
buffer_load_dwordx4 v31, s[28:31], s32 offen offset:3072 sc1 lds
s_add_u32 m0, s33, 4096
s_nop 0
s_add_u32 s32, s32, 4096
buffer_load_dwordx4 v31, s[28:31], s32 offen offset:0 sc1 lds
buffer_load_dwordx4 v31, s[28:31], s32 offen offset:1024 sc1 lds
buffer_load_dwordx4 v31, s[28:31], s32 offen offset:2048 sc1 lds
buffer_load_dwordx4 v31, s[28:31], s32 offen offset:3072 sc1 lds
s_add_u32 s32, s32, 28672
s_add_u32 s33, s33, 0x8000
s_and_b32 s33, s33, 0x1ffff
v_mov_b32 v60, 0
v_mov_b32 v61, 0
v_mov_b32 v62, 0
v_mov_b32 v63, 0
s_nop 1
v_mfma_f32_32x32x16_bf16 a[128:143], v[60:63], v[60:63], 0
v_mfma_f32_32x32x16_bf16 a[144:159], v[60:63], v[60:63], 0
v_mfma_f32_32x32x16_bf16 a[160:175], v[60:63], v[60:63], 0
v_mfma_f32_32x32x16_bf16 a[176:191], v[60:63], v[60:63], 0
v_mfma_f32_32x32x16_bf16 a[192:207], v[60:63], v[60:63], 0
v_mfma_f32_32x32x16_bf16 a[208:223], v[60:63], v[60:63], 0
v_mfma_f32_32x32x16_bf16 a[224:239], v[60:63], v[60:63], 0
v_mfma_f32_32x32x16_bf16 a[240:255], v[60:63], v[60:63], 0
v_mfma_f32_32x32x16_bf16 a[96:111], v[60:63], v[60:63], 0
s_waitcnt vmcnt(0)
s_branch L_att
L_end:
s_endpgm
.section .rodata,"a"
.p2align 6
.amdhsa_kernel gated_mix__linear_kernel_hedgehog__compressed_kv_cla__prompt_kernel
  .amdhsa_next_free_vgpr 512
  .amdhsa_next_free_sgpr 102
  .amdhsa_accum_offset 256
  .amdhsa_group_segment_fixed_size 0
  .amdhsa_kernarg_size 112
  .amdhsa_user_sgpr_count 2
  .amdhsa_user_sgpr_kernarg_segment_ptr 1
  .amdhsa_system_sgpr_workgroup_id_x 1
.end_amdhsa_kernel
```
